```python
import torch

def _softmax(x, axis=-1):
    return torch.softmax(x, dim=axis)
def _gelu(x):
    return torch.nn.functional.gelu(x, approximate="tanh")
def _silu(x):
    return torch.nn.functional.silu(x)
def _sigmoid(x):
    return torch.sigmoid(x)
def _layernorm(x, axis=-1, eps=1e-5):
    m = x.mean(dim=axis, keepdim=True)
    v = x.var(dim=axis, keepdim=True, unbiased=False)
    return (x - m) / torch.sqrt(v + eps)
def _scatter_add(tgt, idx, src, axis=0):
    return tgt.clone().index_add_(axis, idx, src)
def _segment_sum(src, seg, n):
    out = torch.zeros((n,) + src.shape[1:], dtype=src.dtype)
    return out.index_add_(0, seg, src)
def _pad(x, pw):
    flat = tuple(v for pair in reversed(pw) for v in pair)
    return torch.nn.functional.pad(x, flat)

kernel_name = 'standalone__mha_softmax__near_ridge'

def setup_inputs():

    _w = (lambda a: (lambda t: t.to(torch.bfloat16) if t.is_floating_point() else t)(torch.as_tensor(a)))
    B, H, Sq, Sk, D = 16, 32, 848, 512, 128
    return {
        "q": _w((lambda *s: torch.randn(*s, dtype=torch.bfloat16) * 0.8)(B, H, Sq, D)),
        "k": _w((lambda *s: torch.randn(*s, dtype=torch.bfloat16) * 0.8)(B, H, Sk, D)),
        "v": _w((lambda *s: torch.randn(*s, dtype=torch.bfloat16) * 0.05)(B, H, Sk, D)),
    }

def reference(q, k, v):
    scale = q.shape[-1] ** -0.5
    scores = torch.einsum("bhqd,bhkd->bhqk", q, k) * scale
    p = _softmax(scores, axis=-1)
    return torch.einsum("bhqk,bhkd->bhqd", p, v)
```

```asm
; @launch grid=(256,1,1) block=(256,1,1) lds=161888
.amdgcn_target "amdgcn-amd-amdhsa--gfx950"
.text
.globl standalone__mha_softmax__near_ridge_kernel
.p2align 8
.type standalone__mha_softmax__near_ridge_kernel,@function
standalone__mha_softmax__near_ridge_kernel:
 s_cmp_ge_u32 s2, 256
 s_cbranch_scc1 L_end
 s_load_dwordx4 s[52:55], s[0:1], 0
 s_load_dwordx4 s[56:59], s[0:1], 16
 s_getpc_b64 s[78:79]
 L_pc:
 v_lshlrev_b32 v16, 7, v0
 v_add_u32 v10, 0, v16
 v_min_u32 v10, L_slow_blk-L_pc, v10
 v_mov_b32 v11, s79
 v_add_co_u32 v10, vcc, s78, v10
 s_nop 1
 v_addc_co_u32 v11, vcc, 0, v11, vcc
 global_load_dword v17, v[10:11], off
 v_add_u32 v12, 32768, v16
 v_min_u32 v12, L_slow_blk-L_pc, v12
 v_mov_b32 v13, s79
 v_add_co_u32 v12, vcc, s78, v12
 s_nop 1
 v_addc_co_u32 v13, vcc, 0, v13, vcc
 global_load_dword v18, v[12:13], off
 v_lshrrev_b32 v1, 6, v0
 v_and_b32 v0, 63, v0
 v_readfirstlane_b32 s100, v1
 s_and_b32 s26, s2, 7
 s_lshr_b32 s25, s2, 3
 s_mov_b32 s20, 0x3e0293ee
 s_mov_b32 s21, 0x3e0293ee
 s_mov_b32 s39, 0x57800000
 s_mov_b32 s45, 0
 s_mov_b32 s24, 0
 s_mul_i32 s22, s100, 4160
 s_mul_i32 s23, s100, 4104
 s_add_u32 s23, s23, 67584
 s_mul_i32 s46, s100, 20480
 s_mul_i32 s47, s100, 16384
 s_add_u32 s48, s47, 151552
 s_add_u32 s47, s47, 81920
 s_cmp_eq_u32 s100, 0
 s_cselect_b32 s48, 147456, s48
 s_cselect_b32 s49, 1, 0
 v_and_b32 v2, 15, v0
 v_lshrrev_b32 v3, 4, v0
 v_lshlrev_b32 v4, 8, v2
 v_lshl_add_u32 v251, v3, 4, v4
 s_mul_i32 s62, s100, 11264
 s_add_u32 s62, s62, 116832
 v_lshlrev_b32 v4, 4, v0
 v_add_u32 v252, s62, v4
 v_lshrrev_b32 v5, 3, v0
 v_and_b32 v6, 7, v0
 v_xor_b32 v6, v6, v5
 v_lshlrev_b32 v6, 4, v6
 v_lshl_add_u32 v255, v5, 8, v6
 v_and_b32 v6, 7, v0
 v_xor_b32 v6, v6, v3
 v_lshlrev_b32 v6, 4, v6
 v_lshl_add_u32 v6, v2, 7, v6
 v_add_u32 v253, s62, v6
 v_xor_b32 v6, 64, v6
 v_add_u32 v254, s62, v6
 v_xor_b32 v5, v3, v2
 v_lshlrev_b32 v5, 4, v5
 v_lshl_add_u32 v249, v3, 8, v5
 s_lshl_b32 s37, s100, 12
 v_lshlrev_b32 v5, 2, v3
 v_xor_b32 v5, v5, v2
 v_lshlrev_b32 v5, 4, v5
 v_lshl_add_u32 v5, v3, 8, v5
 v_lshl_add_u32 v250, v1, 12, v5
 s_waitcnt lgkmcnt(0)
 s_mov_b32 s4, s52
 s_mov_b32 s5, s53
 s_mov_b32 s6, 111149056
 s_mov_b32 s7, 0x20000
 s_add_u32 s8, s54, s37
 s_addc_u32 s9, s55, 0
 s_sub_u32 s10, 67108864, s37
 s_mov_b32 s11, 0x20000
 s_mov_b32 s12, s56
 s_mov_b32 s13, s57
 s_mov_b32 s14, 67108864
 s_mov_b32 s15, 0x20000
 s_mov_b32 s16, s58
 s_mov_b32 s17, s59
 s_mov_b32 s18, 111149056
 s_mov_b32 s19, 0x20000
 s_add_u32 s55, s24, 0
 s_lshl_b32 s52, s55, 5
 s_add_u32 s52, s52, s25
 s_mul_i32 s53, s52, 43691
 s_lshr_b32 s53, s53, 17
 s_mul_i32 s54, s53, 3
 s_sub_u32 s54, s52, s54
 s_lshl_b32 s53, s53, 3
 s_add_u32 s53, s53, s26
 s_lshl_b32 s28, s53, 17
 s_mul_i32 s53, s53, 217088
 s_cmp_eq_u32 s54, 0
 s_cselect_b32 s52, s46, s47
 s_cselect_b32 s31, 1, 0
 s_cmp_eq_u32 s54, 2
 s_cselect_b32 s52, s48, s52
 s_cselect_b32 s31, s49, s31
 s_add_u32 s30, s53, s52
 s_cmp_ge_u32 s55, 6
 s_cselect_b32 s28, 67108864, s28
 s_cselect_b32 s30, 117440512, s30
 s_mov_b32 s32, s30
 s_add_u32 s33, s30, 4096
 s_add_u32 s34, s30, 8192
 s_add_u32 s35, s30, 12288
 s_add_u32 s36, s30, 16384
 s_cmp_eq_u32 s31, 0
 s_cselect_b32 s36, 117440512, s36
 s_mov_b32 s27, s28
 s_mov_b32 s29, s30
    s_add_u32 s37, s27, 0
    s_add_u32 m0, s22, 1024
    s_nop 0
    buffer_load_dwordx4 v249, s[8:11], s37 offen offset:0 lds
    buffer_load_dwordx4 v249, s[8:11], s37 offen offset:1024 lds
    buffer_load_dwordx4 v249, s[8:11], s37 offen offset:2048 lds
    buffer_load_dwordx4 v249, s[8:11], s37 offen offset:3072 lds
    buffer_load_dwordx4 a[32:35], v251, s[4:7], s32 offen offset:0
    buffer_load_dwordx4 a[36:39], v251, s[4:7], s32 offen offset:64
    buffer_load_dwordx4 a[40:43], v251, s[4:7], s32 offen offset:128
    buffer_load_dwordx4 a[44:47], v251, s[4:7], s32 offen offset:192
    s_add_u32 s37, s27, 16384
    s_add_u32 m0, s22, 17664
    s_nop 0
    buffer_load_dwordx4 v249, s[8:11], s37 offen offset:0 lds
    buffer_load_dwordx4 v249, s[8:11], s37 offen offset:1024 lds
    buffer_load_dwordx4 v249, s[8:11], s37 offen offset:2048 lds
    buffer_load_dwordx4 v249, s[8:11], s37 offen offset:3072 lds
    s_add_u32 s38, s27, 0
    s_add_u32 m0, s23, 0
    s_nop 0
    buffer_load_dwordx4 v250, s[12:15], s38 offen offset:0 lds
    buffer_load_dwordx4 v250, s[12:15], s38 offen offset:1024 lds
    buffer_load_dwordx4 v250, s[12:15], s38 offen offset:2048 lds
    buffer_load_dwordx4 v250, s[12:15], s38 offen offset:3072 lds
    buffer_load_dwordx4 a[48:51], v251, s[4:7], s33 offen offset:0
    buffer_load_dwordx4 a[52:55], v251, s[4:7], s33 offen offset:64
    buffer_load_dwordx4 a[56:59], v251, s[4:7], s33 offen offset:128
    buffer_load_dwordx4 a[60:63], v251, s[4:7], s33 offen offset:192
 v_lshrrev_b32 v4, 2, v2
 v_and_b32 v5, 3, v2
 v_xor_b32 v7, v3, v5
 v_lshlrev_b32 v7, 4, v7
 v_lshl_add_u32 v7, v5, 8, v7
 v_mul_u32_u24 v6, 4160, v4
 v_add_u32 v244, v6, v7
 v_mul_u32_u24 v6, 4104, v3
 v_lshl_add_u32 v6, v4, 8, v6
 v_lshl_add_u32 v6, v5, 4, v6
 v_add_u32 v6, 67584, v6
 v_xor_b32 v7, 0, v4
 v_lshl_add_u32 v245, v7, 6, v6
 v_xor_b32 v7, 1, v4
 v_lshl_add_u32 v246, v7, 6, v6
 v_xor_b32 v7, 2, v4
 v_lshl_add_u32 v247, v7, 6, v6
 v_xor_b32 v7, 3, v4
 v_lshl_add_u32 v248, v7, 6, v6
 v_mov_b32 v7, 0x3f803f80
 v_cmp_eq_u32 vcc, 0, v5
 s_nop 1
 v_cndmask_b32 v7, 0, v7, vcc
 v_accvgpr_write_b32 a132, v7
 v_accvgpr_write_b32 a133, v7
 v_accvgpr_write_b32 a134, v7
 v_accvgpr_write_b32 a135, v7
 v_mov_b32 v7, 0
 ds_write_b32 v249, v7
 s_mov_b32 s59, 0xc3520000
 s_mov_b32 s2, 0
 s_mov_b32 s57, 0
 s_mov_b32 s50, 117440512
 s_mov_b32 s51, 117440512
 s_mov_b32 s60, 117440512
 s_mov_b32 s61, 117440512
 s_mov_b32 s3, 117440512
 s_waitcnt lgkmcnt(0)
 s_cmp_eq_u32 s31, 0
 s_cbranch_scc1 L_blk4f
.p2align 6
L_blk5f:
 s_waitcnt vmcnt(12)
 s_barrier
 ds_read_b128 a[136:139], v244 offset:1024
 s_waitcnt lgkmcnt(0)
 v_mfma_f32_16x16x32_bf16 v[208:211], a[136:139], a[32:35], 0
 s_add_u32 s55, s24, 1
 ds_read_b128 a[140:143], v244 offset:1088
 ds_read_b128 a[144:147], v244 offset:1152
 ds_read_b128 a[148:151], v244 offset:1216
 ds_read_b128 a[164:167], v244 offset:2240
 ds_read_b128 a[160:163], v244 offset:2176
 ds_read_b128 a[152:155], v244 offset:2048
 ds_read_b128 a[156:159], v244 offset:2112
 ds_read_b128 a[168:171], v244 offset:3072
 ds_read_b128 a[172:175], v244 offset:3136
 ds_read_b128 a[176:179], v244 offset:3200
 ds_read_b128 a[180:183], v244 offset:3264
 ds_read_b128 a[184:187], v244 offset:4096
 ds_read_b128 a[188:191], v244 offset:4160
 ds_read_b128 a[192:195], v244 offset:4224
 ds_read_b128 a[196:199], v244 offset:4288
 s_waitcnt lgkmcnt(14)
 v_mfma_f32_16x16x32_bf16 v[208:211], a[140:143], a[36:39], v[208:211]
 s_waitcnt lgkmcnt(13)
 v_mfma_f32_16x16x32_bf16 v[208:211], a[144:147], a[40:43], v[208:211]
 s_waitcnt lgkmcnt(12)
 buffer_load_dwordx4 a[64:67], v251, s[4:7], s34 offen offset:0
 v_mfma_f32_16x16x32_bf16 v[208:211], a[148:151], a[44:47], v[208:211]
 s_waitcnt lgkmcnt(11)
 buffer_load_dwordx4 a[68:71], v251, s[4:7], s34 offen offset:64
 s_nop 5
 v_max3_f32 v169, v208, v209, v210
 v_max_f32 v168, v169, v211
 v_max_f32 v169, v169, v211
 s_nop 1
 v_permlane32_swap_b32 v168, v169
 v_max_f32 v170, v168, v169
 v_max_f32 v171, v168, v169
 s_nop 1
 v_permlane16_swap_b32 v170, v171
 v_max_f32 v168, v170, v171
 v_sub_f32 v224, s59, v168
 v_sub_f32 v225, s59, v168
 v_sub_f32 v226, s59, v168
 v_sub_f32 v227, s59, v168
 s_nop 1
 v_mfma_f32_16x16x32_bf16 v[212:215], a[164:167], a[44:47], v[224:227]
 s_waitcnt lgkmcnt(10)
 buffer_load_dwordx4 a[72:75], v251, s[4:7], s34 offen offset:128
 v_pk_add_f32 v[208:209], v[208:209], v[224:225]
 v_pk_add_f32 v[210:211], v[210:211], v[226:227]
 v_pk_mul_f32 v[208:209], v[208:209], s[20:21]
 v_pk_mul_f32 v[210:211], v[210:211], s[20:21]
 v_exp_f32 v208, v208
 v_mfma_f32_16x16x32_bf16 v[212:215], a[160:163], a[40:43], v[212:215]
 s_waitcnt lgkmcnt(8)
 buffer_load_dwordx4 a[76:79], v251, s[4:7], s34 offen offset:192
 v_mfma_f32_16x16x32_bf16 v[212:215], a[156:159], a[36:39], v[212:215]
 s_lshl_b32 s52, s55, 5
 v_exp_f32 v209, v209
 v_mfma_f32_16x16x32_bf16 v[212:215], a[152:155], a[32:35], v[212:215]
 s_waitcnt vmcnt(8) lgkmcnt(0)
 v_exp_f32 v210, v210
 v_mfma_f32_16x16x32_bf16 v[216:219], a[168:171], a[32:35], v[224:227]
 s_barrier
 ds_read_b128 a[216:219], v244 offset:17664
 v_cvt_pk_bf16_f32 v128, v208, v209
 ds_read_b128 a[220:223], v244 offset:17728
 v_mfma_f32_16x16x32_bf16 v[216:219], a[172:175], a[36:39], v[216:219]
 s_add_u32 s52, s52, s25
 ds_read_b128 a[224:227], v244 offset:17792
 v_mul_f32 v212, s20, v212
 v_mfma_f32_16x16x32_bf16 v[216:219], a[176:179], a[40:43], v[216:219]
 s_mul_i32 s53, s52, 43691
 buffer_load_dwordx4 a[80:83], v251, s[4:7], s35 offen offset:0
 ds_read_b128 a[228:231], v244 offset:17856
 v_mfma_f32_16x16x32_bf16 v[216:219], a[180:183], a[44:47], v[216:219]
 s_lshr_b32 s53, s53, 17
 buffer_load_dwordx4 a[84:87], v251, s[4:7], s35 offen offset:64
 ds_read_b128 a[244:247], v244 offset:18880
 v_mfma_f32_16x16x32_bf16 v[220:223], a[196:199], a[44:47], v[224:227]
 s_mul_i32 s54, s53, 3
 buffer_load_dwordx4 a[88:91], v251, s[4:7], s35 offen offset:128
 ds_read_b128 a[240:243], v244 offset:18816
 v_mfma_f32_16x16x32_bf16 v[220:223], a[192:195], a[40:43], v[220:223]
 s_sub_u32 s54, s52, s54
 buffer_load_dwordx4 a[92:95], v251, s[4:7], s35 offen offset:192
 ds_read_b128 a[236:239], v244 offset:18752
 v_exp_f32 v211, v211
 v_pk_mul_f32 v[214:215], v[214:215], s[20:21]
 v_pk_mul_f32 v[216:217], v[216:217], s[20:21]
 v_pk_mul_f32 v[218:219], v[218:219], s[20:21]
 v_cvt_pk_bf16_f32 v129, v210, v211
 v_mfma_f32_16x16x32_bf16 v[220:223], a[188:191], a[36:39], v[220:223]
 s_lshl_b32 s53, s53, 3
 ds_read_b128 a[232:235], v244 offset:18688
 v_mul_f32 v213, s20, v213
 v_mfma_f32_16x16x32_bf16 v[220:223], a[184:187], a[32:35], v[220:223]
 s_waitcnt lgkmcnt(7)
 v_exp_f32 v212, v212
 v_mfma_f32_16x16x32_bf16 v[208:211], a[216:219], a[32:35], v[224:227]
 s_waitcnt lgkmcnt(6)
 ds_read_b128 a[216:219], v244 offset:19712
 ds_read_b64_tr_b16 a[200:201], v245 offset:0
 v_mfma_f32_16x16x32_bf16 v[208:211], a[220:223], a[36:39], v[208:211]
 s_waitcnt lgkmcnt(7)
 ds_read_b128 a[220:223], v244 offset:19776
 v_mul_f32 v220, s20, v220
 v_mfma_f32_16x16x32_bf16 v[208:211], a[224:227], a[40:43], v[208:211]
 s_waitcnt lgkmcnt(7)
 ds_read_b128 a[224:227], v244 offset:19840
 v_mul_f32 v221, s20, v221
 v_exp_f32 v213, v213
 v_exp_f32 v214, v214
 v_exp_f32 v215, v215
 v_mfma_f32_16x16x32_bf16 v[208:211], a[228:231], a[44:47], v[208:211]
 s_waitcnt lgkmcnt(7)
 ds_read_b128 a[228:231], v244 offset:19904
 v_cvt_pk_bf16_f32 v130, v212, v213
 v_cvt_pk_bf16_f32 v131, v214, v215
 v_mfma_f32_16x16x32_bf16 v[212:215], a[244:247], a[44:47], v[224:227]
 s_waitcnt lgkmcnt(7)
 v_exp_f32 v216, v216
 v_mfma_f32_16x16x32_bf16 v[212:215], a[240:243], a[40:43], v[212:215]
 s_waitcnt lgkmcnt(6)
 v_exp_f32 v217, v217
 v_exp_f32 v218, v218
 v_exp_f32 v219, v219
 v_pk_mul_f32 v[222:223], v[222:223], s[20:21]
 v_pk_mul_f32 v[208:209], v[208:209], s[20:21]
 v_pk_mul_f32 v[210:211], v[210:211], s[20:21]
 v_cvt_pk_bf16_f32 v132, v216, v217
 v_mfma_f32_16x16x32_bf16 v[212:215], a[236:239], a[36:39], v[212:215]
 s_waitcnt lgkmcnt(5)
 ds_read_b64_tr_b16 a[202:203], v245 offset:1024
 v_cvt_pk_bf16_f32 v133, v218, v219
 v_mfma_f32_16x16x32_bf16 v[212:215], a[232:235], a[32:35], v[212:215]
 s_waitcnt lgkmcnt(5)
 ds_read_b64_tr_b16 a[204:205], v245 offset:2048
 ds_read_b64_tr_b16 a[206:207], v245 offset:3072
 v_mfma_f32_16x16x32_bf16 v[216:219], a[216:219], a[32:35], v[224:227]
 s_waitcnt lgkmcnt(5)
 v_exp_f32 v220, v220
 v_mfma_f32_16x16x32_bf16 v[216:219], a[220:223], a[36:39], v[216:219]
 s_waitcnt lgkmcnt(4)
 v_exp_f32 v221, v221
 v_exp_f32 v222, v222
 v_exp_f32 v223, v223
 v_pk_mul_f32 v[212:213], v[212:213], s[20:21]
 v_pk_mul_f32 v[214:215], v[214:215], s[20:21]
 v_cvt_pk_bf16_f32 v134, v220, v221
 v_mfma_f32_16x16x32_bf16 v[216:219], a[224:227], a[40:43], v[216:219]
 s_waitcnt lgkmcnt(3)
 ds_read_b64_tr_b16 a[208:209], v245 offset:8
 v_cvt_pk_bf16_f32 v135, v222, v223
 v_mfma_f32_16x16x32_bf16 v[216:219], a[228:231], a[44:47], v[216:219]
 s_waitcnt vmcnt(8)
 v_exp_f32 v208, v208
 v_mfma_f32_16x16x32_bf16 v[220:223], a[136:139], a[48:51], 0
 s_add_u32 s53, s53, s26
 ds_read_b64_tr_b16 a[210:211], v245 offset:1032
 ds_read_b64_tr_b16 a[212:213], v245 offset:2056
 v_mfma_f32_16x16x32_bf16 v[220:223], a[140:143], a[52:55], v[220:223]
 s_cmp_eq_u32 s54, 0
 ds_read_b64_tr_b16 a[214:215], v245 offset:3080
 v_mul_f32 v216, s20, v216
 v_mfma_f32_16x16x32_bf16 v[220:223], a[144:147], a[56:59], v[220:223]
 s_cselect_b32 s52, s46, s47
 buffer_load_dwordx4 a[96:99], v251, s[4:7], s36 offen offset:0
 v_mfma_f32_16x16x32_bf16 v[220:223], a[148:151], a[60:63], v[220:223]
 s_waitcnt lgkmcnt(6)
 buffer_load_dwordx4 a[100:103], v251, s[4:7], s36 offen offset:64
 v_mfma_f32_16x16x32_bf16 v[0:3], a[200:203], v[128:131], 0
 s_waitcnt lgkmcnt(4)
 buffer_load_dwordx4 a[104:107], v251, s[4:7], s36 offen offset:128
 v_exp_f32 v209, v209
 v_exp_f32 v210, v210
 v_exp_f32 v211, v211
 v_max3_f32 v177, v220, v221, v222
 v_max_f32 v176, v177, v223
 v_max_f32 v177, v177, v223
 v_mfma_f32_16x16x32_bf16 v[0:3], a[204:207], v[132:135], v[0:3]
 s_cselect_b32 s31, 1, 0
 buffer_load_dwordx4 a[108:111], v251, s[4:7], s36 offen offset:192
 v_permlane32_swap_b32 v176, v177
 v_max_f32 v178, v176, v177
 v_max_f32 v179, v176, v177
 v_cvt_pk_bf16_f32 v168, v208, v209
 v_cvt_pk_bf16_f32 v169, v210, v211
 v_permlane16_swap_b32 v178, v179
 v_max_f32 v176, v178, v179
 v_sub_f32 v228, s59, v176
 v_sub_f32 v229, s59, v176
 v_sub_f32 v230, s59, v176
 v_sub_f32 v231, s59, v176
 v_pk_mul_f32 v[218:219], v[218:219], s[20:21]
 v_pk_add_f32 v[220:221], v[220:221], v[228:229]
 v_pk_add_f32 v[222:223], v[222:223], v[230:231]
 v_pk_mul_f32 v[220:221], v[220:221], s[20:21]
 v_pk_mul_f32 v[222:223], v[222:223], s[20:21]
 v_exp_f32 v212, v212
 v_mfma_f32_16x16x32_bf16 v[208:211], a[164:167], a[60:63], v[228:231]
 s_add_u32 s37, s27, 32768
 ds_read_b64_tr_b16 a[200:201], v246 offset:0
 v_mul_f32 v217, s20, v217
 v_mfma_f32_16x16x32_bf16 v[208:211], a[160:163], a[56:59], v[208:211]
 s_add_u32 m0, s22, 34304
 ds_read_b64_tr_b16 a[202:203], v246 offset:1024
 ds_read_b64_tr_b16 a[204:205], v246 offset:2048
 v_mfma_f32_16x16x32_bf16 v[208:211], a[156:159], a[52:55], v[208:211]
 s_lshl_b32 s28, s53, 17
 buffer_load_dwordx4 v249, s[8:11], s37 offen offset:0 lds
 ds_read_b64_tr_b16 a[206:207], v246 offset:3072
 v_mfma_f32_16x16x32_bf16 v[208:211], a[152:155], a[48:51], v[208:211]
 s_waitcnt lgkmcnt(6)
 buffer_load_dwordx4 v249, s[8:11], s37 offen offset:1024 lds
 v_mfma_f32_16x16x32_bf16 v[4:7], a[208:211], v[128:131], 0
 s_waitcnt lgkmcnt(4)
 v_exp_f32 v213, v213
 v_exp_f32 v214, v214
 v_exp_f32 v215, v215
 v_mfma_f32_16x16x32_bf16 v[4:7], a[212:215], v[132:135], v[4:7]
 s_cmp_eq_u32 s54, 2
 buffer_load_dwordx4 v249, s[8:11], s37 offen offset:2048 lds
 v_cvt_pk_bf16_f32 v170, v212, v213
 v_cvt_pk_bf16_f32 v171, v214, v215
 v_pk_mul_f32 v[208:209], v[208:209], s[20:21]
 v_pk_mul_f32 v[210:211], v[210:211], s[20:21]
 v_exp_f32 v216, v216
 v_mfma_f32_16x16x32_bf16 v[212:215], a[168:171], a[48:51], v[228:231]
 s_cselect_b32 s52, s48, s52
 buffer_load_dwordx4 v249, s[8:11], s37 offen offset:3072 lds
 v_mfma_f32_16x16x32_bf16 v[212:215], a[172:175], a[52:55], v[212:215]
 s_cselect_b32 s31, s49, s31
 ds_read_b64_tr_b16 a[208:209], v246 offset:8
 ds_read_b64_tr_b16 a[210:211], v246 offset:1032
 v_mfma_f32_16x16x32_bf16 v[212:215], a[176:179], a[56:59], v[212:215]
 s_mul_i32 s53, s53, 217088
 ds_read_b64_tr_b16 a[212:213], v246 offset:2056
 ds_read_b64_tr_b16 a[214:215], v246 offset:3080
 v_mfma_f32_16x16x32_bf16 v[212:215], a[180:183], a[60:63], v[212:215]
 s_waitcnt lgkmcnt(6)
 ds_read_b128 a[216:219], v244 offset:17664
 ds_read_b128 a[220:223], v244 offset:17728
 v_mfma_f32_16x16x32_bf16 v[8:11], a[200:203], v[128:131], 0
 s_waitcnt lgkmcnt(6)
 v_exp_f32 v217, v217
 v_exp_f32 v218, v218
 v_exp_f32 v219, v219
 v_pk_mul_f32 v[212:213], v[212:213], s[20:21]
 v_pk_mul_f32 v[214:215], v[214:215], s[20:21]
 v_cvt_pk_bf16_f32 v172, v216, v217
 v_mfma_f32_16x16x32_bf16 v[8:11], a[204:207], v[132:135], v[8:11]
 s_add_u32 s30, s53, s52
 ds_read_b128 a[224:227], v244 offset:17792
 v_cvt_pk_bf16_f32 v173, v218, v219
 v_mfma_f32_16x16x32_bf16 v[216:219], a[196:199], a[60:63], v[228:231]
 s_cmp_ge_u32 s55, 6
 ds_read_b128 a[228:231], v244 offset:17856
 ds_read_b64_tr_b16 a[200:201], v247 offset:0
 v_mfma_f32_16x16x32_bf16 v[216:219], a[192:195], a[56:59], v[216:219]
 s_cselect_b32 s30, 117440512, s30
 ds_read_b64_tr_b16 a[202:203], v247 offset:1024
 ds_read_b64_tr_b16 a[204:205], v247 offset:2048
 v_mfma_f32_16x16x32_bf16 v[216:219], a[188:191], a[52:55], v[216:219]
 s_cselect_b32 s28, 67108864, s28
 ds_read_b64_tr_b16 a[206:207], v247 offset:3072
 ds_read_b128 a[244:247], v244 offset:18880
 v_mfma_f32_16x16x32_bf16 v[216:219], a[184:187], a[48:51], v[216:219]
 s_waitcnt lgkmcnt(11)
 v_exp_f32 v220, v220
 v_mfma_f32_16x16x32_bf16 v[12:15], a[208:211], v[128:131], 0
 s_waitcnt lgkmcnt(9)
 v_exp_f32 v221, v221
 ds_read_b128 a[240:243], v244 offset:18816
 v_exp_f32 v222, v222
 v_exp_f32 v223, v223
 v_pk_mul_f32 v[216:217], v[216:217], s[20:21]
 v_pk_mul_f32 v[218:219], v[218:219], s[20:21]
 v_cvt_pk_bf16_f32 v136, v220, v221
 v_mfma_f32_16x16x32_bf16 v[12:15], a[212:215], v[132:135], v[12:15]
 s_waitcnt lgkmcnt(9)
 ds_read_b128 a[236:239], v244 offset:18752
 v_cvt_pk_bf16_f32 v137, v222, v223
 v_mfma_f32_16x16x32_bf16 v[220:223], a[216:219], a[48:51], v[228:231]
 s_waitcnt lgkmcnt(9)
 ds_read_b128 a[232:235], v244 offset:18688
 ds_read_b64_tr_b16 a[208:209], v247 offset:8
 v_mfma_f32_16x16x32_bf16 v[220:223], a[220:223], a[52:55], v[220:223]
 s_waitcnt lgkmcnt(10)
 ds_read_b64_tr_b16 a[210:211], v247 offset:1032
 ds_read_b64_tr_b16 a[212:213], v247 offset:2056
 v_mfma_f32_16x16x32_bf16 v[220:223], a[224:227], a[56:59], v[220:223]
 s_waitcnt lgkmcnt(11)
 ds_read_b64_tr_b16 a[214:215], v247 offset:3080
 ds_read_b128 a[216:219], v244 offset:19712
 v_mfma_f32_16x16x32_bf16 v[220:223], a[228:231], a[60:63], v[220:223]
 s_waitcnt lgkmcnt(11)
 v_exp_f32 v208, v208
 v_mfma_f32_16x16x32_bf16 v[16:19], a[200:203], v[128:131], 0
 s_waitcnt lgkmcnt(9)
 v_exp_f32 v209, v209
 v_exp_f32 v210, v210
 v_exp_f32 v211, v211
 ds_read_b128 a[220:223], v244 offset:19776
 v_pk_mul_f32 v[220:221], v[220:221], s[20:21]
 v_pk_mul_f32 v[222:223], v[222:223], s[20:21]
 v_cvt_pk_bf16_f32 v138, v208, v209
 v_mfma_f32_16x16x32_bf16 v[16:19], a[204:207], v[132:135], v[16:19]
 s_waitcnt lgkmcnt(9)
 ds_read_b128 a[224:227], v244 offset:19840
 v_cvt_pk_bf16_f32 v139, v210, v211
 v_mfma_f32_16x16x32_bf16 v[208:211], a[244:247], a[60:63], v[228:231]
 s_waitcnt lgkmcnt(9)
 ds_read_b128 a[228:231], v244 offset:19904
 ds_read_b64_tr_b16 a[204:205], v245 offset:2048
 v_mfma_f32_16x16x32_bf16 v[208:211], a[240:243], a[56:59], v[208:211]
 s_waitcnt lgkmcnt(10)
 v_exp_f32 v212, v212
 v_mfma_f32_16x16x32_bf16 v[208:211], a[236:239], a[52:55], v[208:211]
 s_waitcnt lgkmcnt(9)
 v_exp_f32 v213, v213
 v_mfma_f32_16x16x32_bf16 v[208:211], a[232:235], a[48:51], v[208:211]
 s_waitcnt lgkmcnt(7)
 v_exp_f32 v214, v214
 v_mfma_f32_16x16x32_bf16 v[20:23], a[208:211], v[128:131], 0
 s_waitcnt lgkmcnt(5)
 v_exp_f32 v215, v215
 v_mfma_f32_16x16x32_bf16 v[20:23], a[212:215], v[132:135], v[20:23]
 s_waitcnt lgkmcnt(4)
 ds_read_b64_tr_b16 a[206:207], v245 offset:3072
 v_cvt_pk_bf16_f32 v140, v212, v213
 v_cvt_pk_bf16_f32 v141, v214, v215
 v_exp_f32 v216, v216
 v_pk_mul_f32 v[208:209], v[208:209], s[20:21]
 v_pk_mul_f32 v[210:211], v[210:211], s[20:21]
 v_exp_f32 v217, v217
 v_mfma_f32_16x16x32_bf16 v[212:215], a[216:219], a[48:51], v[228:231]
 s_waitcnt lgkmcnt(4)
 ds_read_b64_tr_b16 a[200:201], v245 offset:0
 v_cvt_pk_bf16_f32 v142, v216, v217
 v_mfma_f32_16x16x32_bf16 v[212:215], a[220:223], a[52:55], v[212:215]
 s_waitcnt lgkmcnt(4)
 ds_read_b64_tr_b16 a[202:203], v245 offset:1024
 ds_read_b64_tr_b16 a[212:213], v245 offset:2056
 v_mfma_f32_16x16x32_bf16 v[212:215], a[224:227], a[56:59], v[212:215]
 s_waitcnt lgkmcnt(5)
 v_exp_f32 v218, v218
 v_mfma_f32_16x16x32_bf16 v[212:215], a[228:231], a[60:63], v[212:215]
 s_add_u32 s36, s30, 16384
 v_exp_f32 v219, v219
 v_mfma_f32_16x16x32_bf16 a[112:115], a[132:135], v[128:131], 0
 s_add_u32 s38, s27, 16384
 ds_read_b64_tr_b16 a[214:215], v245 offset:3080
 v_cvt_pk_bf16_f32 v143, v218, v219
 v_mfma_f32_16x16x32_bf16 a[112:115], a[132:135], v[132:135], a[112:115]
 s_waitcnt vmcnt(12)
 ds_read_b64_tr_b16 a[208:209], v245 offset:8
 v_mul_f32 v212, s20, v212
 v_mfma_f32_16x16x32_bf16 v[216:219], a[136:139], a[64:67], 0
 s_add_u32 m0, s23, 16416
 ds_read_b64_tr_b16 a[210:211], v245 offset:1032
 v_mul_f32 v213, s20, v213
 v_mfma_f32_16x16x32_bf16 v[216:219], a[140:143], a[68:71], v[216:219]
 s_cmp_eq_u32 s31, 0
 v_exp_f32 v220, v220
 v_mfma_f32_16x16x32_bf16 v[216:219], a[144:147], a[72:75], v[216:219]
 s_cselect_b32 s36, 117440512, s36
 buffer_load_dwordx4 v250, s[12:15], s38 offen offset:0 lds
 v_mfma_f32_16x16x32_bf16 v[216:219], a[148:151], a[76:79], v[216:219]
 s_waitcnt lgkmcnt(6)
 buffer_load_dwordx4 v250, s[12:15], s38 offen offset:1024 lds
 v_mfma_f32_16x16x32_bf16 v[32:35], a[204:207], v[140:143], 0
 s_waitcnt lgkmcnt(4)
 buffer_load_dwordx4 v250, s[12:15], s38 offen offset:2048 lds
 v_exp_f32 v221, v221
 v_exp_f32 v222, v222
 v_exp_f32 v223, v223
 v_max3_f32 v185, v216, v217, v218
 v_max_f32 v184, v185, v219
 v_max_f32 v185, v185, v219
 v_mfma_f32_16x16x32_bf16 v[32:35], a[200:203], v[136:139], v[32:35]
 s_add_u32 s37, s27, 49152
 buffer_load_dwordx4 v250, s[12:15], s38 offen offset:3072 lds
 v_permlane32_swap_b32 v184, v185
 v_max_f32 v186, v184, v185
 v_max_f32 v187, v184, v185
 v_cvt_pk_bf16_f32 v176, v220, v221
 v_cvt_pk_bf16_f32 v177, v222, v223
 v_permlane16_swap_b32 v186, v187
 v_max_f32 v184, v186, v187
 v_sub_f32 v232, s59, v184
 v_sub_f32 v233, s59, v184
 v_sub_f32 v234, s59, v184
 v_sub_f32 v235, s59, v184
 v_pk_mul_f32 v[214:215], v[214:215], s[20:21]
 v_pk_add_f32 v[216:217], v[216:217], v[232:233]
 v_pk_add_f32 v[218:219], v[218:219], v[234:235]
 v_pk_mul_f32 v[216:217], v[216:217], s[20:21]
 v_pk_mul_f32 v[218:219], v[218:219], s[20:21]
 v_exp_f32 v208, v208
 v_mfma_f32_16x16x32_bf16 v[220:223], a[164:167], a[76:79], v[232:235]
 s_add_u32 m0, s22, 50944
 ds_read_b64_tr_b16 a[204:205], v246 offset:2048
 ds_read_b64_tr_b16 a[206:207], v246 offset:3072
 v_mfma_f32_16x16x32_bf16 v[220:223], a[160:163], a[72:75], v[220:223]
 s_mov_b32 s32, s30
 ds_read_b64_tr_b16 a[200:201], v246 offset:0
 ds_read_b64_tr_b16 a[202:203], v246 offset:1024
 v_mfma_f32_16x16x32_bf16 v[220:223], a[156:159], a[68:71], v[220:223]
 s_add_u32 s33, s30, 4096
 buffer_load_dwordx4 v249, s[8:11], s37 offen offset:0 lds
 v_mfma_f32_16x16x32_bf16 v[220:223], a[152:155], a[64:67], v[220:223]
 s_waitcnt lgkmcnt(6)
 buffer_load_dwordx4 v249, s[8:11], s37 offen offset:1024 lds
 v_mfma_f32_16x16x32_bf16 v[36:39], a[212:215], v[140:143], 0
 s_waitcnt lgkmcnt(4)
 v_exp_f32 v209, v209
 v_exp_f32 v210, v210
 v_exp_f32 v211, v211
 v_mfma_f32_16x16x32_bf16 v[36:39], a[208:211], v[136:139], v[36:39]
 s_add_u32 s34, s30, 8192
 buffer_load_dwordx4 v249, s[8:11], s37 offen offset:2048 lds
 v_cvt_pk_bf16_f32 v178, v208, v209
 v_cvt_pk_bf16_f32 v179, v210, v211
 v_pk_mul_f32 v[220:221], v[220:221], s[20:21]
 v_pk_mul_f32 v[222:223], v[222:223], s[20:21]
 v_exp_f32 v212, v212
 v_mfma_f32_16x16x32_bf16 v[208:211], a[168:171], a[64:67], v[232:235]
 s_add_u32 s35, s30, 12288
 buffer_load_dwordx4 v249, s[8:11], s37 offen offset:3072 lds
 v_mfma_f32_16x16x32_bf16 v[208:211], a[172:175], a[68:71], v[208:211]
 s_add_u32 s40, s29, 0
 ds_read_b64_tr_b16 a[212:213], v246 offset:2056
 ds_read_b64_tr_b16 a[214:215], v246 offset:3080
 v_mfma_f32_16x16x32_bf16 v[208:211], a[176:179], a[72:75], v[208:211]
 s_add_u32 s41, s29, 4096
 ds_read_b64_tr_b16 a[208:209], v246 offset:8
 ds_read_b64_tr_b16 a[210:211], v246 offset:1032
 v_mfma_f32_16x16x32_bf16 v[208:211], a[180:183], a[76:79], v[208:211]
 s_waitcnt lgkmcnt(6)
 ds_read_b128 a[216:219], v244 offset:17664
 ds_read_b128 a[220:223], v244 offset:17728
 v_mfma_f32_16x16x32_bf16 v[40:43], a[204:207], v[140:143], 0
 s_waitcnt lgkmcnt(6)
 v_exp_f32 v213, v213
 v_exp_f32 v214, v214
 v_exp_f32 v215, v215
 v_pk_mul_f32 v[208:209], v[208:209], s[20:21]
 v_pk_mul_f32 v[210:211], v[210:211], s[20:21]
 v_cvt_pk_bf16_f32 v180, v212, v213
 v_mfma_f32_16x16x32_bf16 v[40:43], a[200:203], v[136:139], v[40:43]
 s_add_u32 s42, s29, 8192
 ds_read_b128 a[224:227], v244 offset:17792
 v_cvt_pk_bf16_f32 v181, v214, v215
 v_mfma_f32_16x16x32_bf16 v[212:215], a[196:199], a[76:79], v[232:235]
 s_add_u32 s43, s29, 12288
 ds_read_b128 a[228:231], v244 offset:17856
 ds_read_b64_tr_b16 a[204:205], v247 offset:2048
 v_mfma_f32_16x16x32_bf16 v[212:215], a[192:195], a[72:75], v[212:215]
 s_add_u32 s44, s29, 16384
 ds_read_b64_tr_b16 a[206:207], v247 offset:3072
 ds_read_b64_tr_b16 a[200:201], v247 offset:0
 v_mfma_f32_16x16x32_bf16 v[212:215], a[188:191], a[68:71], v[212:215]
 s_lshl_b32 s63, 1, s24
 ds_read_b64_tr_b16 a[202:203], v247 offset:1024
 ds_read_b128 a[244:247], v244 offset:18880
 v_mfma_f32_16x16x32_bf16 v[212:215], a[184:187], a[64:67], v[212:215]
 s_waitcnt lgkmcnt(11)
 v_exp_f32 v216, v216
 v_mfma_f32_16x16x32_bf16 v[44:47], a[212:215], v[140:143], 0
 s_waitcnt lgkmcnt(9)
 v_exp_f32 v217, v217
 ds_read_b128 a[240:243], v244 offset:18816
 v_exp_f32 v218, v218
 v_exp_f32 v219, v219
 v_pk_mul_f32 v[212:213], v[212:213], s[20:21]
 v_pk_mul_f32 v[214:215], v[214:215], s[20:21]
 v_cvt_pk_bf16_f32 v144, v216, v217
 v_mfma_f32_16x16x32_bf16 v[44:47], a[208:211], v[136:139], v[44:47]
 s_waitcnt lgkmcnt(9)
 ds_read_b128 a[236:239], v244 offset:18752
 v_cvt_pk_bf16_f32 v145, v218, v219
 v_mfma_f32_16x16x32_bf16 v[216:219], a[216:219], a[64:67], v[232:235]
 s_waitcnt lgkmcnt(9)
 ds_read_b128 a[232:235], v244 offset:18688
 ds_read_b64_tr_b16 a[212:213], v247 offset:2056
 v_mfma_f32_16x16x32_bf16 v[216:219], a[220:223], a[68:71], v[216:219]
 s_waitcnt lgkmcnt(10)
 ds_read_b64_tr_b16 a[214:215], v247 offset:3080
 ds_read_b64_tr_b16 a[208:209], v247 offset:8
 v_mfma_f32_16x16x32_bf16 v[216:219], a[224:227], a[72:75], v[216:219]
 s_waitcnt lgkmcnt(11)
 ds_read_b64_tr_b16 a[210:211], v247 offset:1032
 ds_read_b128 a[216:219], v244 offset:19712
 v_mfma_f32_16x16x32_bf16 v[216:219], a[228:231], a[76:79], v[216:219]
 s_waitcnt lgkmcnt(11)
 v_exp_f32 v220, v220
 v_mfma_f32_16x16x32_bf16 v[48:51], a[204:207], v[140:143], 0
 s_waitcnt lgkmcnt(9)
 v_exp_f32 v221, v221
 v_exp_f32 v222, v222
 v_exp_f32 v223, v223
 ds_read_b128 a[220:223], v244 offset:19776
 v_pk_mul_f32 v[216:217], v[216:217], s[20:21]
 v_pk_mul_f32 v[218:219], v[218:219], s[20:21]
 v_cvt_pk_bf16_f32 v146, v220, v221
 v_mfma_f32_16x16x32_bf16 v[48:51], a[200:203], v[136:139], v[48:51]
 s_waitcnt lgkmcnt(9)
 ds_read_b128 a[224:227], v244 offset:19840
 v_cvt_pk_bf16_f32 v147, v222, v223
 v_mfma_f32_16x16x32_bf16 v[220:223], a[244:247], a[76:79], v[232:235]
 s_waitcnt lgkmcnt(9)
 ds_read_b128 a[228:231], v244 offset:19904
 ds_read_b64_tr_b16 a[200:201], v245 offset:0
 v_mfma_f32_16x16x32_bf16 v[220:223], a[240:243], a[72:75], v[220:223]
 s_waitcnt lgkmcnt(10)
 v_exp_f32 v208, v208
 v_mfma_f32_16x16x32_bf16 v[220:223], a[236:239], a[68:71], v[220:223]
 s_waitcnt lgkmcnt(9)
 v_exp_f32 v209, v209
 v_mfma_f32_16x16x32_bf16 v[220:223], a[232:235], a[64:67], v[220:223]
 s_waitcnt lgkmcnt(7)
 v_exp_f32 v210, v210
 v_mfma_f32_16x16x32_bf16 v[52:55], a[212:215], v[140:143], 0
 s_waitcnt lgkmcnt(5)
 v_exp_f32 v211, v211
 v_mfma_f32_16x16x32_bf16 v[52:55], a[208:211], v[136:139], v[52:55]
 s_waitcnt lgkmcnt(4)
 ds_read_b64_tr_b16 a[202:203], v245 offset:1024
 v_cvt_pk_bf16_f32 v148, v208, v209
 v_cvt_pk_bf16_f32 v149, v210, v211
 v_exp_f32 v212, v212
 v_pk_mul_f32 v[220:221], v[220:221], s[20:21]
 v_pk_mul_f32 v[222:223], v[222:223], s[20:21]
 v_exp_f32 v213, v213
 v_mfma_f32_16x16x32_bf16 v[208:211], a[216:219], a[64:67], v[232:235]
 s_waitcnt lgkmcnt(4)
 ds_read_b64_tr_b16 a[204:205], v245 offset:2048
 v_cvt_pk_bf16_f32 v150, v212, v213
 v_mfma_f32_16x16x32_bf16 v[208:211], a[220:223], a[68:71], v[208:211]
 s_waitcnt lgkmcnt(4)
 ds_read_b64_tr_b16 a[206:207], v245 offset:3072
 ds_read_b64_tr_b16 a[208:209], v245 offset:8
 v_mfma_f32_16x16x32_bf16 v[208:211], a[224:227], a[72:75], v[208:211]
 s_waitcnt lgkmcnt(5)
 v_exp_f32 v214, v214
 v_mfma_f32_16x16x32_bf16 v[208:211], a[228:231], a[76:79], v[208:211]
 s_mov_b32 s29, s30
 v_exp_f32 v215, v215
 v_mfma_f32_16x16x32_bf16 a[116:119], a[132:135], v[136:139], 0
 s_add_u32 s38, s27, 32768
 ds_read_b64_tr_b16 a[210:211], v245 offset:1032
 v_cvt_pk_bf16_f32 v151, v214, v215
 v_mfma_f32_16x16x32_bf16 a[116:119], a[132:135], v[140:143], a[116:119]
 s_waitcnt vmcnt(16)
 ds_read_b64_tr_b16 a[212:213], v245 offset:2056
 v_mul_f32 v208, s20, v208
 v_mfma_f32_16x16x32_bf16 v[212:215], a[136:139], a[80:83], 0
 s_add_u32 m0, s23, 32832
 ds_read_b64_tr_b16 a[214:215], v245 offset:3080
 v_mul_f32 v209, s20, v209
 v_mfma_f32_16x16x32_bf16 v[212:215], a[140:143], a[84:87], v[212:215]
 v_exp_f32 v216, v216
 v_mfma_f32_16x16x32_bf16 v[212:215], a[144:147], a[88:91], v[212:215]
 buffer_load_dwordx4 v250, s[12:15], s38 offen offset:0 lds
 v_mfma_f32_16x16x32_bf16 v[212:215], a[148:151], a[92:95], v[212:215]
 s_waitcnt lgkmcnt(6)
 buffer_load_dwordx4 v250, s[12:15], s38 offen offset:1024 lds
 v_mfma_f32_16x16x32_bf16 v[64:67], a[200:203], v[144:147], 0
 s_waitcnt lgkmcnt(4)
 buffer_load_dwordx4 v250, s[12:15], s38 offen offset:2048 lds
 v_exp_f32 v217, v217
 v_exp_f32 v218, v218
 v_exp_f32 v219, v219
 v_max3_f32 v193, v212, v213, v214
 v_max_f32 v192, v193, v215
 v_max_f32 v193, v193, v215
 v_mfma_f32_16x16x32_bf16 v[64:67], a[204:207], v[148:151], v[64:67]
 s_add_u32 s37, s27, 65536
 buffer_load_dwordx4 v250, s[12:15], s38 offen offset:3072 lds
 v_permlane32_swap_b32 v192, v193
 v_max_f32 v194, v192, v193
 v_max_f32 v195, v192, v193
 v_cvt_pk_bf16_f32 v184, v216, v217
 v_cvt_pk_bf16_f32 v185, v218, v219
 v_permlane16_swap_b32 v194, v195
 v_max_f32 v192, v194, v195
 v_sub_f32 v236, s59, v192
 v_sub_f32 v237, s59, v192
 v_sub_f32 v238, s59, v192
 v_sub_f32 v239, s59, v192
 v_pk_mul_f32 v[210:211], v[210:211], s[20:21]
 v_pk_add_f32 v[212:213], v[212:213], v[236:237]
 v_pk_add_f32 v[214:215], v[214:215], v[238:239]
 v_pk_mul_f32 v[212:213], v[212:213], s[20:21]
 v_pk_mul_f32 v[214:215], v[214:215], s[20:21]
 v_exp_f32 v220, v220
 v_mfma_f32_16x16x32_bf16 v[216:219], a[164:167], a[92:95], v[236:239]
 s_add_u32 m0, s22, 1024
 ds_read_b64_tr_b16 a[200:201], v246 offset:0
 ds_read_b64_tr_b16 a[202:203], v246 offset:1024
 v_mfma_f32_16x16x32_bf16 v[216:219], a[160:163], a[88:91], v[216:219]
 ds_read_b64_tr_b16 a[204:205], v246 offset:2048
 ds_read_b64_tr_b16 a[206:207], v246 offset:3072
 v_mfma_f32_16x16x32_bf16 v[216:219], a[156:159], a[84:87], v[216:219]
 buffer_load_dwordx4 v249, s[8:11], s37 offen offset:0 lds
 v_mfma_f32_16x16x32_bf16 v[216:219], a[152:155], a[80:83], v[216:219]
 s_waitcnt lgkmcnt(6)
 buffer_load_dwordx4 v249, s[8:11], s37 offen offset:1024 lds
 v_mfma_f32_16x16x32_bf16 v[68:71], a[208:211], v[144:147], 0
 s_waitcnt lgkmcnt(4)
 v_exp_f32 v221, v221
 v_exp_f32 v222, v222
 v_exp_f32 v223, v223
 v_mfma_f32_16x16x32_bf16 v[68:71], a[212:215], v[148:151], v[68:71]
 buffer_load_dwordx4 v249, s[8:11], s37 offen offset:2048 lds
 v_cvt_pk_bf16_f32 v186, v220, v221
 v_cvt_pk_bf16_f32 v187, v222, v223
 v_pk_mul_f32 v[216:217], v[216:217], s[20:21]
 v_pk_mul_f32 v[218:219], v[218:219], s[20:21]
 v_exp_f32 v208, v208
 v_mfma_f32_16x16x32_bf16 v[220:223], a[168:171], a[80:83], v[236:239]
 buffer_load_dwordx4 v249, s[8:11], s37 offen offset:3072 lds
 v_mfma_f32_16x16x32_bf16 v[220:223], a[172:175], a[84:87], v[220:223]
 ds_read_b64_tr_b16 a[208:209], v246 offset:8
 ds_read_b64_tr_b16 a[210:211], v246 offset:1032
 v_mfma_f32_16x16x32_bf16 v[220:223], a[176:179], a[88:91], v[220:223]
 ds_read_b64_tr_b16 a[212:213], v246 offset:2056
 ds_read_b64_tr_b16 a[214:215], v246 offset:3080
 v_mfma_f32_16x16x32_bf16 v[220:223], a[180:183], a[92:95], v[220:223]
 s_waitcnt lgkmcnt(6)
 ds_read_b128 a[216:219], v244 offset:17664
 ds_read_b128 a[220:223], v244 offset:17728
 v_mfma_f32_16x16x32_bf16 v[72:75], a[200:203], v[144:147], 0
 s_waitcnt lgkmcnt(6)
 v_exp_f32 v209, v209
 v_exp_f32 v210, v210
 v_exp_f32 v211, v211
 v_pk_mul_f32 v[220:221], v[220:221], s[20:21]
 v_pk_mul_f32 v[222:223], v[222:223], s[20:21]
 v_cvt_pk_bf16_f32 v188, v208, v209
 v_mfma_f32_16x16x32_bf16 v[72:75], a[204:207], v[148:151], v[72:75]
 ds_read_b128 a[224:227], v244 offset:17792
 v_cvt_pk_bf16_f32 v189, v210, v211
 v_mfma_f32_16x16x32_bf16 v[208:211], a[196:199], a[92:95], v[236:239]
 ds_read_b128 a[228:231], v244 offset:17856
 ds_read_b64_tr_b16 a[200:201], v247 offset:0
 v_mfma_f32_16x16x32_bf16 v[208:211], a[192:195], a[88:91], v[208:211]
 ds_read_b64_tr_b16 a[202:203], v247 offset:1024
 ds_read_b64_tr_b16 a[204:205], v247 offset:2048
 v_mfma_f32_16x16x32_bf16 v[208:211], a[188:191], a[84:87], v[208:211]
 ds_read_b64_tr_b16 a[206:207], v247 offset:3072
 ds_read_b128 a[244:247], v244 offset:18880
 v_mfma_f32_16x16x32_bf16 v[208:211], a[184:187], a[80:83], v[208:211]
 s_waitcnt lgkmcnt(11)
 v_exp_f32 v212, v212
 v_mfma_f32_16x16x32_bf16 v[76:79], a[208:211], v[144:147], 0
 s_waitcnt lgkmcnt(9)
 v_exp_f32 v213, v213
 ds_read_b128 a[240:243], v244 offset:18816
 v_exp_f32 v214, v214
 v_exp_f32 v215, v215
 v_pk_mul_f32 v[208:209], v[208:209], s[20:21]
 v_pk_mul_f32 v[210:211], v[210:211], s[20:21]
 v_cvt_pk_bf16_f32 v152, v212, v213
 v_mfma_f32_16x16x32_bf16 v[76:79], a[212:215], v[148:151], v[76:79]
 s_waitcnt lgkmcnt(9)
 ds_read_b128 a[236:239], v244 offset:18752
 v_cvt_pk_bf16_f32 v153, v214, v215
 v_mfma_f32_16x16x32_bf16 v[212:215], a[216:219], a[80:83], v[236:239]
 s_waitcnt lgkmcnt(9)
 ds_read_b128 a[232:235], v244 offset:18688
 ds_read_b64_tr_b16 a[208:209], v247 offset:8
 v_mfma_f32_16x16x32_bf16 v[212:215], a[220:223], a[84:87], v[212:215]
 s_waitcnt lgkmcnt(10)
 ds_read_b64_tr_b16 a[210:211], v247 offset:1032
 ds_read_b64_tr_b16 a[212:213], v247 offset:2056
 v_mfma_f32_16x16x32_bf16 v[212:215], a[224:227], a[88:91], v[212:215]
 s_waitcnt lgkmcnt(11)
 ds_read_b64_tr_b16 a[214:215], v247 offset:3080
 ds_read_b128 a[216:219], v244 offset:19712
 v_mfma_f32_16x16x32_bf16 v[212:215], a[228:231], a[92:95], v[212:215]
 s_waitcnt lgkmcnt(11)
 v_exp_f32 v216, v216
 v_mfma_f32_16x16x32_bf16 v[80:83], a[200:203], v[144:147], 0
 s_waitcnt lgkmcnt(9)
 v_exp_f32 v217, v217
 v_exp_f32 v218, v218
 v_exp_f32 v219, v219
 ds_read_b128 a[220:223], v244 offset:19776
 v_pk_mul_f32 v[212:213], v[212:213], s[20:21]
 v_pk_mul_f32 v[214:215], v[214:215], s[20:21]
 v_cvt_pk_bf16_f32 v154, v216, v217
 v_mfma_f32_16x16x32_bf16 v[80:83], a[204:207], v[148:151], v[80:83]
 s_waitcnt lgkmcnt(9)
 ds_read_b128 a[224:227], v244 offset:19840
 v_cvt_pk_bf16_f32 v155, v218, v219
 v_mfma_f32_16x16x32_bf16 v[216:219], a[244:247], a[92:95], v[236:239]
 s_waitcnt lgkmcnt(9)
 ds_read_b128 a[228:231], v244 offset:19904
 ds_read_b64_tr_b16 a[204:205], v245 offset:2048
 v_mfma_f32_16x16x32_bf16 v[216:219], a[240:243], a[88:91], v[216:219]
 s_waitcnt lgkmcnt(10)
 v_exp_f32 v220, v220
 v_mfma_f32_16x16x32_bf16 v[216:219], a[236:239], a[84:87], v[216:219]
 s_waitcnt lgkmcnt(9)
 v_exp_f32 v221, v221
 v_mfma_f32_16x16x32_bf16 v[216:219], a[232:235], a[80:83], v[216:219]
 s_waitcnt lgkmcnt(7)
 v_exp_f32 v222, v222
 v_mfma_f32_16x16x32_bf16 v[84:87], a[208:211], v[144:147], 0
 s_waitcnt lgkmcnt(5)
 v_exp_f32 v223, v223
 v_mfma_f32_16x16x32_bf16 v[84:87], a[212:215], v[148:151], v[84:87]
 s_waitcnt lgkmcnt(4)
 ds_read_b64_tr_b16 a[206:207], v245 offset:3072
 v_cvt_pk_bf16_f32 v156, v220, v221
 v_cvt_pk_bf16_f32 v157, v222, v223
 v_exp_f32 v208, v208
 v_pk_mul_f32 v[216:217], v[216:217], s[20:21]
 v_pk_mul_f32 v[218:219], v[218:219], s[20:21]
 v_exp_f32 v209, v209
 v_mfma_f32_16x16x32_bf16 v[220:223], a[216:219], a[80:83], v[236:239]
 s_waitcnt lgkmcnt(4)
 ds_read_b64_tr_b16 a[200:201], v245 offset:0
 v_cvt_pk_bf16_f32 v158, v208, v209
 v_mfma_f32_16x16x32_bf16 v[220:223], a[220:223], a[84:87], v[220:223]
 s_waitcnt lgkmcnt(4)
 ds_read_b64_tr_b16 a[202:203], v245 offset:1024
 ds_read_b64_tr_b16 a[212:213], v245 offset:2056
 v_mfma_f32_16x16x32_bf16 v[220:223], a[224:227], a[88:91], v[220:223]
 s_waitcnt lgkmcnt(5)
 v_exp_f32 v210, v210
 v_mfma_f32_16x16x32_bf16 v[220:223], a[228:231], a[92:95], v[220:223]
 v_exp_f32 v211, v211
 v_mfma_f32_16x16x32_bf16 a[120:123], a[132:135], v[144:147], 0
 ds_read_b64_tr_b16 a[214:215], v245 offset:3080
 v_cvt_pk_bf16_f32 v159, v210, v211
 v_mfma_f32_16x16x32_bf16 a[120:123], a[132:135], v[148:151], a[120:123]
 s_waitcnt vmcnt(20)
 v_exp_f32 v212, v212
 v_mfma_f32_16x16x32_bf16 v[208:211], a[136:139], a[96:99], 0
 ds_read_b64_tr_b16 a[208:209], v245 offset:8
 v_mul_f32 v220, s20, v220
 v_mfma_f32_16x16x32_bf16 v[208:211], a[140:143], a[100:103], v[208:211]
 ds_read_b64_tr_b16 a[210:211], v245 offset:1032
 v_mul_f32 v221, s20, v221
 v_mfma_f32_16x16x32_bf16 v[208:211], a[144:147], a[104:107], v[208:211]
 v_exp_f32 v213, v213
 v_mfma_f32_16x16x32_bf16 v[208:211], a[148:151], a[108:111], v[208:211]
 s_waitcnt lgkmcnt(6)
 v_exp_f32 v214, v214
 v_mfma_f32_16x16x32_bf16 v[96:99], a[204:207], v[156:159], 0
 s_waitcnt lgkmcnt(4)
 v_exp_f32 v215, v215
 v_mfma_f32_16x16x32_bf16 v[96:99], a[200:203], v[152:155], v[96:99]
 ds_read_b64_tr_b16 a[204:205], v246 offset:2048
 v_cvt_pk_bf16_f32 v192, v212, v213
 v_max3_f32 v201, v208, v209, v210
 v_max_f32 v200, v201, v211
 v_max_f32 v201, v201, v211
 v_cvt_pk_bf16_f32 v193, v214, v215
 s_nop 0
 v_permlane32_swap_b32 v200, v201
 v_max_f32 v202, v200, v201
 v_max_f32 v203, v200, v201
 s_nop 1
 v_permlane16_swap_b32 v202, v203
 v_max_f32 v200, v202, v203
 v_sub_f32 v240, s59, v200
 v_sub_f32 v241, s59, v200
 v_sub_f32 v242, s59, v200
 v_sub_f32 v243, s59, v200
 s_nop 1
 v_mfma_f32_16x16x32_bf16 v[212:215], a[164:167], a[108:111], v[240:243]
 ds_read_b64_tr_b16 a[206:207], v246 offset:3072
 v_mul_f32 v222, s20, v222
 v_exp_f32 v216, v216
 v_exp_f32 v217, v217
 v_pk_add_f32 v[208:209], v[208:209], v[240:241]
 v_pk_add_f32 v[210:211], v[210:211], v[242:243]
 v_pk_mul_f32 v[208:209], v[208:209], s[20:21]
 v_pk_mul_f32 v[210:211], v[210:211], s[20:21]
 v_exp_f32 v218, v218
 v_mfma_f32_16x16x32_bf16 v[212:215], a[160:163], a[104:107], v[212:215]
 ds_read_b64_tr_b16 a[200:201], v246 offset:0
 v_cvt_pk_bf16_f32 v194, v216, v217
 v_mfma_f32_16x16x32_bf16 v[212:215], a[156:159], a[100:103], v[212:215]
 ds_read_b64_tr_b16 a[202:203], v246 offset:1024
 v_mul_f32 v223, s20, v223
 v_mfma_f32_16x16x32_bf16 v[212:215], a[152:155], a[96:99], v[212:215]
 s_waitcnt lgkmcnt(6)
 v_exp_f32 v219, v219
 v_mfma_f32_16x16x32_bf16 v[100:103], a[212:215], v[156:159], 0
 s_waitcnt lgkmcnt(4)
 ds_read_b64_tr_b16 a[212:213], v246 offset:2056
 v_cvt_pk_bf16_f32 v195, v218, v219
 v_mfma_f32_16x16x32_bf16 v[100:103], a[208:211], v[152:155], v[100:103]
 v_exp_f32 v220, v220
 v_exp_f32 v221, v221
 v_exp_f32 v222, v222
 v_pk_mul_f32 v[212:213], v[212:213], s[20:21]
 v_pk_mul_f32 v[214:215], v[214:215], s[20:21]
 v_exp_f32 v223, v223
 v_mfma_f32_16x16x32_bf16 v[216:219], a[168:171], a[96:99], v[240:243]
 ds_read_b64_tr_b16 a[214:215], v246 offset:3080
 v_cvt_pk_bf16_f32 v196, v220, v221
 v_mfma_f32_16x16x32_bf16 v[216:219], a[172:175], a[100:103], v[216:219]
 ds_read_b64_tr_b16 a[208:209], v246 offset:8
 v_cvt_pk_bf16_f32 v197, v222, v223
 v_mfma_f32_16x16x32_bf16 v[216:219], a[176:179], a[104:107], v[216:219]
 ds_read_b64_tr_b16 a[210:211], v246 offset:1032
 ds_read_b128 a[216:219], v244 offset:17664
 v_mfma_f32_16x16x32_bf16 v[216:219], a[180:183], a[108:111], v[216:219]
 s_waitcnt lgkmcnt(7)
 ds_read_b128 a[220:223], v244 offset:17728
 ds_read_b128 a[224:227], v244 offset:17792
 v_mfma_f32_16x16x32_bf16 v[104:107], a[204:207], v[156:159], 0
 s_waitcnt lgkmcnt(7)
 v_exp_f32 v208, v208
 v_mfma_f32_16x16x32_bf16 v[104:107], a[200:203], v[152:155], v[104:107]
 ds_read_b128 a[228:231], v244 offset:17856
 ds_read_b64_tr_b16 a[204:205], v247 offset:2048
 v_exp_f32 v209, v209
 v_exp_f32 v210, v210
 v_pk_mul_f32 v[216:217], v[216:217], s[20:21]
 v_pk_mul_f32 v[218:219], v[218:219], s[20:21]
 v_exp_f32 v211, v211
 v_mfma_f32_16x16x32_bf16 v[220:223], a[196:199], a[108:111], v[240:243]
 ds_read_b64_tr_b16 a[206:207], v247 offset:3072
 v_cvt_pk_bf16_f32 v160, v208, v209
 v_mfma_f32_16x16x32_bf16 v[220:223], a[192:195], a[104:107], v[220:223]
 ds_read_b64_tr_b16 a[200:201], v247 offset:0
 v_cvt_pk_bf16_f32 v161, v210, v211
 v_mfma_f32_16x16x32_bf16 v[220:223], a[188:191], a[100:103], v[220:223]
 ds_read_b64_tr_b16 a[202:203], v247 offset:1024
 ds_read_b128 a[244:247], v244 offset:18880
 v_mfma_f32_16x16x32_bf16 v[220:223], a[184:187], a[96:99], v[220:223]
 s_waitcnt lgkmcnt(11)
 ds_read_b128 a[240:243], v244 offset:18816
 ds_read_b128 a[236:239], v244 offset:18752
 v_mfma_f32_16x16x32_bf16 v[108:111], a[212:215], v[156:159], 0
 s_waitcnt lgkmcnt(11)
 v_exp_f32 v212, v212
 v_mfma_f32_16x16x32_bf16 v[108:111], a[208:211], v[152:155], v[108:111]
 s_waitcnt lgkmcnt(10)
 ds_read_b128 a[232:235], v244 offset:18688
 v_mul_f32 v220, s20, v220
 v_mfma_f32_16x16x32_bf16 v[208:211], a[216:219], a[96:99], v[240:243]
 s_waitcnt lgkmcnt(10)
 ds_read_b64_tr_b16 a[212:213], v247 offset:2056
 v_mul_f32 v221, s20, v221
 v_mfma_f32_16x16x32_bf16 v[208:211], a[220:223], a[100:103], v[208:211]
 s_waitcnt lgkmcnt(10)
 ds_read_b64_tr_b16 a[214:215], v247 offset:3080
 v_mul_f32 v222, s20, v222
 v_mfma_f32_16x16x32_bf16 v[208:211], a[224:227], a[104:107], v[208:211]
 s_waitcnt lgkmcnt(10)
 ds_read_b64_tr_b16 a[208:209], v247 offset:8
 v_mul_f32 v223, s20, v223
 ds_read_b64_tr_b16 a[210:211], v247 offset:1032
 v_mfma_f32_16x16x32_bf16 v[208:211], a[228:231], a[108:111], v[208:211]
 s_waitcnt lgkmcnt(10)
 ds_read_b128 a[216:219], v244 offset:19712
 ds_read_b128 a[220:223], v244 offset:19776
 v_mfma_f32_16x16x32_bf16 v[112:115], a[204:207], v[156:159], 0
 s_waitcnt lgkmcnt(10)
 v_exp_f32 v213, v213
 v_exp_f32 v214, v214
 v_exp_f32 v215, v215
 v_pk_mul_f32 v[208:209], v[208:209], s[20:21]
 v_pk_mul_f32 v[210:211], v[210:211], s[20:21]
 v_cvt_pk_bf16_f32 v162, v212, v213
 v_mfma_f32_16x16x32_bf16 v[112:115], a[200:203], v[152:155], v[112:115]
 s_waitcnt lgkmcnt(9)
 ds_read_b128 a[224:227], v244 offset:19840
 v_cvt_pk_bf16_f32 v163, v214, v215
 v_mfma_f32_16x16x32_bf16 v[212:215], a[244:247], a[108:111], v[240:243]
 s_waitcnt lgkmcnt(9)
 ds_read_b128 a[228:231], v244 offset:19904
 ds_read_b128 a[244:247], v244 offset:20928
 v_mfma_f32_16x16x32_bf16 v[212:215], a[240:243], a[104:107], v[212:215]
 s_waitcnt lgkmcnt(10)
 v_exp_f32 v216, v216
 v_mfma_f32_16x16x32_bf16 v[212:215], a[236:239], a[100:103], v[212:215]
 s_waitcnt lgkmcnt(9)
 ds_read_b128 a[236:239], v244 offset:20800
 ds_read_b128 a[240:243], v244 offset:20864
 v_mfma_f32_16x16x32_bf16 v[212:215], a[232:235], a[96:99], v[212:215]
 s_waitcnt lgkmcnt(9)
 ds_read_b128 a[232:235], v244 offset:20736
 ds_read_b64_tr_b16 a[184:185], v245 offset:0
 v_mfma_f32_16x16x32_bf16 v[116:119], a[212:215], v[156:159], 0
 s_waitcnt lgkmcnt(9)
 v_exp_f32 v217, v217
 v_exp_f32 v218, v218
 v_exp_f32 v219, v219
 v_pk_mul_f32 v[212:213], v[212:213], s[20:21]
 v_pk_mul_f32 v[214:215], v[214:215], s[20:21]
 v_cvt_pk_bf16_f32 v164, v216, v217
 v_mfma_f32_16x16x32_bf16 v[116:119], a[208:211], v[152:155], v[116:119]
 s_waitcnt lgkmcnt(8)
 ds_read_b64_tr_b16 a[186:187], v245 offset:1024
 v_cvt_pk_bf16_f32 v165, v218, v219
 v_mfma_f32_16x16x32_bf16 v[216:219], a[216:219], a[96:99], v[240:243]
 s_waitcnt lgkmcnt(8)
 ds_read_b64_tr_b16 a[188:189], v245 offset:2048
 ds_read_b64_tr_b16 a[190:191], v245 offset:3072
 v_mfma_f32_16x16x32_bf16 v[216:219], a[220:223], a[100:103], v[216:219]
 s_waitcnt lgkmcnt(9)
 v_exp_f32 v220, v220
 v_mfma_f32_16x16x32_bf16 v[216:219], a[224:227], a[104:107], v[216:219]
 s_waitcnt lgkmcnt(8)
 v_exp_f32 v221, v221
 v_exp_f32 v222, v222
 v_exp_f32 v223, v223
 v_mfma_f32_16x16x32_bf16 v[216:219], a[228:231], a[108:111], v[216:219]
 s_waitcnt lgkmcnt(4)
 ds_read_b64_tr_b16 a[192:193], v245 offset:8
 v_cvt_pk_bf16_f32 v166, v220, v221
 v_cvt_pk_bf16_f32 v167, v222, v223
 v_mfma_f32_16x16x32_bf16 v[220:223], a[232:235], a[32:35], v[224:227]
 s_add_u32 m0, s62, 0
 ds_read_b64_tr_b16 a[194:195], v245 offset:1032
 ds_read_b64_tr_b16 a[196:197], v245 offset:2056
 ds_read_b64_tr_b16 a[198:199], v245 offset:3080
 ds_read_b64_tr_b16 a[248:249], v246 offset:0
 ds_read_b64_tr_b16 a[250:251], v246 offset:1024
 ds_read_b64_tr_b16 a[252:253], v246 offset:2048
 ds_read_b64_tr_b16 a[254:255], v246 offset:3072
 ds_read_b64_tr_b16 a[168:169], v248 offset:0
 ds_read_b64_tr_b16 a[170:171], v248 offset:1024
 ds_read_b64_tr_b16 a[172:173], v248 offset:2048
 ds_read_b64_tr_b16 a[174:175], v248 offset:3072
 ds_read_b64_tr_b16 a[176:177], v248 offset:8
 ds_read_b64_tr_b16 a[178:179], v248 offset:1032
 ds_read_b64_tr_b16 a[180:181], v248 offset:2056
 ds_read_b64_tr_b16 a[182:183], v248 offset:3080
 ds_read_b64_tr_b16 a[200:201], v246 offset:8
 ds_read_b64_tr_b16 a[202:203], v246 offset:1032
 ds_read_b64_tr_b16 a[204:205], v246 offset:2056
 ds_read_b64_tr_b16 a[206:207], v246 offset:3080
 ds_read_b64_tr_b16 a[208:209], v247 offset:0
 ds_read_b64_tr_b16 a[210:211], v247 offset:1024
 ds_read_b64_tr_b16 a[212:213], v247 offset:2048
 ds_read_b64_tr_b16 a[214:215], v247 offset:3072
 ds_read_b64_tr_b16 a[216:217], v247 offset:8
 ds_read_b64_tr_b16 a[218:219], v247 offset:1032
 ds_read_b64_tr_b16 a[220:221], v247 offset:2056
 ds_read_b64_tr_b16 a[222:223], v247 offset:3080
 v_pk_mul_f32 v[216:217], v[216:217], s[20:21]
 v_pk_mul_f32 v[218:219], v[218:219], s[20:21]
 v_exp_f32 v208, v208
 v_mfma_f32_16x16x32_bf16 v[220:223], a[236:239], a[36:39], v[220:223]
 v_exp_f32 v209, v209
 v_mfma_f32_16x16x32_bf16 v[220:223], a[240:243], a[40:43], v[220:223]
 buffer_load_dwordx4 v251, s[4:7], s32 offen offset:0 lds
 v_mfma_f32_16x16x32_bf16 v[220:223], a[244:247], a[44:47], v[220:223]
 s_waitcnt lgkmcnt(15)
 v_exp_f32 v210, v210
 v_mfma_f32_16x16x32_bf16 a[0:3], a[184:187], v[160:163], 0
 s_add_u32 m0, s62, 960
 v_exp_f32 v211, v211
 v_mfma_f32_16x16x32_bf16 a[0:3], a[188:191], v[164:167], a[0:3]
 buffer_load_dwordx4 v251, s[4:7], s32 offen offset:64 lds
 v_cvt_pk_bf16_f32 v200, v208, v209
 v_cvt_pk_bf16_f32 v201, v210, v211
 v_pk_mul_f32 v[220:221], v[220:221], s[20:21]
 v_pk_mul_f32 v[222:223], v[222:223], s[20:21]
 v_exp_f32 v212, v212
 v_mfma_f32_16x16x32_bf16 v[208:211], a[244:247], a[60:63], v[228:231]
 v_exp_f32 v213, v213
 v_mfma_f32_16x16x32_bf16 v[208:211], a[240:243], a[56:59], v[208:211]
 v_exp_f32 v214, v214
 v_mfma_f32_16x16x32_bf16 v[208:211], a[236:239], a[52:55], v[208:211]
 s_waitcnt vmcnt(14) lgkmcnt(0)
 ds_inc_u32 v249, v252
 v_cvt_pk_bf16_f32 v202, v212, v213
 v_mfma_f32_16x16x32_bf16 v[208:211], a[232:235], a[48:51], v[208:211]
 s_add_u32 s2, s2, 4
 v_exp_f32 v215, v215
 v_mfma_f32_16x16x32_bf16 a[4:7], a[192:195], v[160:163], 0
 v_cvt_pk_bf16_f32 v203, v214, v215
 v_mfma_f32_16x16x32_bf16 a[4:7], a[196:199], v[164:167], a[4:7]
 v_exp_f32 v216, v216
 v_mfma_f32_16x16x32_bf16 v[212:215], a[232:235], a[64:67], v[232:235]
 v_exp_f32 v217, v217
 v_exp_f32 v218, v218
 v_exp_f32 v219, v219
 v_pk_mul_f32 v[208:209], v[208:209], s[20:21]
 v_pk_mul_f32 v[210:211], v[210:211], s[20:21]
 v_cvt_pk_bf16_f32 v204, v216, v217
 v_mfma_f32_16x16x32_bf16 v[212:215], a[236:239], a[68:71], v[212:215]
 v_exp_f32 v220, v220
 v_mfma_f32_16x16x32_bf16 v[212:215], a[240:243], a[72:75], v[212:215]
 v_exp_f32 v221, v221
 v_mfma_f32_16x16x32_bf16 v[212:215], a[244:247], a[76:79], v[212:215]
 v_cvt_pk_bf16_f32 v205, v218, v219
 v_cvt_pk_bf16_f32 v174, v220, v221
 v_mfma_f32_16x16x32_bf16 a[8:11], a[248:251], v[160:163], 0
 v_exp_f32 v222, v222
 v_mfma_f32_16x16x32_bf16 a[8:11], a[252:255], v[164:167], a[8:11]
 v_exp_f32 v223, v223
 v_mfma_f32_16x16x32_bf16 v[216:219], a[244:247], a[92:95], v[236:239]
 v_exp_f32 v208, v208
 v_cvt_pk_bf16_f32 v175, v222, v223
 v_exp_f32 v209, v209
 v_pk_mul_f32 v[212:213], v[212:213], s[20:21]
 v_pk_mul_f32 v[214:215], v[214:215], s[20:21]
 v_exp_f32 v210, v210
 v_mfma_f32_16x16x32_bf16 v[216:219], a[240:243], a[88:91], v[216:219]
 v_exp_f32 v211, v211
 v_mfma_f32_16x16x32_bf16 v[216:219], a[236:239], a[84:87], v[216:219]
 v_exp_f32 v212, v212
 v_mfma_f32_16x16x32_bf16 v[216:219], a[232:235], a[80:83], v[216:219]
 v_exp_f32 v213, v213
 v_mfma_f32_16x16x32_bf16 a[12:15], a[200:203], v[160:163], 0
 v_cvt_pk_bf16_f32 v182, v208, v209
 v_cvt_pk_bf16_f32 v183, v210, v211
 v_mfma_f32_16x16x32_bf16 a[12:15], a[204:207], v[164:167], a[12:15]
 v_mfma_f32_16x16x32_bf16 v[220:223], a[232:235], a[96:99], v[240:243]
 v_mfma_f32_16x16x32_bf16 v[220:223], a[236:239], a[100:103], v[220:223]
 v_mfma_f32_16x16x32_bf16 v[220:223], a[240:243], a[104:107], v[220:223]
 v_mul_f32 v216, s20, v216
 v_mfma_f32_16x16x32_bf16 v[220:223], a[244:247], a[108:111], v[220:223]
 v_mfma_f32_16x16x32_bf16 a[16:19], a[208:211], v[160:163], 0
 v_mfma_f32_16x16x32_bf16 a[16:19], a[212:215], v[164:167], a[16:19]
 v_mfma_f32_16x16x32_bf16 a[20:23], a[216:219], v[160:163], 0
 v_mfma_f32_16x16x32_bf16 a[20:23], a[220:223], v[164:167], a[20:23]
 ds_read_b32 v207, v249
 v_mfma_f32_16x16x32_bf16 a[128:131], a[132:135], v[160:163], 0
 v_mfma_f32_16x16x32_bf16 a[128:131], a[132:135], v[164:167], a[128:131]
 v_mfma_f32_16x16x32_bf16 v[24:27], a[168:171], v[128:131], 0
 v_mfma_f32_16x16x32_bf16 v[24:27], a[172:175], v[132:135], v[24:27]
 v_mfma_f32_16x16x32_bf16 v[56:59], a[172:175], v[140:143], 0
 v_mfma_f32_16x16x32_bf16 v[56:59], a[168:171], v[136:139], v[56:59]
 v_mfma_f32_16x16x32_bf16 v[88:91], a[168:171], v[144:147], 0
 s_waitcnt lgkmcnt(0)
 v_cmp_gt_u32 vcc, s2, v207
 v_mfma_f32_16x16x32_bf16 v[88:91], a[172:175], v[148:151], v[88:91]
 v_mfma_f32_16x16x32_bf16 v[120:123], a[172:175], v[156:159], 0
 s_cbranch_vccnz Lspin5f_1
Lback5f_1:
 s_add_u32 s38, s27, 49152
 s_waitcnt lgkmcnt(0)
 s_nop 7
 s_branch Lback5_1
.p2align 6
L_blk4f:
 s_waitcnt vmcnt(12)
 s_barrier
 ds_read_b128 a[136:139], v244 offset:1024
 s_waitcnt lgkmcnt(0)
 v_mfma_f32_16x16x32_bf16 v[208:211], a[136:139], a[32:35], 0
 s_add_u32 s55, s24, 1
 ds_read_b128 a[140:143], v244 offset:1088
 ds_read_b128 a[144:147], v244 offset:1152
 ds_read_b128 a[148:151], v244 offset:1216
 ds_read_b128 a[164:167], v244 offset:2240
 ds_read_b128 a[160:163], v244 offset:2176
 ds_read_b128 a[152:155], v244 offset:2048
 ds_read_b128 a[156:159], v244 offset:2112
 ds_read_b128 a[168:171], v244 offset:3072
 ds_read_b128 a[172:175], v244 offset:3136
 ds_read_b128 a[176:179], v244 offset:3200
 ds_read_b128 a[180:183], v244 offset:3264
 ds_read_b128 a[184:187], v244 offset:4096
 ds_read_b128 a[188:191], v244 offset:4160
 ds_read_b128 a[192:195], v244 offset:4224
 ds_read_b128 a[196:199], v244 offset:4288
 s_waitcnt lgkmcnt(14)
 v_mfma_f32_16x16x32_bf16 v[208:211], a[140:143], a[36:39], v[208:211]
 s_waitcnt lgkmcnt(13)
 v_mfma_f32_16x16x32_bf16 v[208:211], a[144:147], a[40:43], v[208:211]
 s_waitcnt lgkmcnt(12)
 buffer_load_dwordx4 a[64:67], v251, s[4:7], s34 offen offset:0
 v_mfma_f32_16x16x32_bf16 v[208:211], a[148:151], a[44:47], v[208:211]
 s_waitcnt lgkmcnt(11)
 buffer_load_dwordx4 a[68:71], v251, s[4:7], s34 offen offset:64
 s_nop 5
 v_max3_f32 v169, v208, v209, v210
 v_max_f32 v168, v169, v211
 v_max_f32 v169, v169, v211
 s_nop 1
 v_permlane32_swap_b32 v168, v169
 v_max_f32 v170, v168, v169
 v_max_f32 v171, v168, v169
 s_nop 1
 v_permlane16_swap_b32 v170, v171
 v_max_f32 v168, v170, v171
 v_sub_f32 v224, s59, v168
 v_sub_f32 v225, s59, v168
 v_sub_f32 v226, s59, v168
 v_sub_f32 v227, s59, v168
 s_nop 1
 v_mfma_f32_16x16x32_bf16 v[212:215], a[164:167], a[44:47], v[224:227]
 s_waitcnt lgkmcnt(10)
 buffer_load_dwordx4 a[72:75], v251, s[4:7], s34 offen offset:128
 v_pk_add_f32 v[208:209], v[208:209], v[224:225]
 v_pk_add_f32 v[210:211], v[210:211], v[226:227]
 v_pk_mul_f32 v[208:209], v[208:209], s[20:21]
 v_pk_mul_f32 v[210:211], v[210:211], s[20:21]
 v_exp_f32 v208, v208
 v_mfma_f32_16x16x32_bf16 v[212:215], a[160:163], a[40:43], v[212:215]
 s_waitcnt lgkmcnt(8)
 buffer_load_dwordx4 a[76:79], v251, s[4:7], s34 offen offset:192
 v_mfma_f32_16x16x32_bf16 v[212:215], a[156:159], a[36:39], v[212:215]
 s_lshl_b32 s52, s55, 5
 v_exp_f32 v209, v209
 v_mfma_f32_16x16x32_bf16 v[212:215], a[152:155], a[32:35], v[212:215]
 s_waitcnt vmcnt(8) lgkmcnt(0)
 v_exp_f32 v210, v210
 v_mfma_f32_16x16x32_bf16 v[216:219], a[168:171], a[32:35], v[224:227]
 s_barrier
 ds_read_b128 a[216:219], v244 offset:17664
 v_cvt_pk_bf16_f32 v128, v208, v209
 ds_read_b128 a[220:223], v244 offset:17728
 v_mfma_f32_16x16x32_bf16 v[216:219], a[172:175], a[36:39], v[216:219]
 s_add_u32 s52, s52, s25
 ds_read_b128 a[224:227], v244 offset:17792
 v_mul_f32 v212, s20, v212
 v_mfma_f32_16x16x32_bf16 v[216:219], a[176:179], a[40:43], v[216:219]
 s_mul_i32 s53, s52, 43691
 buffer_load_dwordx4 a[80:83], v251, s[4:7], s35 offen offset:0
 ds_read_b128 a[228:231], v244 offset:17856
 v_mfma_f32_16x16x32_bf16 v[216:219], a[180:183], a[44:47], v[216:219]
 s_lshr_b32 s53, s53, 17
 buffer_load_dwordx4 a[84:87], v251, s[4:7], s35 offen offset:64
 ds_read_b128 a[244:247], v244 offset:18880
 v_mfma_f32_16x16x32_bf16 v[220:223], a[196:199], a[44:47], v[224:227]
 s_mul_i32 s54, s53, 3
 buffer_load_dwordx4 a[88:91], v251, s[4:7], s35 offen offset:128
 ds_read_b128 a[240:243], v244 offset:18816
 v_mfma_f32_16x16x32_bf16 v[220:223], a[192:195], a[40:43], v[220:223]
 s_sub_u32 s54, s52, s54
 buffer_load_dwordx4 a[92:95], v251, s[4:7], s35 offen offset:192
 ds_read_b128 a[236:239], v244 offset:18752
 v_exp_f32 v211, v211
 v_pk_mul_f32 v[214:215], v[214:215], s[20:21]
 v_pk_mul_f32 v[216:217], v[216:217], s[20:21]
 v_pk_mul_f32 v[218:219], v[218:219], s[20:21]
 v_cvt_pk_bf16_f32 v129, v210, v211
 v_mfma_f32_16x16x32_bf16 v[220:223], a[188:191], a[36:39], v[220:223]
 s_lshl_b32 s53, s53, 3
 ds_read_b128 a[232:235], v244 offset:18688
 v_mul_f32 v213, s20, v213
 v_mfma_f32_16x16x32_bf16 v[220:223], a[184:187], a[32:35], v[220:223]
 s_waitcnt lgkmcnt(7)
 v_exp_f32 v212, v212
 v_mfma_f32_16x16x32_bf16 v[208:211], a[216:219], a[32:35], v[224:227]
 s_waitcnt lgkmcnt(6)
 ds_read_b128 a[216:219], v244 offset:19712
 ds_read_b64_tr_b16 a[200:201], v245 offset:0
 v_mfma_f32_16x16x32_bf16 v[208:211], a[220:223], a[36:39], v[208:211]
 s_waitcnt lgkmcnt(7)
 ds_read_b128 a[220:223], v244 offset:19776
 v_mul_f32 v220, s20, v220
 v_mfma_f32_16x16x32_bf16 v[208:211], a[224:227], a[40:43], v[208:211]
 s_waitcnt lgkmcnt(7)
 ds_read_b128 a[224:227], v244 offset:19840
 v_mul_f32 v221, s20, v221
 v_exp_f32 v213, v213
 v_exp_f32 v214, v214
 v_exp_f32 v215, v215
 v_mfma_f32_16x16x32_bf16 v[208:211], a[228:231], a[44:47], v[208:211]
 s_waitcnt lgkmcnt(7)
 ds_read_b128 a[228:231], v244 offset:19904
 v_cvt_pk_bf16_f32 v130, v212, v213
 v_cvt_pk_bf16_f32 v131, v214, v215
 v_mfma_f32_16x16x32_bf16 v[212:215], a[244:247], a[44:47], v[224:227]
 s_waitcnt lgkmcnt(7)
 v_exp_f32 v216, v216
 v_mfma_f32_16x16x32_bf16 v[212:215], a[240:243], a[40:43], v[212:215]
 s_waitcnt lgkmcnt(6)
 v_exp_f32 v217, v217
 v_exp_f32 v218, v218
 v_exp_f32 v219, v219
 v_pk_mul_f32 v[222:223], v[222:223], s[20:21]
 v_pk_mul_f32 v[208:209], v[208:209], s[20:21]
 v_pk_mul_f32 v[210:211], v[210:211], s[20:21]
 v_cvt_pk_bf16_f32 v132, v216, v217
 v_mfma_f32_16x16x32_bf16 v[212:215], a[236:239], a[36:39], v[212:215]
 s_waitcnt lgkmcnt(5)
 ds_read_b64_tr_b16 a[202:203], v245 offset:1024
 v_cvt_pk_bf16_f32 v133, v218, v219
 v_mfma_f32_16x16x32_bf16 v[212:215], a[232:235], a[32:35], v[212:215]
 s_waitcnt lgkmcnt(5)
 ds_read_b64_tr_b16 a[204:205], v245 offset:2048
 ds_read_b64_tr_b16 a[206:207], v245 offset:3072
 v_mfma_f32_16x16x32_bf16 v[216:219], a[216:219], a[32:35], v[224:227]
 s_waitcnt lgkmcnt(5)
 v_exp_f32 v220, v220
 v_mfma_f32_16x16x32_bf16 v[216:219], a[220:223], a[36:39], v[216:219]
 s_waitcnt lgkmcnt(4)
 v_exp_f32 v221, v221
 v_exp_f32 v222, v222
 v_exp_f32 v223, v223
 v_pk_mul_f32 v[212:213], v[212:213], s[20:21]
 v_pk_mul_f32 v[214:215], v[214:215], s[20:21]
 v_cvt_pk_bf16_f32 v134, v220, v221
 v_mfma_f32_16x16x32_bf16 v[216:219], a[224:227], a[40:43], v[216:219]
 s_waitcnt lgkmcnt(3)
 ds_read_b64_tr_b16 a[208:209], v245 offset:8
 v_cvt_pk_bf16_f32 v135, v222, v223
 v_mfma_f32_16x16x32_bf16 v[216:219], a[228:231], a[44:47], v[216:219]
 s_waitcnt vmcnt(8)
 v_exp_f32 v208, v208
 v_mfma_f32_16x16x32_bf16 v[220:223], a[136:139], a[48:51], 0
 s_add_u32 s53, s53, s26
 ds_read_b64_tr_b16 a[210:211], v245 offset:1032
 ds_read_b64_tr_b16 a[212:213], v245 offset:2056
 v_mfma_f32_16x16x32_bf16 v[220:223], a[140:143], a[52:55], v[220:223]
 s_cmp_eq_u32 s54, 0
 ds_read_b64_tr_b16 a[214:215], v245 offset:3080
 v_mul_f32 v216, s20, v216
 v_mfma_f32_16x16x32_bf16 v[220:223], a[144:147], a[56:59], v[220:223]
 s_cselect_b32 s52, s46, s47
 v_exp_f32 v209, v209
 v_mfma_f32_16x16x32_bf16 v[220:223], a[148:151], a[60:63], v[220:223]
 s_waitcnt lgkmcnt(6)
 v_exp_f32 v210, v210
 v_mfma_f32_16x16x32_bf16 v[0:3], a[200:203], v[128:131], 0
 s_waitcnt lgkmcnt(4)
 v_exp_f32 v211, v211
 v_mfma_f32_16x16x32_bf16 v[0:3], a[204:207], v[132:135], v[0:3]
 s_cselect_b32 s31, 1, 0
 ds_read_b64_tr_b16 a[200:201], v246 offset:0
 v_cvt_pk_bf16_f32 v168, v208, v209
 v_max3_f32 v177, v220, v221, v222
 v_max_f32 v176, v177, v223
 v_max_f32 v177, v177, v223
 v_cvt_pk_bf16_f32 v169, v210, v211
 s_nop 0
 v_permlane32_swap_b32 v176, v177
 v_max_f32 v178, v176, v177
 v_max_f32 v179, v176, v177
 s_nop 1
 v_permlane16_swap_b32 v178, v179
 v_max_f32 v176, v178, v179
 v_sub_f32 v228, s59, v176
 v_sub_f32 v229, s59, v176
 v_sub_f32 v230, s59, v176
 v_sub_f32 v231, s59, v176
 s_nop 1
 v_mfma_f32_16x16x32_bf16 v[208:211], a[164:167], a[60:63], v[228:231]
 s_add_u32 s37, s27, 32768
 ds_read_b64_tr_b16 a[202:203], v246 offset:1024
 v_mul_f32 v217, s20, v217
 v_exp_f32 v212, v212
 v_exp_f32 v213, v213
 v_pk_mul_f32 v[218:219], v[218:219], s[20:21]
 v_pk_add_f32 v[220:221], v[220:221], v[228:229]
 v_pk_add_f32 v[222:223], v[222:223], v[230:231]
 v_pk_mul_f32 v[220:221], v[220:221], s[20:21]
 v_pk_mul_f32 v[222:223], v[222:223], s[20:21]
 v_exp_f32 v214, v214
 v_mfma_f32_16x16x32_bf16 v[208:211], a[160:163], a[56:59], v[208:211]
 s_add_u32 m0, s22, 34304
 ds_read_b64_tr_b16 a[204:205], v246 offset:2048
 v_cvt_pk_bf16_f32 v170, v212, v213
 v_mfma_f32_16x16x32_bf16 v[208:211], a[156:159], a[52:55], v[208:211]
 s_lshl_b32 s28, s53, 17
 buffer_load_dwordx4 v249, s[8:11], s37 offen offset:0 lds
 ds_read_b64_tr_b16 a[206:207], v246 offset:3072
 v_mfma_f32_16x16x32_bf16 v[208:211], a[152:155], a[48:51], v[208:211]
 s_waitcnt lgkmcnt(6)
 buffer_load_dwordx4 v249, s[8:11], s37 offen offset:1024 lds
 v_mfma_f32_16x16x32_bf16 v[4:7], a[208:211], v[128:131], 0
 s_waitcnt lgkmcnt(4)
 v_exp_f32 v215, v215
 v_mfma_f32_16x16x32_bf16 v[4:7], a[212:215], v[132:135], v[4:7]
 s_cmp_eq_u32 s54, 2
 buffer_load_dwordx4 v249, s[8:11], s37 offen offset:2048 lds
 v_cvt_pk_bf16_f32 v171, v214, v215
 v_exp_f32 v216, v216
 v_pk_mul_f32 v[208:209], v[208:209], s[20:21]
 v_pk_mul_f32 v[210:211], v[210:211], s[20:21]
 v_exp_f32 v217, v217
 v_mfma_f32_16x16x32_bf16 v[212:215], a[168:171], a[48:51], v[228:231]
 s_cselect_b32 s52, s48, s52
 buffer_load_dwordx4 v249, s[8:11], s37 offen offset:3072 lds
 v_mfma_f32_16x16x32_bf16 v[212:215], a[172:175], a[52:55], v[212:215]
 s_cselect_b32 s31, s49, s31
 ds_read_b64_tr_b16 a[208:209], v246 offset:8
 v_cvt_pk_bf16_f32 v172, v216, v217
 ds_read_b64_tr_b16 a[210:211], v246 offset:1032
 v_mfma_f32_16x16x32_bf16 v[212:215], a[176:179], a[56:59], v[212:215]
 s_mul_i32 s53, s53, 217088
 ds_read_b64_tr_b16 a[212:213], v246 offset:2056
 ds_read_b64_tr_b16 a[214:215], v246 offset:3080
 v_mfma_f32_16x16x32_bf16 v[212:215], a[180:183], a[60:63], v[212:215]
 s_waitcnt lgkmcnt(6)
 ds_read_b128 a[216:219], v244 offset:17664
 ds_read_b128 a[220:223], v244 offset:17728
 v_mfma_f32_16x16x32_bf16 v[8:11], a[200:203], v[128:131], 0
 s_waitcnt lgkmcnt(6)
 v_exp_f32 v218, v218
 v_exp_f32 v219, v219
 v_mfma_f32_16x16x32_bf16 v[8:11], a[204:207], v[132:135], v[8:11]
 s_add_u32 s30, s53, s52
 ds_read_b128 a[224:227], v244 offset:17792
 v_cvt_pk_bf16_f32 v173, v218, v219
 v_exp_f32 v220, v220
 v_exp_f32 v221, v221
 v_pk_mul_f32 v[212:213], v[212:213], s[20:21]
 v_pk_mul_f32 v[214:215], v[214:215], s[20:21]
 v_exp_f32 v222, v222
 v_mfma_f32_16x16x32_bf16 v[216:219], a[196:199], a[60:63], v[228:231]
 s_cmp_ge_u32 s55, 6
 ds_read_b128 a[228:231], v244 offset:17856
 v_cvt_pk_bf16_f32 v136, v220, v221
 v_mfma_f32_16x16x32_bf16 v[216:219], a[192:195], a[56:59], v[216:219]
 s_cselect_b32 s30, 117440512, s30
 ds_read_b64_tr_b16 a[200:201], v247 offset:0
 ds_read_b64_tr_b16 a[202:203], v247 offset:1024
 v_mfma_f32_16x16x32_bf16 v[216:219], a[188:191], a[52:55], v[216:219]
 s_cselect_b32 s28, 67108864, s28
 ds_read_b64_tr_b16 a[204:205], v247 offset:2048
 ds_read_b64_tr_b16 a[206:207], v247 offset:3072
 v_mfma_f32_16x16x32_bf16 v[216:219], a[184:187], a[48:51], v[216:219]
 s_waitcnt lgkmcnt(10)
 ds_read_b128 a[244:247], v244 offset:18880
 ds_read_b128 a[240:243], v244 offset:18816
 v_mfma_f32_16x16x32_bf16 v[12:15], a[208:211], v[128:131], 0
 s_waitcnt lgkmcnt(10)
 v_exp_f32 v223, v223
 v_mfma_f32_16x16x32_bf16 v[12:15], a[212:215], v[132:135], v[12:15]
 s_waitcnt lgkmcnt(9)
 ds_read_b128 a[236:239], v244 offset:18752
 v_cvt_pk_bf16_f32 v137, v222, v223
 v_exp_f32 v208, v208
 v_exp_f32 v209, v209
 v_pk_mul_f32 v[216:217], v[216:217], s[20:21]
 v_pk_mul_f32 v[218:219], v[218:219], s[20:21]
 v_exp_f32 v210, v210
 v_mfma_f32_16x16x32_bf16 v[220:223], a[216:219], a[48:51], v[228:231]
 s_waitcnt lgkmcnt(9)
 ds_read_b128 a[232:235], v244 offset:18688
 v_cvt_pk_bf16_f32 v138, v208, v209
 v_mfma_f32_16x16x32_bf16 v[220:223], a[220:223], a[52:55], v[220:223]
 s_waitcnt lgkmcnt(9)
 ds_read_b64_tr_b16 a[208:209], v247 offset:8
 ds_read_b64_tr_b16 a[210:211], v247 offset:1032
 v_mfma_f32_16x16x32_bf16 v[220:223], a[224:227], a[56:59], v[220:223]
 s_waitcnt lgkmcnt(10)
 ds_read_b64_tr_b16 a[212:213], v247 offset:2056
 ds_read_b64_tr_b16 a[214:215], v247 offset:3080
 v_mfma_f32_16x16x32_bf16 v[220:223], a[228:231], a[60:63], v[220:223]
 s_waitcnt lgkmcnt(10)
 ds_read_b128 a[216:219], v244 offset:19712
 ds_read_b128 a[220:223], v244 offset:19776
 v_mfma_f32_16x16x32_bf16 v[16:19], a[200:203], v[128:131], 0
 s_waitcnt lgkmcnt(10)
 v_exp_f32 v211, v211
 v_mfma_f32_16x16x32_bf16 v[16:19], a[204:207], v[132:135], v[16:19]
 s_waitcnt lgkmcnt(9)
 ds_read_b128 a[224:227], v244 offset:19840
 v_cvt_pk_bf16_f32 v139, v210, v211
 v_exp_f32 v212, v212
 v_exp_f32 v213, v213
 v_pk_mul_f32 v[220:221], v[220:221], s[20:21]
 v_pk_mul_f32 v[222:223], v[222:223], s[20:21]
 v_exp_f32 v214, v214
 v_mfma_f32_16x16x32_bf16 v[208:211], a[244:247], a[60:63], v[228:231]
 s_waitcnt lgkmcnt(9)
 ds_read_b128 a[228:231], v244 offset:19904
 v_cvt_pk_bf16_f32 v140, v212, v213
 v_mfma_f32_16x16x32_bf16 v[208:211], a[240:243], a[56:59], v[208:211]
 s_waitcnt lgkmcnt(9)
 v_exp_f32 v215, v215
 v_mfma_f32_16x16x32_bf16 v[208:211], a[236:239], a[52:55], v[208:211]
 s_waitcnt lgkmcnt(8)
 ds_read_b64_tr_b16 a[204:205], v245 offset:2048
 v_cvt_pk_bf16_f32 v141, v214, v215
 v_mfma_f32_16x16x32_bf16 v[208:211], a[232:235], a[48:51], v[208:211]
 s_waitcnt lgkmcnt(7)
 v_exp_f32 v216, v216
 v_mfma_f32_16x16x32_bf16 v[20:23], a[208:211], v[128:131], 0
 s_waitcnt lgkmcnt(5)
 v_exp_f32 v217, v217
 v_mfma_f32_16x16x32_bf16 v[20:23], a[212:215], v[132:135], v[20:23]
 s_waitcnt lgkmcnt(4)
 ds_read_b64_tr_b16 a[206:207], v245 offset:3072
 v_cvt_pk_bf16_f32 v142, v216, v217
 v_exp_f32 v218, v218
 v_exp_f32 v219, v219
 v_pk_mul_f32 v[208:209], v[208:209], s[20:21]
 v_pk_mul_f32 v[210:211], v[210:211], s[20:21]
 v_cvt_pk_bf16_f32 v143, v218, v219
 v_mfma_f32_16x16x32_bf16 v[212:215], a[216:219], a[48:51], v[228:231]
 s_waitcnt lgkmcnt(4)
 v_exp_f32 v220, v220
 v_mfma_f32_16x16x32_bf16 v[212:215], a[220:223], a[52:55], v[212:215]
 s_waitcnt lgkmcnt(3)
 ds_read_b64_tr_b16 a[200:201], v245 offset:0
 ds_read_b64_tr_b16 a[202:203], v245 offset:1024
 v_mfma_f32_16x16x32_bf16 v[212:215], a[224:227], a[56:59], v[212:215]
 s_waitcnt lgkmcnt(4)
 v_exp_f32 v221, v221
 v_mfma_f32_16x16x32_bf16 v[212:215], a[228:231], a[60:63], v[212:215]
 s_add_u32 s36, s30, 16384
 ds_read_b64_tr_b16 a[212:213], v245 offset:2056
 v_cvt_pk_bf16_f32 v176, v220, v221
 v_mfma_f32_16x16x32_bf16 a[112:115], a[132:135], v[128:131], 0
 s_add_u32 s38, s27, 16384
 v_exp_f32 v222, v222
 v_mfma_f32_16x16x32_bf16 a[112:115], a[132:135], v[132:135], a[112:115]
 s_waitcnt vmcnt(8)
 ds_read_b64_tr_b16 a[214:215], v245 offset:3080
 v_mul_f32 v212, s20, v212
 v_mfma_f32_16x16x32_bf16 v[216:219], a[136:139], a[64:67], 0
 s_add_u32 m0, s23, 16416
 ds_read_b64_tr_b16 a[208:209], v245 offset:8
 v_mul_f32 v213, s20, v213
 v_mfma_f32_16x16x32_bf16 v[216:219], a[140:143], a[68:71], v[216:219]
 s_cmp_eq_u32 s31, 0
 ds_read_b64_tr_b16 a[210:211], v245 offset:1032
 v_mul_f32 v214, s20, v214
 v_mfma_f32_16x16x32_bf16 v[216:219], a[144:147], a[72:75], v[216:219]
 s_cselect_b32 s36, 117440512, s36
 buffer_load_dwordx4 v250, s[12:15], s38 offen offset:0 lds
 v_mfma_f32_16x16x32_bf16 v[216:219], a[148:151], a[76:79], v[216:219]
 s_waitcnt lgkmcnt(6)
 buffer_load_dwordx4 v250, s[12:15], s38 offen offset:1024 lds
 v_mfma_f32_16x16x32_bf16 v[32:35], a[204:207], v[140:143], 0
 s_waitcnt lgkmcnt(4)
 buffer_load_dwordx4 v250, s[12:15], s38 offen offset:2048 lds
 v_exp_f32 v223, v223
 v_mfma_f32_16x16x32_bf16 v[32:35], a[200:203], v[136:139], v[32:35]
 s_add_u32 s37, s27, 49152
 buffer_load_dwordx4 v250, s[12:15], s38 offen offset:3072 lds
 v_max3_f32 v185, v216, v217, v218
 v_max_f32 v184, v185, v219
 v_max_f32 v185, v185, v219
 v_cvt_pk_bf16_f32 v177, v222, v223
 s_nop 0
 v_permlane32_swap_b32 v184, v185
 v_max_f32 v186, v184, v185
 v_max_f32 v187, v184, v185
 s_nop 1
 v_permlane16_swap_b32 v186, v187
 v_max_f32 v184, v186, v187
 v_sub_f32 v232, s59, v184
 v_sub_f32 v233, s59, v184
 v_sub_f32 v234, s59, v184
 v_sub_f32 v235, s59, v184
 s_nop 1
 v_mfma_f32_16x16x32_bf16 v[220:223], a[164:167], a[76:79], v[232:235]
 s_add_u32 m0, s22, 50944
 ds_read_b64_tr_b16 a[204:205], v246 offset:2048
 v_mul_f32 v215, s20, v215
 v_exp_f32 v208, v208
 v_exp_f32 v209, v209
 v_pk_add_f32 v[216:217], v[216:217], v[232:233]
 v_pk_add_f32 v[218:219], v[218:219], v[234:235]
 v_pk_mul_f32 v[216:217], v[216:217], s[20:21]
 v_pk_mul_f32 v[218:219], v[218:219], s[20:21]
 v_exp_f32 v210, v210
 v_mfma_f32_16x16x32_bf16 v[220:223], a[160:163], a[72:75], v[220:223]
 s_mov_b32 s32, s30
 ds_read_b64_tr_b16 a[206:207], v246 offset:3072
 v_cvt_pk_bf16_f32 v178, v208, v209
 v_mfma_f32_16x16x32_bf16 v[220:223], a[156:159], a[68:71], v[220:223]
 s_add_u32 s33, s30, 4096
 buffer_load_dwordx4 v249, s[8:11], s37 offen offset:0 lds
 ds_read_b64_tr_b16 a[200:201], v246 offset:0
 ds_read_b64_tr_b16 a[202:203], v246 offset:1024
 v_mfma_f32_16x16x32_bf16 v[220:223], a[152:155], a[64:67], v[220:223]
 s_waitcnt lgkmcnt(6)
 buffer_load_dwordx4 v249, s[8:11], s37 offen offset:1024 lds
 v_mfma_f32_16x16x32_bf16 v[36:39], a[212:215], v[140:143], 0
 s_waitcnt lgkmcnt(4)
 v_exp_f32 v211, v211
 v_mfma_f32_16x16x32_bf16 v[36:39], a[208:211], v[136:139], v[36:39]
 s_add_u32 s34, s30, 8192
 buffer_load_dwordx4 v249, s[8:11], s37 offen offset:2048 lds
 v_cvt_pk_bf16_f32 v179, v210, v211
 v_exp_f32 v212, v212
 v_pk_mul_f32 v[220:221], v[220:221], s[20:21]
 v_pk_mul_f32 v[222:223], v[222:223], s[20:21]
 v_exp_f32 v213, v213
 v_mfma_f32_16x16x32_bf16 v[208:211], a[168:171], a[64:67], v[232:235]
 s_add_u32 s35, s30, 12288
 buffer_load_dwordx4 v249, s[8:11], s37 offen offset:3072 lds
 v_mfma_f32_16x16x32_bf16 v[208:211], a[172:175], a[68:71], v[208:211]
 s_add_u32 s40, s29, 0
 ds_read_b64_tr_b16 a[212:213], v246 offset:2056
 v_cvt_pk_bf16_f32 v180, v212, v213
 ds_read_b64_tr_b16 a[214:215], v246 offset:3080
 v_mfma_f32_16x16x32_bf16 v[208:211], a[176:179], a[72:75], v[208:211]
 s_add_u32 s41, s29, 4096
 ds_read_b64_tr_b16 a[208:209], v246 offset:8
 ds_read_b64_tr_b16 a[210:211], v246 offset:1032
 v_mfma_f32_16x16x32_bf16 v[208:211], a[180:183], a[76:79], v[208:211]
 s_waitcnt lgkmcnt(6)
 ds_read_b128 a[216:219], v244 offset:17664
 ds_read_b128 a[220:223], v244 offset:17728
 v_mfma_f32_16x16x32_bf16 v[40:43], a[204:207], v[140:143], 0
 s_waitcnt lgkmcnt(6)
 v_exp_f32 v214, v214
 v_exp_f32 v215, v215
 v_mfma_f32_16x16x32_bf16 v[40:43], a[200:203], v[136:139], v[40:43]
 s_add_u32 s42, s29, 8192
 ds_read_b128 a[224:227], v244 offset:17792
 v_cvt_pk_bf16_f32 v181, v214, v215
 v_exp_f32 v216, v216
 v_exp_f32 v217, v217
 v_pk_mul_f32 v[208:209], v[208:209], s[20:21]
 v_pk_mul_f32 v[210:211], v[210:211], s[20:21]
 v_exp_f32 v218, v218
 v_mfma_f32_16x16x32_bf16 v[212:215], a[196:199], a[76:79], v[232:235]
 s_add_u32 s43, s29, 12288
 ds_read_b128 a[228:231], v244 offset:17856
 v_cvt_pk_bf16_f32 v144, v216, v217
 v_mfma_f32_16x16x32_bf16 v[212:215], a[192:195], a[72:75], v[212:215]
 s_lshl_b32 s63, 1, s24
 ds_read_b64_tr_b16 a[204:205], v247 offset:2048
 ds_read_b64_tr_b16 a[206:207], v247 offset:3072
 v_mfma_f32_16x16x32_bf16 v[212:215], a[188:191], a[68:71], v[212:215]
 s_mov_b32 s29, s30
 ds_read_b64_tr_b16 a[200:201], v247 offset:0
 ds_read_b64_tr_b16 a[202:203], v247 offset:1024
 v_mfma_f32_16x16x32_bf16 v[212:215], a[184:187], a[64:67], v[212:215]
 s_waitcnt lgkmcnt(10)
 ds_read_b128 a[244:247], v244 offset:18880
 ds_read_b128 a[240:243], v244 offset:18816
 v_mfma_f32_16x16x32_bf16 v[44:47], a[212:215], v[140:143], 0
 s_waitcnt lgkmcnt(10)
 v_exp_f32 v219, v219
 v_mfma_f32_16x16x32_bf16 v[44:47], a[208:211], v[136:139], v[44:47]
 s_waitcnt lgkmcnt(9)
 ds_read_b128 a[236:239], v244 offset:18752
 v_cvt_pk_bf16_f32 v145, v218, v219
 v_exp_f32 v220, v220
 v_exp_f32 v221, v221
 v_pk_mul_f32 v[212:213], v[212:213], s[20:21]
 v_pk_mul_f32 v[214:215], v[214:215], s[20:21]
 v_exp_f32 v222, v222
 v_mfma_f32_16x16x32_bf16 v[216:219], a[216:219], a[64:67], v[232:235]
 s_waitcnt lgkmcnt(9)
 ds_read_b128 a[232:235], v244 offset:18688
 v_cvt_pk_bf16_f32 v146, v220, v221
 v_mfma_f32_16x16x32_bf16 v[216:219], a[220:223], a[68:71], v[216:219]
 s_waitcnt lgkmcnt(9)
 ds_read_b64_tr_b16 a[212:213], v247 offset:2056
 ds_read_b64_tr_b16 a[214:215], v247 offset:3080
 v_mfma_f32_16x16x32_bf16 v[216:219], a[224:227], a[72:75], v[216:219]
 s_waitcnt lgkmcnt(10)
 ds_read_b64_tr_b16 a[208:209], v247 offset:8
 ds_read_b64_tr_b16 a[210:211], v247 offset:1032
 v_mfma_f32_16x16x32_bf16 v[216:219], a[228:231], a[76:79], v[216:219]
 s_waitcnt lgkmcnt(10)
 ds_read_b128 a[216:219], v244 offset:19712
 ds_read_b128 a[220:223], v244 offset:19776
 v_mfma_f32_16x16x32_bf16 v[48:51], a[204:207], v[140:143], 0
 s_waitcnt lgkmcnt(10)
 v_exp_f32 v223, v223
 v_mfma_f32_16x16x32_bf16 v[48:51], a[200:203], v[136:139], v[48:51]
 s_waitcnt lgkmcnt(9)
 ds_read_b128 a[224:227], v244 offset:19840
 v_cvt_pk_bf16_f32 v147, v222, v223
 v_exp_f32 v208, v208
 v_exp_f32 v209, v209
 v_pk_mul_f32 v[216:217], v[216:217], s[20:21]
 v_pk_mul_f32 v[218:219], v[218:219], s[20:21]
 v_exp_f32 v210, v210
 v_mfma_f32_16x16x32_bf16 v[220:223], a[244:247], a[76:79], v[232:235]
 s_waitcnt lgkmcnt(9)
 ds_read_b128 a[228:231], v244 offset:19904
 v_cvt_pk_bf16_f32 v148, v208, v209
 v_mfma_f32_16x16x32_bf16 v[220:223], a[240:243], a[72:75], v[220:223]
 s_waitcnt lgkmcnt(9)
 v_exp_f32 v211, v211
 v_mfma_f32_16x16x32_bf16 v[220:223], a[236:239], a[68:71], v[220:223]
 s_waitcnt lgkmcnt(8)
 ds_read_b64_tr_b16 a[200:201], v245 offset:0
 v_cvt_pk_bf16_f32 v149, v210, v211
 v_mfma_f32_16x16x32_bf16 v[220:223], a[232:235], a[64:67], v[220:223]
 s_waitcnt lgkmcnt(7)
 v_exp_f32 v212, v212
 v_mfma_f32_16x16x32_bf16 v[52:55], a[212:215], v[140:143], 0
 s_waitcnt lgkmcnt(5)
 v_exp_f32 v213, v213
 v_mfma_f32_16x16x32_bf16 v[52:55], a[208:211], v[136:139], v[52:55]
 s_waitcnt lgkmcnt(4)
 ds_read_b64_tr_b16 a[202:203], v245 offset:1024
 v_cvt_pk_bf16_f32 v150, v212, v213
 v_exp_f32 v214, v214
 v_exp_f32 v215, v215
 v_pk_mul_f32 v[220:221], v[220:221], s[20:21]
 v_pk_mul_f32 v[222:223], v[222:223], s[20:21]
 v_cvt_pk_bf16_f32 v151, v214, v215
 v_mfma_f32_16x16x32_bf16 v[208:211], a[216:219], a[64:67], v[232:235]
 s_waitcnt lgkmcnt(4)
 v_exp_f32 v216, v216
 v_mfma_f32_16x16x32_bf16 v[208:211], a[220:223], a[68:71], v[208:211]
 s_waitcnt lgkmcnt(3)
 ds_read_b64_tr_b16 a[204:205], v245 offset:2048
 ds_read_b64_tr_b16 a[206:207], v245 offset:3072
 v_mfma_f32_16x16x32_bf16 v[208:211], a[224:227], a[72:75], v[208:211]
 s_waitcnt lgkmcnt(4)
 v_exp_f32 v217, v217
 v_mfma_f32_16x16x32_bf16 v[208:211], a[228:231], a[76:79], v[208:211]
 ds_read_b64_tr_b16 a[208:209], v245 offset:8
 v_cvt_pk_bf16_f32 v184, v216, v217
 v_mfma_f32_16x16x32_bf16 a[116:119], a[132:135], v[136:139], 0
 s_add_u32 s38, s27, 32768
 v_exp_f32 v218, v218
 v_mfma_f32_16x16x32_bf16 a[116:119], a[132:135], v[140:143], a[116:119]
 s_waitcnt vmcnt(12)
 v_exp_f32 v219, v219
 v_exp_f32 v220, v220
 v_cvt_pk_bf16_f32 v185, v218, v219
 v_pk_mul_f32 v[208:209], v[208:209], s[20:21]
 v_pk_mul_f32 v[210:211], v[210:211], s[20:21]
 v_exp_f32 v221, v221
 v_mfma_f32_16x16x32_bf16 v[212:215], a[136:139], a[80:83], 0
 s_add_u32 m0, s23, 32832
 ds_read_b64_tr_b16 a[210:211], v245 offset:1032
 v_cvt_pk_bf16_f32 v186, v220, v221
 v_mfma_f32_16x16x32_bf16 v[212:215], a[140:143], a[84:87], v[212:215]
 ds_read_b64_tr_b16 a[212:213], v245 offset:2056
 ds_read_b64_tr_b16 a[214:215], v245 offset:3080
 v_mfma_f32_16x16x32_bf16 v[212:215], a[144:147], a[88:91], v[212:215]
 buffer_load_dwordx4 v250, s[12:15], s38 offen offset:0 lds
 v_mfma_f32_16x16x32_bf16 v[212:215], a[148:151], a[92:95], v[212:215]
 s_waitcnt lgkmcnt(6)
 buffer_load_dwordx4 v250, s[12:15], s38 offen offset:1024 lds
 v_mfma_f32_16x16x32_bf16 v[64:67], a[200:203], v[144:147], 0
 s_waitcnt lgkmcnt(4)
 buffer_load_dwordx4 v250, s[12:15], s38 offen offset:2048 lds
 v_mfma_f32_16x16x32_bf16 v[64:67], a[204:207], v[148:151], v[64:67]
 s_add_u32 s37, s27, 65536
 buffer_load_dwordx4 v250, s[12:15], s38 offen offset:3072 lds
 v_max3_f32 v193, v212, v213, v214
 v_max_f32 v192, v193, v215
 v_max_f32 v193, v193, v215
 s_nop 1
 v_permlane32_swap_b32 v192, v193
 v_max_f32 v194, v192, v193
 v_max_f32 v195, v192, v193
 s_nop 1
 v_permlane16_swap_b32 v194, v195
 v_max_f32 v192, v194, v195
 v_sub_f32 v236, s59, v192
 v_sub_f32 v237, s59, v192
 v_sub_f32 v238, s59, v192
 v_sub_f32 v239, s59, v192
 s_nop 1
 v_mfma_f32_16x16x32_bf16 v[216:219], a[164:167], a[92:95], v[236:239]
 s_add_u32 m0, s22, 1024
 ds_read_b64_tr_b16 a[200:201], v246 offset:0
 v_add_f32 v212, v236, v212
 v_mfma_f32_16x16x32_bf16 v[216:219], a[160:163], a[88:91], v[216:219]
 ds_read_b64_tr_b16 a[202:203], v246 offset:1024
 v_add_f32 v213, v237, v213
 v_exp_f32 v222, v222
 v_exp_f32 v223, v223
 v_pk_add_f32 v[214:215], v[214:215], v[238:239]
 v_pk_mul_f32 v[212:213], v[212:213], s[20:21]
 v_pk_mul_f32 v[214:215], v[214:215], s[20:21]
 v_cvt_pk_bf16_f32 v187, v222, v223
 v_mfma_f32_16x16x32_bf16 v[216:219], a[156:159], a[84:87], v[216:219]
 buffer_load_dwordx4 v249, s[8:11], s37 offen offset:0 lds
 ds_read_b64_tr_b16 a[204:205], v246 offset:2048
 ds_read_b64_tr_b16 a[206:207], v246 offset:3072
 v_mfma_f32_16x16x32_bf16 v[216:219], a[152:155], a[80:83], v[216:219]
 s_waitcnt lgkmcnt(6)
 buffer_load_dwordx4 v249, s[8:11], s37 offen offset:1024 lds
 v_mfma_f32_16x16x32_bf16 v[68:71], a[208:211], v[144:147], 0
 s_waitcnt lgkmcnt(4)
 v_exp_f32 v208, v208
 v_mfma_f32_16x16x32_bf16 v[68:71], a[212:215], v[148:151], v[68:71]
 buffer_load_dwordx4 v249, s[8:11], s37 offen offset:2048 lds
 v_mfma_f32_16x16x32_bf16 v[220:223], a[168:171], a[80:83], v[236:239]
 buffer_load_dwordx4 v249, s[8:11], s37 offen offset:3072 lds
 v_exp_f32 v209, v209
 v_pk_mul_f32 v[216:217], v[216:217], s[20:21]
 v_pk_mul_f32 v[218:219], v[218:219], s[20:21]
 v_exp_f32 v210, v210
 v_mfma_f32_16x16x32_bf16 v[220:223], a[172:175], a[84:87], v[220:223]
 ds_read_b64_tr_b16 a[208:209], v246 offset:8
 v_cvt_pk_bf16_f32 v188, v208, v209
 ds_read_b64_tr_b16 a[210:211], v246 offset:1032
 v_mfma_f32_16x16x32_bf16 v[220:223], a[176:179], a[88:91], v[220:223]
 ds_read_b64_tr_b16 a[212:213], v246 offset:2056
 ds_read_b64_tr_b16 a[214:215], v246 offset:3080
 v_mfma_f32_16x16x32_bf16 v[220:223], a[180:183], a[92:95], v[220:223]
 s_waitcnt lgkmcnt(6)
 ds_read_b128 a[216:219], v244 offset:17664
 ds_read_b128 a[220:223], v244 offset:17728
 v_mfma_f32_16x16x32_bf16 v[72:75], a[200:203], v[144:147], 0
 s_waitcnt lgkmcnt(6)
 v_exp_f32 v211, v211
 v_mfma_f32_16x16x32_bf16 v[72:75], a[204:207], v[148:151], v[72:75]
 ds_read_b128 a[224:227], v244 offset:17792
 v_cvt_pk_bf16_f32 v189, v210, v211
 v_exp_f32 v212, v212
 v_exp_f32 v213, v213
 v_pk_mul_f32 v[220:221], v[220:221], s[20:21]
 v_pk_mul_f32 v[222:223], v[222:223], s[20:21]
 v_exp_f32 v214, v214
 v_mfma_f32_16x16x32_bf16 v[208:211], a[196:199], a[92:95], v[236:239]
 ds_read_b128 a[228:231], v244 offset:17856
 v_cvt_pk_bf16_f32 v152, v212, v213
 v_mfma_f32_16x16x32_bf16 v[208:211], a[192:195], a[88:91], v[208:211]
 ds_read_b64_tr_b16 a[200:201], v247 offset:0
 ds_read_b64_tr_b16 a[202:203], v247 offset:1024
 v_mfma_f32_16x16x32_bf16 v[208:211], a[188:191], a[84:87], v[208:211]
 ds_read_b64_tr_b16 a[204:205], v247 offset:2048
 ds_read_b64_tr_b16 a[206:207], v247 offset:3072
 v_mfma_f32_16x16x32_bf16 v[208:211], a[184:187], a[80:83], v[208:211]
 s_waitcnt lgkmcnt(10)
 ds_read_b128 a[244:247], v244 offset:18880
 ds_read_b128 a[240:243], v244 offset:18816
 v_mfma_f32_16x16x32_bf16 v[76:79], a[208:211], v[144:147], 0
 s_waitcnt lgkmcnt(10)
 v_exp_f32 v215, v215
 v_mfma_f32_16x16x32_bf16 v[76:79], a[212:215], v[148:151], v[76:79]
 s_waitcnt lgkmcnt(9)
 ds_read_b128 a[236:239], v244 offset:18752
 v_cvt_pk_bf16_f32 v153, v214, v215
 v_exp_f32 v216, v216
 v_exp_f32 v217, v217
 v_pk_mul_f32 v[208:209], v[208:209], s[20:21]
 v_pk_mul_f32 v[210:211], v[210:211], s[20:21]
 v_exp_f32 v218, v218
 v_mfma_f32_16x16x32_bf16 v[212:215], a[216:219], a[80:83], v[236:239]
 s_waitcnt lgkmcnt(9)
 ds_read_b128 a[232:235], v244 offset:18688
 v_cvt_pk_bf16_f32 v154, v216, v217
 v_mfma_f32_16x16x32_bf16 v[212:215], a[220:223], a[84:87], v[212:215]
 s_waitcnt lgkmcnt(9)
 ds_read_b64_tr_b16 a[208:209], v247 offset:8
 ds_read_b64_tr_b16 a[210:211], v247 offset:1032
 v_mfma_f32_16x16x32_bf16 v[212:215], a[224:227], a[88:91], v[212:215]
 s_waitcnt lgkmcnt(10)
 ds_read_b64_tr_b16 a[212:213], v247 offset:2056
 ds_read_b64_tr_b16 a[214:215], v247 offset:3080
 v_mfma_f32_16x16x32_bf16 v[212:215], a[228:231], a[92:95], v[212:215]
 s_waitcnt lgkmcnt(10)
 ds_read_b128 a[216:219], v244 offset:19712
 ds_read_b128 a[220:223], v244 offset:19776
 v_mfma_f32_16x16x32_bf16 v[80:83], a[200:203], v[144:147], 0
 s_waitcnt lgkmcnt(10)
 v_exp_f32 v219, v219
 v_mfma_f32_16x16x32_bf16 v[80:83], a[204:207], v[148:151], v[80:83]
 s_waitcnt lgkmcnt(9)
 ds_read_b128 a[224:227], v244 offset:19840
 v_cvt_pk_bf16_f32 v155, v218, v219
 v_exp_f32 v220, v220
 v_exp_f32 v221, v221
 v_pk_mul_f32 v[212:213], v[212:213], s[20:21]
 v_pk_mul_f32 v[214:215], v[214:215], s[20:21]
 v_exp_f32 v222, v222
 v_mfma_f32_16x16x32_bf16 v[216:219], a[244:247], a[92:95], v[236:239]
 s_waitcnt lgkmcnt(9)
 ds_read_b128 a[228:231], v244 offset:19904
 v_cvt_pk_bf16_f32 v156, v220, v221
 v_mfma_f32_16x16x32_bf16 v[216:219], a[240:243], a[88:91], v[216:219]
 s_waitcnt lgkmcnt(9)
 v_exp_f32 v223, v223
 v_mfma_f32_16x16x32_bf16 v[216:219], a[236:239], a[84:87], v[216:219]
 s_waitcnt lgkmcnt(8)
 ds_read_b128 a[236:239], v244 offset:20800
 v_cvt_pk_bf16_f32 v157, v222, v223
 v_mfma_f32_16x16x32_bf16 v[216:219], a[232:235], a[80:83], v[216:219]
 s_waitcnt lgkmcnt(7)
 ds_read_b128 a[232:235], v244 offset:20736
 ds_read_b128 a[240:243], v244 offset:20864
 v_mfma_f32_16x16x32_bf16 v[84:87], a[208:211], v[144:147], 0
 s_waitcnt lgkmcnt(7)
 v_exp_f32 v208, v208
 v_mfma_f32_16x16x32_bf16 v[84:87], a[212:215], v[148:151], v[84:87]
 s_waitcnt lgkmcnt(6)
 ds_read_b128 a[244:247], v244 offset:20928
 v_mul_f32 v216, s20, v216
 v_mfma_f32_16x16x32_bf16 v[220:223], a[216:219], a[80:83], v[236:239]
 s_waitcnt lgkmcnt(6)
 ds_read_b64_tr_b16 a[188:189], v245 offset:2048
 v_mul_f32 v217, s20, v217
 v_mfma_f32_16x16x32_bf16 v[220:223], a[220:223], a[84:87], v[220:223]
 s_waitcnt lgkmcnt(6)
 ds_read_b64_tr_b16 a[190:191], v245 offset:3072
 v_mul_f32 v218, s20, v218
 v_mfma_f32_16x16x32_bf16 v[220:223], a[224:227], a[88:91], v[220:223]
 s_waitcnt lgkmcnt(6)
 ds_read_b64_tr_b16 a[184:185], v245 offset:0
 v_mul_f32 v219, s20, v219
 ds_read_b64_tr_b16 a[186:187], v245 offset:1024
 v_mfma_f32_16x16x32_bf16 v[220:223], a[228:231], a[92:95], v[220:223]
 v_exp_f32 v209, v209
 v_mfma_f32_16x16x32_bf16 a[120:123], a[132:135], v[144:147], 0
 s_add_u32 m0, s62, 0
 v_exp_f32 v210, v210
 v_exp_f32 v211, v211
 v_mfma_f32_16x16x32_bf16 a[120:123], a[132:135], v[148:151], a[120:123]
 s_waitcnt lgkmcnt(6)
 ds_read_b64_tr_b16 a[192:193], v245 offset:8
 v_cvt_pk_bf16_f32 v158, v208, v209
 v_cvt_pk_bf16_f32 v159, v210, v211
 v_exp_f32 v212, v212
 v_pk_mul_f32 v[220:221], v[220:221], s[20:21]
 v_pk_mul_f32 v[222:223], v[222:223], s[20:21]
 v_exp_f32 v213, v213
 v_mfma_f32_16x16x32_bf16 v[208:211], a[232:235], a[32:35], v[224:227]
 ds_read_b64_tr_b16 a[194:195], v245 offset:1032
 v_cvt_pk_bf16_f32 v192, v212, v213
 ds_read_b64_tr_b16 a[196:197], v245 offset:2056
 ds_read_b64_tr_b16 a[198:199], v245 offset:3080
 ds_read_b64_tr_b16 a[248:249], v246 offset:0
 ds_read_b64_tr_b16 a[250:251], v246 offset:1024
 ds_read_b64_tr_b16 a[252:253], v246 offset:2048
 ds_read_b64_tr_b16 a[254:255], v246 offset:3072
 ds_read_b64_tr_b16 a[168:169], v248 offset:0
 ds_read_b64_tr_b16 a[170:171], v248 offset:1024
 ds_read_b64_tr_b16 a[172:173], v248 offset:2048
 ds_read_b64_tr_b16 a[174:175], v248 offset:3072
 ds_read_b64_tr_b16 a[176:177], v248 offset:8
 ds_read_b64_tr_b16 a[178:179], v248 offset:1032
 ds_read_b64_tr_b16 a[180:181], v248 offset:2056
 ds_read_b64_tr_b16 a[182:183], v248 offset:3080
 ds_read_b64_tr_b16 a[200:201], v246 offset:8
 ds_read_b64_tr_b16 a[202:203], v246 offset:1032
 ds_read_b64_tr_b16 a[204:205], v246 offset:2056
 ds_read_b64_tr_b16 a[206:207], v246 offset:3080
 ds_read_b64_tr_b16 a[208:209], v247 offset:0
 ds_read_b64_tr_b16 a[210:211], v247 offset:1024
 ds_read_b64_tr_b16 a[212:213], v247 offset:2048
 ds_read_b64_tr_b16 a[214:215], v247 offset:3072
 ds_read_b64_tr_b16 a[216:217], v247 offset:8
 ds_read_b64_tr_b16 a[218:219], v247 offset:1032
 ds_read_b64_tr_b16 a[220:221], v247 offset:2056
 ds_read_b64_tr_b16 a[222:223], v247 offset:3080
 v_mfma_f32_16x16x32_bf16 v[208:211], a[236:239], a[36:39], v[208:211]
 s_waitcnt lgkmcnt(15)
 buffer_load_dwordx4 v251, s[4:7], s32 offen offset:0 lds
 v_mfma_f32_16x16x32_bf16 v[208:211], a[240:243], a[40:43], v[208:211]
 s_add_u32 m0, s62, 960
 v_exp_f32 v214, v214
 v_mfma_f32_16x16x32_bf16 v[208:211], a[244:247], a[44:47], v[208:211]
 buffer_load_dwordx4 v251, s[4:7], s32 offen offset:64 lds
 v_mfma_f32_16x16x32_bf16 v[96:99], a[188:191], v[156:159], 0
 v_exp_f32 v215, v215
 v_mfma_f32_16x16x32_bf16 v[96:99], a[184:187], v[152:155], v[96:99]
 v_cvt_pk_bf16_f32 v193, v214, v215
 v_mfma_f32_16x16x32_bf16 v[212:215], a[244:247], a[60:63], v[228:231]
 v_exp_f32 v216, v216
 v_mfma_f32_16x16x32_bf16 v[212:215], a[240:243], a[56:59], v[212:215]
 v_exp_f32 v217, v217
 v_exp_f32 v218, v218
 v_exp_f32 v219, v219
 v_pk_mul_f32 v[208:209], v[208:209], s[20:21]
 v_pk_mul_f32 v[210:211], v[210:211], s[20:21]
 v_cvt_pk_bf16_f32 v194, v216, v217
 v_mfma_f32_16x16x32_bf16 v[212:215], a[236:239], a[52:55], v[212:215]
 s_waitcnt vmcnt(14) lgkmcnt(0)
 ds_inc_u32 v249, v252
 v_cvt_pk_bf16_f32 v195, v218, v219
 v_mfma_f32_16x16x32_bf16 v[212:215], a[232:235], a[48:51], v[212:215]
 s_add_u32 s2, s2, 4
 v_exp_f32 v220, v220
 v_mfma_f32_16x16x32_bf16 v[100:103], a[196:199], v[156:159], 0
 v_exp_f32 v221, v221
 v_mfma_f32_16x16x32_bf16 v[100:103], a[192:195], v[152:155], v[100:103]
 v_exp_f32 v222, v222
 v_mfma_f32_16x16x32_bf16 v[216:219], a[232:235], a[64:67], v[232:235]
 v_exp_f32 v223, v223
 v_cvt_pk_bf16_f32 v196, v220, v221
 v_cvt_pk_bf16_f32 v197, v222, v223
 v_exp_f32 v208, v208
 v_pk_mul_f32 v[212:213], v[212:213], s[20:21]
 v_pk_mul_f32 v[214:215], v[214:215], s[20:21]
 v_exp_f32 v209, v209
 v_mfma_f32_16x16x32_bf16 v[216:219], a[236:239], a[68:71], v[216:219]
 v_exp_f32 v210, v210
 v_mfma_f32_16x16x32_bf16 v[216:219], a[240:243], a[72:75], v[216:219]
 v_exp_f32 v211, v211
 v_mfma_f32_16x16x32_bf16 v[216:219], a[244:247], a[76:79], v[216:219]
 v_exp_f32 v212, v212
 v_mfma_f32_16x16x32_bf16 v[104:107], a[252:255], v[156:159], 0
 v_exp_f32 v213, v213
 v_mfma_f32_16x16x32_bf16 v[104:107], a[248:251], v[152:155], v[104:107]
 v_exp_f32 v214, v214
 v_mfma_f32_16x16x32_bf16 v[220:223], a[244:247], a[92:95], v[236:239]
 v_cvt_pk_bf16_f32 v174, v208, v209
 v_cvt_pk_bf16_f32 v175, v210, v211
 v_mfma_f32_16x16x32_bf16 v[220:223], a[240:243], a[88:91], v[220:223]
 v_cvt_pk_bf16_f32 v182, v212, v213
 v_mfma_f32_16x16x32_bf16 v[220:223], a[236:239], a[84:87], v[220:223]
 v_mfma_f32_16x16x32_bf16 v[220:223], a[232:235], a[80:83], v[220:223]
 v_mfma_f32_16x16x32_bf16 v[108:111], a[204:207], v[156:159], 0
 v_mfma_f32_16x16x32_bf16 v[108:111], a[200:203], v[152:155], v[108:111]
 ds_read_b32 v199, v249
 v_mfma_f32_16x16x32_bf16 v[112:115], a[212:215], v[156:159], 0
 v_mfma_f32_16x16x32_bf16 v[112:115], a[208:211], v[152:155], v[112:115]
 v_mfma_f32_16x16x32_bf16 v[116:119], a[220:223], v[156:159], 0
 v_mfma_f32_16x16x32_bf16 v[116:119], a[216:219], v[152:155], v[116:119]
 v_mfma_f32_16x16x32_bf16 v[24:27], a[168:171], v[128:131], 0
 v_mfma_f32_16x16x32_bf16 v[24:27], a[172:175], v[132:135], v[24:27]
 v_mfma_f32_16x16x32_bf16 v[56:59], a[172:175], v[140:143], 0
 s_waitcnt lgkmcnt(0)
 v_cmp_gt_u32 vcc, s2, v199
 v_mfma_f32_16x16x32_bf16 v[56:59], a[168:171], v[136:139], v[56:59]
 v_mfma_f32_16x16x32_bf16 v[88:91], a[168:171], v[144:147], 0
 s_cbranch_vccnz Lspin4f_1
Lback4f_1:
 s_add_u32 s38, s27, 49152
 s_waitcnt lgkmcnt(0)
 s_nop 7
 s_branch Lback4_1
.p2align 6
L_blk5:
 v_mfma_f32_16x16x32_bf16 v[208:211], a[136:139], a[32:35], 0
 s_add_u32 s55, s24, 1
 ds_write_b128 v253, v[20:23] offset:0
 v_mfma_f32_16x16x32_bf16 v[208:211], a[140:143], a[36:39], v[208:211]
 s_lshl_b32 s52, s55, 5
 v_mfma_f32_16x16x32_bf16 v[208:211], a[144:147], a[40:43], v[208:211]
 s_add_u32 s52, s52, s25
 v_mfma_f32_16x16x32_bf16 v[208:211], a[148:151], a[44:47], v[208:211]
 s_mul_i32 s53, s52, 43691
 ds_write_b128 v254, v[28:31] offset:0
 v_mfma_f32_16x16x32_bf16 v[212:215], a[148:151], a[60:63], 0
 s_lshr_b32 s53, s53, 17
 ds_read_b128 v[24:27], v252 offset:0
 ds_read_b128 v[28:31], v252 offset:1024
 v_mfma_f32_16x16x32_bf16 v[212:215], a[144:147], a[56:59], v[212:215]
 s_mul_i32 s54, s53, 3
 v_max3_f32 v169, v208, v209, v210
 v_max_f32 v168, v169, v211
 v_max_f32 v169, v169, v211
 v_mfma_f32_16x16x32_bf16 v[212:215], a[140:143], a[52:55], v[212:215]
 s_sub_u32 s54, s52, s54
 ds_write_b128 v253, v[52:55] offset:2048
 v_permlane32_swap_b32 v168, v169
 v_max_f32 v170, v168, v169
 v_max_f32 v171, v168, v169
 v_mfma_f32_16x16x32_bf16 v[212:215], a[136:139], a[48:51], v[212:215]
 s_lshl_b32 s53, s53, 3
 v_permlane16_swap_b32 v170, v171
 v_max_f32 v168, v170, v171
 v_sub_f32 v224, s59, v168
 v_sub_f32 v225, s59, v168
 v_sub_f32 v226, s59, v168
 v_sub_f32 v227, s59, v168
 v_pk_add_f32 v[208:209], v[208:209], v[224:225]
 v_pk_add_f32 v[210:211], v[210:211], v[226:227]
 v_pk_mul_f32 v[208:209], v[208:209], s[20:21]
 v_pk_mul_f32 v[210:211], v[210:211], s[20:21]
 v_max3_f32 v177, v212, v213, v214
 v_mfma_f32_16x16x32_bf16 v[216:219], a[152:155], a[32:35], v[224:227]
 s_add_u32 s53, s53, s26
 v_exp_f32 v208, v208
 v_mfma_f32_16x16x32_bf16 v[216:219], a[156:159], a[36:39], v[216:219]
 s_cmp_eq_u32 s54, 0
 ds_write_b128 v254, v[60:63] offset:2048
 v_mfma_f32_16x16x32_bf16 v[216:219], a[160:163], a[40:43], v[216:219]
 s_cselect_b32 s52, s46, s47
 ds_read_b128 v[56:59], v252 offset:2048
 v_max_f32 v176, v177, v215
 v_mfma_f32_16x16x32_bf16 v[216:219], a[164:167], a[44:47], v[216:219]
 s_cselect_b32 s31, 1, 0
 ds_read_b128 v[60:63], v252 offset:3072
 v_max_f32 v177, v177, v215
 v_mfma_f32_16x16x32_bf16 v[220:223], a[180:183], a[44:47], v[224:227]
 s_lshl_b32 s28, s53, 17
 ds_write_b128 v253, v[84:87] offset:4096
 v_mfma_f32_16x16x32_bf16 v[220:223], a[176:179], a[40:43], v[220:223]
 s_cmp_eq_u32 s54, 2
 v_exp_f32 v209, v209
 v_exp_f32 v210, v210
 v_exp_f32 v211, v211
 v_pk_mul_f32 v[216:217], v[216:217], s[20:21]
 v_pk_mul_f32 v[218:219], v[218:219], s[20:21]
 v_permlane32_swap_b32 v176, v177
 v_mfma_f32_16x16x32_bf16 v[220:223], a[172:175], a[36:39], v[220:223]
 s_cselect_b32 s52, s48, s52
 v_cvt_pk_bf16_f32 v128, v208, v209
 v_cvt_pk_bf16_f32 v129, v210, v211
 v_mfma_f32_16x16x32_bf16 v[220:223], a[168:171], a[32:35], v[220:223]
 s_cselect_b32 s31, s49, s31
 ds_write_b128 v254, v[92:95] offset:4096
 v_max_f32 v178, v176, v177
 v_max_f32 v179, v176, v177
 v_mfma_f32_16x16x32_bf16 v[208:211], a[184:187], a[32:35], v[224:227]
 s_mul_i32 s53, s53, 217088
 ds_read_b128 v[88:91], v252 offset:4096
 v_permlane16_swap_b32 v178, v179
 v_max_f32 v176, v178, v179
 v_sub_f32 v228, s59, v176
 v_sub_f32 v229, s59, v176
 v_pk_add_f32 v[212:213], v[212:213], v[228:229]
 v_pk_mul_f32 v[212:213], v[212:213], s[20:21]
 v_pk_mul_f32 v[220:221], v[220:221], s[20:21]
 v_pk_mul_f32 v[222:223], v[222:223], s[20:21]
 v_sub_f32 v230, s59, v176
 v_mfma_f32_16x16x32_bf16 v[208:211], a[188:191], a[36:39], v[208:211]
 s_add_u32 s30, s53, s52
 ds_read_b128 v[92:95], v252 offset:5120
 v_sub_f32 v231, s59, v176
 v_add_f32 v214, v230, v214
 v_add_f32 v215, v231, v215
 v_mfma_f32_16x16x32_bf16 v[208:211], a[192:195], a[40:43], v[208:211]
 s_cmp_ge_u32 s55, 6
 ds_write_b128 v253, v[116:119] offset:6144
 v_mul_f32 v214, s20, v214
 v_mul_f32 v215, s20, v215
 v_exp_f32 v212, v212
 v_exp_f32 v213, v213
 v_exp_f32 v214, v214
 v_exp_f32 v215, v215
 v_mfma_f32_16x16x32_bf16 v[208:211], a[196:199], a[44:47], v[208:211]
 s_waitcnt vmcnt(8)
 v_cvt_pk_bf16_f32 v136, v212, v213
 v_cvt_pk_bf16_f32 v137, v214, v215
 v_mfma_f32_16x16x32_bf16 v[212:215], a[148:151], a[76:79], 0
 s_cselect_b32 s30, 117440512, s30
 v_exp_f32 v216, v216
 v_mfma_f32_16x16x32_bf16 v[212:215], a[144:147], a[72:75], v[212:215]
 s_cselect_b32 s28, 67108864, s28
 ds_write_b128 v254, v[124:127] offset:6144
 v_exp_f32 v217, v217
 v_pk_mul_f32 v[208:209], v[208:209], s[20:21]
 v_pk_mul_f32 v[210:211], v[210:211], s[20:21]
 v_exp_f32 v218, v218
 v_mfma_f32_16x16x32_bf16 v[212:215], a[140:143], a[68:71], v[212:215]
 s_add_u32 s37, s27, 49152
 v_exp_f32 v219, v219
 v_mfma_f32_16x16x32_bf16 v[212:215], a[136:139], a[64:67], v[212:215]
 s_add_u32 m0, s22, 50944
 ds_read_b128 v[120:123], v252 offset:6144
 v_cvt_pk_bf16_f32 v130, v216, v217
 v_cvt_pk_bf16_f32 v131, v218, v219
 v_mfma_f32_16x16x32_bf16 v[216:219], a[152:155], a[48:51], v[228:231]
 s_add_u32 s36, s30, 16384
 ds_read_b128 v[124:127], v252 offset:7168
 v_mfma_f32_16x16x32_bf16 v[216:219], a[156:159], a[52:55], v[216:219]
 s_cmp_eq_u32 s31, 0
 v_exp_f32 v220, v220
 v_mfma_f32_16x16x32_bf16 v[216:219], a[160:163], a[56:59], v[216:219]
 s_cselect_b32 s36, 117440512, s36
 v_exp_f32 v221, v221
 v_exp_f32 v222, v222
 v_exp_f32 v223, v223
 v_mfma_f32_16x16x32_bf16 v[216:219], a[164:167], a[60:63], v[216:219]
 s_mov_b32 s32, s30
 buffer_load_dwordx4 v249, s[8:11], s37 offen offset:0 lds
 v_cvt_pk_bf16_f32 v132, v220, v221
 v_cvt_pk_bf16_f32 v133, v222, v223
 v_mfma_f32_16x16x32_bf16 v[220:223], a[180:183], a[60:63], v[228:231]
 s_add_u32 s33, s30, 4096
 v_max3_f32 v185, v212, v213, v214
 v_max_f32 v184, v185, v215
 v_exp_f32 v208, v208
 v_exp_f32 v209, v209
 v_pk_mul_f32 v[216:217], v[216:217], s[20:21]
 v_pk_mul_f32 v[218:219], v[218:219], s[20:21]
 v_exp_f32 v210, v210
 v_mfma_f32_16x16x32_bf16 v[220:223], a[176:179], a[56:59], v[220:223]
 s_add_u32 s34, s30, 8192
 v_exp_f32 v211, v211
 v_mfma_f32_16x16x32_bf16 v[220:223], a[172:175], a[52:55], v[220:223]
 ds_inc_u32 v249, v252
 v_max_f32 v185, v185, v215
 v_mfma_f32_16x16x32_bf16 v[220:223], a[168:171], a[48:51], v[220:223]
 s_add_u32 s2, s2, 4
 v_permlane32_swap_b32 v184, v185
 v_cvt_pk_bf16_f32 v134, v208, v209
 v_cvt_pk_bf16_f32 v135, v210, v211
 v_max_f32 v186, v184, v185
 v_max_f32 v187, v184, v185
 v_mfma_f32_16x16x32_bf16 v[208:211], a[184:187], a[48:51], v[228:231]
 s_add_u32 s35, s30, 12288
 s_waitcnt lgkmcnt(14)
 buffer_store_dwordx4 v[24:27], v255, s[16:19], s50 offen offset:128 nt
 v_permlane16_swap_b32 v186, v187
 s_waitcnt lgkmcnt(13)
 buffer_store_dwordx4 v[28:31], v255, s[16:19], s50 offen offset:2176 nt
 v_max_f32 v184, v186, v187
 v_pk_mul_f32 v[220:221], v[220:221], s[20:21]
 v_pk_mul_f32 v[222:223], v[222:223], s[20:21]
 v_sub_f32 v232, s59, v184
 v_mfma_f32_16x16x32_bf16 v[208:211], a[188:191], a[52:55], v[208:211]
 s_add_u32 s40, s29, 0
 buffer_load_dwordx4 v249, s[8:11], s37 offen offset:1024 lds
 v_sub_f32 v233, s59, v184
 v_sub_f32 v234, s59, v184
 v_sub_f32 v235, s59, v184
 v_add_f32 v212, v232, v212
 v_add_f32 v213, v233, v213
 v_add_f32 v214, v234, v214
 v_add_f32 v215, v235, v215
 v_mfma_f32_16x16x32_bf16 v[208:211], a[192:195], a[56:59], v[208:211]
 s_add_u32 s41, s29, 4096
 v_mul_f32 v212, s20, v212
 v_mul_f32 v213, s20, v213
 v_mul_f32 v214, s20, v214
 v_mul_f32 v215, s20, v215
 v_exp_f32 v212, v212
 v_exp_f32 v213, v213
 v_exp_f32 v214, v214
 v_exp_f32 v215, v215
 v_mfma_f32_16x16x32_bf16 v[208:211], a[196:199], a[60:63], v[208:211]
 s_waitcnt vmcnt(8)
 v_cvt_pk_bf16_f32 v144, v212, v213
 v_cvt_pk_bf16_f32 v145, v214, v215
 v_mfma_f32_16x16x32_bf16 v[212:215], a[148:151], a[92:95], 0
 s_add_u32 s42, s29, 8192
 v_exp_f32 v216, v216
 v_mfma_f32_16x16x32_bf16 v[212:215], a[144:147], a[88:91], v[212:215]
 s_add_u32 s43, s29, 12288
 v_exp_f32 v217, v217
 v_exp_f32 v218, v218
 v_exp_f32 v219, v219
 v_pk_mul_f32 v[208:209], v[208:209], s[20:21]
 v_pk_mul_f32 v[210:211], v[210:211], s[20:21]
 v_cvt_pk_bf16_f32 v138, v216, v217
 v_mfma_f32_16x16x32_bf16 v[212:215], a[140:143], a[84:87], v[212:215]
 s_add_u32 s44, s29, 16384
 v_cvt_pk_bf16_f32 v139, v218, v219
 v_mfma_f32_16x16x32_bf16 v[212:215], a[136:139], a[80:83], v[212:215]
 s_lshl_b32 s63, 1, s24
 buffer_load_dwordx4 v249, s[8:11], s37 offen offset:2048 lds
 v_mfma_f32_16x16x32_bf16 v[216:219], a[152:155], a[64:67], v[232:235]
 s_mov_b32 s29, s30
 v_exp_f32 v220, v220
 v_mfma_f32_16x16x32_bf16 v[216:219], a[156:159], a[68:71], v[216:219]
 v_exp_f32 v221, v221
 v_mfma_f32_16x16x32_bf16 v[216:219], a[160:163], a[72:75], v[216:219]
 v_exp_f32 v222, v222
 v_exp_f32 v223, v223
 v_mfma_f32_16x16x32_bf16 v[216:219], a[164:167], a[76:79], v[216:219]
 v_cvt_pk_bf16_f32 v140, v220, v221
 v_cvt_pk_bf16_f32 v141, v222, v223
 v_mfma_f32_16x16x32_bf16 v[220:223], a[180:183], a[76:79], v[232:235]
 v_max3_f32 v193, v212, v213, v214
 v_max_f32 v192, v193, v215
 v_mfma_f32_16x16x32_bf16 v[220:223], a[176:179], a[72:75], v[220:223]
 buffer_load_dwordx4 v249, s[8:11], s37 offen offset:3072 lds
 v_mfma_f32_16x16x32_bf16 v[220:223], a[172:175], a[68:71], v[220:223]
 v_exp_f32 v208, v208
 v_exp_f32 v209, v209
 v_exp_f32 v210, v210
 v_exp_f32 v211, v211
 v_max_f32 v193, v193, v215
 v_pk_mul_f32 v[216:217], v[216:217], s[20:21]
 v_pk_mul_f32 v[218:219], v[218:219], s[20:21]
 v_permlane32_swap_b32 v192, v193
 v_mfma_f32_16x16x32_bf16 v[220:223], a[168:171], a[64:67], v[220:223]
 v_cvt_pk_bf16_f32 v142, v208, v209
 v_cvt_pk_bf16_f32 v143, v210, v211
 v_max_f32 v194, v192, v193
 v_max_f32 v195, v192, v193
 v_mfma_f32_16x16x32_bf16 v[208:211], a[184:187], a[64:67], v[232:235]
 v_exp_f32 v216, v216
 v_permlane16_swap_b32 v194, v195
 v_max_f32 v192, v194, v195
 v_sub_f32 v236, s59, v192
 v_pk_mul_f32 v[220:221], v[220:221], s[20:21]
 v_pk_mul_f32 v[222:223], v[222:223], s[20:21]
 v_sub_f32 v237, s59, v192
 v_mfma_f32_16x16x32_bf16 v[208:211], a[188:191], a[68:71], v[208:211]
 v_sub_f32 v238, s59, v192
 v_sub_f32 v239, s59, v192
 v_add_f32 v212, v236, v212
 v_add_f32 v213, v237, v213
 v_add_f32 v214, v238, v214
 v_add_f32 v215, v239, v215
 v_mfma_f32_16x16x32_bf16 v[208:211], a[192:195], a[72:75], v[208:211]
 v_mul_f32 v212, s20, v212
 v_mul_f32 v213, s20, v213
 v_mul_f32 v214, s20, v214
 v_mul_f32 v215, s20, v215
 v_exp_f32 v212, v212
 v_exp_f32 v213, v213
 v_exp_f32 v214, v214
 v_exp_f32 v215, v215
 v_mfma_f32_16x16x32_bf16 v[208:211], a[196:199], a[76:79], v[208:211]
 s_waitcnt vmcnt(6)
 v_cvt_pk_bf16_f32 v152, v212, v213
 v_cvt_pk_bf16_f32 v153, v214, v215
 v_mfma_f32_16x16x32_bf16 v[212:215], a[148:151], a[108:111], 0
 v_exp_f32 v217, v217
 v_mfma_f32_16x16x32_bf16 v[212:215], a[144:147], a[104:107], v[212:215]
 ds_read_b32 v207, v249
 v_cvt_pk_bf16_f32 v146, v216, v217
 v_exp_f32 v218, v218
 v_exp_f32 v219, v219
 v_pk_mul_f32 v[208:209], v[208:209], s[20:21]
 v_pk_mul_f32 v[210:211], v[210:211], s[20:21]
 v_cvt_pk_bf16_f32 v147, v218, v219
 v_mfma_f32_16x16x32_bf16 v[212:215], a[140:143], a[100:103], v[212:215]
 v_exp_f32 v220, v220
 v_mfma_f32_16x16x32_bf16 v[212:215], a[136:139], a[96:99], v[212:215]
 v_exp_f32 v221, v221
 v_mfma_f32_16x16x32_bf16 v[216:219], a[152:155], a[80:83], v[236:239]
 s_waitcnt lgkmcnt(2)
 v_exp_f32 v222, v222
 v_mfma_f32_16x16x32_bf16 v[216:219], a[156:159], a[84:87], v[216:219]
 v_exp_f32 v223, v223
 v_mfma_f32_16x16x32_bf16 v[216:219], a[160:163], a[88:91], v[216:219]
 v_cvt_pk_bf16_f32 v148, v220, v221
 v_cvt_pk_bf16_f32 v149, v222, v223
 v_mfma_f32_16x16x32_bf16 v[216:219], a[164:167], a[92:95], v[216:219]
 v_exp_f32 v208, v208
 v_mfma_f32_16x16x32_bf16 v[220:223], a[180:183], a[92:95], v[236:239]
 s_waitcnt lgkmcnt(0)
 v_cmp_gt_u32 vcc, s2, v207
 v_max3_f32 v201, v212, v213, v214
 v_mfma_f32_16x16x32_bf16 v[220:223], a[176:179], a[88:91], v[220:223]
 s_add_u32 s38, s27, 16384
 v_max_f32 v200, v201, v215
 v_max_f32 v201, v201, v215
 v_exp_f32 v209, v209
 v_exp_f32 v210, v210
 v_pk_mul_f32 v[216:217], v[216:217], s[20:21]
 v_pk_mul_f32 v[218:219], v[218:219], s[20:21]
 v_exp_f32 v211, v211
 v_mfma_f32_16x16x32_bf16 v[220:223], a[172:175], a[84:87], v[220:223]
 s_cbranch_vccnz Lspin5_0
Lback5_0:
 ds_read_b128 a[136:139], v244 offset:17664
 v_permlane32_swap_b32 v200, v201
 v_mfma_f32_16x16x32_bf16 v[220:223], a[168:171], a[80:83], v[220:223]
 s_add_u32 m0, s23, 16416
 ds_read_b128 a[140:143], v244 offset:17728
 v_cvt_pk_bf16_f32 v150, v208, v209
 v_cvt_pk_bf16_f32 v151, v210, v211
 v_max_f32 v202, v200, v201
 v_max_f32 v203, v200, v201
 v_mfma_f32_16x16x32_bf16 v[208:211], a[184:187], a[80:83], v[236:239]
 buffer_load_dwordx4 v250, s[12:15], s38 offen offset:0 lds
 v_permlane16_swap_b32 v202, v203
 v_max_f32 v200, v202, v203
 v_pk_mul_f32 v[220:221], v[220:221], s[20:21]
 v_pk_mul_f32 v[222:223], v[222:223], s[20:21]
 v_sub_f32 v240, s59, v200
 v_mfma_f32_16x16x32_bf16 v[208:211], a[188:191], a[84:87], v[208:211]
 buffer_store_dwordx4 v[56:59], v255, s[16:19], s51 offen offset:128 nt
 v_sub_f32 v241, s59, v200
 v_sub_f32 v242, s59, v200
 v_sub_f32 v243, s59, v200
 buffer_store_dwordx4 v[60:63], v255, s[16:19], s51 offen offset:2176 nt
 v_add_f32 v212, v240, v212
 v_add_f32 v213, v241, v213
 v_add_f32 v214, v242, v214
 v_add_f32 v215, v243, v215
 v_mfma_f32_16x16x32_bf16 v[208:211], a[192:195], a[88:91], v[208:211]
 ds_read_b128 a[144:147], v244 offset:17792
 v_mul_f32 v212, s20, v212
 v_mul_f32 v213, s20, v213
 v_mul_f32 v214, s20, v214
 v_mul_f32 v215, s20, v215
 v_exp_f32 v212, v212
 v_exp_f32 v213, v213
 v_exp_f32 v214, v214
 v_exp_f32 v215, v215
 v_mfma_f32_16x16x32_bf16 v[208:211], a[196:199], a[92:95], v[208:211]
 ds_read_b128 a[148:151], v244 offset:17856
 v_cvt_pk_bf16_f32 v160, v212, v213
 v_cvt_pk_bf16_f32 v161, v214, v215
 v_mfma_f32_16x16x32_bf16 v[212:215], a[164:167], a[108:111], v[240:243]
 buffer_load_dwordx4 v250, s[12:15], s38 offen offset:1024 lds
 v_mfma_f32_16x16x32_bf16 v[212:215], a[160:163], a[104:107], v[212:215]
 v_exp_f32 v216, v216
 v_mfma_f32_16x16x32_bf16 v[212:215], a[156:159], a[100:103], v[212:215]
 v_exp_f32 v217, v217
 v_exp_f32 v218, v218
 v_exp_f32 v219, v219
 v_pk_mul_f32 v[208:209], v[208:209], s[20:21]
 v_pk_mul_f32 v[210:211], v[210:211], s[20:21]
 v_cvt_pk_bf16_f32 v154, v216, v217
 v_mfma_f32_16x16x32_bf16 v[212:215], a[152:155], a[96:99], v[212:215]
 ds_read_b64_tr_b16 a[200:201], v245 offset:0
 v_cvt_pk_bf16_f32 v155, v218, v219
 v_mfma_f32_16x16x32_bf16 v[216:219], a[168:171], a[96:99], v[240:243]
 buffer_load_dwordx4 v250, s[12:15], s38 offen offset:2048 lds
 v_mfma_f32_16x16x32_bf16 v[216:219], a[172:175], a[100:103], v[216:219]
 v_exp_f32 v220, v220
 v_mfma_f32_16x16x32_bf16 v[216:219], a[176:179], a[104:107], v[216:219]
 v_exp_f32 v221, v221
 v_exp_f32 v222, v222
 v_exp_f32 v223, v223
 v_pk_mul_f32 v[212:213], v[212:213], s[20:21]
 v_pk_mul_f32 v[214:215], v[214:215], s[20:21]
 v_cvt_pk_bf16_f32 v156, v220, v221
 v_mfma_f32_16x16x32_bf16 v[216:219], a[180:183], a[108:111], v[216:219]
 ds_read_b64_tr_b16 a[202:203], v245 offset:1024
 v_cvt_pk_bf16_f32 v157, v222, v223
 v_mfma_f32_16x16x32_bf16 v[220:223], a[196:199], a[108:111], v[240:243]
 buffer_load_dwordx4 v250, s[12:15], s38 offen offset:3072 lds
 v_mfma_f32_16x16x32_bf16 v[220:223], a[192:195], a[104:107], v[220:223]
 v_exp_f32 v208, v208
 v_mfma_f32_16x16x32_bf16 v[220:223], a[188:191], a[100:103], v[220:223]
 v_exp_f32 v209, v209
 v_exp_f32 v210, v210
 v_exp_f32 v211, v211
 v_pk_mul_f32 v[216:217], v[216:217], s[20:21]
 v_pk_mul_f32 v[218:219], v[218:219], s[20:21]
 v_cvt_pk_bf16_f32 v158, v208, v209
 v_mfma_f32_16x16x32_bf16 v[220:223], a[184:187], a[96:99], v[220:223]
 s_waitcnt lgkmcnt(5)
 ds_read_b64_tr_b16 a[204:205], v245 offset:2048
 v_cvt_pk_bf16_f32 v159, v210, v211
 v_mfma_f32_16x16x32_bf16 v[208:211], a[136:139], a[32:35], v[224:227]
 s_waitcnt lgkmcnt(5)
 v_exp_f32 v212, v212
 v_mfma_f32_16x16x32_bf16 v[208:211], a[140:143], a[36:39], v[208:211]
 s_waitcnt lgkmcnt(4)
 v_exp_f32 v213, v213
 v_exp_f32 v214, v214
 v_exp_f32 v215, v215
 v_pk_mul_f32 v[220:221], v[220:221], s[20:21]
 v_pk_mul_f32 v[222:223], v[222:223], s[20:21]
 v_cvt_pk_bf16_f32 v162, v212, v213
 v_mfma_f32_16x16x32_bf16 v[208:211], a[144:147], a[40:43], v[208:211]
 s_waitcnt lgkmcnt(3)
 ds_read_b64_tr_b16 a[206:207], v245 offset:3072
 v_cvt_pk_bf16_f32 v163, v214, v215
 v_mfma_f32_16x16x32_bf16 v[208:211], a[148:151], a[44:47], v[208:211]
 v_exp_f32 v216, v216
 v_mfma_f32_16x16x32_bf16 v[212:215], a[148:151], a[60:63], v[228:231]
 v_exp_f32 v217, v217
 v_mfma_f32_16x16x32_bf16 v[212:215], a[144:147], a[56:59], v[212:215]
 v_exp_f32 v218, v218
 v_mfma_f32_16x16x32_bf16 v[212:215], a[140:143], a[52:55], v[212:215]
 v_exp_f32 v219, v219
 v_mfma_f32_16x16x32_bf16 v[212:215], a[136:139], a[48:51], v[212:215]
 v_cvt_pk_bf16_f32 v164, v216, v217
 v_cvt_pk_bf16_f32 v165, v218, v219
 v_exp_f32 v220, v220
 v_exp_f32 v221, v221
 v_pk_mul_f32 v[208:209], v[208:209], s[20:21]
 v_pk_mul_f32 v[210:211], v[210:211], s[20:21]
 v_exp_f32 v222, v222
 v_mfma_f32_16x16x32_bf16 v[216:219], a[136:139], a[64:67], v[232:235]
 v_exp_f32 v223, v223
 v_mfma_f32_16x16x32_bf16 v[216:219], a[140:143], a[68:71], v[216:219]
 ds_read_b64_tr_b16 a[208:209], v245 offset:8
 v_cvt_pk_bf16_f32 v166, v220, v221
 v_mfma_f32_16x16x32_bf16 v[216:219], a[144:147], a[72:75], v[216:219]
 ds_read_b64_tr_b16 a[210:211], v245 offset:1032
 v_cvt_pk_bf16_f32 v167, v222, v223
 v_mfma_f32_16x16x32_bf16 v[216:219], a[148:151], a[76:79], v[216:219]
 v_exp_f32 v208, v208
 v_mfma_f32_16x16x32_bf16 v[220:223], a[148:151], a[92:95], v[236:239]
 v_exp_f32 v209, v209
 v_mfma_f32_16x16x32_bf16 v[220:223], a[144:147], a[88:91], v[220:223]
 v_exp_f32 v210, v210
 v_mfma_f32_16x16x32_bf16 v[220:223], a[140:143], a[84:87], v[220:223]
 v_exp_f32 v211, v211
 v_mfma_f32_16x16x32_bf16 v[220:223], a[136:139], a[80:83], v[220:223]
 ds_read_b64_tr_b16 a[212:213], v245 offset:2056
 v_cvt_pk_bf16_f32 v168, v208, v209
 v_cvt_pk_bf16_f32 v169, v210, v211
 v_mfma_f32_16x16x32_bf16 v[208:211], a[136:139], a[96:99], v[240:243]
 ds_read_b64_tr_b16 a[214:215], v245 offset:3080
 v_mul_f32 v212, s20, v212
 v_mfma_f32_16x16x32_bf16 v[208:211], a[140:143], a[100:103], v[208:211]
 ds_read_b128 a[152:155], v244 offset:18688
 v_mul_f32 v213, s20, v213
 v_mfma_f32_16x16x32_bf16 v[208:211], a[144:147], a[104:107], v[208:211]
 ds_read_b128 a[156:159], v244 offset:18752
 v_mul_f32 v214, s20, v214
 v_mfma_f32_16x16x32_bf16 v[208:211], a[148:151], a[108:111], v[208:211]
 s_waitcnt lgkmcnt(8)
 ds_read_b128 a[160:163], v244 offset:18816
 v_mul_f32 v215, s20, v215
 v_mfma_f32_16x16x32_bf16 v[0:3], a[200:203], v[128:131], 0
 s_waitcnt lgkmcnt(7)
 ds_read_b128 a[164:167], v244 offset:18880
 v_mul_f32 v216, s20, v216
 v_mfma_f32_16x16x32_bf16 v[0:3], a[204:207], v[132:135], v[0:3]
 v_exp_f32 v212, v212
 v_mfma_f32_16x16x32_bf16 v[32:35], a[204:207], v[140:143], 0
 v_exp_f32 v213, v213
 v_mfma_f32_16x16x32_bf16 v[32:35], a[200:203], v[136:139], v[32:35]
 v_exp_f32 v214, v214
 v_mfma_f32_16x16x32_bf16 v[64:67], a[200:203], v[144:147], 0
 v_exp_f32 v215, v215
 v_mfma_f32_16x16x32_bf16 v[64:67], a[204:207], v[148:151], v[64:67]
 v_cvt_pk_bf16_f32 v176, v212, v213
 v_cvt_pk_bf16_f32 v177, v214, v215
 v_mfma_f32_16x16x32_bf16 v[96:99], a[204:207], v[156:159], 0
 v_mul_f32 v217, s20, v217
 v_mul_f32 v218, s20, v218
 v_mfma_f32_16x16x32_bf16 v[96:99], a[200:203], v[152:155], v[96:99]
 v_mul_f32 v219, s20, v219
 v_mul_f32 v220, s20, v220
 v_mfma_f32_16x16x32_bf16 a[0:3], a[200:203], v[160:163], 0
 s_add_u32 s37, s27, 65536
 v_exp_f32 v216, v216
 v_mfma_f32_16x16x32_bf16 a[0:3], a[204:207], v[164:167], a[0:3]
 s_waitcnt lgkmcnt(6)
 v_exp_f32 v217, v217
 v_mfma_f32_16x16x32_bf16 v[4:7], a[208:211], v[128:131], 0
 s_waitcnt lgkmcnt(4)
 v_exp_f32 v218, v218
 v_mfma_f32_16x16x32_bf16 v[4:7], a[212:215], v[132:135], v[4:7]
 s_add_u32 m0, s22, 1024
 v_exp_f32 v219, v219
 v_mfma_f32_16x16x32_bf16 v[36:39], a[212:215], v[140:143], 0
 buffer_store_dwordx4 v[88:91], v255, s[16:19], s60 offen offset:128 nt
 buffer_store_dwordx4 v[92:95], v255, s[16:19], s60 offen offset:2176 nt
 v_mfma_f32_16x16x32_bf16 v[36:39], a[208:211], v[136:139], v[36:39]
 buffer_load_dwordx4 v249, s[8:11], s37 offen offset:0 lds
 v_mfma_f32_16x16x32_bf16 v[68:71], a[208:211], v[144:147], 0
 ds_read_b64_tr_b16 a[200:201], v246 offset:0
 v_cvt_pk_bf16_f32 v184, v216, v217
 v_mfma_f32_16x16x32_bf16 v[68:71], a[212:215], v[148:151], v[68:71]
 ds_read_b64_tr_b16 a[202:203], v246 offset:1024
 v_cvt_pk_bf16_f32 v185, v218, v219
 v_mfma_f32_16x16x32_bf16 v[100:103], a[212:215], v[156:159], 0
 ds_read_b64_tr_b16 a[204:205], v246 offset:2048
 v_mul_f32 v221, s20, v221
 v_mfma_f32_16x16x32_bf16 v[100:103], a[208:211], v[152:155], v[100:103]
 ds_read_b64_tr_b16 a[206:207], v246 offset:3072
 v_mul_f32 v222, s20, v222
 v_mfma_f32_16x16x32_bf16 a[4:7], a[208:211], v[160:163], 0
 ds_read_b64_tr_b16 a[208:209], v246 offset:8
 v_mul_f32 v223, s20, v223
 v_mfma_f32_16x16x32_bf16 a[4:7], a[212:215], v[164:167], a[4:7]
 v_exp_f32 v220, v220
 v_mfma_f32_16x16x32_bf16 a[112:115], a[132:135], v[128:131], 0
 v_exp_f32 v221, v221
 v_mfma_f32_16x16x32_bf16 a[112:115], a[132:135], v[132:135], a[112:115]
 v_exp_f32 v222, v222
 v_mfma_f32_16x16x32_bf16 a[128:131], a[132:135], v[160:163], 0
 v_exp_f32 v223, v223
 v_mfma_f32_16x16x32_bf16 a[128:131], a[132:135], v[164:167], a[128:131]
 s_waitcnt lgkmcnt(8)
 v_cvt_pk_bf16_f32 v192, v220, v221
 v_cvt_pk_bf16_f32 v193, v222, v223
 v_mfma_f32_16x16x32_bf16 v[212:215], a[152:155], a[32:35], v[224:227]
 s_waitcnt lgkmcnt(7)
 buffer_load_dwordx4 v249, s[8:11], s37 offen offset:1024 lds
 v_mfma_f32_16x16x32_bf16 v[212:215], a[156:159], a[36:39], v[212:215]
 s_waitcnt lgkmcnt(6)
 ds_read_b64_tr_b16 a[210:211], v246 offset:1032
 v_mul_f32 v208, s20, v208
 v_mfma_f32_16x16x32_bf16 v[212:215], a[160:163], a[40:43], v[212:215]
 s_waitcnt lgkmcnt(6)
 v_mul_f32 v209, s20, v209
 v_mul_f32 v210, s20, v210
 v_mfma_f32_16x16x32_bf16 v[212:215], a[164:167], a[44:47], v[212:215]
 ds_read_b64_tr_b16 a[212:213], v246 offset:2056
 v_mul_f32 v211, s20, v211
 v_mfma_f32_16x16x32_bf16 v[216:219], a[164:167], a[60:63], v[228:231]
 v_exp_f32 v208, v208
 v_mfma_f32_16x16x32_bf16 v[216:219], a[160:163], a[56:59], v[216:219]
 v_exp_f32 v209, v209
 v_mfma_f32_16x16x32_bf16 v[216:219], a[156:159], a[52:55], v[216:219]
 v_exp_f32 v210, v210
 v_mfma_f32_16x16x32_bf16 v[216:219], a[152:155], a[48:51], v[216:219]
 v_exp_f32 v211, v211
 v_mfma_f32_16x16x32_bf16 v[220:223], a[152:155], a[64:67], v[232:235]
 ds_read_b64_tr_b16 a[214:215], v246 offset:3080
 v_cvt_pk_bf16_f32 v200, v208, v209
 v_mfma_f32_16x16x32_bf16 v[220:223], a[156:159], a[68:71], v[220:223]
 v_cvt_pk_bf16_f32 v201, v210, v211
 v_mul_f32 v212, s20, v212
 v_mfma_f32_16x16x32_bf16 v[220:223], a[160:163], a[72:75], v[220:223]
 v_mul_f32 v213, s20, v213
 v_mul_f32 v214, s20, v214
 v_mfma_f32_16x16x32_bf16 v[220:223], a[164:167], a[76:79], v[220:223]
 ds_read_b128 a[136:139], v244 offset:19712
 v_mul_f32 v215, s20, v215
 v_mfma_f32_16x16x32_bf16 v[208:211], a[164:167], a[92:95], v[236:239]
 buffer_load_dwordx4 v249, s[8:11], s37 offen offset:2048 lds
 v_mfma_f32_16x16x32_bf16 v[208:211], a[160:163], a[88:91], v[208:211]
 v_exp_f32 v212, v212
 v_mfma_f32_16x16x32_bf16 v[208:211], a[156:159], a[84:87], v[208:211]
 v_exp_f32 v213, v213
 v_exp_f32 v214, v214
 v_exp_f32 v215, v215
 v_pk_mul_f32 v[216:217], v[216:217], s[20:21]
 v_pk_mul_f32 v[218:219], v[218:219], s[20:21]
 v_pk_mul_f32 v[220:221], v[220:221], s[20:21]
 v_pk_mul_f32 v[222:223], v[222:223], s[20:21]
 v_cvt_pk_bf16_f32 v170, v212, v213
 v_mfma_f32_16x16x32_bf16 v[208:211], a[152:155], a[80:83], v[208:211]
 ds_read_b128 a[140:143], v244 offset:19776
 v_cvt_pk_bf16_f32 v171, v214, v215
 v_mfma_f32_16x16x32_bf16 v[212:215], a[152:155], a[96:99], v[240:243]
 v_exp_f32 v216, v216
 v_mfma_f32_16x16x32_bf16 v[212:215], a[156:159], a[100:103], v[212:215]
 v_exp_f32 v217, v217
 v_mfma_f32_16x16x32_bf16 v[212:215], a[160:163], a[104:107], v[212:215]
 ds_read_b128 a[144:147], v244 offset:19840
 v_cvt_pk_bf16_f32 v178, v216, v217
 v_mfma_f32_16x16x32_bf16 v[212:215], a[164:167], a[108:111], v[212:215]
 s_waitcnt lgkmcnt(9)
 ds_read_b128 a[148:151], v244 offset:19904
 v_mul_f32 v208, s20, v208
 v_mfma_f32_16x16x32_bf16 v[8:11], a[200:203], v[128:131], 0
 s_waitcnt lgkmcnt(8)
 v_exp_f32 v218, v218
 v_mfma_f32_16x16x32_bf16 v[8:11], a[204:207], v[132:135], v[8:11]
 v_exp_f32 v219, v219
 v_mfma_f32_16x16x32_bf16 v[40:43], a[204:207], v[140:143], 0
 v_cvt_pk_bf16_f32 v179, v218, v219
 v_mul_f32 v209, s20, v209
 v_mfma_f32_16x16x32_bf16 v[40:43], a[200:203], v[136:139], v[40:43]
 v_exp_f32 v220, v220
 v_mfma_f32_16x16x32_bf16 v[72:75], a[200:203], v[144:147], 0
 buffer_load_dwordx4 v249, s[8:11], s37 offen offset:3072 lds
 v_mfma_f32_16x16x32_bf16 v[72:75], a[204:207], v[148:151], v[72:75]
 v_exp_f32 v221, v221
 v_mfma_f32_16x16x32_bf16 v[104:107], a[204:207], v[156:159], 0
 v_exp_f32 v222, v222
 v_mfma_f32_16x16x32_bf16 v[104:107], a[200:203], v[152:155], v[104:107]
 v_exp_f32 v223, v223
 v_mfma_f32_16x16x32_bf16 a[8:11], a[200:203], v[160:163], 0
 ds_read_b64_tr_b16 a[200:201], v247 offset:0
 v_cvt_pk_bf16_f32 v186, v220, v221
 v_mfma_f32_16x16x32_bf16 a[8:11], a[204:207], v[164:167], a[8:11]
 s_waitcnt lgkmcnt(7)
 ds_read_b64_tr_b16 a[202:203], v247 offset:1024
 v_cvt_pk_bf16_f32 v187, v222, v223
 v_mfma_f32_16x16x32_bf16 v[12:15], a[208:211], v[128:131], 0
 s_waitcnt lgkmcnt(6)
 ds_read_b64_tr_b16 a[204:205], v247 offset:2048
 v_mul_f32 v210, s20, v210
 v_mfma_f32_16x16x32_bf16 v[12:15], a[212:215], v[132:135], v[12:15]
 ds_read_b64_tr_b16 a[206:207], v247 offset:3072
 v_mul_f32 v211, s20, v211
 v_mfma_f32_16x16x32_bf16 v[44:47], a[212:215], v[140:143], 0
 v_exp_f32 v208, v208
 v_mfma_f32_16x16x32_bf16 v[44:47], a[208:211], v[136:139], v[44:47]
 v_exp_f32 v209, v209
 v_mfma_f32_16x16x32_bf16 v[76:79], a[208:211], v[144:147], 0
 s_add_u32 m0, s62, 0
 v_exp_f32 v210, v210
 v_mfma_f32_16x16x32_bf16 v[76:79], a[212:215], v[148:151], v[76:79]
 v_exp_f32 v211, v211
 v_mfma_f32_16x16x32_bf16 v[108:111], a[212:215], v[156:159], 0
 buffer_load_dwordx4 v251, s[4:7], s32 offen offset:0 lds
 v_mfma_f32_16x16x32_bf16 v[108:111], a[208:211], v[152:155], v[108:111]
 s_add_u32 m0, s62, 960
 v_cvt_pk_bf16_f32 v194, v208, v209
 v_cvt_pk_bf16_f32 v195, v210, v211
 v_mfma_f32_16x16x32_bf16 a[12:15], a[208:211], v[160:163], 0
 ds_read_b64_tr_b16 a[208:209], v247 offset:8
 v_mul_f32 v212, s20, v212
 v_mfma_f32_16x16x32_bf16 a[12:15], a[212:215], v[164:167], a[12:15]
 buffer_load_dwordx4 v251, s[4:7], s32 offen offset:64 lds
 v_mfma_f32_16x16x32_bf16 a[116:119], a[132:135], v[136:139], 0
 ds_read_b64_tr_b16 a[210:211], v247 offset:1032
 v_mul_f32 v213, s20, v213
 v_mfma_f32_16x16x32_bf16 a[116:119], a[132:135], v[140:143], a[116:119]
 s_waitcnt lgkmcnt(9)
 v_mul_f32 v214, s20, v214
 v_mul_f32 v215, s20, v215
 v_mfma_f32_16x16x32_bf16 v[216:219], a[136:139], a[32:35], v[224:227]
 s_waitcnt lgkmcnt(8)
 v_exp_f32 v212, v212
 v_mfma_f32_16x16x32_bf16 v[216:219], a[140:143], a[36:39], v[216:219]
 s_waitcnt lgkmcnt(7)
 v_exp_f32 v213, v213
 v_mfma_f32_16x16x32_bf16 v[216:219], a[144:147], a[40:43], v[216:219]
 s_waitcnt lgkmcnt(6)
 v_exp_f32 v214, v214
 v_mfma_f32_16x16x32_bf16 v[216:219], a[148:151], a[44:47], v[216:219]
 v_exp_f32 v215, v215
 v_mfma_f32_16x16x32_bf16 v[220:223], a[148:151], a[60:63], v[228:231]
 buffer_store_dwordx4 v[120:123], v255, s[16:19], s61 offen offset:128 nt
 buffer_store_dwordx4 v[124:127], v255, s[16:19], s61 offen offset:2176 nt
 v_mfma_f32_16x16x32_bf16 v[220:223], a[144:147], a[56:59], v[220:223]
 ds_read_b64_tr_b16 a[212:213], v247 offset:2056
 v_cvt_pk_bf16_f32 v202, v212, v213
 v_mfma_f32_16x16x32_bf16 v[220:223], a[140:143], a[52:55], v[220:223]
 ds_read_b64_tr_b16 a[214:215], v247 offset:3080
 v_cvt_pk_bf16_f32 v203, v214, v215
 v_mfma_f32_16x16x32_bf16 v[220:223], a[136:139], a[48:51], v[220:223]
 v_mul_f32 v216, s20, v216
 v_mul_f32 v217, s20, v217
 v_mfma_f32_16x16x32_bf16 v[208:211], a[136:139], a[64:67], v[232:235]
 v_mul_f32 v218, s20, v218
 v_mul_f32 v219, s20, v219
 v_mfma_f32_16x16x32_bf16 v[208:211], a[140:143], a[68:71], v[208:211]
 v_exp_f32 v216, v216
 v_mfma_f32_16x16x32_bf16 v[208:211], a[144:147], a[72:75], v[208:211]
 v_exp_f32 v217, v217
 v_mfma_f32_16x16x32_bf16 v[208:211], a[148:151], a[76:79], v[208:211]
 v_exp_f32 v218, v218
 v_mfma_f32_16x16x32_bf16 v[212:215], a[148:151], a[92:95], v[236:239]
 v_exp_f32 v219, v219
 v_mfma_f32_16x16x32_bf16 v[212:215], a[144:147], a[88:91], v[212:215]
 v_cvt_pk_bf16_f32 v172, v216, v217
 v_cvt_pk_bf16_f32 v173, v218, v219
 v_mfma_f32_16x16x32_bf16 v[212:215], a[140:143], a[84:87], v[212:215]
 ds_read_b64_tr_b16 a[168:169], v248 offset:0
 v_mul_f32 v220, s20, v220
 v_mfma_f32_16x16x32_bf16 v[212:215], a[136:139], a[80:83], v[212:215]
 ds_read_b64_tr_b16 a[170:171], v248 offset:1024
 v_mul_f32 v221, s20, v221
 v_mfma_f32_16x16x32_bf16 v[216:219], a[136:139], a[96:99], v[240:243]
 ds_read_b64_tr_b16 a[172:173], v248 offset:2048
 v_mul_f32 v222, s20, v222
 v_mfma_f32_16x16x32_bf16 v[216:219], a[140:143], a[100:103], v[216:219]
 ds_read_b64_tr_b16 a[174:175], v248 offset:3072
 v_mul_f32 v223, s20, v223
 v_mfma_f32_16x16x32_bf16 v[216:219], a[144:147], a[104:107], v[216:219]
 ds_read_b64_tr_b16 a[176:177], v248 offset:8
 v_mul_f32 v208, s20, v208
 v_mfma_f32_16x16x32_bf16 v[216:219], a[148:151], a[108:111], v[216:219]
 s_waitcnt lgkmcnt(11)
 ds_read_b64_tr_b16 a[178:179], v248 offset:1032
 v_mul_f32 v209, s20, v209
 v_mfma_f32_16x16x32_bf16 v[16:19], a[200:203], v[128:131], 0
 s_waitcnt lgkmcnt(10)
 ds_read_b64_tr_b16 a[180:181], v248 offset:2056
 v_mul_f32 v210, s20, v210
 v_mfma_f32_16x16x32_bf16 v[16:19], a[204:207], v[132:135], v[16:19]
 ds_read_b64_tr_b16 a[182:183], v248 offset:3080
 v_mul_f32 v211, s20, v211
 v_mfma_f32_16x16x32_bf16 v[48:51], a[204:207], v[140:143], 0
 ds_read_b128 a[152:155], v244 offset:20736
 v_mul_f32 v212, s20, v212
 v_mfma_f32_16x16x32_bf16 v[48:51], a[200:203], v[136:139], v[48:51]
 ds_read_b128 a[156:159], v244 offset:20800
 v_mul_f32 v213, s20, v213
 v_mfma_f32_16x16x32_bf16 v[80:83], a[200:203], v[144:147], 0
 ds_read_b128 a[160:163], v244 offset:20864
 v_mul_f32 v214, s20, v214
 v_mfma_f32_16x16x32_bf16 v[80:83], a[204:207], v[148:151], v[80:83]
 ds_read_b128 a[164:167], v244 offset:20928
 v_mul_f32 v215, s20, v215
 v_mfma_f32_16x16x32_bf16 v[112:115], a[204:207], v[156:159], 0
 v_exp_f32 v220, v220
 v_mfma_f32_16x16x32_bf16 v[112:115], a[200:203], v[152:155], v[112:115]
 v_exp_f32 v221, v221
 v_mfma_f32_16x16x32_bf16 a[16:19], a[200:203], v[160:163], 0
 v_exp_f32 v222, v222
 v_mfma_f32_16x16x32_bf16 a[16:19], a[204:207], v[164:167], a[16:19]
 s_waitcnt lgkmcnt(14)
 v_exp_f32 v223, v223
 v_mfma_f32_16x16x32_bf16 v[20:23], a[208:211], v[128:131], 0
 s_waitcnt lgkmcnt(12)
 v_cvt_pk_bf16_f32 v180, v220, v221
 v_cvt_pk_bf16_f32 v181, v222, v223
 v_mfma_f32_16x16x32_bf16 v[20:23], a[212:215], v[132:135], v[20:23]
 v_exp_f32 v208, v208
 v_mfma_f32_16x16x32_bf16 v[52:55], a[212:215], v[140:143], 0
 v_exp_f32 v209, v209
 v_mfma_f32_16x16x32_bf16 v[52:55], a[208:211], v[136:139], v[52:55]
 v_exp_f32 v210, v210
 v_mfma_f32_16x16x32_bf16 v[84:87], a[208:211], v[144:147], 0
 v_exp_f32 v211, v211
 v_mfma_f32_16x16x32_bf16 v[84:87], a[212:215], v[148:151], v[84:87]
 v_cvt_pk_bf16_f32 v188, v208, v209
 v_cvt_pk_bf16_f32 v189, v210, v211
 v_mfma_f32_16x16x32_bf16 v[116:119], a[212:215], v[156:159], 0
 v_exp_f32 v212, v212
 v_mfma_f32_16x16x32_bf16 v[116:119], a[208:211], v[152:155], v[116:119]
 v_exp_f32 v213, v213
 v_mfma_f32_16x16x32_bf16 a[20:23], a[208:211], v[160:163], 0
 s_waitcnt vmcnt(10) lgkmcnt(0)
 ds_inc_u32 v249, v252
 v_cvt_pk_bf16_f32 v196, v212, v213
 v_mfma_f32_16x16x32_bf16 a[20:23], a[212:215], v[164:167], a[20:23]
 s_add_u32 s2, s2, 4
 v_exp_f32 v214, v214
 v_mfma_f32_16x16x32_bf16 a[120:123], a[132:135], v[144:147], 0
 v_exp_f32 v215, v215
 v_mfma_f32_16x16x32_bf16 a[120:123], a[132:135], v[148:151], a[120:123]
 v_cvt_pk_bf16_f32 v197, v214, v215
 v_mul_f32 v216, s20, v216
 v_mfma_f32_16x16x32_bf16 v[220:223], a[152:155], a[32:35], v[224:227]
 v_mul_f32 v217, s20, v217
 v_mul_f32 v218, s20, v218
 v_mfma_f32_16x16x32_bf16 v[220:223], a[156:159], a[36:39], v[220:223]
 v_exp_f32 v216, v216
 v_mfma_f32_16x16x32_bf16 v[220:223], a[160:163], a[40:43], v[220:223]
 v_exp_f32 v217, v217
 v_mfma_f32_16x16x32_bf16 v[220:223], a[164:167], a[44:47], v[220:223]
 v_mul_f32 v219, s20, v219
 v_cvt_pk_bf16_f32 v204, v216, v217
 v_mfma_f32_16x16x32_bf16 v[208:211], a[164:167], a[60:63], v[228:231]
 v_exp_f32 v218, v218
 v_mfma_f32_16x16x32_bf16 v[208:211], a[160:163], a[56:59], v[208:211]
 v_exp_f32 v219, v219
 v_mfma_f32_16x16x32_bf16 v[208:211], a[156:159], a[52:55], v[208:211]
 v_cvt_pk_bf16_f32 v205, v218, v219
 v_mul_f32 v220, s20, v220
 v_mfma_f32_16x16x32_bf16 v[208:211], a[152:155], a[48:51], v[208:211]
 v_mul_f32 v221, s20, v221
 v_mul_f32 v222, s20, v222
 v_mfma_f32_16x16x32_bf16 v[212:215], a[152:155], a[64:67], v[232:235]
 v_exp_f32 v220, v220
 v_mfma_f32_16x16x32_bf16 v[212:215], a[156:159], a[68:71], v[212:215]
 v_exp_f32 v221, v221
 v_mfma_f32_16x16x32_bf16 v[212:215], a[160:163], a[72:75], v[212:215]
 v_mul_f32 v223, s20, v223
 v_cvt_pk_bf16_f32 v174, v220, v221
 v_mfma_f32_16x16x32_bf16 v[212:215], a[164:167], a[76:79], v[212:215]
 v_exp_f32 v222, v222
 v_mfma_f32_16x16x32_bf16 v[216:219], a[164:167], a[92:95], v[236:239]
 v_exp_f32 v223, v223
 v_mfma_f32_16x16x32_bf16 v[216:219], a[160:163], a[88:91], v[216:219]
 v_cvt_pk_bf16_f32 v175, v222, v223
 v_mul_f32 v208, s20, v208
 v_mfma_f32_16x16x32_bf16 v[216:219], a[156:159], a[84:87], v[216:219]
 v_mul_f32 v209, s20, v209
 v_mul_f32 v210, s20, v210
 v_mfma_f32_16x16x32_bf16 v[216:219], a[152:155], a[80:83], v[216:219]
 v_mul_f32 v211, s20, v211
 v_mul_f32 v212, s20, v212
 v_mfma_f32_16x16x32_bf16 v[220:223], a[152:155], a[96:99], v[240:243]
 v_exp_f32 v208, v208
 v_mfma_f32_16x16x32_bf16 v[220:223], a[156:159], a[100:103], v[220:223]
 ds_read_b32 v207, v249
 v_mul_f32 v213, s20, v213
 v_mfma_f32_16x16x32_bf16 v[220:223], a[160:163], a[104:107], v[220:223]
 v_exp_f32 v209, v209
 v_mfma_f32_16x16x32_bf16 v[220:223], a[164:167], a[108:111], v[220:223]
 v_exp_f32 v210, v210
 v_mfma_f32_16x16x32_bf16 v[24:27], a[168:171], v[128:131], 0
 v_exp_f32 v211, v211
 v_mfma_f32_16x16x32_bf16 v[24:27], a[172:175], v[132:135], v[24:27]
 v_cvt_pk_bf16_f32 v182, v208, v209
 v_cvt_pk_bf16_f32 v183, v210, v211
 v_mfma_f32_16x16x32_bf16 v[56:59], a[172:175], v[140:143], 0
 v_mul_f32 v214, s20, v214
 v_mul_f32 v215, s20, v215
 v_mfma_f32_16x16x32_bf16 v[56:59], a[168:171], v[136:139], v[56:59]
 v_exp_f32 v212, v212
 v_mfma_f32_16x16x32_bf16 v[88:91], a[168:171], v[144:147], 0
 s_waitcnt lgkmcnt(0)
 v_cmp_gt_u32 vcc, s2, v207
 v_mul_f32 v216, s20, v216
 v_mfma_f32_16x16x32_bf16 v[88:91], a[172:175], v[148:151], v[88:91]
 s_add_u32 s38, s27, 49152
 v_exp_f32 v213, v213
 v_mfma_f32_16x16x32_bf16 v[120:123], a[172:175], v[156:159], 0
 s_cbranch_vccnz Lspin5_1
Lback5_1:
 ds_read_b128 a[136:139], v244 offset:34304
 v_cvt_pk_bf16_f32 v190, v212, v213
 v_mfma_f32_16x16x32_bf16 v[120:123], a[168:171], v[152:155], v[120:123]
 s_add_u32 m0, s23, 0
 ds_read_b128 a[140:143], v244 offset:34368
 v_mul_f32 v217, s20, v217
 v_mfma_f32_16x16x32_bf16 a[24:27], a[168:171], v[160:163], 0
 buffer_load_dwordx4 v250, s[12:15], s38 offen offset:0 lds
 v_mfma_f32_16x16x32_bf16 a[24:27], a[172:175], v[164:167], a[24:27]
 ds_read_b128 a[144:147], v244 offset:34432
 v_mul_f32 v218, s20, v218
 v_mfma_f32_16x16x32_bf16 v[28:31], a[176:179], v[128:131], 0
 ds_read_b128 a[148:151], v244 offset:34496
 v_mul_f32 v219, s20, v219
 v_mfma_f32_16x16x32_bf16 v[28:31], a[180:183], v[132:135], v[28:31]
 v_exp_f32 v214, v214
 v_mfma_f32_16x16x32_bf16 v[60:63], a[180:183], v[140:143], 0
 v_exp_f32 v215, v215
 v_mfma_f32_16x16x32_bf16 v[60:63], a[176:179], v[136:139], v[60:63]
 ds_read_b64_tr_b16 a[200:201], v245 offset:16416
 v_cvt_pk_bf16_f32 v191, v214, v215
 v_mfma_f32_16x16x32_bf16 v[92:95], a[176:179], v[144:147], 0
 v_exp_f32 v216, v216
 v_mfma_f32_16x16x32_bf16 v[92:95], a[180:183], v[148:151], v[92:95]
 v_exp_f32 v217, v217
 v_mfma_f32_16x16x32_bf16 v[124:127], a[180:183], v[156:159], 0
 v_exp_f32 v218, v218
 v_mfma_f32_16x16x32_bf16 v[124:127], a[176:179], v[152:155], v[124:127]
 v_exp_f32 v219, v219
 v_mfma_f32_16x16x32_bf16 a[28:31], a[176:179], v[160:163], 0
 ds_read_b64_tr_b16 a[202:203], v245 offset:17440
 v_cvt_pk_bf16_f32 v198, v216, v217
 v_mfma_f32_16x16x32_bf16 a[28:31], a[180:183], v[164:167], a[28:31]
 ds_read_b64_tr_b16 a[204:205], v245 offset:18464
 v_cvt_pk_bf16_f32 v199, v218, v219
 v_mfma_f32_16x16x32_bf16 a[124:127], a[132:135], v[152:155], 0
 buffer_load_dwordx4 v250, s[12:15], s38 offen offset:1024 lds
 v_mfma_f32_16x16x32_bf16 a[124:127], a[132:135], v[156:159], a[124:127]
 s_waitcnt lgkmcnt(6)
 ds_read_b64_tr_b16 a[206:207], v245 offset:19488
 v_mul_f32 v220, s20, v220
 v_mfma_f32_16x16x32_bf16 v[208:211], a[136:139], a[32:35], v[224:227]
 s_waitcnt lgkmcnt(6)
 ds_read_b64_tr_b16 a[208:209], v245 offset:16424
 v_mul_f32 v221, s20, v221
 v_mfma_f32_16x16x32_bf16 v[208:211], a[140:143], a[36:39], v[208:211]
 s_waitcnt lgkmcnt(6)
 ds_read_b64_tr_b16 a[210:211], v245 offset:17448
 v_mul_f32 v222, s20, v222
 v_mfma_f32_16x16x32_bf16 v[208:211], a[144:147], a[40:43], v[208:211]
 s_waitcnt lgkmcnt(6)
 ds_read_b64_tr_b16 a[212:213], v245 offset:18472
 v_mul_f32 v223, s20, v223
 v_mfma_f32_16x16x32_bf16 v[208:211], a[148:151], a[44:47], v[208:211]
 v_exp_f32 v220, v220
 v_mfma_f32_16x16x32_bf16 v[212:215], a[148:151], a[60:63], v[228:231]
 v_exp_f32 v221, v221
 v_mfma_f32_16x16x32_bf16 v[212:215], a[144:147], a[56:59], v[212:215]
 v_exp_f32 v222, v222
 v_mfma_f32_16x16x32_bf16 v[212:215], a[140:143], a[52:55], v[212:215]
 v_exp_f32 v223, v223
 v_mfma_f32_16x16x32_bf16 v[212:215], a[136:139], a[48:51], v[212:215]
 ds_read_b64_tr_b16 a[214:215], v245 offset:19496
 v_cvt_pk_bf16_f32 v206, v220, v221
 v_mfma_f32_16x16x32_bf16 v[216:219], a[136:139], a[64:67], v[232:235]
 v_cvt_pk_bf16_f32 v207, v222, v223
 v_mul_f32 v208, s20, v208
 v_mfma_f32_16x16x32_bf16 v[216:219], a[140:143], a[68:71], v[216:219]
 v_mul_f32 v209, s20, v209
 v_mul_f32 v210, s20, v210
 v_mfma_f32_16x16x32_bf16 v[216:219], a[144:147], a[72:75], v[216:219]
 buffer_load_dwordx4 v250, s[12:15], s38 offen offset:2048 lds
 v_mfma_f32_16x16x32_bf16 v[216:219], a[148:151], a[76:79], v[216:219]
 ds_read_b128 a[152:155], v244 offset:35328
 v_mul_f32 v211, s20, v211
 v_mfma_f32_16x16x32_bf16 v[220:223], a[148:151], a[92:95], v[236:239]
 v_exp_f32 v208, v208
 v_mfma_f32_16x16x32_bf16 v[220:223], a[144:147], a[88:91], v[220:223]
 v_exp_f32 v209, v209
 v_mfma_f32_16x16x32_bf16 v[220:223], a[140:143], a[84:87], v[220:223]
 v_exp_f32 v210, v210
 v_exp_f32 v211, v211
 v_cvt_pk_bf16_f32 v128, v208, v209
 v_pk_mul_f32 v[212:213], v[212:213], s[20:21]
 v_pk_mul_f32 v[214:215], v[214:215], s[20:21]
 v_pk_mul_f32 v[216:217], v[216:217], s[20:21]
 v_pk_mul_f32 v[218:219], v[218:219], s[20:21]
 v_cvt_pk_bf16_f32 v129, v210, v211
 v_mfma_f32_16x16x32_bf16 v[220:223], a[136:139], a[80:83], v[220:223]
 v_exp_f32 v212, v212
 v_mfma_f32_16x16x32_bf16 v[208:211], a[136:139], a[96:99], v[240:243]
 v_exp_f32 v213, v213
 v_mfma_f32_16x16x32_bf16 v[208:211], a[140:143], a[100:103], v[208:211]
 ds_read_b128 a[156:159], v244 offset:35392
 v_cvt_pk_bf16_f32 v136, v212, v213
 v_mfma_f32_16x16x32_bf16 v[208:211], a[144:147], a[104:107], v[208:211]
 v_exp_f32 v214, v214
 v_mfma_f32_16x16x32_bf16 v[208:211], a[148:151], a[108:111], v[208:211]
 s_waitcnt lgkmcnt(8)
 ds_read_b128 a[160:163], v244 offset:35456
 v_mul_f32 v220, s20, v220
 v_mfma_f32_16x16x32_bf16 v[0:3], a[200:203], v[168:171], v[0:3]
 s_waitcnt lgkmcnt(7)
 ds_read_b128 a[164:167], v244 offset:35520
 v_mul_f32 v221, s20, v221
 v_mfma_f32_16x16x32_bf16 v[0:3], a[204:207], v[172:175], v[0:3]
 v_exp_f32 v215, v215
 v_mfma_f32_16x16x32_bf16 v[32:35], a[204:207], v[180:183], v[32:35]
 buffer_load_dwordx4 v250, s[12:15], s38 offen offset:3072 lds
 v_mfma_f32_16x16x32_bf16 v[32:35], a[200:203], v[176:179], v[32:35]
 v_cvt_pk_bf16_f32 v137, v214, v215
 v_mul_f32 v222, s20, v222
 v_mfma_f32_16x16x32_bf16 v[64:67], a[200:203], v[184:187], v[64:67]
 v_exp_f32 v216, v216
 v_mfma_f32_16x16x32_bf16 v[64:67], a[204:207], v[188:191], v[64:67]
 v_exp_f32 v217, v217
 v_mfma_f32_16x16x32_bf16 v[96:99], a[204:207], v[196:199], v[96:99]
 v_exp_f32 v218, v218
 v_mfma_f32_16x16x32_bf16 v[96:99], a[200:203], v[192:195], v[96:99]
 v_exp_f32 v219, v219
 v_mfma_f32_16x16x32_bf16 a[0:3], a[200:203], v[200:203], a[0:3]
 ds_read_b64_tr_b16 a[200:201], v246 offset:16416
 v_cvt_pk_bf16_f32 v144, v216, v217
 v_mfma_f32_16x16x32_bf16 a[0:3], a[204:207], v[204:207], a[0:3]
 s_waitcnt lgkmcnt(7)
 ds_read_b64_tr_b16 a[202:203], v246 offset:17440
 v_cvt_pk_bf16_f32 v145, v218, v219
 v_mfma_f32_16x16x32_bf16 v[4:7], a[208:211], v[168:171], v[4:7]
 s_waitcnt lgkmcnt(6)
 ds_read_b64_tr_b16 a[204:205], v246 offset:18464
 v_mul_f32 v223, s20, v223
 v_mfma_f32_16x16x32_bf16 v[4:7], a[212:215], v[172:175], v[4:7]
 s_add_u32 s37, s27, 81920
 v_exp_f32 v220, v220
 v_mfma_f32_16x16x32_bf16 v[36:39], a[212:215], v[180:183], v[36:39]
 s_add_u32 m0, s22, 17664
 v_exp_f32 v221, v221
 v_mfma_f32_16x16x32_bf16 v[36:39], a[208:211], v[176:179], v[36:39]
 v_exp_f32 v222, v222
 v_mfma_f32_16x16x32_bf16 v[68:71], a[208:211], v[184:187], v[68:71]
 buffer_load_dwordx4 v249, s[8:11], s37 offen offset:0 lds
 v_mfma_f32_16x16x32_bf16 v[68:71], a[212:215], v[188:191], v[68:71]
 v_exp_f32 v223, v223
 v_mfma_f32_16x16x32_bf16 v[100:103], a[212:215], v[196:199], v[100:103]
 ds_read_b64_tr_b16 a[206:207], v246 offset:19488
 v_cvt_pk_bf16_f32 v152, v220, v221
 v_mfma_f32_16x16x32_bf16 v[100:103], a[208:211], v[192:195], v[100:103]
 v_cvt_pk_bf16_f32 v153, v222, v223
 v_mul_f32 v208, s20, v208
 v_mfma_f32_16x16x32_bf16 a[4:7], a[208:211], v[200:203], a[4:7]
 ds_read_b64_tr_b16 a[208:209], v246 offset:16424
 v_mul_f32 v209, s20, v209
 v_mfma_f32_16x16x32_bf16 a[4:7], a[212:215], v[204:207], a[4:7]
 ds_read_b64_tr_b16 a[210:211], v246 offset:17448
 v_mul_f32 v210, s20, v210
 v_mfma_f32_16x16x32_bf16 a[112:115], a[132:135], v[168:171], a[112:115]
 ds_read_b64_tr_b16 a[212:213], v246 offset:18472
 v_mul_f32 v211, s20, v211
 v_mfma_f32_16x16x32_bf16 a[112:115], a[132:135], v[172:175], a[112:115]
 v_exp_f32 v208, v208
 v_mfma_f32_16x16x32_bf16 a[128:131], a[132:135], v[200:203], a[128:131]
 v_exp_f32 v209, v209
 v_mfma_f32_16x16x32_bf16 a[128:131], a[132:135], v[204:207], a[128:131]
 s_waitcnt lgkmcnt(10)
 v_exp_f32 v210, v210
 v_mfma_f32_16x16x32_bf16 v[212:215], a[152:155], a[32:35], v[224:227]
 s_waitcnt lgkmcnt(9)
 v_exp_f32 v211, v211
 v_mfma_f32_16x16x32_bf16 v[212:215], a[156:159], a[36:39], v[212:215]
 s_waitcnt lgkmcnt(8)
 ds_read_b64_tr_b16 a[214:215], v246 offset:19496
 v_cvt_pk_bf16_f32 v160, v208, v209
 v_mfma_f32_16x16x32_bf16 v[212:215], a[160:163], a[40:43], v[212:215]
 s_waitcnt lgkmcnt(8)
 buffer_load_dwordx4 v249, s[8:11], s37 offen offset:1024 lds
 v_mfma_f32_16x16x32_bf16 v[212:215], a[164:167], a[44:47], v[212:215]
 ds_read_b128 a[136:139], v244 offset:36352
 v_cvt_pk_bf16_f32 v161, v210, v211
 v_mfma_f32_16x16x32_bf16 v[216:219], a[164:167], a[60:63], v[228:231]
 ds_read_b128 a[140:143], v244 offset:36416
 ds_read_b128 a[144:147], v244 offset:36480
 v_mfma_f32_16x16x32_bf16 v[216:219], a[160:163], a[56:59], v[216:219]
 ds_read_b128 a[148:151], v244 offset:36544
 ds_read_b64_tr_b16 a[168:169], v248 offset:16416
 v_mfma_f32_16x16x32_bf16 v[216:219], a[156:159], a[52:55], v[216:219]
 v_mul_f32 v212, s20, v212
 v_mul_f32 v213, s20, v213
 v_mfma_f32_16x16x32_bf16 v[216:219], a[152:155], a[48:51], v[216:219]
 v_mul_f32 v214, s20, v214
 v_mul_f32 v215, s20, v215
 v_mfma_f32_16x16x32_bf16 v[220:223], a[152:155], a[64:67], v[232:235]
 v_exp_f32 v212, v212
 v_mfma_f32_16x16x32_bf16 v[220:223], a[156:159], a[68:71], v[220:223]
 v_exp_f32 v213, v213
 v_mfma_f32_16x16x32_bf16 v[220:223], a[160:163], a[72:75], v[220:223]
 v_exp_f32 v214, v214
 v_mfma_f32_16x16x32_bf16 v[220:223], a[164:167], a[76:79], v[220:223]
 v_exp_f32 v215, v215
 v_mfma_f32_16x16x32_bf16 v[208:211], a[164:167], a[92:95], v[236:239]
 v_cvt_pk_bf16_f32 v130, v212, v213
 v_cvt_pk_bf16_f32 v131, v214, v215
 v_mfma_f32_16x16x32_bf16 v[208:211], a[160:163], a[88:91], v[208:211]
 v_mul_f32 v216, s20, v216
 v_mul_f32 v217, s20, v217
 v_mfma_f32_16x16x32_bf16 v[208:211], a[156:159], a[84:87], v[208:211]
 buffer_load_dwordx4 v249, s[8:11], s37 offen offset:2048 lds
 v_mfma_f32_16x16x32_bf16 v[208:211], a[152:155], a[80:83], v[208:211]
 v_mul_f32 v218, s20, v218
 v_mul_f32 v219, s20, v219
 v_mfma_f32_16x16x32_bf16 v[212:215], a[152:155], a[96:99], v[240:243]
 v_exp_f32 v216, v216
 v_mfma_f32_16x16x32_bf16 v[212:215], a[156:159], a[100:103], v[212:215]
 v_exp_f32 v217, v217
 v_mfma_f32_16x16x32_bf16 v[212:215], a[160:163], a[104:107], v[212:215]
 v_exp_f32 v218, v218
 v_mfma_f32_16x16x32_bf16 v[212:215], a[164:167], a[108:111], v[212:215]
 s_waitcnt lgkmcnt(11)
 v_exp_f32 v219, v219
 v_mfma_f32_16x16x32_bf16 v[8:11], a[200:203], v[168:171], v[8:11]
 s_waitcnt lgkmcnt(9)
 v_cvt_pk_bf16_f32 v138, v216, v217
 v_cvt_pk_bf16_f32 v139, v218, v219
 v_mfma_f32_16x16x32_bf16 v[8:11], a[204:207], v[172:175], v[8:11]
 v_mul_f32 v220, s20, v220
 v_mul_f32 v221, s20, v221
 v_mfma_f32_16x16x32_bf16 v[40:43], a[204:207], v[180:183], v[40:43]
 v_mul_f32 v222, s20, v222
 v_mul_f32 v223, s20, v223
 v_mfma_f32_16x16x32_bf16 v[40:43], a[200:203], v[176:179], v[40:43]
 v_exp_f32 v220, v220
 v_mfma_f32_16x16x32_bf16 v[72:75], a[200:203], v[184:187], v[72:75]
 v_exp_f32 v221, v221
 v_mfma_f32_16x16x32_bf16 v[72:75], a[204:207], v[188:191], v[72:75]
 v_exp_f32 v222, v222
 v_mfma_f32_16x16x32_bf16 v[104:107], a[204:207], v[196:199], v[104:107]
 buffer_load_dwordx4 v249, s[8:11], s37 offen offset:3072 lds
 v_mfma_f32_16x16x32_bf16 v[104:107], a[200:203], v[192:195], v[104:107]
 v_exp_f32 v223, v223
 v_mfma_f32_16x16x32_bf16 a[8:11], a[200:203], v[200:203], a[8:11]
 ds_read_b64_tr_b16 a[200:201], v247 offset:16416
 v_cvt_pk_bf16_f32 v146, v220, v221
 v_mfma_f32_16x16x32_bf16 a[8:11], a[204:207], v[204:207], a[8:11]
 s_waitcnt lgkmcnt(8)
 ds_read_b64_tr_b16 a[202:203], v247 offset:17440
 v_cvt_pk_bf16_f32 v147, v222, v223
 v_mfma_f32_16x16x32_bf16 v[12:15], a[208:211], v[168:171], v[12:15]
 s_waitcnt lgkmcnt(7)
 ds_read_b64_tr_b16 a[204:205], v247 offset:18464
 v_mul_f32 v208, s20, v208
 v_mfma_f32_16x16x32_bf16 v[12:15], a[212:215], v[172:175], v[12:15]
 ds_read_b64_tr_b16 a[206:207], v247 offset:19488
 v_mul_f32 v209, s20, v209
 v_mfma_f32_16x16x32_bf16 v[44:47], a[212:215], v[180:183], v[44:47]
 v_mul_f32 v210, s20, v210
 v_mul_f32 v211, s20, v211
 v_mfma_f32_16x16x32_bf16 v[44:47], a[208:211], v[176:179], v[44:47]
 v_exp_f32 v208, v208
 v_mfma_f32_16x16x32_bf16 v[76:79], a[208:211], v[184:187], v[76:79]
 v_exp_f32 v209, v209
 v_mfma_f32_16x16x32_bf16 v[76:79], a[212:215], v[188:191], v[76:79]
 v_exp_f32 v210, v210
 v_mfma_f32_16x16x32_bf16 v[108:111], a[212:215], v[196:199], v[108:111]
 s_add_u32 m0, s62, 1920
 v_exp_f32 v211, v211
 v_mfma_f32_16x16x32_bf16 v[108:111], a[208:211], v[192:195], v[108:111]
 v_cvt_pk_bf16_f32 v154, v208, v209
 v_cvt_pk_bf16_f32 v155, v210, v211
 v_mfma_f32_16x16x32_bf16 a[12:15], a[208:211], v[200:203], a[12:15]
 buffer_load_dwordx4 v251, s[4:7], s32 offen offset:128 lds
 v_mfma_f32_16x16x32_bf16 a[12:15], a[212:215], v[204:207], a[12:15]
 s_add_u32 m0, s62, 2880
 ds_read_b64_tr_b16 a[208:209], v247 offset:16424
 v_mul_f32 v212, s20, v212
 v_mfma_f32_16x16x32_bf16 a[116:119], a[132:135], v[176:179], a[116:119]
 ds_read_b64_tr_b16 a[210:211], v247 offset:17448
 v_mul_f32 v213, s20, v213
 v_mfma_f32_16x16x32_bf16 a[116:119], a[132:135], v[180:183], a[116:119]
 s_waitcnt lgkmcnt(10)
 buffer_load_dwordx4 v251, s[4:7], s32 offen offset:192 lds
 v_mfma_f32_16x16x32_bf16 v[216:219], a[136:139], a[32:35], v[224:227]
 s_waitcnt lgkmcnt(9)
 v_mul_f32 v214, s20, v214
 v_mul_f32 v215, s20, v215
 v_mfma_f32_16x16x32_bf16 v[216:219], a[140:143], a[36:39], v[216:219]
 s_waitcnt lgkmcnt(8)
 v_exp_f32 v212, v212
 v_mfma_f32_16x16x32_bf16 v[216:219], a[144:147], a[40:43], v[216:219]
 s_waitcnt lgkmcnt(7)
 v_exp_f32 v213, v213
 v_mfma_f32_16x16x32_bf16 v[216:219], a[148:151], a[44:47], v[216:219]
 v_exp_f32 v214, v214
 v_mfma_f32_16x16x32_bf16 v[220:223], a[148:151], a[60:63], v[228:231]
 v_exp_f32 v215, v215
 v_mfma_f32_16x16x32_bf16 v[220:223], a[144:147], a[56:59], v[220:223]
 ds_read_b64_tr_b16 a[212:213], v247 offset:18472
 v_cvt_pk_bf16_f32 v162, v212, v213
 v_mfma_f32_16x16x32_bf16 v[220:223], a[140:143], a[52:55], v[220:223]
 ds_read_b64_tr_b16 a[214:215], v247 offset:19496
 v_cvt_pk_bf16_f32 v163, v214, v215
 v_mfma_f32_16x16x32_bf16 v[220:223], a[136:139], a[48:51], v[220:223]
 v_mul_f32 v216, s20, v216
 v_mul_f32 v217, s20, v217
 v_mfma_f32_16x16x32_bf16 v[208:211], a[136:139], a[64:67], v[232:235]
 v_mul_f32 v218, s20, v218
 v_mul_f32 v219, s20, v219
 v_mfma_f32_16x16x32_bf16 v[208:211], a[140:143], a[68:71], v[208:211]
 v_exp_f32 v216, v216
 v_mfma_f32_16x16x32_bf16 v[208:211], a[144:147], a[72:75], v[208:211]
 v_exp_f32 v217, v217
 v_mfma_f32_16x16x32_bf16 v[208:211], a[148:151], a[76:79], v[208:211]
 v_exp_f32 v218, v218
 v_mfma_f32_16x16x32_bf16 v[212:215], a[148:151], a[92:95], v[236:239]
 v_exp_f32 v219, v219
 v_mfma_f32_16x16x32_bf16 v[212:215], a[144:147], a[88:91], v[212:215]
 v_cvt_pk_bf16_f32 v132, v216, v217
 v_cvt_pk_bf16_f32 v133, v218, v219
 v_mfma_f32_16x16x32_bf16 v[212:215], a[140:143], a[84:87], v[212:215]
 ds_read_b64_tr_b16 a[170:171], v248 offset:17440
 v_mul_f32 v220, s20, v220
 v_mfma_f32_16x16x32_bf16 v[212:215], a[136:139], a[80:83], v[212:215]
 ds_read_b64_tr_b16 a[172:173], v248 offset:18464
 v_mul_f32 v221, s20, v221
 v_mfma_f32_16x16x32_bf16 v[216:219], a[136:139], a[96:99], v[240:243]
 ds_read_b64_tr_b16 a[174:175], v248 offset:19488
 v_mul_f32 v222, s20, v222
 v_mfma_f32_16x16x32_bf16 v[216:219], a[140:143], a[100:103], v[216:219]
 ds_read_b64_tr_b16 a[176:177], v248 offset:16424
 v_mul_f32 v223, s20, v223
 v_mfma_f32_16x16x32_bf16 v[216:219], a[144:147], a[104:107], v[216:219]
 ds_read_b64_tr_b16 a[178:179], v248 offset:17448
 v_mul_f32 v208, s20, v208
 v_mfma_f32_16x16x32_bf16 v[216:219], a[148:151], a[108:111], v[216:219]
 s_waitcnt lgkmcnt(11)
 ds_read_b64_tr_b16 a[180:181], v248 offset:18472
 v_mul_f32 v209, s20, v209
 v_mfma_f32_16x16x32_bf16 v[16:19], a[200:203], v[168:171], v[16:19]
 s_waitcnt lgkmcnt(10)
 ds_read_b64_tr_b16 a[182:183], v248 offset:19496
 v_mul_f32 v210, s20, v210
 v_mfma_f32_16x16x32_bf16 v[16:19], a[204:207], v[172:175], v[16:19]
 ds_read_b128 a[152:155], v244 offset:37376
 v_mul_f32 v211, s20, v211
 v_mfma_f32_16x16x32_bf16 v[48:51], a[204:207], v[180:183], v[48:51]
 ds_read_b128 a[156:159], v244 offset:37440
 v_mul_f32 v212, s20, v212
 v_mfma_f32_16x16x32_bf16 v[48:51], a[200:203], v[176:179], v[48:51]
 ds_read_b128 a[160:163], v244 offset:37504
 v_mul_f32 v213, s20, v213
 v_mfma_f32_16x16x32_bf16 v[80:83], a[200:203], v[184:187], v[80:83]
 ds_read_b128 a[164:167], v244 offset:37568
 v_mul_f32 v214, s20, v214
 v_mfma_f32_16x16x32_bf16 v[80:83], a[204:207], v[188:191], v[80:83]
 v_exp_f32 v220, v220
 v_mfma_f32_16x16x32_bf16 v[112:115], a[204:207], v[196:199], v[112:115]
 v_exp_f32 v221, v221
 v_mfma_f32_16x16x32_bf16 v[112:115], a[200:203], v[192:195], v[112:115]
 v_exp_f32 v222, v222
 v_mfma_f32_16x16x32_bf16 a[16:19], a[200:203], v[200:203], a[16:19]
 v_exp_f32 v223, v223
 v_mfma_f32_16x16x32_bf16 a[16:19], a[204:207], v[204:207], a[16:19]
 s_waitcnt lgkmcnt(13)
 v_cvt_pk_bf16_f32 v140, v220, v221
 v_cvt_pk_bf16_f32 v141, v222, v223
 v_mfma_f32_16x16x32_bf16 v[20:23], a[208:211], v[168:171], v[20:23]
 s_waitcnt lgkmcnt(11)
 v_exp_f32 v208, v208
 v_mfma_f32_16x16x32_bf16 v[20:23], a[212:215], v[172:175], v[20:23]
 v_exp_f32 v209, v209
 v_mfma_f32_16x16x32_bf16 v[52:55], a[212:215], v[180:183], v[52:55]
 v_exp_f32 v210, v210
 v_mfma_f32_16x16x32_bf16 v[52:55], a[208:211], v[176:179], v[52:55]
 v_exp_f32 v211, v211
 v_mfma_f32_16x16x32_bf16 v[84:87], a[208:211], v[184:187], v[84:87]
 v_cvt_pk_bf16_f32 v148, v208, v209
 v_cvt_pk_bf16_f32 v149, v210, v211
 v_mfma_f32_16x16x32_bf16 v[84:87], a[212:215], v[188:191], v[84:87]
 v_mul_f32 v215, s20, v215
 v_mul_f32 v216, s20, v216
 v_mfma_f32_16x16x32_bf16 v[116:119], a[212:215], v[196:199], v[116:119]
 v_exp_f32 v212, v212
 v_mfma_f32_16x16x32_bf16 v[116:119], a[208:211], v[192:195], v[116:119]
 v_exp_f32 v213, v213
 v_mfma_f32_16x16x32_bf16 a[20:23], a[208:211], v[200:203], a[20:23]
 s_waitcnt vmcnt(16) lgkmcnt(0)
 ds_inc_u32 v249, v252
 v_cvt_pk_bf16_f32 v156, v212, v213
 v_mfma_f32_16x16x32_bf16 a[20:23], a[212:215], v[204:207], a[20:23]
 s_add_u32 s2, s2, 4
 v_exp_f32 v214, v214
 v_mfma_f32_16x16x32_bf16 a[120:123], a[132:135], v[184:187], a[120:123]
 v_exp_f32 v215, v215
 v_mfma_f32_16x16x32_bf16 a[120:123], a[132:135], v[188:191], a[120:123]
 v_cvt_pk_bf16_f32 v157, v214, v215
 v_mul_f32 v217, s20, v217
 v_mfma_f32_16x16x32_bf16 v[220:223], a[152:155], a[32:35], v[224:227]
 v_mul_f32 v218, s20, v218
 v_mul_f32 v219, s20, v219
 v_mfma_f32_16x16x32_bf16 v[220:223], a[156:159], a[36:39], v[220:223]
 v_exp_f32 v216, v216
 v_mfma_f32_16x16x32_bf16 v[220:223], a[160:163], a[40:43], v[220:223]
 v_exp_f32 v217, v217
 v_mfma_f32_16x16x32_bf16 v[220:223], a[164:167], a[44:47], v[220:223]
 v_exp_f32 v218, v218
 v_mfma_f32_16x16x32_bf16 v[208:211], a[164:167], a[60:63], v[228:231]
 v_exp_f32 v219, v219
 v_mfma_f32_16x16x32_bf16 v[208:211], a[160:163], a[56:59], v[208:211]
 v_cvt_pk_bf16_f32 v164, v216, v217
 v_cvt_pk_bf16_f32 v165, v218, v219
 v_mfma_f32_16x16x32_bf16 v[208:211], a[156:159], a[52:55], v[208:211]
 v_mfma_f32_16x16x32_bf16 v[208:211], a[152:155], a[48:51], v[208:211]
 v_mul_f32 v220, s20, v220
 v_mul_f32 v221, s20, v221
 v_mfma_f32_16x16x32_bf16 v[212:215], a[152:155], a[64:67], v[232:235]
 v_mul_f32 v222, s20, v222
 v_mul_f32 v223, s20, v223
 v_mfma_f32_16x16x32_bf16 v[212:215], a[156:159], a[68:71], v[212:215]
 v_exp_f32 v220, v220
 v_mfma_f32_16x16x32_bf16 v[212:215], a[160:163], a[72:75], v[212:215]
 v_exp_f32 v221, v221
 v_mfma_f32_16x16x32_bf16 v[212:215], a[164:167], a[76:79], v[212:215]
 v_exp_f32 v222, v222
 v_mfma_f32_16x16x32_bf16 v[216:219], a[164:167], a[92:95], v[236:239]
 v_exp_f32 v223, v223
 v_mfma_f32_16x16x32_bf16 v[216:219], a[160:163], a[88:91], v[216:219]
 v_cvt_pk_bf16_f32 v134, v220, v221
 v_cvt_pk_bf16_f32 v135, v222, v223
 v_mfma_f32_16x16x32_bf16 v[216:219], a[156:159], a[84:87], v[216:219]
 v_mul_f32 v208, s20, v208
 v_mul_f32 v209, s20, v209
 v_mfma_f32_16x16x32_bf16 v[216:219], a[152:155], a[80:83], v[216:219]
 v_mul_f32 v210, s20, v210
 v_mul_f32 v211, s20, v211
 v_mfma_f32_16x16x32_bf16 v[220:223], a[152:155], a[96:99], v[240:243]
 v_exp_f32 v208, v208
 v_mfma_f32_16x16x32_bf16 v[220:223], a[156:159], a[100:103], v[220:223]
 ds_read_b32 v167, v249
 v_mul_f32 v212, s20, v212
 v_mfma_f32_16x16x32_bf16 v[220:223], a[160:163], a[104:107], v[220:223]
 v_exp_f32 v209, v209
 v_mfma_f32_16x16x32_bf16 v[220:223], a[164:167], a[108:111], v[220:223]
 v_exp_f32 v210, v210
 v_mfma_f32_16x16x32_bf16 v[24:27], a[168:171], v[168:171], v[24:27]
 v_exp_f32 v211, v211
 v_mfma_f32_16x16x32_bf16 v[24:27], a[172:175], v[172:175], v[24:27]
 v_cvt_pk_bf16_f32 v142, v208, v209
 v_cvt_pk_bf16_f32 v143, v210, v211
 v_mfma_f32_16x16x32_bf16 v[56:59], a[172:175], v[180:183], v[56:59]
 v_mul_f32 v213, s20, v213
 v_mul_f32 v214, s20, v214
 v_mfma_f32_16x16x32_bf16 v[56:59], a[168:171], v[176:179], v[56:59]
 v_mul_f32 v215, s20, v215
 v_mul_f32 v216, s20, v216
 v_mfma_f32_16x16x32_bf16 v[88:91], a[168:171], v[184:187], v[88:91]
 s_waitcnt lgkmcnt(0)
 v_cmp_gt_u32 vcc, s2, v167
 v_mul_f32 v217, s20, v217
 v_mfma_f32_16x16x32_bf16 v[88:91], a[172:175], v[188:191], v[88:91]
 s_add_u32 s38, s27, 65536
 v_exp_f32 v212, v212
 v_mfma_f32_16x16x32_bf16 v[120:123], a[172:175], v[196:199], v[120:123]
 s_cbranch_vccnz Lspin5_2
Lback5_2:
 ds_read_b128 a[136:139], v244 offset:50944
 v_mul_f32 v218, s20, v218
 v_mfma_f32_16x16x32_bf16 v[120:123], a[168:171], v[192:195], v[120:123]
 s_add_u32 m0, s23, 16416
 ds_read_b128 a[140:143], v244 offset:51008
 v_mul_f32 v219, s20, v219
 v_mfma_f32_16x16x32_bf16 a[24:27], a[168:171], v[200:203], a[24:27]
 buffer_load_dwordx4 v250, s[12:15], s38 offen offset:0 lds
 v_mfma_f32_16x16x32_bf16 a[24:27], a[172:175], v[204:207], a[24:27]
 ds_read_b128 a[144:147], v244 offset:51072
 v_mul_f32 v220, s20, v220
 v_mfma_f32_16x16x32_bf16 v[28:31], a[176:179], v[168:171], v[28:31]
 ds_read_b128 a[148:151], v244 offset:51136
 v_mul_f32 v221, s20, v221
 v_mfma_f32_16x16x32_bf16 v[28:31], a[180:183], v[172:175], v[28:31]
 v_exp_f32 v213, v213
 v_mfma_f32_16x16x32_bf16 v[60:63], a[180:183], v[180:183], v[60:63]
 v_exp_f32 v214, v214
 v_mfma_f32_16x16x32_bf16 v[60:63], a[176:179], v[176:179], v[60:63]
 v_exp_f32 v215, v215
 v_mfma_f32_16x16x32_bf16 v[92:95], a[176:179], v[184:187], v[92:95]
 ds_read_b64_tr_b16 a[200:201], v245 offset:32832
 v_cvt_pk_bf16_f32 v150, v212, v213
 v_mfma_f32_16x16x32_bf16 v[92:95], a[180:183], v[188:191], v[92:95]
 ds_read_b64_tr_b16 a[202:203], v245 offset:33856
 v_cvt_pk_bf16_f32 v151, v214, v215
 v_mfma_f32_16x16x32_bf16 v[124:127], a[180:183], v[196:199], v[124:127]
 v_exp_f32 v216, v216
 v_mfma_f32_16x16x32_bf16 v[124:127], a[176:179], v[192:195], v[124:127]
 v_exp_f32 v217, v217
 v_mfma_f32_16x16x32_bf16 a[28:31], a[176:179], v[200:203], a[28:31]
 v_exp_f32 v218, v218
 v_mfma_f32_16x16x32_bf16 a[28:31], a[180:183], v[204:207], a[28:31]
 v_exp_f32 v219, v219
 v_mfma_f32_16x16x32_bf16 a[124:127], a[132:135], v[192:195], a[124:127]
 buffer_load_dwordx4 v250, s[12:15], s38 offen offset:1024 lds
 v_mfma_f32_16x16x32_bf16 a[124:127], a[132:135], v[196:199], a[124:127]
 s_waitcnt lgkmcnt(5)
 ds_read_b64_tr_b16 a[204:205], v245 offset:34880
 v_cvt_pk_bf16_f32 v158, v216, v217
 v_mfma_f32_16x16x32_bf16 v[208:211], a[136:139], a[32:35], v[224:227]
 s_waitcnt lgkmcnt(5)
 ds_read_b64_tr_b16 a[206:207], v245 offset:35904
 v_cvt_pk_bf16_f32 v159, v218, v219
 v_mfma_f32_16x16x32_bf16 v[208:211], a[140:143], a[36:39], v[208:211]
 s_waitcnt lgkmcnt(5)
 ds_read_b64_tr_b16 a[208:209], v245 offset:32840
 v_mul_f32 v222, s20, v222
 v_mfma_f32_16x16x32_bf16 v[208:211], a[144:147], a[40:43], v[208:211]
 s_waitcnt lgkmcnt(5)
 ds_read_b64_tr_b16 a[210:211], v245 offset:33864
 v_mul_f32 v223, s20, v223
 v_mfma_f32_16x16x32_bf16 v[208:211], a[148:151], a[44:47], v[208:211]
 v_exp_f32 v220, v220
 v_mfma_f32_16x16x32_bf16 v[212:215], a[148:151], a[60:63], v[228:231]
 v_exp_f32 v221, v221
 v_mfma_f32_16x16x32_bf16 v[212:215], a[144:147], a[56:59], v[212:215]
 v_exp_f32 v222, v222
 v_mfma_f32_16x16x32_bf16 v[212:215], a[140:143], a[52:55], v[212:215]
 v_exp_f32 v223, v223
 v_mfma_f32_16x16x32_bf16 v[212:215], a[136:139], a[48:51], v[212:215]
 ds_read_b64_tr_b16 a[212:213], v245 offset:34888
 v_cvt_pk_bf16_f32 v166, v220, v221
 v_mfma_f32_16x16x32_bf16 v[216:219], a[136:139], a[64:67], v[232:235]
 ds_read_b64_tr_b16 a[214:215], v245 offset:35912
 v_cvt_pk_bf16_f32 v167, v222, v223
 v_mfma_f32_16x16x32_bf16 v[216:219], a[140:143], a[68:71], v[216:219]
 v_mul_f32 v208, s20, v208
 v_mul_f32 v209, s20, v209
 v_mfma_f32_16x16x32_bf16 v[216:219], a[144:147], a[72:75], v[216:219]
 buffer_load_dwordx4 v250, s[12:15], s38 offen offset:2048 lds
 v_mfma_f32_16x16x32_bf16 v[216:219], a[148:151], a[76:79], v[216:219]
 v_mul_f32 v210, s20, v210
 v_mul_f32 v211, s20, v211
 v_mfma_f32_16x16x32_bf16 v[220:223], a[148:151], a[92:95], v[236:239]
 v_exp_f32 v208, v208
 v_mfma_f32_16x16x32_bf16 v[220:223], a[144:147], a[88:91], v[220:223]
 v_exp_f32 v209, v209
 v_mfma_f32_16x16x32_bf16 v[220:223], a[140:143], a[84:87], v[220:223]
 v_exp_f32 v210, v210
 v_exp_f32 v211, v211
 v_cvt_pk_bf16_f32 v168, v208, v209
 v_pk_mul_f32 v[212:213], v[212:213], s[20:21]
 v_pk_mul_f32 v[214:215], v[214:215], s[20:21]
 v_pk_mul_f32 v[216:217], v[216:217], s[20:21]
 v_pk_mul_f32 v[218:219], v[218:219], s[20:21]
 v_cvt_pk_bf16_f32 v169, v210, v211
 v_mfma_f32_16x16x32_bf16 v[220:223], a[136:139], a[80:83], v[220:223]
 v_exp_f32 v212, v212
 v_mfma_f32_16x16x32_bf16 v[208:211], a[136:139], a[96:99], v[240:243]
 buffer_store_dwordx4 a[216:219], v255, s[16:19], s3 offen offset:128 nt
 buffer_store_dwordx4 a[220:223], v255, s[16:19], s3 offen offset:2176 nt
 v_mfma_f32_16x16x32_bf16 v[208:211], a[140:143], a[100:103], v[208:211]
 v_exp_f32 v213, v213
 v_mfma_f32_16x16x32_bf16 v[208:211], a[144:147], a[104:107], v[208:211]
 ds_read_b128 a[152:155], v244 offset:51968
 v_cvt_pk_bf16_f32 v176, v212, v213
 v_mfma_f32_16x16x32_bf16 v[208:211], a[148:151], a[108:111], v[208:211]
 s_waitcnt lgkmcnt(7)
 ds_read_b128 a[156:159], v244 offset:52032
 v_mul_f32 v220, s20, v220
 v_mfma_f32_16x16x32_bf16 v[0:3], a[200:203], v[128:131], v[0:3]
 s_waitcnt lgkmcnt(6)
 ds_read_b128 a[160:163], v244 offset:52096
 v_mul_f32 v221, s20, v221
 v_mfma_f32_16x16x32_bf16 v[0:3], a[204:207], v[132:135], v[0:3]
 ds_read_b128 a[164:167], v244 offset:52160
 v_mul_f32 v222, s20, v222
 v_mfma_f32_16x16x32_bf16 v[32:35], a[204:207], v[140:143], v[32:35]
 buffer_load_dwordx4 v250, s[12:15], s38 offen offset:3072 lds
 v_mfma_f32_16x16x32_bf16 v[32:35], a[200:203], v[136:139], v[32:35]
 v_exp_f32 v214, v214
 v_mfma_f32_16x16x32_bf16 v[64:67], a[200:203], v[144:147], v[64:67]
 v_exp_f32 v215, v215
 v_mfma_f32_16x16x32_bf16 v[64:67], a[204:207], v[148:151], v[64:67]
 v_cvt_pk_bf16_f32 v177, v214, v215
 v_mul_f32 v223, s20, v223
 v_mfma_f32_16x16x32_bf16 v[96:99], a[204:207], v[156:159], v[96:99]
 v_exp_f32 v216, v216
 v_mfma_f32_16x16x32_bf16 v[96:99], a[200:203], v[152:155], v[96:99]
 v_exp_f32 v217, v217
 v_mfma_f32_16x16x32_bf16 a[0:3], a[200:203], v[160:163], a[0:3]
 v_exp_f32 v218, v218
 v_mfma_f32_16x16x32_bf16 a[0:3], a[204:207], v[164:167], a[0:3]
 s_waitcnt lgkmcnt(6)
 v_exp_f32 v219, v219
 v_mfma_f32_16x16x32_bf16 v[4:7], a[208:211], v[128:131], v[4:7]
 s_waitcnt lgkmcnt(4)
 ds_read_b64_tr_b16 a[200:201], v246 offset:32832
 v_cvt_pk_bf16_f32 v184, v216, v217
 v_mfma_f32_16x16x32_bf16 v[4:7], a[212:215], v[132:135], v[4:7]
 s_add_u32 s37, s27, 98304
 ds_read_b64_tr_b16 a[202:203], v246 offset:33856
 v_cvt_pk_bf16_f32 v185, v218, v219
 v_mfma_f32_16x16x32_bf16 v[36:39], a[212:215], v[140:143], v[36:39]
 s_add_u32 m0, s22, 34304
 v_exp_f32 v220, v220
 v_mfma_f32_16x16x32_bf16 v[36:39], a[208:211], v[136:139], v[36:39]
 v_exp_f32 v221, v221
 v_mfma_f32_16x16x32_bf16 v[68:71], a[208:211], v[144:147], v[68:71]
 buffer_load_dwordx4 v249, s[8:11], s37 offen offset:0 lds
 v_mfma_f32_16x16x32_bf16 v[68:71], a[212:215], v[148:151], v[68:71]
 v_exp_f32 v222, v222
 v_mfma_f32_16x16x32_bf16 v[100:103], a[212:215], v[156:159], v[100:103]
 v_exp_f32 v223, v223
 v_mfma_f32_16x16x32_bf16 v[100:103], a[208:211], v[152:155], v[100:103]
 ds_read_b64_tr_b16 a[204:205], v246 offset:34880
 v_cvt_pk_bf16_f32 v192, v220, v221
 v_mfma_f32_16x16x32_bf16 a[4:7], a[208:211], v[160:163], a[4:7]
 ds_read_b64_tr_b16 a[206:207], v246 offset:35904
 v_cvt_pk_bf16_f32 v193, v222, v223
 v_mfma_f32_16x16x32_bf16 a[4:7], a[212:215], v[164:167], a[4:7]
 ds_read_b64_tr_b16 a[208:209], v246 offset:32840
 v_mul_f32 v208, s20, v208
 v_mfma_f32_16x16x32_bf16 a[112:115], a[132:135], v[128:131], a[112:115]
 ds_read_b64_tr_b16 a[210:211], v246 offset:33864
 v_mul_f32 v209, s20, v209
 v_mfma_f32_16x16x32_bf16 a[112:115], a[132:135], v[132:135], a[112:115]
 v_mul_f32 v210, s20, v210
 v_mul_f32 v211, s20, v211
 v_mfma_f32_16x16x32_bf16 a[128:131], a[132:135], v[160:163], a[128:131]
 v_exp_f32 v208, v208
 v_mfma_f32_16x16x32_bf16 a[128:131], a[132:135], v[164:167], a[128:131]
 s_waitcnt lgkmcnt(9)
 v_exp_f32 v209, v209
 v_mfma_f32_16x16x32_bf16 v[212:215], a[152:155], a[32:35], v[224:227]
 s_waitcnt lgkmcnt(8)
 v_exp_f32 v210, v210
 v_mfma_f32_16x16x32_bf16 v[212:215], a[156:159], a[36:39], v[212:215]
 s_waitcnt lgkmcnt(7)
 v_exp_f32 v211, v211
 v_mfma_f32_16x16x32_bf16 v[212:215], a[160:163], a[40:43], v[212:215]
 s_waitcnt lgkmcnt(6)
 buffer_load_dwordx4 v249, s[8:11], s37 offen offset:1024 lds
 v_mfma_f32_16x16x32_bf16 v[212:215], a[164:167], a[44:47], v[212:215]
 ds_read_b64_tr_b16 a[212:213], v246 offset:34888
 v_cvt_pk_bf16_f32 v200, v208, v209
 v_mfma_f32_16x16x32_bf16 v[216:219], a[164:167], a[60:63], v[228:231]
 ds_read_b64_tr_b16 a[214:215], v246 offset:35912
 v_cvt_pk_bf16_f32 v201, v210, v211
 v_mfma_f32_16x16x32_bf16 v[216:219], a[160:163], a[56:59], v[216:219]
 ds_read_b128 a[136:139], v244 offset:52992
 ds_read_b128 a[140:143], v244 offset:53056
 v_mfma_f32_16x16x32_bf16 v[216:219], a[156:159], a[52:55], v[216:219]
 v_mul_f32 v212, s20, v212
 v_mul_f32 v213, s20, v213
 v_mfma_f32_16x16x32_bf16 v[216:219], a[152:155], a[48:51], v[216:219]
 v_mul_f32 v214, s20, v214
 v_mul_f32 v215, s20, v215
 v_mfma_f32_16x16x32_bf16 v[220:223], a[152:155], a[64:67], v[232:235]
 v_exp_f32 v212, v212
 v_mfma_f32_16x16x32_bf16 v[220:223], a[156:159], a[68:71], v[220:223]
 v_exp_f32 v213, v213
 v_mfma_f32_16x16x32_bf16 v[220:223], a[160:163], a[72:75], v[220:223]
 v_exp_f32 v214, v214
 v_mfma_f32_16x16x32_bf16 v[220:223], a[164:167], a[76:79], v[220:223]
 v_exp_f32 v215, v215
 v_mfma_f32_16x16x32_bf16 v[208:211], a[164:167], a[92:95], v[236:239]
 v_cvt_pk_bf16_f32 v170, v212, v213
 v_cvt_pk_bf16_f32 v171, v214, v215
 v_mfma_f32_16x16x32_bf16 v[208:211], a[160:163], a[88:91], v[208:211]
 ds_read_b128 a[144:147], v244 offset:53120
 v_mul_f32 v216, s20, v216
 v_mfma_f32_16x16x32_bf16 v[208:211], a[156:159], a[84:87], v[208:211]
 buffer_load_dwordx4 v249, s[8:11], s37 offen offset:2048 lds
 v_mfma_f32_16x16x32_bf16 v[208:211], a[152:155], a[80:83], v[208:211]
 ds_read_b128 a[148:151], v244 offset:53184
 v_mul_f32 v217, s20, v217
 v_mfma_f32_16x16x32_bf16 v[212:215], a[152:155], a[96:99], v[240:243]
 v_mul_f32 v218, s20, v218
 v_mul_f32 v219, s20, v219
 v_mfma_f32_16x16x32_bf16 v[212:215], a[156:159], a[100:103], v[212:215]
 v_exp_f32 v216, v216
 v_mfma_f32_16x16x32_bf16 v[212:215], a[160:163], a[104:107], v[212:215]
 v_exp_f32 v217, v217
 v_mfma_f32_16x16x32_bf16 v[212:215], a[164:167], a[108:111], v[212:215]
 s_waitcnt lgkmcnt(10)
 v_exp_f32 v218, v218
 v_mfma_f32_16x16x32_bf16 v[8:11], a[200:203], v[128:131], v[8:11]
 s_waitcnt lgkmcnt(8)
 v_exp_f32 v219, v219
 v_mfma_f32_16x16x32_bf16 v[8:11], a[204:207], v[132:135], v[8:11]
 v_cvt_pk_bf16_f32 v178, v216, v217
 v_cvt_pk_bf16_f32 v179, v218, v219
 v_mfma_f32_16x16x32_bf16 v[40:43], a[204:207], v[140:143], v[40:43]
 v_mul_f32 v220, s20, v220
 v_mul_f32 v221, s20, v221
 v_mfma_f32_16x16x32_bf16 v[40:43], a[200:203], v[136:139], v[40:43]
 v_mul_f32 v222, s20, v222
 v_mul_f32 v223, s20, v223
 v_mfma_f32_16x16x32_bf16 v[72:75], a[200:203], v[144:147], v[72:75]
 v_exp_f32 v220, v220
 v_mfma_f32_16x16x32_bf16 v[72:75], a[204:207], v[148:151], v[72:75]
 v_exp_f32 v221, v221
 v_mfma_f32_16x16x32_bf16 v[104:107], a[204:207], v[156:159], v[104:107]
 buffer_load_dwordx4 v249, s[8:11], s37 offen offset:3072 lds
 v_mfma_f32_16x16x32_bf16 v[104:107], a[200:203], v[152:155], v[104:107]
 v_exp_f32 v222, v222
 v_mfma_f32_16x16x32_bf16 a[8:11], a[200:203], v[160:163], a[8:11]
 v_exp_f32 v223, v223
 v_mfma_f32_16x16x32_bf16 a[8:11], a[204:207], v[164:167], a[8:11]
 s_waitcnt lgkmcnt(6)
 ds_read_b64_tr_b16 a[200:201], v247 offset:32832
 v_cvt_pk_bf16_f32 v186, v220, v221
 v_mfma_f32_16x16x32_bf16 v[12:15], a[208:211], v[128:131], v[12:15]
 s_waitcnt lgkmcnt(5)
 ds_read_b64_tr_b16 a[202:203], v247 offset:33856
 v_cvt_pk_bf16_f32 v187, v222, v223
 v_mfma_f32_16x16x32_bf16 v[12:15], a[212:215], v[132:135], v[12:15]
 ds_read_b64_tr_b16 a[204:205], v247 offset:34880
 v_mul_f32 v208, s20, v208
 v_mfma_f32_16x16x32_bf16 v[44:47], a[212:215], v[140:143], v[44:47]
 ds_read_b64_tr_b16 a[206:207], v247 offset:35904
 v_mul_f32 v209, s20, v209
 v_mfma_f32_16x16x32_bf16 v[44:47], a[208:211], v[136:139], v[44:47]
 v_mul_f32 v210, s20, v210
 v_mul_f32 v211, s20, v211
 v_mfma_f32_16x16x32_bf16 v[76:79], a[208:211], v[144:147], v[76:79]
 v_exp_f32 v208, v208
 v_mfma_f32_16x16x32_bf16 v[76:79], a[212:215], v[148:151], v[76:79]
 v_exp_f32 v209, v209
 v_mfma_f32_16x16x32_bf16 v[108:111], a[212:215], v[156:159], v[108:111]
 s_add_u32 m0, s62, 4096
 v_exp_f32 v210, v210
 v_mfma_f32_16x16x32_bf16 v[108:111], a[208:211], v[152:155], v[108:111]
 v_exp_f32 v211, v211
 v_mfma_f32_16x16x32_bf16 a[12:15], a[208:211], v[160:163], a[12:15]
 buffer_load_dwordx4 v251, s[4:7], s33 offen offset:0 lds
 v_mfma_f32_16x16x32_bf16 a[12:15], a[212:215], v[164:167], a[12:15]
 s_add_u32 m0, s62, 5056
 v_cvt_pk_bf16_f32 v194, v208, v209
 v_cvt_pk_bf16_f32 v195, v210, v211
 v_mfma_f32_16x16x32_bf16 a[116:119], a[132:135], v[136:139], a[116:119]
 ds_read_b64_tr_b16 a[208:209], v247 offset:32840
 v_mul_f32 v212, s20, v212
 v_mfma_f32_16x16x32_bf16 a[116:119], a[132:135], v[140:143], a[116:119]
 s_waitcnt lgkmcnt(8)
 buffer_load_dwordx4 v251, s[4:7], s33 offen offset:64 lds
 v_mfma_f32_16x16x32_bf16 v[216:219], a[136:139], a[32:35], v[224:227]
 s_waitcnt lgkmcnt(7)
 ds_read_b64_tr_b16 a[210:211], v247 offset:33864
 v_mul_f32 v213, s20, v213
 v_mfma_f32_16x16x32_bf16 v[216:219], a[140:143], a[36:39], v[216:219]
 s_waitcnt lgkmcnt(7)
 v_mul_f32 v214, s20, v214
 v_mul_f32 v215, s20, v215
 v_mfma_f32_16x16x32_bf16 v[216:219], a[144:147], a[40:43], v[216:219]
 s_waitcnt lgkmcnt(6)
 v_exp_f32 v212, v212
 v_mfma_f32_16x16x32_bf16 v[216:219], a[148:151], a[44:47], v[216:219]
 v_exp_f32 v213, v213
 v_mfma_f32_16x16x32_bf16 v[220:223], a[148:151], a[60:63], v[228:231]
 v_exp_f32 v214, v214
 v_mfma_f32_16x16x32_bf16 v[220:223], a[144:147], a[56:59], v[220:223]
 v_exp_f32 v215, v215
 v_mfma_f32_16x16x32_bf16 v[220:223], a[140:143], a[52:55], v[220:223]
 ds_read_b64_tr_b16 a[212:213], v247 offset:34888
 v_cvt_pk_bf16_f32 v202, v212, v213
 v_mfma_f32_16x16x32_bf16 v[220:223], a[136:139], a[48:51], v[220:223]
 ds_read_b64_tr_b16 a[214:215], v247 offset:35912
 v_cvt_pk_bf16_f32 v203, v214, v215
 v_mfma_f32_16x16x32_bf16 v[208:211], a[136:139], a[64:67], v[232:235]
 v_mul_f32 v216, s20, v216
 v_mul_f32 v217, s20, v217
 v_mfma_f32_16x16x32_bf16 v[208:211], a[140:143], a[68:71], v[208:211]
 v_mul_f32 v218, s20, v218
 v_mul_f32 v219, s20, v219
 v_mfma_f32_16x16x32_bf16 v[208:211], a[144:147], a[72:75], v[208:211]
 v_exp_f32 v216, v216
 v_mfma_f32_16x16x32_bf16 v[208:211], a[148:151], a[76:79], v[208:211]
 v_exp_f32 v217, v217
 v_mfma_f32_16x16x32_bf16 v[212:215], a[148:151], a[92:95], v[236:239]
 v_exp_f32 v218, v218
 v_mfma_f32_16x16x32_bf16 v[212:215], a[144:147], a[88:91], v[212:215]
 v_exp_f32 v219, v219
 v_mfma_f32_16x16x32_bf16 v[212:215], a[140:143], a[84:87], v[212:215]
 v_cvt_pk_bf16_f32 v172, v216, v217
 v_cvt_pk_bf16_f32 v173, v218, v219
 v_mfma_f32_16x16x32_bf16 v[212:215], a[136:139], a[80:83], v[212:215]
 ds_read_b64_tr_b16 a[168:169], v248 offset:32832
 v_mul_f32 v220, s20, v220
 v_mfma_f32_16x16x32_bf16 v[216:219], a[136:139], a[96:99], v[240:243]
 ds_read_b64_tr_b16 a[170:171], v248 offset:33856
 v_mul_f32 v221, s20, v221
 v_mfma_f32_16x16x32_bf16 v[216:219], a[140:143], a[100:103], v[216:219]
 ds_read_b64_tr_b16 a[172:173], v248 offset:34880
 v_mul_f32 v222, s20, v222
 v_mfma_f32_16x16x32_bf16 v[216:219], a[144:147], a[104:107], v[216:219]
 ds_read_b64_tr_b16 a[174:175], v248 offset:35904
 v_mul_f32 v223, s20, v223
 v_mfma_f32_16x16x32_bf16 v[216:219], a[148:151], a[108:111], v[216:219]
 s_waitcnt lgkmcnt(10)
 ds_read_b64_tr_b16 a[176:177], v248 offset:32840
 v_mul_f32 v208, s20, v208
 v_mfma_f32_16x16x32_bf16 v[16:19], a[200:203], v[128:131], v[16:19]
 s_waitcnt lgkmcnt(9)
 ds_read_b64_tr_b16 a[178:179], v248 offset:33864
 v_mul_f32 v209, s20, v209
 v_mfma_f32_16x16x32_bf16 v[16:19], a[204:207], v[132:135], v[16:19]
 ds_read_b64_tr_b16 a[180:181], v248 offset:34888
 v_mul_f32 v210, s20, v210
 v_mfma_f32_16x16x32_bf16 v[48:51], a[204:207], v[140:143], v[48:51]
 ds_read_b64_tr_b16 a[182:183], v248 offset:35912
 v_mul_f32 v211, s20, v211
 v_mfma_f32_16x16x32_bf16 v[48:51], a[200:203], v[136:139], v[48:51]
 ds_read_b128 a[152:155], v244 offset:54016
 v_mul_f32 v212, s20, v212
 v_mfma_f32_16x16x32_bf16 v[80:83], a[200:203], v[144:147], v[80:83]
 ds_read_b128 a[156:159], v244 offset:54080
 v_mul_f32 v213, s20, v213
 v_mfma_f32_16x16x32_bf16 v[80:83], a[204:207], v[148:151], v[80:83]
 ds_read_b128 a[160:163], v244 offset:54144
 v_mul_f32 v214, s20, v214
 v_mfma_f32_16x16x32_bf16 v[112:115], a[204:207], v[156:159], v[112:115]
 ds_read_b128 a[164:167], v244 offset:54208
 v_mul_f32 v215, s20, v215
 v_mfma_f32_16x16x32_bf16 v[112:115], a[200:203], v[152:155], v[112:115]
 v_exp_f32 v220, v220
 v_mfma_f32_16x16x32_bf16 a[16:19], a[200:203], v[160:163], a[16:19]
 v_exp_f32 v221, v221
 v_mfma_f32_16x16x32_bf16 a[16:19], a[204:207], v[164:167], a[16:19]
 s_waitcnt lgkmcnt(14)
 v_exp_f32 v222, v222
 v_mfma_f32_16x16x32_bf16 v[20:23], a[208:211], v[128:131], v[20:23]
 s_waitcnt lgkmcnt(12)
 v_exp_f32 v223, v223
 v_mfma_f32_16x16x32_bf16 v[20:23], a[212:215], v[132:135], v[20:23]
 v_cvt_pk_bf16_f32 v180, v220, v221
 v_cvt_pk_bf16_f32 v181, v222, v223
 v_mfma_f32_16x16x32_bf16 v[52:55], a[212:215], v[140:143], v[52:55]
 v_exp_f32 v208, v208
 v_mfma_f32_16x16x32_bf16 v[52:55], a[208:211], v[136:139], v[52:55]
 v_exp_f32 v209, v209
 v_mfma_f32_16x16x32_bf16 v[84:87], a[208:211], v[144:147], v[84:87]
 v_exp_f32 v210, v210
 v_mfma_f32_16x16x32_bf16 v[84:87], a[212:215], v[148:151], v[84:87]
 v_exp_f32 v211, v211
 v_mfma_f32_16x16x32_bf16 v[116:119], a[212:215], v[156:159], v[116:119]
 v_cvt_pk_bf16_f32 v188, v208, v209
 v_cvt_pk_bf16_f32 v189, v210, v211
 v_mfma_f32_16x16x32_bf16 v[116:119], a[208:211], v[152:155], v[116:119]
 v_exp_f32 v212, v212
 v_mfma_f32_16x16x32_bf16 a[20:23], a[208:211], v[160:163], a[20:23]
 s_waitcnt vmcnt(18) lgkmcnt(0)
 ds_inc_u32 v249, v252
 v_mul_f32 v216, s20, v216
 v_mfma_f32_16x16x32_bf16 a[20:23], a[212:215], v[164:167], a[20:23]
 s_add_u32 s2, s2, 4
 v_exp_f32 v213, v213
 v_mfma_f32_16x16x32_bf16 a[120:123], a[132:135], v[144:147], a[120:123]
 v_exp_f32 v214, v214
 v_mfma_f32_16x16x32_bf16 a[120:123], a[132:135], v[148:151], a[120:123]
 v_exp_f32 v215, v215
 v_mfma_f32_16x16x32_bf16 v[220:223], a[152:155], a[32:35], v[224:227]
 v_cvt_pk_bf16_f32 v196, v212, v213
 v_cvt_pk_bf16_f32 v197, v214, v215
 v_mfma_f32_16x16x32_bf16 v[220:223], a[156:159], a[36:39], v[220:223]
 v_mul_f32 v217, s20, v217
 v_mul_f32 v218, s20, v218
 v_mfma_f32_16x16x32_bf16 v[220:223], a[160:163], a[40:43], v[220:223]
 v_exp_f32 v216, v216
 v_mfma_f32_16x16x32_bf16 v[220:223], a[164:167], a[44:47], v[220:223]
 v_exp_f32 v217, v217
 v_mfma_f32_16x16x32_bf16 v[208:211], a[164:167], a[60:63], v[228:231]
 v_mul_f32 v219, s20, v219
 v_cvt_pk_bf16_f32 v204, v216, v217
 v_mfma_f32_16x16x32_bf16 v[208:211], a[160:163], a[56:59], v[208:211]
 v_exp_f32 v218, v218
 v_mfma_f32_16x16x32_bf16 v[208:211], a[156:159], a[52:55], v[208:211]
 v_exp_f32 v219, v219
 v_mfma_f32_16x16x32_bf16 v[208:211], a[152:155], a[48:51], v[208:211]
 v_cvt_pk_bf16_f32 v205, v218, v219
 v_mul_f32 v220, s20, v220
 v_mfma_f32_16x16x32_bf16 v[212:215], a[152:155], a[64:67], v[232:235]
 v_mul_f32 v221, s20, v221
 v_mul_f32 v222, s20, v222
 v_mfma_f32_16x16x32_bf16 v[212:215], a[156:159], a[68:71], v[212:215]
 v_exp_f32 v220, v220
 v_mfma_f32_16x16x32_bf16 v[212:215], a[160:163], a[72:75], v[212:215]
 v_mul_f32 v223, s20, v223
 v_mul_f32 v208, s20, v208
 v_mfma_f32_16x16x32_bf16 v[212:215], a[164:167], a[76:79], v[212:215]
 v_exp_f32 v221, v221
 v_mfma_f32_16x16x32_bf16 v[216:219], a[164:167], a[92:95], v[236:239]
 v_exp_f32 v222, v222
 v_mfma_f32_16x16x32_bf16 v[216:219], a[160:163], a[88:91], v[216:219]
 v_exp_f32 v223, v223
 v_mfma_f32_16x16x32_bf16 v[216:219], a[156:159], a[84:87], v[216:219]
 v_cvt_pk_bf16_f32 v174, v220, v221
 v_cvt_pk_bf16_f32 v175, v222, v223
 v_mfma_f32_16x16x32_bf16 v[216:219], a[152:155], a[80:83], v[216:219]
 v_mul_f32 v209, s20, v209
 v_mul_f32 v210, s20, v210
 v_mfma_f32_16x16x32_bf16 v[220:223], a[152:155], a[96:99], v[240:243]
 v_mul_f32 v211, s20, v211
 v_mul_f32 v212, s20, v212
 v_mfma_f32_16x16x32_bf16 v[220:223], a[156:159], a[100:103], v[220:223]
 ds_read_b32 v207, v249
 v_mul_f32 v213, s20, v213
 v_mfma_f32_16x16x32_bf16 v[220:223], a[160:163], a[104:107], v[220:223]
 v_exp_f32 v208, v208
 v_mfma_f32_16x16x32_bf16 v[220:223], a[164:167], a[108:111], v[220:223]
 v_exp_f32 v209, v209
 v_mfma_f32_16x16x32_bf16 v[24:27], a[168:171], v[128:131], v[24:27]
 v_exp_f32 v210, v210
 v_mfma_f32_16x16x32_bf16 v[24:27], a[172:175], v[132:135], v[24:27]
 v_exp_f32 v211, v211
 v_mfma_f32_16x16x32_bf16 v[56:59], a[172:175], v[140:143], v[56:59]
 v_cvt_pk_bf16_f32 v182, v208, v209
 v_cvt_pk_bf16_f32 v183, v210, v211
 v_mfma_f32_16x16x32_bf16 v[56:59], a[168:171], v[136:139], v[56:59]
 v_mul_f32 v214, s20, v214
 v_mul_f32 v215, s20, v215
 v_mfma_f32_16x16x32_bf16 v[88:91], a[168:171], v[144:147], v[88:91]
 s_waitcnt lgkmcnt(0)
 v_cmp_gt_u32 vcc, s2, v207
 v_mul_f32 v216, s20, v216
 v_mfma_f32_16x16x32_bf16 v[88:91], a[172:175], v[148:151], v[88:91]
 s_add_u32 s38, s27, 81920
 v_exp_f32 v212, v212
 v_mfma_f32_16x16x32_bf16 v[120:123], a[172:175], v[156:159], v[120:123]
 s_cbranch_vccnz Lspin5_3
Lback5_3:
 ds_read_b128 a[136:139], v244 offset:1024
 v_mul_f32 v217, s20, v217
 v_mfma_f32_16x16x32_bf16 v[120:123], a[168:171], v[152:155], v[120:123]
 s_add_u32 m0, s23, 32832
 ds_read_b128 a[140:143], v244 offset:1088
 v_mul_f32 v218, s20, v218
 v_mfma_f32_16x16x32_bf16 a[24:27], a[168:171], v[160:163], a[24:27]
 buffer_load_dwordx4 v250, s[12:15], s38 offen offset:0 lds
 v_mfma_f32_16x16x32_bf16 a[24:27], a[172:175], v[164:167], a[24:27]
 ds_read_b128 a[144:147], v244 offset:1152
 v_mul_f32 v219, s20, v219
 v_mfma_f32_16x16x32_bf16 v[28:31], a[176:179], v[128:131], v[28:31]
 ds_read_b128 a[148:151], v244 offset:1216
 v_mul_f32 v220, s20, v220
 v_mfma_f32_16x16x32_bf16 v[28:31], a[180:183], v[132:135], v[28:31]
 v_exp_f32 v213, v213
 v_mfma_f32_16x16x32_bf16 v[60:63], a[180:183], v[140:143], v[60:63]
 v_exp_f32 v214, v214
 v_mfma_f32_16x16x32_bf16 v[60:63], a[176:179], v[136:139], v[60:63]
 v_exp_f32 v215, v215
 v_mfma_f32_16x16x32_bf16 v[92:95], a[176:179], v[144:147], v[92:95]
 ds_read_b64_tr_b16 a[200:201], v245 offset:0
 v_cvt_pk_bf16_f32 v190, v212, v213
 v_mfma_f32_16x16x32_bf16 v[92:95], a[180:183], v[148:151], v[92:95]
 ds_read_b64_tr_b16 a[202:203], v245 offset:1024
 v_cvt_pk_bf16_f32 v191, v214, v215
 v_mfma_f32_16x16x32_bf16 v[124:127], a[180:183], v[156:159], v[124:127]
 v_exp_f32 v216, v216
 v_mfma_f32_16x16x32_bf16 v[124:127], a[176:179], v[152:155], v[124:127]
 v_exp_f32 v217, v217
 v_mfma_f32_16x16x32_bf16 a[28:31], a[176:179], v[160:163], a[28:31]
 v_exp_f32 v218, v218
 v_mfma_f32_16x16x32_bf16 a[28:31], a[180:183], v[164:167], a[28:31]
 v_exp_f32 v219, v219
 v_mfma_f32_16x16x32_bf16 a[124:127], a[132:135], v[152:155], a[124:127]
 buffer_load_dwordx4 v250, s[12:15], s38 offen offset:1024 lds
 v_mfma_f32_16x16x32_bf16 a[124:127], a[132:135], v[156:159], a[124:127]
 s_waitcnt lgkmcnt(5)
 ds_read_b64_tr_b16 a[204:205], v245 offset:2048
 v_cvt_pk_bf16_f32 v198, v216, v217
 v_mfma_f32_16x16x32_bf16 v[208:211], a[136:139], a[32:35], v[224:227]
 s_waitcnt lgkmcnt(5)
 ds_read_b64_tr_b16 a[206:207], v245 offset:3072
 v_cvt_pk_bf16_f32 v199, v218, v219
 v_mfma_f32_16x16x32_bf16 v[208:211], a[140:143], a[36:39], v[208:211]
 s_waitcnt lgkmcnt(5)
 ds_read_b64_tr_b16 a[208:209], v245 offset:8
 v_mul_f32 v221, s20, v221
 v_mfma_f32_16x16x32_bf16 v[208:211], a[144:147], a[40:43], v[208:211]
 s_waitcnt lgkmcnt(5)
 ds_read_b64_tr_b16 a[210:211], v245 offset:1032
 v_mul_f32 v222, s20, v222
 v_mfma_f32_16x16x32_bf16 v[208:211], a[148:151], a[44:47], v[208:211]
 ds_read_b64_tr_b16 a[212:213], v245 offset:2056
 v_mul_f32 v223, s20, v223
 v_mfma_f32_16x16x32_bf16 v[212:215], a[148:151], a[60:63], v[228:231]
 v_exp_f32 v220, v220
 v_mfma_f32_16x16x32_bf16 v[212:215], a[144:147], a[56:59], v[212:215]
 v_exp_f32 v221, v221
 v_mfma_f32_16x16x32_bf16 v[212:215], a[140:143], a[52:55], v[212:215]
 v_exp_f32 v222, v222
 v_mfma_f32_16x16x32_bf16 v[212:215], a[136:139], a[48:51], v[212:215]
 v_exp_f32 v223, v223
 v_mfma_f32_16x16x32_bf16 v[216:219], a[136:139], a[64:67], v[232:235]
 ds_read_b64_tr_b16 a[214:215], v245 offset:3080
 v_cvt_pk_bf16_f32 v206, v220, v221
 v_mfma_f32_16x16x32_bf16 v[216:219], a[140:143], a[68:71], v[216:219]
 v_cvt_pk_bf16_f32 v207, v222, v223
 v_mul_f32 v208, s20, v208
 v_mfma_f32_16x16x32_bf16 v[216:219], a[144:147], a[72:75], v[216:219]
 buffer_load_dwordx4 v250, s[12:15], s38 offen offset:2048 lds
 v_mfma_f32_16x16x32_bf16 v[216:219], a[148:151], a[76:79], v[216:219]
 v_mul_f32 v209, s20, v209
 v_mul_f32 v210, s20, v210
 v_mfma_f32_16x16x32_bf16 v[220:223], a[148:151], a[92:95], v[236:239]
 ds_read_b128 a[152:155], v244 offset:2048
 v_mul_f32 v211, s20, v211
 v_mfma_f32_16x16x32_bf16 v[220:223], a[144:147], a[88:91], v[220:223]
 v_exp_f32 v208, v208
 v_mfma_f32_16x16x32_bf16 v[220:223], a[140:143], a[84:87], v[220:223]
 v_exp_f32 v209, v209
 v_exp_f32 v210, v210
 v_exp_f32 v211, v211
 v_pk_mul_f32 v[212:213], v[212:213], s[20:21]
 v_pk_mul_f32 v[214:215], v[214:215], s[20:21]
 v_pk_mul_f32 v[216:217], v[216:217], s[20:21]
 v_pk_mul_f32 v[218:219], v[218:219], s[20:21]
 v_cvt_pk_bf16_f32 v128, v208, v209
 v_mfma_f32_16x16x32_bf16 v[220:223], a[136:139], a[80:83], v[220:223]
 ds_read_b128 a[156:159], v244 offset:2112
 v_cvt_pk_bf16_f32 v129, v210, v211
 v_mfma_f32_16x16x32_bf16 v[208:211], a[136:139], a[96:99], v[240:243]
 buffer_store_dwordx4 a[224:227], v255, s[16:19], s50 offen offset:0 nt
 buffer_store_dwordx4 a[228:231], v255, s[16:19], s50 offen offset:2048 nt
 v_mfma_f32_16x16x32_bf16 v[208:211], a[140:143], a[100:103], v[208:211]
 v_exp_f32 v212, v212
 v_mfma_f32_16x16x32_bf16 v[208:211], a[144:147], a[104:107], v[208:211]
 ds_read_b128 a[160:163], v244 offset:2176
 v_mul_f32 v220, s20, v220
 v_mfma_f32_16x16x32_bf16 v[208:211], a[148:151], a[108:111], v[208:211]
 s_waitcnt lgkmcnt(9)
 ds_read_b128 a[164:167], v244 offset:2240
 v_mul_f32 v221, s20, v221
 v_mfma_f32_16x16x32_bf16 v[0:3], a[200:203], v[168:171], v[0:3]
 s_waitcnt lgkmcnt(8)
 v_exp_f32 v213, v213
 v_mfma_f32_16x16x32_bf16 v[0:3], a[204:207], v[172:175], v[0:3]
 v_exp_f32 v214, v214
 v_mfma_f32_16x16x32_bf16 v[32:35], a[204:207], v[180:183], v[32:35]
 buffer_load_dwordx4 v250, s[12:15], s38 offen offset:3072 lds
 v_mfma_f32_16x16x32_bf16 v[32:35], a[200:203], v[176:179], v[32:35]
 v_exp_f32 v215, v215
 v_mfma_f32_16x16x32_bf16 v[64:67], a[200:203], v[184:187], v[64:67]
 v_cvt_pk_bf16_f32 v136, v212, v213
 v_cvt_pk_bf16_f32 v137, v214, v215
 v_mfma_f32_16x16x32_bf16 v[64:67], a[204:207], v[188:191], v[64:67]
 v_exp_f32 v216, v216
 v_mfma_f32_16x16x32_bf16 v[96:99], a[204:207], v[196:199], v[96:99]
 v_exp_f32 v217, v217
 v_mfma_f32_16x16x32_bf16 v[96:99], a[200:203], v[192:195], v[96:99]
 v_exp_f32 v218, v218
 v_mfma_f32_16x16x32_bf16 a[0:3], a[200:203], v[200:203], a[0:3]
 v_exp_f32 v219, v219
 v_mfma_f32_16x16x32_bf16 a[0:3], a[204:207], v[204:207], a[0:3]
 s_waitcnt lgkmcnt(6)
 ds_read_b64_tr_b16 a[200:201], v246 offset:0
 v_cvt_pk_bf16_f32 v144, v216, v217
 v_mfma_f32_16x16x32_bf16 v[4:7], a[208:211], v[168:171], v[4:7]
 s_waitcnt lgkmcnt(5)
 ds_read_b64_tr_b16 a[202:203], v246 offset:1024
 v_cvt_pk_bf16_f32 v145, v218, v219
 v_mfma_f32_16x16x32_bf16 v[4:7], a[212:215], v[172:175], v[4:7]
 s_add_u32 s37, s27, 114688
 ds_read_b64_tr_b16 a[204:205], v246 offset:2048
 v_mul_f32 v222, s20, v222
 v_mfma_f32_16x16x32_bf16 v[36:39], a[212:215], v[180:183], v[36:39]
 s_add_u32 m0, s22, 50944
 ds_read_b64_tr_b16 a[206:207], v246 offset:3072
 v_mul_f32 v223, s20, v223
 v_mfma_f32_16x16x32_bf16 v[36:39], a[208:211], v[176:179], v[36:39]
 v_exp_f32 v220, v220
 v_mfma_f32_16x16x32_bf16 v[68:71], a[208:211], v[184:187], v[68:71]
 buffer_load_dwordx4 v249, s[8:11], s37 offen offset:0 lds
 v_mfma_f32_16x16x32_bf16 v[68:71], a[212:215], v[188:191], v[68:71]
 v_exp_f32 v221, v221
 v_mfma_f32_16x16x32_bf16 v[100:103], a[212:215], v[196:199], v[100:103]
 v_exp_f32 v222, v222
 v_mfma_f32_16x16x32_bf16 v[100:103], a[208:211], v[192:195], v[100:103]
 v_exp_f32 v223, v223
 v_mfma_f32_16x16x32_bf16 a[4:7], a[208:211], v[200:203], a[4:7]
 v_cvt_pk_bf16_f32 v152, v220, v221
 v_cvt_pk_bf16_f32 v153, v222, v223
 v_mfma_f32_16x16x32_bf16 a[4:7], a[212:215], v[204:207], a[4:7]
 ds_read_b64_tr_b16 a[208:209], v246 offset:8
 v_mul_f32 v208, s20, v208
 v_mfma_f32_16x16x32_bf16 a[112:115], a[132:135], v[168:171], a[112:115]
 ds_read_b64_tr_b16 a[210:211], v246 offset:1032
 v_mul_f32 v209, s20, v209
 v_mfma_f32_16x16x32_bf16 a[112:115], a[132:135], v[172:175], a[112:115]
 v_mul_f32 v210, s20, v210
 v_mul_f32 v211, s20, v211
 v_mfma_f32_16x16x32_bf16 a[128:131], a[132:135], v[200:203], a[128:131]
 v_exp_f32 v208, v208
 v_mfma_f32_16x16x32_bf16 a[128:131], a[132:135], v[204:207], a[128:131]
 s_waitcnt lgkmcnt(9)
 v_exp_f32 v209, v209
 v_mfma_f32_16x16x32_bf16 v[212:215], a[152:155], a[32:35], v[224:227]
 s_waitcnt lgkmcnt(8)
 v_exp_f32 v210, v210
 v_mfma_f32_16x16x32_bf16 v[212:215], a[156:159], a[36:39], v[212:215]
 s_waitcnt lgkmcnt(7)
 v_exp_f32 v211, v211
 v_mfma_f32_16x16x32_bf16 v[212:215], a[160:163], a[40:43], v[212:215]
 s_waitcnt lgkmcnt(6)
 buffer_load_dwordx4 v249, s[8:11], s37 offen offset:1024 lds
 v_mfma_f32_16x16x32_bf16 v[212:215], a[164:167], a[44:47], v[212:215]
 ds_read_b64_tr_b16 a[212:213], v246 offset:2056
 v_cvt_pk_bf16_f32 v160, v208, v209
 v_mfma_f32_16x16x32_bf16 v[216:219], a[164:167], a[60:63], v[228:231]
 ds_read_b64_tr_b16 a[214:215], v246 offset:3080
 v_cvt_pk_bf16_f32 v161, v210, v211
 v_mfma_f32_16x16x32_bf16 v[216:219], a[160:163], a[56:59], v[216:219]
 ds_read_b128 a[136:139], v244 offset:3072
 ds_read_b128 a[140:143], v244 offset:3136
 v_mfma_f32_16x16x32_bf16 v[216:219], a[156:159], a[52:55], v[216:219]
 v_mul_f32 v212, s20, v212
 v_mul_f32 v213, s20, v213
 v_mfma_f32_16x16x32_bf16 v[216:219], a[152:155], a[48:51], v[216:219]
 v_mul_f32 v214, s20, v214
 v_mul_f32 v215, s20, v215
 v_mfma_f32_16x16x32_bf16 v[220:223], a[152:155], a[64:67], v[232:235]
 v_exp_f32 v212, v212
 v_mfma_f32_16x16x32_bf16 v[220:223], a[156:159], a[68:71], v[220:223]
 v_exp_f32 v213, v213
 v_mfma_f32_16x16x32_bf16 v[220:223], a[160:163], a[72:75], v[220:223]
 v_exp_f32 v214, v214
 v_mfma_f32_16x16x32_bf16 v[220:223], a[164:167], a[76:79], v[220:223]
 v_exp_f32 v215, v215
 v_mfma_f32_16x16x32_bf16 v[208:211], a[164:167], a[92:95], v[236:239]
 v_cvt_pk_bf16_f32 v130, v212, v213
 v_cvt_pk_bf16_f32 v131, v214, v215
 v_mfma_f32_16x16x32_bf16 v[208:211], a[160:163], a[88:91], v[208:211]
 ds_read_b128 a[144:147], v244 offset:3200
 v_mul_f32 v216, s20, v216
 v_mfma_f32_16x16x32_bf16 v[208:211], a[156:159], a[84:87], v[208:211]
 buffer_load_dwordx4 v249, s[8:11], s37 offen offset:2048 lds
 v_mfma_f32_16x16x32_bf16 v[208:211], a[152:155], a[80:83], v[208:211]
 ds_read_b128 a[148:151], v244 offset:3264
 v_mul_f32 v217, s20, v217
 v_mfma_f32_16x16x32_bf16 v[212:215], a[152:155], a[96:99], v[240:243]
 v_mul_f32 v218, s20, v218
 v_mul_f32 v219, s20, v219
 v_mfma_f32_16x16x32_bf16 v[212:215], a[156:159], a[100:103], v[212:215]
 v_exp_f32 v216, v216
 v_mfma_f32_16x16x32_bf16 v[212:215], a[160:163], a[104:107], v[212:215]
 v_exp_f32 v217, v217
 v_mfma_f32_16x16x32_bf16 v[212:215], a[164:167], a[108:111], v[212:215]
 s_waitcnt lgkmcnt(10)
 v_exp_f32 v218, v218
 v_mfma_f32_16x16x32_bf16 v[8:11], a[200:203], v[168:171], v[8:11]
 s_waitcnt lgkmcnt(8)
 v_exp_f32 v219, v219
 v_mfma_f32_16x16x32_bf16 v[8:11], a[204:207], v[172:175], v[8:11]
 v_cvt_pk_bf16_f32 v138, v216, v217
 v_cvt_pk_bf16_f32 v139, v218, v219
 v_mfma_f32_16x16x32_bf16 v[40:43], a[204:207], v[180:183], v[40:43]
 v_mul_f32 v220, s20, v220
 v_mul_f32 v221, s20, v221
 v_mfma_f32_16x16x32_bf16 v[40:43], a[200:203], v[176:179], v[40:43]
 v_mul_f32 v222, s20, v222
 v_mul_f32 v223, s20, v223
 v_mfma_f32_16x16x32_bf16 v[72:75], a[200:203], v[184:187], v[72:75]
 v_exp_f32 v220, v220
 v_mfma_f32_16x16x32_bf16 v[72:75], a[204:207], v[188:191], v[72:75]
 v_exp_f32 v221, v221
 v_mfma_f32_16x16x32_bf16 v[104:107], a[204:207], v[196:199], v[104:107]
 buffer_load_dwordx4 v249, s[8:11], s37 offen offset:3072 lds
 v_mfma_f32_16x16x32_bf16 v[104:107], a[200:203], v[192:195], v[104:107]
 v_exp_f32 v222, v222
 v_mfma_f32_16x16x32_bf16 a[8:11], a[200:203], v[200:203], a[8:11]
 v_exp_f32 v223, v223
 v_mfma_f32_16x16x32_bf16 a[8:11], a[204:207], v[204:207], a[8:11]
 s_waitcnt lgkmcnt(6)
 ds_read_b64_tr_b16 a[200:201], v247 offset:0
 v_cvt_pk_bf16_f32 v146, v220, v221
 v_mfma_f32_16x16x32_bf16 v[12:15], a[208:211], v[168:171], v[12:15]
 s_waitcnt lgkmcnt(5)
 ds_read_b64_tr_b16 a[202:203], v247 offset:1024
 v_cvt_pk_bf16_f32 v147, v222, v223
 v_mfma_f32_16x16x32_bf16 v[12:15], a[212:215], v[172:175], v[12:15]
 ds_read_b64_tr_b16 a[204:205], v247 offset:2048
 v_mul_f32 v208, s20, v208
 v_mfma_f32_16x16x32_bf16 v[44:47], a[212:215], v[180:183], v[44:47]
 ds_read_b64_tr_b16 a[206:207], v247 offset:3072
 v_mul_f32 v209, s20, v209
 v_mfma_f32_16x16x32_bf16 v[44:47], a[208:211], v[176:179], v[44:47]
 v_mul_f32 v210, s20, v210
 v_mul_f32 v211, s20, v211
 v_mfma_f32_16x16x32_bf16 v[76:79], a[208:211], v[184:187], v[76:79]
 v_exp_f32 v208, v208
 v_mfma_f32_16x16x32_bf16 v[76:79], a[212:215], v[188:191], v[76:79]
 v_exp_f32 v209, v209
 v_mfma_f32_16x16x32_bf16 v[108:111], a[212:215], v[196:199], v[108:111]
 s_add_u32 m0, s62, 6016
 v_exp_f32 v210, v210
 v_mfma_f32_16x16x32_bf16 v[108:111], a[208:211], v[192:195], v[108:111]
 v_exp_f32 v211, v211
 v_mfma_f32_16x16x32_bf16 a[12:15], a[208:211], v[200:203], a[12:15]
 buffer_load_dwordx4 v251, s[4:7], s33 offen offset:128 lds
 v_mfma_f32_16x16x32_bf16 a[12:15], a[212:215], v[204:207], a[12:15]
 s_add_u32 m0, s62, 6976
 v_cvt_pk_bf16_f32 v154, v208, v209
 v_cvt_pk_bf16_f32 v155, v210, v211
 v_mfma_f32_16x16x32_bf16 a[116:119], a[132:135], v[176:179], a[116:119]
 ds_read_b64_tr_b16 a[208:209], v247 offset:8
 v_mul_f32 v212, s20, v212
 v_mfma_f32_16x16x32_bf16 a[116:119], a[132:135], v[180:183], a[116:119]
 s_waitcnt lgkmcnt(8)
 buffer_load_dwordx4 v251, s[4:7], s33 offen offset:192 lds
 v_mfma_f32_16x16x32_bf16 v[216:219], a[136:139], a[32:35], v[224:227]
 s_waitcnt lgkmcnt(7)
 ds_read_b64_tr_b16 a[210:211], v247 offset:1032
 v_mul_f32 v213, s20, v213
 v_mfma_f32_16x16x32_bf16 v[216:219], a[140:143], a[36:39], v[216:219]
 s_waitcnt lgkmcnt(7)
 v_mul_f32 v214, s20, v214
 v_mul_f32 v215, s20, v215
 v_mfma_f32_16x16x32_bf16 v[216:219], a[144:147], a[40:43], v[216:219]
 s_waitcnt lgkmcnt(6)
 v_exp_f32 v212, v212
 v_mfma_f32_16x16x32_bf16 v[216:219], a[148:151], a[44:47], v[216:219]
 v_exp_f32 v213, v213
 v_mfma_f32_16x16x32_bf16 v[220:223], a[148:151], a[60:63], v[228:231]
 v_exp_f32 v214, v214
 v_mfma_f32_16x16x32_bf16 v[220:223], a[144:147], a[56:59], v[220:223]
 v_exp_f32 v215, v215
 v_mfma_f32_16x16x32_bf16 v[220:223], a[140:143], a[52:55], v[220:223]
 ds_read_b64_tr_b16 a[212:213], v247 offset:2056
 v_cvt_pk_bf16_f32 v162, v212, v213
 v_mfma_f32_16x16x32_bf16 v[220:223], a[136:139], a[48:51], v[220:223]
 ds_read_b64_tr_b16 a[214:215], v247 offset:3080
 v_cvt_pk_bf16_f32 v163, v214, v215
 v_mfma_f32_16x16x32_bf16 v[208:211], a[136:139], a[64:67], v[232:235]
 v_mul_f32 v216, s20, v216
 v_mul_f32 v217, s20, v217
 v_mfma_f32_16x16x32_bf16 v[208:211], a[140:143], a[68:71], v[208:211]
 v_mul_f32 v218, s20, v218
 v_mul_f32 v219, s20, v219
 v_mfma_f32_16x16x32_bf16 v[208:211], a[144:147], a[72:75], v[208:211]
 v_exp_f32 v216, v216
 v_mfma_f32_16x16x32_bf16 v[208:211], a[148:151], a[76:79], v[208:211]
 v_exp_f32 v217, v217
 v_mfma_f32_16x16x32_bf16 v[212:215], a[148:151], a[92:95], v[236:239]
 v_exp_f32 v218, v218
 v_mfma_f32_16x16x32_bf16 v[212:215], a[144:147], a[88:91], v[212:215]
 v_exp_f32 v219, v219
 v_mfma_f32_16x16x32_bf16 v[212:215], a[140:143], a[84:87], v[212:215]
 v_cvt_pk_bf16_f32 v132, v216, v217
 v_cvt_pk_bf16_f32 v133, v218, v219
 v_mfma_f32_16x16x32_bf16 v[212:215], a[136:139], a[80:83], v[212:215]
 ds_read_b64_tr_b16 a[168:169], v248 offset:0
 v_mul_f32 v220, s20, v220
 v_mfma_f32_16x16x32_bf16 v[216:219], a[136:139], a[96:99], v[240:243]
 ds_read_b64_tr_b16 a[170:171], v248 offset:1024
 v_mul_f32 v221, s20, v221
 v_mfma_f32_16x16x32_bf16 v[216:219], a[140:143], a[100:103], v[216:219]
 ds_read_b64_tr_b16 a[172:173], v248 offset:2048
 v_mul_f32 v222, s20, v222
 v_mfma_f32_16x16x32_bf16 v[216:219], a[144:147], a[104:107], v[216:219]
 ds_read_b64_tr_b16 a[174:175], v248 offset:3072
 v_mul_f32 v223, s20, v223
 v_mfma_f32_16x16x32_bf16 v[216:219], a[148:151], a[108:111], v[216:219]
 s_waitcnt lgkmcnt(10)
 ds_read_b64_tr_b16 a[176:177], v248 offset:8
 v_mul_f32 v208, s20, v208
 v_mfma_f32_16x16x32_bf16 v[16:19], a[200:203], v[168:171], v[16:19]
 s_waitcnt lgkmcnt(9)
 ds_read_b64_tr_b16 a[178:179], v248 offset:1032
 v_mul_f32 v209, s20, v209
 v_mfma_f32_16x16x32_bf16 v[16:19], a[204:207], v[172:175], v[16:19]
 ds_read_b64_tr_b16 a[180:181], v248 offset:2056
 v_mul_f32 v210, s20, v210
 v_mfma_f32_16x16x32_bf16 v[48:51], a[204:207], v[180:183], v[48:51]
 ds_read_b64_tr_b16 a[182:183], v248 offset:3080
 v_mul_f32 v211, s20, v211
 v_mfma_f32_16x16x32_bf16 v[48:51], a[200:203], v[176:179], v[48:51]
 ds_read_b128 a[152:155], v244 offset:4096
 v_mul_f32 v212, s20, v212
 v_mfma_f32_16x16x32_bf16 v[80:83], a[200:203], v[184:187], v[80:83]
 ds_read_b128 a[156:159], v244 offset:4160
 v_mul_f32 v213, s20, v213
 v_mfma_f32_16x16x32_bf16 v[80:83], a[204:207], v[188:191], v[80:83]
 ds_read_b128 a[160:163], v244 offset:4224
 v_mul_f32 v214, s20, v214
 v_mfma_f32_16x16x32_bf16 v[112:115], a[204:207], v[196:199], v[112:115]
 ds_read_b128 a[164:167], v244 offset:4288
 v_mul_f32 v215, s20, v215
 v_mfma_f32_16x16x32_bf16 v[112:115], a[200:203], v[192:195], v[112:115]
 v_exp_f32 v220, v220
 v_mfma_f32_16x16x32_bf16 a[16:19], a[200:203], v[200:203], a[16:19]
 v_exp_f32 v221, v221
 v_mfma_f32_16x16x32_bf16 a[16:19], a[204:207], v[204:207], a[16:19]
 s_waitcnt lgkmcnt(14)
 v_exp_f32 v222, v222
 v_mfma_f32_16x16x32_bf16 v[20:23], a[208:211], v[168:171], v[20:23]
 s_waitcnt lgkmcnt(12)
 v_exp_f32 v223, v223
 v_mfma_f32_16x16x32_bf16 v[20:23], a[212:215], v[172:175], v[20:23]
 v_cvt_pk_bf16_f32 v140, v220, v221
 v_cvt_pk_bf16_f32 v141, v222, v223
 v_mfma_f32_16x16x32_bf16 v[52:55], a[212:215], v[180:183], v[52:55]
 v_exp_f32 v208, v208
 v_mfma_f32_16x16x32_bf16 v[52:55], a[208:211], v[176:179], v[52:55]
 v_exp_f32 v209, v209
 v_mfma_f32_16x16x32_bf16 v[84:87], a[208:211], v[184:187], v[84:87]
 v_exp_f32 v210, v210
 v_mfma_f32_16x16x32_bf16 v[84:87], a[212:215], v[188:191], v[84:87]
 v_exp_f32 v211, v211
 v_mfma_f32_16x16x32_bf16 v[116:119], a[212:215], v[196:199], v[116:119]
 v_cvt_pk_bf16_f32 v148, v208, v209
 v_cvt_pk_bf16_f32 v149, v210, v211
 v_mfma_f32_16x16x32_bf16 v[116:119], a[208:211], v[192:195], v[116:119]
 v_exp_f32 v212, v212
 v_mfma_f32_16x16x32_bf16 a[20:23], a[208:211], v[200:203], a[20:23]
 s_waitcnt vmcnt(18) lgkmcnt(0)
 ds_inc_u32 v249, v252
 v_mul_f32 v216, s20, v216
 v_mfma_f32_16x16x32_bf16 a[20:23], a[212:215], v[204:207], a[20:23]
 s_add_u32 s2, s2, 4
 v_exp_f32 v213, v213
 v_mfma_f32_16x16x32_bf16 a[120:123], a[132:135], v[184:187], a[120:123]
 v_exp_f32 v214, v214
 v_mfma_f32_16x16x32_bf16 a[120:123], a[132:135], v[188:191], a[120:123]
 v_exp_f32 v215, v215
 v_mfma_f32_16x16x32_bf16 v[220:223], a[152:155], a[32:35], v[224:227]
 v_cvt_pk_bf16_f32 v156, v212, v213
 v_cvt_pk_bf16_f32 v157, v214, v215
 v_mfma_f32_16x16x32_bf16 v[220:223], a[156:159], a[36:39], v[220:223]
 v_mul_f32 v217, s20, v217
 v_mul_f32 v218, s20, v218
 v_mfma_f32_16x16x32_bf16 v[220:223], a[160:163], a[40:43], v[220:223]
 v_exp_f32 v216, v216
 v_mfma_f32_16x16x32_bf16 v[220:223], a[164:167], a[44:47], v[220:223]
 v_exp_f32 v217, v217
 v_mfma_f32_16x16x32_bf16 v[208:211], a[164:167], a[60:63], v[228:231]
 v_mul_f32 v219, s20, v219
 v_cvt_pk_bf16_f32 v164, v216, v217
 v_mfma_f32_16x16x32_bf16 v[208:211], a[160:163], a[56:59], v[208:211]
 v_exp_f32 v218, v218
 v_mfma_f32_16x16x32_bf16 v[208:211], a[156:159], a[52:55], v[208:211]
 v_exp_f32 v219, v219
 v_mfma_f32_16x16x32_bf16 v[208:211], a[152:155], a[48:51], v[208:211]
 v_cvt_pk_bf16_f32 v165, v218, v219
 v_mul_f32 v220, s20, v220
 v_mfma_f32_16x16x32_bf16 v[212:215], a[152:155], a[64:67], v[232:235]
 v_mul_f32 v221, s20, v221
 v_mul_f32 v222, s20, v222
 v_mfma_f32_16x16x32_bf16 v[212:215], a[156:159], a[68:71], v[212:215]
 v_exp_f32 v220, v220
 v_mfma_f32_16x16x32_bf16 v[212:215], a[160:163], a[72:75], v[212:215]
 v_mul_f32 v223, s20, v223
 v_mul_f32 v208, s20, v208
 v_mfma_f32_16x16x32_bf16 v[212:215], a[164:167], a[76:79], v[212:215]
 v_exp_f32 v221, v221
 v_mfma_f32_16x16x32_bf16 v[216:219], a[164:167], a[92:95], v[236:239]
 v_exp_f32 v222, v222
 v_mfma_f32_16x16x32_bf16 v[216:219], a[160:163], a[88:91], v[216:219]
 v_exp_f32 v223, v223
 v_mfma_f32_16x16x32_bf16 v[216:219], a[156:159], a[84:87], v[216:219]
 v_cvt_pk_bf16_f32 v134, v220, v221
 v_cvt_pk_bf16_f32 v135, v222, v223
 v_mfma_f32_16x16x32_bf16 v[216:219], a[152:155], a[80:83], v[216:219]
 v_mul_f32 v209, s20, v209
 v_mul_f32 v210, s20, v210
 v_mfma_f32_16x16x32_bf16 v[220:223], a[152:155], a[96:99], v[240:243]
 v_mul_f32 v211, s20, v211
 v_mul_f32 v212, s20, v212
 v_mfma_f32_16x16x32_bf16 v[220:223], a[156:159], a[100:103], v[220:223]
 ds_read_b32 v167, v249
 v_mul_f32 v213, s20, v213
 v_mfma_f32_16x16x32_bf16 v[220:223], a[160:163], a[104:107], v[220:223]
 v_exp_f32 v208, v208
 v_mfma_f32_16x16x32_bf16 v[220:223], a[164:167], a[108:111], v[220:223]
 v_exp_f32 v209, v209
 v_mfma_f32_16x16x32_bf16 v[24:27], a[168:171], v[168:171], v[24:27]
 v_exp_f32 v210, v210
 v_mfma_f32_16x16x32_bf16 v[24:27], a[172:175], v[172:175], v[24:27]
 v_exp_f32 v211, v211
 v_mfma_f32_16x16x32_bf16 v[56:59], a[172:175], v[180:183], v[56:59]
 v_cvt_pk_bf16_f32 v142, v208, v209
 v_cvt_pk_bf16_f32 v143, v210, v211
 v_mfma_f32_16x16x32_bf16 v[56:59], a[168:171], v[176:179], v[56:59]
 v_mul_f32 v214, s20, v214
 v_mul_f32 v215, s20, v215
 v_mfma_f32_16x16x32_bf16 v[88:91], a[168:171], v[184:187], v[88:91]
 s_waitcnt lgkmcnt(0)
 v_cmp_gt_u32 vcc, s2, v167
 v_mul_f32 v216, s20, v216
 v_mfma_f32_16x16x32_bf16 v[88:91], a[172:175], v[188:191], v[88:91]
 s_add_u32 s38, s27, 98304
 v_exp_f32 v212, v212
 v_mfma_f32_16x16x32_bf16 v[120:123], a[172:175], v[196:199], v[120:123]
 s_cbranch_vccnz Lspin5_4
Lback5_4:
 ds_read_b128 a[136:139], v244 offset:17664
 v_mul_f32 v217, s20, v217
 v_mfma_f32_16x16x32_bf16 v[120:123], a[168:171], v[192:195], v[120:123]
 s_add_u32 m0, s23, 0
 ds_read_b128 a[140:143], v244 offset:17728
 v_mul_f32 v218, s20, v218
 v_mfma_f32_16x16x32_bf16 a[24:27], a[168:171], v[200:203], a[24:27]
 buffer_load_dwordx4 v250, s[12:15], s38 offen offset:0 lds
 v_mfma_f32_16x16x32_bf16 a[24:27], a[172:175], v[204:207], a[24:27]
 ds_read_b128 a[144:147], v244 offset:17792
 v_mul_f32 v219, s20, v219
 v_mfma_f32_16x16x32_bf16 v[28:31], a[176:179], v[168:171], v[28:31]
 ds_read_b128 a[148:151], v244 offset:17856
 v_mul_f32 v220, s20, v220
 v_mfma_f32_16x16x32_bf16 v[28:31], a[180:183], v[172:175], v[28:31]
 v_exp_f32 v213, v213
 v_mfma_f32_16x16x32_bf16 v[60:63], a[180:183], v[180:183], v[60:63]
 v_exp_f32 v214, v214
 v_mfma_f32_16x16x32_bf16 v[60:63], a[176:179], v[176:179], v[60:63]
 v_exp_f32 v215, v215
 v_mfma_f32_16x16x32_bf16 v[92:95], a[176:179], v[184:187], v[92:95]
 ds_read_b64_tr_b16 a[200:201], v245 offset:16416
 v_cvt_pk_bf16_f32 v150, v212, v213
 v_mfma_f32_16x16x32_bf16 v[92:95], a[180:183], v[188:191], v[92:95]
 ds_read_b64_tr_b16 a[202:203], v245 offset:17440
 v_cvt_pk_bf16_f32 v151, v214, v215
 v_mfma_f32_16x16x32_bf16 v[124:127], a[180:183], v[196:199], v[124:127]
 v_exp_f32 v216, v216
 v_mfma_f32_16x16x32_bf16 v[124:127], a[176:179], v[192:195], v[124:127]
 v_exp_f32 v217, v217
 v_mfma_f32_16x16x32_bf16 a[28:31], a[176:179], v[200:203], a[28:31]
 v_exp_f32 v218, v218
 v_mfma_f32_16x16x32_bf16 a[28:31], a[180:183], v[204:207], a[28:31]
 v_exp_f32 v219, v219
 v_mfma_f32_16x16x32_bf16 a[124:127], a[132:135], v[192:195], a[124:127]
 buffer_load_dwordx4 v250, s[12:15], s38 offen offset:1024 lds
 v_mfma_f32_16x16x32_bf16 a[124:127], a[132:135], v[196:199], a[124:127]
 s_waitcnt lgkmcnt(5)
 ds_read_b64_tr_b16 a[204:205], v245 offset:18464
 v_cvt_pk_bf16_f32 v158, v216, v217
 v_mfma_f32_16x16x32_bf16 v[208:211], a[136:139], a[32:35], v[224:227]
 s_waitcnt lgkmcnt(5)
 ds_read_b64_tr_b16 a[206:207], v245 offset:19488
 v_cvt_pk_bf16_f32 v159, v218, v219
 v_mfma_f32_16x16x32_bf16 v[208:211], a[140:143], a[36:39], v[208:211]
 s_waitcnt lgkmcnt(5)
 ds_read_b64_tr_b16 a[208:209], v245 offset:16424
 v_mul_f32 v221, s20, v221
 v_mfma_f32_16x16x32_bf16 v[208:211], a[144:147], a[40:43], v[208:211]
 s_waitcnt lgkmcnt(5)
 ds_read_b64_tr_b16 a[210:211], v245 offset:17448
 v_mul_f32 v222, s20, v222
 v_mfma_f32_16x16x32_bf16 v[208:211], a[148:151], a[44:47], v[208:211]
 ds_read_b64_tr_b16 a[212:213], v245 offset:18472
 v_mul_f32 v223, s20, v223
 v_mfma_f32_16x16x32_bf16 v[212:215], a[148:151], a[60:63], v[228:231]
 v_exp_f32 v220, v220
 v_mfma_f32_16x16x32_bf16 v[212:215], a[144:147], a[56:59], v[212:215]
 v_exp_f32 v221, v221
 v_mfma_f32_16x16x32_bf16 v[212:215], a[140:143], a[52:55], v[212:215]
 v_exp_f32 v222, v222
 v_mfma_f32_16x16x32_bf16 v[212:215], a[136:139], a[48:51], v[212:215]
 v_exp_f32 v223, v223
 v_mfma_f32_16x16x32_bf16 v[216:219], a[136:139], a[64:67], v[232:235]
 ds_read_b64_tr_b16 a[214:215], v245 offset:19496
 v_cvt_pk_bf16_f32 v166, v220, v221
 v_mfma_f32_16x16x32_bf16 v[216:219], a[140:143], a[68:71], v[216:219]
 v_cvt_pk_bf16_f32 v167, v222, v223
 v_mul_f32 v208, s20, v208
 v_mfma_f32_16x16x32_bf16 v[216:219], a[144:147], a[72:75], v[216:219]
 buffer_load_dwordx4 v250, s[12:15], s38 offen offset:2048 lds
 v_mfma_f32_16x16x32_bf16 v[216:219], a[148:151], a[76:79], v[216:219]
 v_mul_f32 v209, s20, v209
 v_mul_f32 v210, s20, v210
 v_mfma_f32_16x16x32_bf16 v[220:223], a[148:151], a[92:95], v[236:239]
 ds_read_b128 a[152:155], v244 offset:18688
 v_mul_f32 v211, s20, v211
 v_mfma_f32_16x16x32_bf16 v[220:223], a[144:147], a[88:91], v[220:223]
 v_exp_f32 v208, v208
 v_mfma_f32_16x16x32_bf16 v[220:223], a[140:143], a[84:87], v[220:223]
 v_exp_f32 v209, v209
 v_exp_f32 v210, v210
 v_exp_f32 v211, v211
 v_pk_mul_f32 v[212:213], v[212:213], s[20:21]
 v_pk_mul_f32 v[214:215], v[214:215], s[20:21]
 v_pk_mul_f32 v[216:217], v[216:217], s[20:21]
 v_pk_mul_f32 v[218:219], v[218:219], s[20:21]
 v_cvt_pk_bf16_f32 v168, v208, v209
 v_mfma_f32_16x16x32_bf16 v[220:223], a[136:139], a[80:83], v[220:223]
 ds_read_b128 a[156:159], v244 offset:18752
 v_cvt_pk_bf16_f32 v169, v210, v211
 v_mfma_f32_16x16x32_bf16 v[208:211], a[136:139], a[96:99], v[240:243]
 buffer_store_dwordx4 a[232:235], v255, s[16:19], s51 offen offset:0 nt
 buffer_store_dwordx4 a[236:239], v255, s[16:19], s51 offen offset:2048 nt
 v_mfma_f32_16x16x32_bf16 v[208:211], a[140:143], a[100:103], v[208:211]
 v_exp_f32 v212, v212
 v_mfma_f32_16x16x32_bf16 v[208:211], a[144:147], a[104:107], v[208:211]
 ds_read_b128 a[160:163], v244 offset:18816
 v_mul_f32 v220, s20, v220
 v_mfma_f32_16x16x32_bf16 v[208:211], a[148:151], a[108:111], v[208:211]
 s_waitcnt lgkmcnt(9)
 ds_read_b128 a[164:167], v244 offset:18880
 v_mul_f32 v221, s20, v221
 v_mfma_f32_16x16x32_bf16 v[0:3], a[200:203], v[128:131], v[0:3]
 s_waitcnt lgkmcnt(8)
 v_exp_f32 v213, v213
 v_mfma_f32_16x16x32_bf16 v[0:3], a[204:207], v[132:135], v[0:3]
 v_exp_f32 v214, v214
 v_mfma_f32_16x16x32_bf16 v[32:35], a[204:207], v[140:143], v[32:35]
 buffer_load_dwordx4 v250, s[12:15], s38 offen offset:3072 lds
 v_mfma_f32_16x16x32_bf16 v[32:35], a[200:203], v[136:139], v[32:35]
 v_exp_f32 v215, v215
 v_mfma_f32_16x16x32_bf16 v[64:67], a[200:203], v[144:147], v[64:67]
 v_cvt_pk_bf16_f32 v176, v212, v213
 v_cvt_pk_bf16_f32 v177, v214, v215
 v_mfma_f32_16x16x32_bf16 v[64:67], a[204:207], v[148:151], v[64:67]
 v_exp_f32 v216, v216
 v_mfma_f32_16x16x32_bf16 v[96:99], a[204:207], v[156:159], v[96:99]
 v_exp_f32 v217, v217
 v_mfma_f32_16x16x32_bf16 v[96:99], a[200:203], v[152:155], v[96:99]
 v_exp_f32 v218, v218
 v_mfma_f32_16x16x32_bf16 a[0:3], a[200:203], v[160:163], a[0:3]
 v_exp_f32 v219, v219
 v_mfma_f32_16x16x32_bf16 a[0:3], a[204:207], v[164:167], a[0:3]
 s_waitcnt lgkmcnt(6)
 ds_read_b64_tr_b16 a[200:201], v246 offset:16416
 v_cvt_pk_bf16_f32 v184, v216, v217
 v_mfma_f32_16x16x32_bf16 v[4:7], a[208:211], v[128:131], v[4:7]
 s_waitcnt lgkmcnt(5)
 ds_read_b64_tr_b16 a[202:203], v246 offset:17440
 v_cvt_pk_bf16_f32 v185, v218, v219
 v_mfma_f32_16x16x32_bf16 v[4:7], a[212:215], v[132:135], v[4:7]
 s_add_u32 s37, s28, 0
 ds_read_b64_tr_b16 a[204:205], v246 offset:18464
 v_mul_f32 v222, s20, v222
 v_mfma_f32_16x16x32_bf16 v[36:39], a[212:215], v[140:143], v[36:39]
 s_add_u32 m0, s22, 1024
 ds_read_b64_tr_b16 a[206:207], v246 offset:19488
 v_mul_f32 v223, s20, v223
 v_mfma_f32_16x16x32_bf16 v[36:39], a[208:211], v[136:139], v[36:39]
 v_exp_f32 v220, v220
 v_mfma_f32_16x16x32_bf16 v[68:71], a[208:211], v[144:147], v[68:71]
 buffer_load_dwordx4 v249, s[8:11], s37 offen offset:0 lds
 v_mfma_f32_16x16x32_bf16 v[68:71], a[212:215], v[148:151], v[68:71]
 v_exp_f32 v221, v221
 v_mfma_f32_16x16x32_bf16 v[100:103], a[212:215], v[156:159], v[100:103]
 v_exp_f32 v222, v222
 v_mfma_f32_16x16x32_bf16 v[100:103], a[208:211], v[152:155], v[100:103]
 v_exp_f32 v223, v223
 v_mfma_f32_16x16x32_bf16 a[4:7], a[208:211], v[160:163], a[4:7]
 v_cvt_pk_bf16_f32 v192, v220, v221
 v_cvt_pk_bf16_f32 v193, v222, v223
 v_mfma_f32_16x16x32_bf16 a[4:7], a[212:215], v[164:167], a[4:7]
 ds_read_b64_tr_b16 a[208:209], v246 offset:16424
 v_mul_f32 v208, s20, v208
 v_mfma_f32_16x16x32_bf16 a[112:115], a[132:135], v[128:131], a[112:115]
 ds_read_b64_tr_b16 a[210:211], v246 offset:17448
 v_mul_f32 v209, s20, v209
 v_mfma_f32_16x16x32_bf16 a[112:115], a[132:135], v[132:135], a[112:115]
 v_mul_f32 v210, s20, v210
 v_mul_f32 v211, s20, v211
 v_mfma_f32_16x16x32_bf16 a[128:131], a[132:135], v[160:163], a[128:131]
 v_exp_f32 v208, v208
 v_mfma_f32_16x16x32_bf16 a[128:131], a[132:135], v[164:167], a[128:131]
 s_waitcnt lgkmcnt(9)
 v_exp_f32 v209, v209
 v_mfma_f32_16x16x32_bf16 v[212:215], a[152:155], a[32:35], v[224:227]
 s_waitcnt lgkmcnt(8)
 v_exp_f32 v210, v210
 v_mfma_f32_16x16x32_bf16 v[212:215], a[156:159], a[36:39], v[212:215]
 s_waitcnt lgkmcnt(7)
 v_exp_f32 v211, v211
 v_mfma_f32_16x16x32_bf16 v[212:215], a[160:163], a[40:43], v[212:215]
 s_waitcnt lgkmcnt(6)
 buffer_load_dwordx4 v249, s[8:11], s37 offen offset:1024 lds
 v_mfma_f32_16x16x32_bf16 v[212:215], a[164:167], a[44:47], v[212:215]
 ds_read_b64_tr_b16 a[212:213], v246 offset:18472
 v_cvt_pk_bf16_f32 v200, v208, v209
 v_mfma_f32_16x16x32_bf16 v[216:219], a[164:167], a[60:63], v[228:231]
 ds_read_b64_tr_b16 a[214:215], v246 offset:19496
 v_cvt_pk_bf16_f32 v201, v210, v211
 v_mfma_f32_16x16x32_bf16 v[216:219], a[160:163], a[56:59], v[216:219]
 ds_read_b128 a[136:139], v244 offset:19712
 ds_read_b128 a[140:143], v244 offset:19776
 v_mfma_f32_16x16x32_bf16 v[216:219], a[156:159], a[52:55], v[216:219]
 v_mul_f32 v212, s20, v212
 v_mul_f32 v213, s20, v213
 v_mfma_f32_16x16x32_bf16 v[216:219], a[152:155], a[48:51], v[216:219]
 v_mul_f32 v214, s20, v214
 v_mul_f32 v215, s20, v215
 v_mfma_f32_16x16x32_bf16 v[220:223], a[152:155], a[64:67], v[232:235]
 v_exp_f32 v212, v212
 v_mfma_f32_16x16x32_bf16 v[220:223], a[156:159], a[68:71], v[220:223]
 v_exp_f32 v213, v213
 v_mfma_f32_16x16x32_bf16 v[220:223], a[160:163], a[72:75], v[220:223]
 v_exp_f32 v214, v214
 v_mfma_f32_16x16x32_bf16 v[220:223], a[164:167], a[76:79], v[220:223]
 v_exp_f32 v215, v215
 v_mfma_f32_16x16x32_bf16 v[208:211], a[164:167], a[92:95], v[236:239]
 v_cvt_pk_bf16_f32 v170, v212, v213
 v_cvt_pk_bf16_f32 v171, v214, v215
 v_mfma_f32_16x16x32_bf16 v[208:211], a[160:163], a[88:91], v[208:211]
 ds_read_b128 a[144:147], v244 offset:19840
 v_mul_f32 v216, s20, v216
 v_mfma_f32_16x16x32_bf16 v[208:211], a[156:159], a[84:87], v[208:211]
 buffer_load_dwordx4 v249, s[8:11], s37 offen offset:2048 lds
 v_mfma_f32_16x16x32_bf16 v[208:211], a[152:155], a[80:83], v[208:211]
 ds_read_b128 a[148:151], v244 offset:19904
 v_mul_f32 v217, s20, v217
 v_mfma_f32_16x16x32_bf16 v[212:215], a[152:155], a[96:99], v[240:243]
 v_mul_f32 v218, s20, v218
 v_mul_f32 v219, s20, v219
 v_mfma_f32_16x16x32_bf16 v[212:215], a[156:159], a[100:103], v[212:215]
 v_exp_f32 v216, v216
 v_mfma_f32_16x16x32_bf16 v[212:215], a[160:163], a[104:107], v[212:215]
 v_exp_f32 v217, v217
 v_mfma_f32_16x16x32_bf16 v[212:215], a[164:167], a[108:111], v[212:215]
 s_waitcnt lgkmcnt(10)
 v_exp_f32 v218, v218
 v_mfma_f32_16x16x32_bf16 v[8:11], a[200:203], v[128:131], v[8:11]
 s_waitcnt lgkmcnt(8)
 v_exp_f32 v219, v219
 v_mfma_f32_16x16x32_bf16 v[8:11], a[204:207], v[132:135], v[8:11]
 v_cvt_pk_bf16_f32 v178, v216, v217
 v_cvt_pk_bf16_f32 v179, v218, v219
 v_mfma_f32_16x16x32_bf16 v[40:43], a[204:207], v[140:143], v[40:43]
 v_mul_f32 v220, s20, v220
 v_mul_f32 v221, s20, v221
 v_mfma_f32_16x16x32_bf16 v[40:43], a[200:203], v[136:139], v[40:43]
 v_mul_f32 v222, s20, v222
 v_mul_f32 v223, s20, v223
 v_mfma_f32_16x16x32_bf16 v[72:75], a[200:203], v[144:147], v[72:75]
 v_exp_f32 v220, v220
 v_mfma_f32_16x16x32_bf16 v[72:75], a[204:207], v[148:151], v[72:75]
 v_exp_f32 v221, v221
 v_mfma_f32_16x16x32_bf16 v[104:107], a[204:207], v[156:159], v[104:107]
 buffer_load_dwordx4 v249, s[8:11], s37 offen offset:3072 lds
 v_mfma_f32_16x16x32_bf16 v[104:107], a[200:203], v[152:155], v[104:107]
 v_exp_f32 v222, v222
 v_mfma_f32_16x16x32_bf16 a[8:11], a[200:203], v[160:163], a[8:11]
 v_exp_f32 v223, v223
 v_mfma_f32_16x16x32_bf16 a[8:11], a[204:207], v[164:167], a[8:11]
 s_waitcnt lgkmcnt(6)
 ds_read_b64_tr_b16 a[200:201], v247 offset:16416
 v_cvt_pk_bf16_f32 v186, v220, v221
 v_mfma_f32_16x16x32_bf16 v[12:15], a[208:211], v[128:131], v[12:15]
 s_waitcnt lgkmcnt(5)
 ds_read_b64_tr_b16 a[202:203], v247 offset:17440
 v_cvt_pk_bf16_f32 v187, v222, v223
 v_mfma_f32_16x16x32_bf16 v[12:15], a[212:215], v[132:135], v[12:15]
 ds_read_b64_tr_b16 a[204:205], v247 offset:18464
 v_mul_f32 v208, s20, v208
 v_mfma_f32_16x16x32_bf16 v[44:47], a[212:215], v[140:143], v[44:47]
 ds_read_b64_tr_b16 a[206:207], v247 offset:19488
 v_mul_f32 v209, s20, v209
 v_mfma_f32_16x16x32_bf16 v[44:47], a[208:211], v[136:139], v[44:47]
 v_mul_f32 v210, s20, v210
 v_mul_f32 v211, s20, v211
 v_mfma_f32_16x16x32_bf16 v[76:79], a[208:211], v[144:147], v[76:79]
 v_exp_f32 v208, v208
 v_mfma_f32_16x16x32_bf16 v[76:79], a[212:215], v[148:151], v[76:79]
 v_exp_f32 v209, v209
 v_mfma_f32_16x16x32_bf16 v[108:111], a[212:215], v[156:159], v[108:111]
 s_add_u32 m0, s62, 8192
 v_exp_f32 v210, v210
 v_mfma_f32_16x16x32_bf16 v[108:111], a[208:211], v[152:155], v[108:111]
 v_exp_f32 v211, v211
 v_mfma_f32_16x16x32_bf16 a[12:15], a[208:211], v[160:163], a[12:15]
 buffer_load_dwordx4 v251, s[4:7], s34 offen offset:0 lds
 v_mfma_f32_16x16x32_bf16 a[12:15], a[212:215], v[164:167], a[12:15]
 s_add_u32 m0, s62, 9152
 v_cvt_pk_bf16_f32 v194, v208, v209
 v_cvt_pk_bf16_f32 v195, v210, v211
 v_mfma_f32_16x16x32_bf16 a[116:119], a[132:135], v[136:139], a[116:119]
 ds_read_b64_tr_b16 a[208:209], v247 offset:16424
 v_mul_f32 v212, s20, v212
 v_mfma_f32_16x16x32_bf16 a[116:119], a[132:135], v[140:143], a[116:119]
 s_waitcnt lgkmcnt(8)
 buffer_load_dwordx4 v251, s[4:7], s34 offen offset:64 lds
 v_mfma_f32_16x16x32_bf16 v[216:219], a[136:139], a[32:35], v[224:227]
 s_waitcnt lgkmcnt(7)
 ds_read_b64_tr_b16 a[210:211], v247 offset:17448
 v_mul_f32 v213, s20, v213
 v_mfma_f32_16x16x32_bf16 v[216:219], a[140:143], a[36:39], v[216:219]
 s_waitcnt lgkmcnt(7)
 v_mul_f32 v214, s20, v214
 v_mul_f32 v215, s20, v215
 v_mfma_f32_16x16x32_bf16 v[216:219], a[144:147], a[40:43], v[216:219]
 s_waitcnt lgkmcnt(6)
 v_exp_f32 v212, v212
 v_mfma_f32_16x16x32_bf16 v[216:219], a[148:151], a[44:47], v[216:219]
 v_exp_f32 v213, v213
 v_mfma_f32_16x16x32_bf16 v[220:223], a[148:151], a[60:63], v[228:231]
 v_exp_f32 v214, v214
 v_mfma_f32_16x16x32_bf16 v[220:223], a[144:147], a[56:59], v[220:223]
 v_exp_f32 v215, v215
 v_mfma_f32_16x16x32_bf16 v[220:223], a[140:143], a[52:55], v[220:223]
 ds_read_b64_tr_b16 a[212:213], v247 offset:18472
 v_cvt_pk_bf16_f32 v202, v212, v213
 v_mfma_f32_16x16x32_bf16 v[220:223], a[136:139], a[48:51], v[220:223]
 ds_read_b64_tr_b16 a[214:215], v247 offset:19496
 v_cvt_pk_bf16_f32 v203, v214, v215
 v_mfma_f32_16x16x32_bf16 v[208:211], a[136:139], a[64:67], v[232:235]
 v_mul_f32 v216, s20, v216
 v_mul_f32 v217, s20, v217
 v_mfma_f32_16x16x32_bf16 v[208:211], a[140:143], a[68:71], v[208:211]
 v_mul_f32 v218, s20, v218
 v_mul_f32 v219, s20, v219
 v_mfma_f32_16x16x32_bf16 v[208:211], a[144:147], a[72:75], v[208:211]
 v_exp_f32 v216, v216
 v_mfma_f32_16x16x32_bf16 v[208:211], a[148:151], a[76:79], v[208:211]
 v_exp_f32 v217, v217
 v_mfma_f32_16x16x32_bf16 v[212:215], a[148:151], a[92:95], v[236:239]
 v_exp_f32 v218, v218
 v_mfma_f32_16x16x32_bf16 v[212:215], a[144:147], a[88:91], v[212:215]
 v_exp_f32 v219, v219
 v_mfma_f32_16x16x32_bf16 v[212:215], a[140:143], a[84:87], v[212:215]
 v_cvt_pk_bf16_f32 v172, v216, v217
 v_cvt_pk_bf16_f32 v173, v218, v219
 v_mfma_f32_16x16x32_bf16 v[212:215], a[136:139], a[80:83], v[212:215]
 ds_read_b64_tr_b16 a[168:169], v248 offset:16416
 v_mul_f32 v220, s20, v220
 v_mfma_f32_16x16x32_bf16 v[216:219], a[136:139], a[96:99], v[240:243]
 ds_read_b64_tr_b16 a[170:171], v248 offset:17440
 v_mul_f32 v221, s20, v221
 v_mfma_f32_16x16x32_bf16 v[216:219], a[140:143], a[100:103], v[216:219]
 ds_read_b64_tr_b16 a[172:173], v248 offset:18464
 v_mul_f32 v222, s20, v222
 v_mfma_f32_16x16x32_bf16 v[216:219], a[144:147], a[104:107], v[216:219]
 ds_read_b64_tr_b16 a[174:175], v248 offset:19488
 v_mul_f32 v223, s20, v223
 v_mfma_f32_16x16x32_bf16 v[216:219], a[148:151], a[108:111], v[216:219]
 s_waitcnt lgkmcnt(10)
 ds_read_b64_tr_b16 a[176:177], v248 offset:16424
 v_mul_f32 v208, s20, v208
 v_mfma_f32_16x16x32_bf16 v[16:19], a[200:203], v[128:131], v[16:19]
 s_waitcnt lgkmcnt(9)
 ds_read_b64_tr_b16 a[178:179], v248 offset:17448
 v_mul_f32 v209, s20, v209
 v_mfma_f32_16x16x32_bf16 v[16:19], a[204:207], v[132:135], v[16:19]
 ds_read_b64_tr_b16 a[180:181], v248 offset:18472
 v_mul_f32 v210, s20, v210
 v_mfma_f32_16x16x32_bf16 v[48:51], a[204:207], v[140:143], v[48:51]
 ds_read_b64_tr_b16 a[182:183], v248 offset:19496
 v_mul_f32 v211, s20, v211
 v_mfma_f32_16x16x32_bf16 v[48:51], a[200:203], v[136:139], v[48:51]
 ds_read_b128 a[152:155], v244 offset:20736
 v_mul_f32 v212, s20, v212
 v_mfma_f32_16x16x32_bf16 v[80:83], a[200:203], v[144:147], v[80:83]
 ds_read_b128 a[156:159], v244 offset:20800
 v_mul_f32 v213, s20, v213
 v_mfma_f32_16x16x32_bf16 v[80:83], a[204:207], v[148:151], v[80:83]
 ds_read_b128 a[160:163], v244 offset:20864
 v_mul_f32 v214, s20, v214
 v_mfma_f32_16x16x32_bf16 v[112:115], a[204:207], v[156:159], v[112:115]
 ds_read_b128 a[164:167], v244 offset:20928
 v_mul_f32 v215, s20, v215
 v_mfma_f32_16x16x32_bf16 v[112:115], a[200:203], v[152:155], v[112:115]
 v_exp_f32 v220, v220
 v_mfma_f32_16x16x32_bf16 a[16:19], a[200:203], v[160:163], a[16:19]
 v_exp_f32 v221, v221
 v_mfma_f32_16x16x32_bf16 a[16:19], a[204:207], v[164:167], a[16:19]
 s_waitcnt lgkmcnt(14)
 v_exp_f32 v222, v222
 v_mfma_f32_16x16x32_bf16 v[20:23], a[208:211], v[128:131], v[20:23]
 s_waitcnt lgkmcnt(12)
 v_exp_f32 v223, v223
 v_mfma_f32_16x16x32_bf16 v[20:23], a[212:215], v[132:135], v[20:23]
 v_cvt_pk_bf16_f32 v180, v220, v221
 v_cvt_pk_bf16_f32 v181, v222, v223
 v_mfma_f32_16x16x32_bf16 v[52:55], a[212:215], v[140:143], v[52:55]
 v_exp_f32 v208, v208
 v_mfma_f32_16x16x32_bf16 v[52:55], a[208:211], v[136:139], v[52:55]
 v_exp_f32 v209, v209
 v_mfma_f32_16x16x32_bf16 v[84:87], a[208:211], v[144:147], v[84:87]
 v_exp_f32 v210, v210
 v_mfma_f32_16x16x32_bf16 v[84:87], a[212:215], v[148:151], v[84:87]
 v_exp_f32 v211, v211
 v_mfma_f32_16x16x32_bf16 v[116:119], a[212:215], v[156:159], v[116:119]
 v_cvt_pk_bf16_f32 v188, v208, v209
 v_cvt_pk_bf16_f32 v189, v210, v211
 v_mfma_f32_16x16x32_bf16 v[116:119], a[208:211], v[152:155], v[116:119]
 v_exp_f32 v212, v212
 v_mfma_f32_16x16x32_bf16 a[20:23], a[208:211], v[160:163], a[20:23]
 s_waitcnt vmcnt(18) lgkmcnt(0)
 ds_inc_u32 v249, v252
 v_mul_f32 v216, s20, v216
 v_mfma_f32_16x16x32_bf16 a[20:23], a[212:215], v[164:167], a[20:23]
 s_add_u32 s2, s2, 4
 v_exp_f32 v213, v213
 v_mfma_f32_16x16x32_bf16 a[120:123], a[132:135], v[144:147], a[120:123]
 v_exp_f32 v214, v214
 v_mfma_f32_16x16x32_bf16 a[120:123], a[132:135], v[148:151], a[120:123]
 v_exp_f32 v215, v215
 v_mfma_f32_16x16x32_bf16 v[220:223], a[152:155], a[32:35], v[224:227]
 v_cvt_pk_bf16_f32 v196, v212, v213
 v_cvt_pk_bf16_f32 v197, v214, v215
 v_mfma_f32_16x16x32_bf16 v[220:223], a[156:159], a[36:39], v[220:223]
 v_mul_f32 v217, s20, v217
 v_mul_f32 v218, s20, v218
 v_mfma_f32_16x16x32_bf16 v[220:223], a[160:163], a[40:43], v[220:223]
 v_exp_f32 v216, v216
 v_mfma_f32_16x16x32_bf16 v[220:223], a[164:167], a[44:47], v[220:223]
 v_exp_f32 v217, v217
 v_mfma_f32_16x16x32_bf16 v[208:211], a[164:167], a[60:63], v[228:231]
 v_mul_f32 v219, s20, v219
 v_cvt_pk_bf16_f32 v204, v216, v217
 v_mfma_f32_16x16x32_bf16 v[208:211], a[160:163], a[56:59], v[208:211]
 v_exp_f32 v218, v218
 v_mfma_f32_16x16x32_bf16 v[208:211], a[156:159], a[52:55], v[208:211]
 v_exp_f32 v219, v219
 v_mfma_f32_16x16x32_bf16 v[208:211], a[152:155], a[48:51], v[208:211]
 v_cvt_pk_bf16_f32 v205, v218, v219
 v_mul_f32 v220, s20, v220
 v_mfma_f32_16x16x32_bf16 v[212:215], a[152:155], a[64:67], v[232:235]
 v_mul_f32 v221, s20, v221
 v_mul_f32 v222, s20, v222
 v_mfma_f32_16x16x32_bf16 v[212:215], a[156:159], a[68:71], v[212:215]
 v_exp_f32 v220, v220
 v_mfma_f32_16x16x32_bf16 v[212:215], a[160:163], a[72:75], v[212:215]
 v_mul_f32 v223, s20, v223
 v_mul_f32 v208, s20, v208
 v_mfma_f32_16x16x32_bf16 v[212:215], a[164:167], a[76:79], v[212:215]
 v_exp_f32 v221, v221
 v_mfma_f32_16x16x32_bf16 v[216:219], a[164:167], a[92:95], v[236:239]
 v_exp_f32 v222, v222
 v_mfma_f32_16x16x32_bf16 v[216:219], a[160:163], a[88:91], v[216:219]
 v_exp_f32 v223, v223
 v_mfma_f32_16x16x32_bf16 v[216:219], a[156:159], a[84:87], v[216:219]
 v_cvt_pk_bf16_f32 v174, v220, v221
 v_cvt_pk_bf16_f32 v175, v222, v223
 v_mfma_f32_16x16x32_bf16 v[216:219], a[152:155], a[80:83], v[216:219]
 v_mul_f32 v209, s20, v209
 v_mul_f32 v210, s20, v210
 v_mfma_f32_16x16x32_bf16 v[220:223], a[152:155], a[96:99], v[240:243]
 v_mul_f32 v211, s20, v211
 v_mul_f32 v212, s20, v212
 v_mfma_f32_16x16x32_bf16 v[220:223], a[156:159], a[100:103], v[220:223]
 ds_read_b32 v207, v249
 v_mul_f32 v213, s20, v213
 v_mfma_f32_16x16x32_bf16 v[220:223], a[160:163], a[104:107], v[220:223]
 v_exp_f32 v208, v208
 v_mfma_f32_16x16x32_bf16 v[220:223], a[164:167], a[108:111], v[220:223]
 v_exp_f32 v209, v209
 v_mfma_f32_16x16x32_bf16 v[24:27], a[168:171], v[128:131], v[24:27]
 v_exp_f32 v210, v210
 v_mfma_f32_16x16x32_bf16 v[24:27], a[172:175], v[132:135], v[24:27]
 v_exp_f32 v211, v211
 v_mfma_f32_16x16x32_bf16 v[56:59], a[172:175], v[140:143], v[56:59]
 v_cvt_pk_bf16_f32 v182, v208, v209
 v_cvt_pk_bf16_f32 v183, v210, v211
 v_mfma_f32_16x16x32_bf16 v[56:59], a[168:171], v[136:139], v[56:59]
 v_mul_f32 v214, s20, v214
 v_mul_f32 v215, s20, v215
 v_mfma_f32_16x16x32_bf16 v[88:91], a[168:171], v[144:147], v[88:91]
 s_waitcnt lgkmcnt(0)
 v_cmp_gt_u32 vcc, s2, v207
 v_mul_f32 v216, s20, v216
 v_mfma_f32_16x16x32_bf16 v[88:91], a[172:175], v[148:151], v[88:91]
 s_add_u32 s38, s27, 114688
 v_exp_f32 v212, v212
 v_mfma_f32_16x16x32_bf16 v[120:123], a[172:175], v[156:159], v[120:123]
 s_cbranch_vccnz Lspin5_5
Lback5_5:
 ds_read_b128 a[136:139], v244 offset:34304
 v_mul_f32 v217, s20, v217
 v_mfma_f32_16x16x32_bf16 v[120:123], a[168:171], v[152:155], v[120:123]
 s_add_u32 m0, s23, 16416
 ds_read_b128 a[140:143], v244 offset:34368
 v_mul_f32 v218, s20, v218
 v_mfma_f32_16x16x32_bf16 a[24:27], a[168:171], v[160:163], a[24:27]
 buffer_load_dwordx4 v250, s[12:15], s38 offen offset:0 lds
 v_mfma_f32_16x16x32_bf16 a[24:27], a[172:175], v[164:167], a[24:27]
 ds_read_b128 a[144:147], v244 offset:34432
 v_mul_f32 v219, s20, v219
 v_mfma_f32_16x16x32_bf16 v[28:31], a[176:179], v[128:131], v[28:31]
 ds_read_b128 a[148:151], v244 offset:34496
 v_mul_f32 v220, s20, v220
 v_mfma_f32_16x16x32_bf16 v[28:31], a[180:183], v[132:135], v[28:31]
 v_exp_f32 v213, v213
 v_mfma_f32_16x16x32_bf16 v[60:63], a[180:183], v[140:143], v[60:63]
 v_exp_f32 v214, v214
 v_mfma_f32_16x16x32_bf16 v[60:63], a[176:179], v[136:139], v[60:63]
 v_exp_f32 v215, v215
 v_mfma_f32_16x16x32_bf16 v[92:95], a[176:179], v[144:147], v[92:95]
 ds_read_b64_tr_b16 a[200:201], v245 offset:32832
 v_cvt_pk_bf16_f32 v190, v212, v213
 v_mfma_f32_16x16x32_bf16 v[92:95], a[180:183], v[148:151], v[92:95]
 ds_read_b64_tr_b16 a[202:203], v245 offset:33856
 v_cvt_pk_bf16_f32 v191, v214, v215
 v_mfma_f32_16x16x32_bf16 v[124:127], a[180:183], v[156:159], v[124:127]
 v_exp_f32 v216, v216
 v_mfma_f32_16x16x32_bf16 v[124:127], a[176:179], v[152:155], v[124:127]
 v_exp_f32 v217, v217
 v_mfma_f32_16x16x32_bf16 a[28:31], a[176:179], v[160:163], a[28:31]
 v_exp_f32 v218, v218
 v_mfma_f32_16x16x32_bf16 a[28:31], a[180:183], v[164:167], a[28:31]
 v_exp_f32 v219, v219
 v_mfma_f32_16x16x32_bf16 a[124:127], a[132:135], v[152:155], a[124:127]
 buffer_load_dwordx4 v250, s[12:15], s38 offen offset:1024 lds
 v_mfma_f32_16x16x32_bf16 a[124:127], a[132:135], v[156:159], a[124:127]
 s_waitcnt lgkmcnt(5)
 ds_read_b64_tr_b16 a[204:205], v245 offset:34880
 v_cvt_pk_bf16_f32 v198, v216, v217
 v_mfma_f32_16x16x32_bf16 v[208:211], a[136:139], a[32:35], v[224:227]
 s_waitcnt lgkmcnt(5)
 ds_read_b64_tr_b16 a[206:207], v245 offset:35904
 v_cvt_pk_bf16_f32 v199, v218, v219
 v_mfma_f32_16x16x32_bf16 v[208:211], a[140:143], a[36:39], v[208:211]
 s_waitcnt lgkmcnt(5)
 ds_read_b64_tr_b16 a[208:209], v245 offset:32840
 v_mul_f32 v221, s20, v221
 v_mfma_f32_16x16x32_bf16 v[208:211], a[144:147], a[40:43], v[208:211]
 s_waitcnt lgkmcnt(5)
 ds_read_b64_tr_b16 a[210:211], v245 offset:33864
 v_mul_f32 v222, s20, v222
 v_mfma_f32_16x16x32_bf16 v[208:211], a[148:151], a[44:47], v[208:211]
 ds_read_b64_tr_b16 a[212:213], v245 offset:34888
 v_mul_f32 v223, s20, v223
 v_mfma_f32_16x16x32_bf16 v[212:215], a[148:151], a[60:63], v[228:231]
 v_exp_f32 v220, v220
 v_mfma_f32_16x16x32_bf16 v[212:215], a[144:147], a[56:59], v[212:215]
 v_exp_f32 v221, v221
 v_mfma_f32_16x16x32_bf16 v[212:215], a[140:143], a[52:55], v[212:215]
 v_exp_f32 v222, v222
 v_mfma_f32_16x16x32_bf16 v[212:215], a[136:139], a[48:51], v[212:215]
 v_exp_f32 v223, v223
 v_mfma_f32_16x16x32_bf16 v[216:219], a[136:139], a[64:67], v[232:235]
 ds_read_b64_tr_b16 a[214:215], v245 offset:35912
 v_cvt_pk_bf16_f32 v206, v220, v221
 v_mfma_f32_16x16x32_bf16 v[216:219], a[140:143], a[68:71], v[216:219]
 v_cvt_pk_bf16_f32 v207, v222, v223
 v_mul_f32 v208, s20, v208
 v_mfma_f32_16x16x32_bf16 v[216:219], a[144:147], a[72:75], v[216:219]
 buffer_load_dwordx4 v250, s[12:15], s38 offen offset:2048 lds
 v_mfma_f32_16x16x32_bf16 v[216:219], a[148:151], a[76:79], v[216:219]
 v_mul_f32 v209, s20, v209
 v_mul_f32 v210, s20, v210
 v_mfma_f32_16x16x32_bf16 v[220:223], a[148:151], a[92:95], v[236:239]
 ds_read_b128 a[152:155], v244 offset:35328
 v_mul_f32 v211, s20, v211
 v_mfma_f32_16x16x32_bf16 v[220:223], a[144:147], a[88:91], v[220:223]
 v_exp_f32 v208, v208
 v_mfma_f32_16x16x32_bf16 v[220:223], a[140:143], a[84:87], v[220:223]
 v_exp_f32 v209, v209
 v_exp_f32 v210, v210
 v_exp_f32 v211, v211
 v_pk_mul_f32 v[212:213], v[212:213], s[20:21]
 v_pk_mul_f32 v[214:215], v[214:215], s[20:21]
 v_pk_mul_f32 v[216:217], v[216:217], s[20:21]
 v_pk_mul_f32 v[218:219], v[218:219], s[20:21]
 v_cvt_pk_bf16_f32 v128, v208, v209
 v_mfma_f32_16x16x32_bf16 v[220:223], a[136:139], a[80:83], v[220:223]
 ds_read_b128 a[156:159], v244 offset:35392
 v_cvt_pk_bf16_f32 v129, v210, v211
 v_mfma_f32_16x16x32_bf16 v[208:211], a[136:139], a[96:99], v[240:243]
 buffer_store_dwordx4 a[240:243], v255, s[16:19], s60 offen offset:0 nt
 buffer_store_dwordx4 a[244:247], v255, s[16:19], s60 offen offset:2048 nt
 v_mfma_f32_16x16x32_bf16 v[208:211], a[140:143], a[100:103], v[208:211]
 v_exp_f32 v212, v212
 v_mfma_f32_16x16x32_bf16 v[208:211], a[144:147], a[104:107], v[208:211]
 ds_read_b128 a[160:163], v244 offset:35456
 v_mul_f32 v220, s20, v220
 v_mfma_f32_16x16x32_bf16 v[208:211], a[148:151], a[108:111], v[208:211]
 s_waitcnt lgkmcnt(9)
 ds_read_b128 a[164:167], v244 offset:35520
 v_mul_f32 v221, s20, v221
 v_mfma_f32_16x16x32_bf16 v[0:3], a[200:203], v[168:171], v[0:3]
 s_waitcnt lgkmcnt(8)
 v_exp_f32 v213, v213
 v_mfma_f32_16x16x32_bf16 v[0:3], a[204:207], v[172:175], v[0:3]
 v_exp_f32 v214, v214
 v_mfma_f32_16x16x32_bf16 v[32:35], a[204:207], v[180:183], v[32:35]
 buffer_load_dwordx4 v250, s[12:15], s38 offen offset:3072 lds
 v_mfma_f32_16x16x32_bf16 v[32:35], a[200:203], v[176:179], v[32:35]
 v_exp_f32 v215, v215
 v_mfma_f32_16x16x32_bf16 v[64:67], a[200:203], v[184:187], v[64:67]
 v_cvt_pk_bf16_f32 v136, v212, v213
 v_cvt_pk_bf16_f32 v137, v214, v215
 v_mfma_f32_16x16x32_bf16 v[64:67], a[204:207], v[188:191], v[64:67]
 v_exp_f32 v216, v216
 v_mfma_f32_16x16x32_bf16 v[96:99], a[204:207], v[196:199], v[96:99]
 v_exp_f32 v217, v217
 v_mfma_f32_16x16x32_bf16 v[96:99], a[200:203], v[192:195], v[96:99]
 v_exp_f32 v218, v218
 v_mfma_f32_16x16x32_bf16 a[0:3], a[200:203], v[200:203], a[0:3]
 v_exp_f32 v219, v219
 v_mfma_f32_16x16x32_bf16 a[0:3], a[204:207], v[204:207], a[0:3]
 s_waitcnt lgkmcnt(6)
 ds_read_b64_tr_b16 a[200:201], v246 offset:32832
 v_cvt_pk_bf16_f32 v144, v216, v217
 v_mfma_f32_16x16x32_bf16 v[4:7], a[208:211], v[168:171], v[4:7]
 s_waitcnt lgkmcnt(5)
 ds_read_b64_tr_b16 a[202:203], v246 offset:33856
 v_cvt_pk_bf16_f32 v145, v218, v219
 v_mfma_f32_16x16x32_bf16 v[4:7], a[212:215], v[172:175], v[4:7]
 s_add_u32 s37, s28, 16384
 ds_read_b64_tr_b16 a[204:205], v246 offset:34880
 v_mul_f32 v222, s20, v222
 v_mfma_f32_16x16x32_bf16 v[36:39], a[212:215], v[180:183], v[36:39]
 s_add_u32 m0, s22, 17664
 ds_read_b64_tr_b16 a[206:207], v246 offset:35904
 v_mul_f32 v223, s20, v223
 v_mfma_f32_16x16x32_bf16 v[36:39], a[208:211], v[176:179], v[36:39]
 v_exp_f32 v220, v220
 v_mfma_f32_16x16x32_bf16 v[68:71], a[208:211], v[184:187], v[68:71]
 buffer_load_dwordx4 v249, s[8:11], s37 offen offset:0 lds
 v_mfma_f32_16x16x32_bf16 v[68:71], a[212:215], v[188:191], v[68:71]
 v_exp_f32 v221, v221
 v_mfma_f32_16x16x32_bf16 v[100:103], a[212:215], v[196:199], v[100:103]
 v_exp_f32 v222, v222
 v_mfma_f32_16x16x32_bf16 v[100:103], a[208:211], v[192:195], v[100:103]
 v_exp_f32 v223, v223
 v_mfma_f32_16x16x32_bf16 a[4:7], a[208:211], v[200:203], a[4:7]
 v_cvt_pk_bf16_f32 v152, v220, v221
 v_cvt_pk_bf16_f32 v153, v222, v223
 v_mfma_f32_16x16x32_bf16 a[4:7], a[212:215], v[204:207], a[4:7]
 ds_read_b64_tr_b16 a[208:209], v246 offset:32840
 v_mul_f32 v208, s20, v208
 v_mfma_f32_16x16x32_bf16 a[112:115], a[132:135], v[168:171], a[112:115]
 ds_read_b64_tr_b16 a[210:211], v246 offset:33864
 v_mul_f32 v209, s20, v209
 v_mfma_f32_16x16x32_bf16 a[112:115], a[132:135], v[172:175], a[112:115]
 v_mul_f32 v210, s20, v210
 v_mul_f32 v211, s20, v211
 v_mfma_f32_16x16x32_bf16 a[128:131], a[132:135], v[200:203], a[128:131]
 v_exp_f32 v208, v208
 v_mfma_f32_16x16x32_bf16 a[128:131], a[132:135], v[204:207], a[128:131]
 s_waitcnt lgkmcnt(9)
 v_exp_f32 v209, v209
 v_mfma_f32_16x16x32_bf16 v[212:215], a[152:155], a[32:35], v[224:227]
 s_waitcnt lgkmcnt(8)
 v_exp_f32 v210, v210
 v_mfma_f32_16x16x32_bf16 v[212:215], a[156:159], a[36:39], v[212:215]
 s_waitcnt lgkmcnt(7)
 v_exp_f32 v211, v211
 v_mfma_f32_16x16x32_bf16 v[212:215], a[160:163], a[40:43], v[212:215]
 s_waitcnt lgkmcnt(6)
 buffer_load_dwordx4 v249, s[8:11], s37 offen offset:1024 lds
 v_mfma_f32_16x16x32_bf16 v[212:215], a[164:167], a[44:47], v[212:215]
 ds_read_b64_tr_b16 a[212:213], v246 offset:34888
 v_cvt_pk_bf16_f32 v160, v208, v209
 v_mfma_f32_16x16x32_bf16 v[216:219], a[164:167], a[60:63], v[228:231]
 ds_read_b64_tr_b16 a[214:215], v246 offset:35912
 v_cvt_pk_bf16_f32 v161, v210, v211
 v_mfma_f32_16x16x32_bf16 v[216:219], a[160:163], a[56:59], v[216:219]
 ds_read_b128 a[136:139], v244 offset:36352
 ds_read_b128 a[140:143], v244 offset:36416
 v_mfma_f32_16x16x32_bf16 v[216:219], a[156:159], a[52:55], v[216:219]
 v_mul_f32 v212, s20, v212
 v_mul_f32 v213, s20, v213
 v_mfma_f32_16x16x32_bf16 v[216:219], a[152:155], a[48:51], v[216:219]
 v_mul_f32 v214, s20, v214
 v_mul_f32 v215, s20, v215
 v_mfma_f32_16x16x32_bf16 v[220:223], a[152:155], a[64:67], v[232:235]
 v_exp_f32 v212, v212
 v_mfma_f32_16x16x32_bf16 v[220:223], a[156:159], a[68:71], v[220:223]
 v_exp_f32 v213, v213
 v_mfma_f32_16x16x32_bf16 v[220:223], a[160:163], a[72:75], v[220:223]
 v_exp_f32 v214, v214
 v_mfma_f32_16x16x32_bf16 v[220:223], a[164:167], a[76:79], v[220:223]
 v_exp_f32 v215, v215
 v_mfma_f32_16x16x32_bf16 v[208:211], a[164:167], a[92:95], v[236:239]
 v_cvt_pk_bf16_f32 v130, v212, v213
 v_cvt_pk_bf16_f32 v131, v214, v215
 v_mfma_f32_16x16x32_bf16 v[208:211], a[160:163], a[88:91], v[208:211]
 ds_read_b128 a[144:147], v244 offset:36480
 v_mul_f32 v216, s20, v216
 v_mfma_f32_16x16x32_bf16 v[208:211], a[156:159], a[84:87], v[208:211]
 buffer_load_dwordx4 v249, s[8:11], s37 offen offset:2048 lds
 v_mfma_f32_16x16x32_bf16 v[208:211], a[152:155], a[80:83], v[208:211]
 ds_read_b128 a[148:151], v244 offset:36544
 v_mul_f32 v217, s20, v217
 v_mfma_f32_16x16x32_bf16 v[212:215], a[152:155], a[96:99], v[240:243]
 v_mul_f32 v218, s20, v218
 v_mul_f32 v219, s20, v219
 v_mfma_f32_16x16x32_bf16 v[212:215], a[156:159], a[100:103], v[212:215]
 v_exp_f32 v216, v216
 v_mfma_f32_16x16x32_bf16 v[212:215], a[160:163], a[104:107], v[212:215]
 v_exp_f32 v217, v217
 v_mfma_f32_16x16x32_bf16 v[212:215], a[164:167], a[108:111], v[212:215]
 s_waitcnt lgkmcnt(10)
 v_exp_f32 v218, v218
 v_mfma_f32_16x16x32_bf16 v[8:11], a[200:203], v[168:171], v[8:11]
 s_waitcnt lgkmcnt(8)
 v_exp_f32 v219, v219
 v_mfma_f32_16x16x32_bf16 v[8:11], a[204:207], v[172:175], v[8:11]
 v_cvt_pk_bf16_f32 v138, v216, v217
 v_cvt_pk_bf16_f32 v139, v218, v219
 v_mfma_f32_16x16x32_bf16 v[40:43], a[204:207], v[180:183], v[40:43]
 v_mul_f32 v220, s20, v220
 v_mul_f32 v221, s20, v221
 v_mfma_f32_16x16x32_bf16 v[40:43], a[200:203], v[176:179], v[40:43]
 v_mul_f32 v222, s20, v222
 v_mul_f32 v223, s20, v223
 v_mfma_f32_16x16x32_bf16 v[72:75], a[200:203], v[184:187], v[72:75]
 v_exp_f32 v220, v220
 v_mfma_f32_16x16x32_bf16 v[72:75], a[204:207], v[188:191], v[72:75]
 v_exp_f32 v221, v221
 v_mfma_f32_16x16x32_bf16 v[104:107], a[204:207], v[196:199], v[104:107]
 buffer_load_dwordx4 v249, s[8:11], s37 offen offset:3072 lds
 v_mfma_f32_16x16x32_bf16 v[104:107], a[200:203], v[192:195], v[104:107]
 v_exp_f32 v222, v222
 v_mfma_f32_16x16x32_bf16 a[8:11], a[200:203], v[200:203], a[8:11]
 v_exp_f32 v223, v223
 v_mfma_f32_16x16x32_bf16 a[8:11], a[204:207], v[204:207], a[8:11]
 s_waitcnt lgkmcnt(6)
 ds_read_b64_tr_b16 a[200:201], v247 offset:32832
 v_cvt_pk_bf16_f32 v146, v220, v221
 v_mfma_f32_16x16x32_bf16 v[12:15], a[208:211], v[168:171], v[12:15]
 s_waitcnt lgkmcnt(5)
 ds_read_b64_tr_b16 a[202:203], v247 offset:33856
 v_cvt_pk_bf16_f32 v147, v222, v223
 v_mfma_f32_16x16x32_bf16 v[12:15], a[212:215], v[172:175], v[12:15]
 ds_read_b64_tr_b16 a[204:205], v247 offset:34880
 v_mul_f32 v208, s20, v208
 v_mfma_f32_16x16x32_bf16 v[44:47], a[212:215], v[180:183], v[44:47]
 ds_read_b64_tr_b16 a[206:207], v247 offset:35904
 v_mul_f32 v209, s20, v209
 v_mfma_f32_16x16x32_bf16 v[44:47], a[208:211], v[176:179], v[44:47]
 v_mul_f32 v210, s20, v210
 v_mul_f32 v211, s20, v211
 v_mfma_f32_16x16x32_bf16 v[76:79], a[208:211], v[184:187], v[76:79]
 v_exp_f32 v208, v208
 v_mfma_f32_16x16x32_bf16 v[76:79], a[212:215], v[188:191], v[76:79]
 v_exp_f32 v209, v209
 v_mfma_f32_16x16x32_bf16 v[108:111], a[212:215], v[196:199], v[108:111]
 s_add_u32 m0, s62, 10112
 v_exp_f32 v210, v210
 v_mfma_f32_16x16x32_bf16 v[108:111], a[208:211], v[192:195], v[108:111]
 v_exp_f32 v211, v211
 v_mfma_f32_16x16x32_bf16 a[12:15], a[208:211], v[200:203], a[12:15]
 buffer_load_dwordx4 v251, s[4:7], s34 offen offset:128 lds
 v_mfma_f32_16x16x32_bf16 a[12:15], a[212:215], v[204:207], a[12:15]
 v_cvt_pk_bf16_f32 v154, v208, v209
 v_cvt_pk_bf16_f32 v155, v210, v211
 v_mfma_f32_16x16x32_bf16 a[116:119], a[132:135], v[176:179], a[116:119]
 ds_read_b64_tr_b16 a[208:209], v247 offset:32840
 v_mul_f32 v212, s20, v212
 v_mfma_f32_16x16x32_bf16 a[116:119], a[132:135], v[180:183], a[116:119]
 s_waitcnt lgkmcnt(8)
 ds_read_b64_tr_b16 a[210:211], v247 offset:33864
 v_mul_f32 v213, s20, v213
 v_mfma_f32_16x16x32_bf16 v[216:219], a[136:139], a[32:35], v[224:227]
 s_waitcnt lgkmcnt(8)
 v_mul_f32 v214, s20, v214
 v_mul_f32 v215, s20, v215
 v_mfma_f32_16x16x32_bf16 v[216:219], a[140:143], a[36:39], v[216:219]
 s_waitcnt lgkmcnt(7)
 v_exp_f32 v212, v212
 v_mfma_f32_16x16x32_bf16 v[216:219], a[144:147], a[40:43], v[216:219]
 s_waitcnt lgkmcnt(6)
 v_exp_f32 v213, v213
 v_mfma_f32_16x16x32_bf16 v[216:219], a[148:151], a[44:47], v[216:219]
 v_exp_f32 v214, v214
 v_mfma_f32_16x16x32_bf16 v[220:223], a[148:151], a[60:63], v[228:231]
 v_exp_f32 v215, v215
 v_mfma_f32_16x16x32_bf16 v[220:223], a[144:147], a[56:59], v[220:223]
 ds_read_b64_tr_b16 a[212:213], v247 offset:34888
 v_cvt_pk_bf16_f32 v162, v212, v213
 v_mfma_f32_16x16x32_bf16 v[220:223], a[140:143], a[52:55], v[220:223]
 ds_read_b64_tr_b16 a[214:215], v247 offset:35912
 v_cvt_pk_bf16_f32 v163, v214, v215
 v_mfma_f32_16x16x32_bf16 v[220:223], a[136:139], a[48:51], v[220:223]
 v_mul_f32 v216, s20, v216
 v_mul_f32 v217, s20, v217
 v_mfma_f32_16x16x32_bf16 v[208:211], a[136:139], a[64:67], v[232:235]
 v_mul_f32 v218, s20, v218
 v_mul_f32 v219, s20, v219
 v_mfma_f32_16x16x32_bf16 v[208:211], a[140:143], a[68:71], v[208:211]
 v_exp_f32 v216, v216
 v_mfma_f32_16x16x32_bf16 v[208:211], a[144:147], a[72:75], v[208:211]
 v_exp_f32 v217, v217
 v_mfma_f32_16x16x32_bf16 v[208:211], a[148:151], a[76:79], v[208:211]
 v_exp_f32 v218, v218
 v_mfma_f32_16x16x32_bf16 v[212:215], a[148:151], a[92:95], v[236:239]
 v_exp_f32 v219, v219
 v_mfma_f32_16x16x32_bf16 v[212:215], a[144:147], a[88:91], v[212:215]
 v_cvt_pk_bf16_f32 v132, v216, v217
 v_cvt_pk_bf16_f32 v133, v218, v219
 v_mfma_f32_16x16x32_bf16 v[212:215], a[140:143], a[84:87], v[212:215]
 ds_read_b64_tr_b16 a[168:169], v248 offset:32832
 v_mul_f32 v220, s20, v220
 v_mfma_f32_16x16x32_bf16 v[212:215], a[136:139], a[80:83], v[212:215]
 ds_read_b64_tr_b16 a[170:171], v248 offset:33856
 v_mul_f32 v221, s20, v221
 v_mfma_f32_16x16x32_bf16 v[216:219], a[136:139], a[96:99], v[240:243]
 ds_read_b64_tr_b16 a[172:173], v248 offset:34880
 v_mul_f32 v222, s20, v222
 v_mfma_f32_16x16x32_bf16 v[216:219], a[140:143], a[100:103], v[216:219]
 ds_read_b64_tr_b16 a[174:175], v248 offset:35904
 v_mul_f32 v223, s20, v223
 v_mfma_f32_16x16x32_bf16 v[216:219], a[144:147], a[104:107], v[216:219]
 ds_read_b64_tr_b16 a[176:177], v248 offset:32840
 v_mul_f32 v208, s20, v208
 v_mfma_f32_16x16x32_bf16 v[216:219], a[148:151], a[108:111], v[216:219]
 s_waitcnt lgkmcnt(11)
 ds_read_b64_tr_b16 a[178:179], v248 offset:33864
 v_mul_f32 v209, s20, v209
 v_mfma_f32_16x16x32_bf16 v[16:19], a[200:203], v[168:171], v[16:19]
 s_waitcnt lgkmcnt(10)
 ds_read_b64_tr_b16 a[180:181], v248 offset:34888
 v_mul_f32 v210, s20, v210
 v_mfma_f32_16x16x32_bf16 v[16:19], a[204:207], v[172:175], v[16:19]
 ds_read_b64_tr_b16 a[182:183], v248 offset:35912
 v_mul_f32 v211, s20, v211
 v_mfma_f32_16x16x32_bf16 v[48:51], a[204:207], v[180:183], v[48:51]
 ds_read_b128 a[152:155], v244 offset:37376
 v_mul_f32 v212, s20, v212
 v_mfma_f32_16x16x32_bf16 v[48:51], a[200:203], v[176:179], v[48:51]
 ds_read_b128 a[156:159], v244 offset:37440
 v_mul_f32 v213, s20, v213
 v_mfma_f32_16x16x32_bf16 v[80:83], a[200:203], v[184:187], v[80:83]
 ds_read_b128 a[160:163], v244 offset:37504
 v_mul_f32 v214, s20, v214
 v_mfma_f32_16x16x32_bf16 v[80:83], a[204:207], v[188:191], v[80:83]
 ds_read_b128 a[164:167], v244 offset:37568
 v_mul_f32 v215, s20, v215
 v_mfma_f32_16x16x32_bf16 v[112:115], a[204:207], v[196:199], v[112:115]
 v_exp_f32 v220, v220
 v_mfma_f32_16x16x32_bf16 v[112:115], a[200:203], v[192:195], v[112:115]
 v_exp_f32 v221, v221
 v_mfma_f32_16x16x32_bf16 a[16:19], a[200:203], v[200:203], a[16:19]
 v_exp_f32 v222, v222
 v_mfma_f32_16x16x32_bf16 a[16:19], a[204:207], v[204:207], a[16:19]
 s_waitcnt lgkmcnt(14)
 v_exp_f32 v223, v223
 v_mfma_f32_16x16x32_bf16 v[20:23], a[208:211], v[168:171], v[20:23]
 s_waitcnt lgkmcnt(12)
 v_cvt_pk_bf16_f32 v140, v220, v221
 v_cvt_pk_bf16_f32 v141, v222, v223
 v_mfma_f32_16x16x32_bf16 v[20:23], a[212:215], v[172:175], v[20:23]
 v_exp_f32 v208, v208
 v_mfma_f32_16x16x32_bf16 v[52:55], a[212:215], v[180:183], v[52:55]
 v_exp_f32 v209, v209
 v_mfma_f32_16x16x32_bf16 v[52:55], a[208:211], v[176:179], v[52:55]
 v_exp_f32 v210, v210
 v_mfma_f32_16x16x32_bf16 v[84:87], a[208:211], v[184:187], v[84:87]
 v_exp_f32 v211, v211
 v_mfma_f32_16x16x32_bf16 v[84:87], a[212:215], v[188:191], v[84:87]
 v_cvt_pk_bf16_f32 v148, v208, v209
 v_cvt_pk_bf16_f32 v149, v210, v211
 v_mfma_f32_16x16x32_bf16 v[116:119], a[212:215], v[196:199], v[116:119]
 v_exp_f32 v212, v212
 v_mfma_f32_16x16x32_bf16 v[116:119], a[208:211], v[192:195], v[116:119]
 v_exp_f32 v213, v213
 v_mfma_f32_16x16x32_bf16 a[20:23], a[208:211], v[200:203], a[20:23]
 s_waitcnt vmcnt(17) lgkmcnt(0)
 ds_inc_u32 v249, v252
 v_cvt_pk_bf16_f32 v156, v212, v213
 v_mfma_f32_16x16x32_bf16 a[20:23], a[212:215], v[204:207], a[20:23]
 s_add_u32 s2, s2, 4
 v_exp_f32 v214, v214
 v_mfma_f32_16x16x32_bf16 a[120:123], a[132:135], v[184:187], a[120:123]
 v_exp_f32 v215, v215
 v_mfma_f32_16x16x32_bf16 a[120:123], a[132:135], v[188:191], a[120:123]
 v_cvt_pk_bf16_f32 v157, v214, v215
 v_mul_f32 v216, s20, v216
 v_mfma_f32_16x16x32_bf16 v[220:223], a[152:155], a[32:35], v[224:227]
 v_mul_f32 v217, s20, v217
 v_mul_f32 v218, s20, v218
 v_mfma_f32_16x16x32_bf16 v[220:223], a[156:159], a[36:39], v[220:223]
 v_exp_f32 v216, v216
 v_mfma_f32_16x16x32_bf16 v[220:223], a[160:163], a[40:43], v[220:223]
 v_exp_f32 v217, v217
 v_mfma_f32_16x16x32_bf16 v[220:223], a[164:167], a[44:47], v[220:223]
 v_mul_f32 v219, s20, v219
 v_cvt_pk_bf16_f32 v164, v216, v217
 v_mfma_f32_16x16x32_bf16 v[208:211], a[164:167], a[60:63], v[228:231]
 v_exp_f32 v218, v218
 v_mfma_f32_16x16x32_bf16 v[208:211], a[160:163], a[56:59], v[208:211]
 v_exp_f32 v219, v219
 v_mfma_f32_16x16x32_bf16 v[208:211], a[156:159], a[52:55], v[208:211]
 v_cvt_pk_bf16_f32 v165, v218, v219
 v_mul_f32 v220, s20, v220
 v_mfma_f32_16x16x32_bf16 v[208:211], a[152:155], a[48:51], v[208:211]
 v_mul_f32 v221, s20, v221
 v_mul_f32 v222, s20, v222
 v_mfma_f32_16x16x32_bf16 v[212:215], a[152:155], a[64:67], v[232:235]
 v_exp_f32 v220, v220
 v_mfma_f32_16x16x32_bf16 v[212:215], a[156:159], a[68:71], v[212:215]
 v_exp_f32 v221, v221
 v_mfma_f32_16x16x32_bf16 v[212:215], a[160:163], a[72:75], v[212:215]
 v_mul_f32 v223, s20, v223
 v_cvt_pk_bf16_f32 v134, v220, v221
 v_mfma_f32_16x16x32_bf16 v[212:215], a[164:167], a[76:79], v[212:215]
 v_exp_f32 v222, v222
 v_mfma_f32_16x16x32_bf16 v[216:219], a[164:167], a[92:95], v[236:239]
 v_exp_f32 v223, v223
 v_mfma_f32_16x16x32_bf16 v[216:219], a[160:163], a[88:91], v[216:219]
 v_cvt_pk_bf16_f32 v135, v222, v223
 v_mul_f32 v208, s20, v208
 v_mfma_f32_16x16x32_bf16 v[216:219], a[156:159], a[84:87], v[216:219]
 v_mul_f32 v209, s20, v209
 v_mul_f32 v210, s20, v210
 v_mfma_f32_16x16x32_bf16 v[216:219], a[152:155], a[80:83], v[216:219]
 v_mul_f32 v211, s20, v211
 v_mul_f32 v212, s20, v212
 v_mfma_f32_16x16x32_bf16 v[220:223], a[152:155], a[96:99], v[240:243]
 v_exp_f32 v208, v208
 v_mfma_f32_16x16x32_bf16 v[220:223], a[156:159], a[100:103], v[220:223]
 ds_read_b32 v167, v249
 v_mul_f32 v213, s20, v213
 v_mfma_f32_16x16x32_bf16 v[220:223], a[160:163], a[104:107], v[220:223]
 v_exp_f32 v209, v209
 v_mfma_f32_16x16x32_bf16 v[220:223], a[164:167], a[108:111], v[220:223]
 v_exp_f32 v210, v210
 v_mfma_f32_16x16x32_bf16 v[24:27], a[168:171], v[168:171], v[24:27]
 v_exp_f32 v211, v211
 v_mfma_f32_16x16x32_bf16 v[24:27], a[172:175], v[172:175], v[24:27]
 v_cvt_pk_bf16_f32 v142, v208, v209
 v_cvt_pk_bf16_f32 v143, v210, v211
 v_mfma_f32_16x16x32_bf16 v[56:59], a[172:175], v[180:183], v[56:59]
 v_mul_f32 v214, s20, v214
 v_mul_f32 v215, s20, v215
 v_mfma_f32_16x16x32_bf16 v[56:59], a[168:171], v[176:179], v[56:59]
 v_exp_f32 v212, v212
 v_mfma_f32_16x16x32_bf16 v[88:91], a[168:171], v[184:187], v[88:91]
 s_waitcnt lgkmcnt(0)
 v_cmp_gt_u32 vcc, s2, v167
 v_mul_f32 v216, s20, v216
 v_mfma_f32_16x16x32_bf16 v[88:91], a[172:175], v[188:191], v[88:91]
 s_add_u32 s37, s28, 32768
 v_exp_f32 v213, v213
 v_mfma_f32_16x16x32_bf16 v[120:123], a[172:175], v[196:199], v[120:123]
 s_cbranch_vccnz Lspin5_6
Lback5_6:
 ds_read_b128 a[136:139], v244 offset:50944
 v_cvt_pk_bf16_f32 v150, v212, v213
 v_mfma_f32_16x16x32_bf16 v[120:123], a[168:171], v[192:195], v[120:123]
 s_add_u32 m0, s22, 34304
 ds_read_b128 a[140:143], v244 offset:51008
 v_mul_f32 v217, s20, v217
 v_mfma_f32_16x16x32_bf16 a[24:27], a[168:171], v[200:203], a[24:27]
 buffer_load_dwordx4 v249, s[8:11], s37 offen offset:0 lds
 v_mfma_f32_16x16x32_bf16 a[24:27], a[172:175], v[204:207], a[24:27]
 ds_read_b128 a[144:147], v244 offset:51072
 v_mul_f32 v218, s20, v218
 v_mfma_f32_16x16x32_bf16 v[28:31], a[176:179], v[168:171], v[28:31]
 ds_read_b128 a[148:151], v244 offset:51136
 v_mul_f32 v219, s20, v219
 v_mfma_f32_16x16x32_bf16 v[28:31], a[180:183], v[172:175], v[28:31]
 v_exp_f32 v214, v214
 v_mfma_f32_16x16x32_bf16 v[60:63], a[180:183], v[180:183], v[60:63]
 v_exp_f32 v215, v215
 v_mfma_f32_16x16x32_bf16 v[60:63], a[176:179], v[176:179], v[60:63]
 ds_read_b64_tr_b16 a[200:201], v245 offset:0
 v_cvt_pk_bf16_f32 v151, v214, v215
 v_mfma_f32_16x16x32_bf16 v[92:95], a[176:179], v[184:187], v[92:95]
 v_exp_f32 v216, v216
 v_mfma_f32_16x16x32_bf16 v[92:95], a[180:183], v[188:191], v[92:95]
 v_exp_f32 v217, v217
 v_mfma_f32_16x16x32_bf16 v[124:127], a[180:183], v[196:199], v[124:127]
 v_exp_f32 v218, v218
 v_mfma_f32_16x16x32_bf16 v[124:127], a[176:179], v[192:195], v[124:127]
 v_exp_f32 v219, v219
 v_mfma_f32_16x16x32_bf16 a[28:31], a[176:179], v[200:203], a[28:31]
 ds_read_b64_tr_b16 a[202:203], v245 offset:1024
 v_cvt_pk_bf16_f32 v158, v216, v217
 v_mfma_f32_16x16x32_bf16 a[28:31], a[180:183], v[204:207], a[28:31]
 ds_read_b64_tr_b16 a[204:205], v245 offset:2048
 v_cvt_pk_bf16_f32 v159, v218, v219
 v_mfma_f32_16x16x32_bf16 a[124:127], a[132:135], v[192:195], a[124:127]
 ds_read_b64_tr_b16 a[206:207], v245 offset:3072
 v_mul_f32 v220, s20, v220
 v_mfma_f32_16x16x32_bf16 a[124:127], a[132:135], v[196:199], a[124:127]
 s_waitcnt lgkmcnt(7)
 buffer_load_dwordx4 v249, s[8:11], s37 offen offset:1024 lds
 v_mfma_f32_16x16x32_bf16 v[208:211], a[136:139], a[32:35], v[224:227]
 s_waitcnt lgkmcnt(6)
 ds_read_b64_tr_b16 a[208:209], v245 offset:8
 v_mul_f32 v221, s20, v221
 v_mfma_f32_16x16x32_bf16 v[208:211], a[140:143], a[36:39], v[208:211]
 s_waitcnt lgkmcnt(6)
 ds_read_b64_tr_b16 a[210:211], v245 offset:1032
 v_mul_f32 v222, s20, v222
 v_mfma_f32_16x16x32_bf16 v[208:211], a[144:147], a[40:43], v[208:211]
 s_waitcnt lgkmcnt(6)
 ds_read_b64_tr_b16 a[212:213], v245 offset:2056
 v_mul_f32 v223, s20, v223
 v_mfma_f32_16x16x32_bf16 v[208:211], a[148:151], a[44:47], v[208:211]
 v_exp_f32 v220, v220
 v_mfma_f32_16x16x32_bf16 v[212:215], a[148:151], a[60:63], v[228:231]
 v_exp_f32 v221, v221
 v_mfma_f32_16x16x32_bf16 v[212:215], a[144:147], a[56:59], v[212:215]
 v_exp_f32 v222, v222
 v_mfma_f32_16x16x32_bf16 v[212:215], a[140:143], a[52:55], v[212:215]
 v_exp_f32 v223, v223
 v_mfma_f32_16x16x32_bf16 v[212:215], a[136:139], a[48:51], v[212:215]
 ds_read_b64_tr_b16 a[214:215], v245 offset:3080
 v_cvt_pk_bf16_f32 v166, v220, v221
 v_mfma_f32_16x16x32_bf16 v[216:219], a[136:139], a[64:67], v[232:235]
 v_cvt_pk_bf16_f32 v167, v222, v223
 v_mul_f32 v208, s20, v208
 v_mfma_f32_16x16x32_bf16 v[216:219], a[140:143], a[68:71], v[216:219]
 v_mul_f32 v209, s20, v209
 v_mul_f32 v210, s20, v210
 v_mfma_f32_16x16x32_bf16 v[216:219], a[144:147], a[72:75], v[216:219]
 ds_read_b128 a[152:155], v244 offset:51968
 v_mul_f32 v211, s20, v211
 v_mfma_f32_16x16x32_bf16 v[216:219], a[148:151], a[76:79], v[216:219]
 v_exp_f32 v208, v208
 v_mfma_f32_16x16x32_bf16 v[220:223], a[148:151], a[92:95], v[236:239]
 buffer_load_dwordx4 v249, s[8:11], s37 offen offset:2048 lds
 v_mfma_f32_16x16x32_bf16 v[220:223], a[144:147], a[88:91], v[220:223]
 v_exp_f32 v209, v209
 v_mfma_f32_16x16x32_bf16 v[220:223], a[140:143], a[84:87], v[220:223]
 v_exp_f32 v210, v210
 v_exp_f32 v211, v211
 v_cvt_pk_bf16_f32 v168, v208, v209
 v_pk_mul_f32 v[212:213], v[212:213], s[20:21]
 v_pk_mul_f32 v[214:215], v[214:215], s[20:21]
 v_pk_mul_f32 v[216:217], v[216:217], s[20:21]
 v_pk_mul_f32 v[218:219], v[218:219], s[20:21]
 v_cvt_pk_bf16_f32 v169, v210, v211
 v_mfma_f32_16x16x32_bf16 v[220:223], a[136:139], a[80:83], v[220:223]
 v_exp_f32 v212, v212
 v_mfma_f32_16x16x32_bf16 v[208:211], a[136:139], a[96:99], v[240:243]
 v_exp_f32 v213, v213
 v_mfma_f32_16x16x32_bf16 v[208:211], a[140:143], a[100:103], v[208:211]
 ds_read_b128 a[156:159], v244 offset:52032
 v_cvt_pk_bf16_f32 v176, v212, v213
 v_mfma_f32_16x16x32_bf16 v[208:211], a[144:147], a[104:107], v[208:211]
 buffer_store_dwordx4 a[248:251], v255, s[16:19], s61 offen offset:0 nt
 buffer_store_dwordx4 a[252:255], v255, s[16:19], s61 offen offset:2048 nt
 v_mfma_f32_16x16x32_bf16 v[208:211], a[148:151], a[108:111], v[208:211]
 s_waitcnt lgkmcnt(8)
 ds_read_b128 a[160:163], v244 offset:52096
 v_mul_f32 v220, s20, v220
 v_mfma_f32_16x16x32_bf16 v[0:3], a[200:203], v[128:131], v[0:3]
 s_waitcnt lgkmcnt(7)
 ds_read_b128 a[164:167], v244 offset:52160
 v_mul_f32 v221, s20, v221
 v_mfma_f32_16x16x32_bf16 v[0:3], a[204:207], v[132:135], v[0:3]
 v_exp_f32 v214, v214
 v_mfma_f32_16x16x32_bf16 v[32:35], a[204:207], v[140:143], v[32:35]
 v_exp_f32 v215, v215
 v_mfma_f32_16x16x32_bf16 v[32:35], a[200:203], v[136:139], v[32:35]
 v_cvt_pk_bf16_f32 v177, v214, v215
 v_mul_f32 v222, s20, v222
 v_mfma_f32_16x16x32_bf16 v[64:67], a[200:203], v[144:147], v[64:67]
 v_exp_f32 v216, v216
 v_mfma_f32_16x16x32_bf16 v[64:67], a[204:207], v[148:151], v[64:67]
 buffer_load_dwordx4 v249, s[8:11], s37 offen offset:3072 lds
 v_mfma_f32_16x16x32_bf16 v[96:99], a[204:207], v[156:159], v[96:99]
 v_exp_f32 v217, v217
 v_mfma_f32_16x16x32_bf16 v[96:99], a[200:203], v[152:155], v[96:99]
 v_exp_f32 v218, v218
 v_mfma_f32_16x16x32_bf16 a[0:3], a[200:203], v[160:163], a[0:3]
 v_exp_f32 v219, v219
 v_mfma_f32_16x16x32_bf16 a[0:3], a[204:207], v[164:167], a[0:3]
 s_waitcnt lgkmcnt(6)
 ds_read_b64_tr_b16 a[200:201], v246 offset:0
 v_cvt_pk_bf16_f32 v184, v216, v217
 v_mfma_f32_16x16x32_bf16 v[4:7], a[208:211], v[128:131], v[4:7]
 s_waitcnt lgkmcnt(5)
 ds_read_b64_tr_b16 a[202:203], v246 offset:1024
 v_cvt_pk_bf16_f32 v185, v218, v219
 v_mfma_f32_16x16x32_bf16 v[4:7], a[212:215], v[132:135], v[4:7]
 ds_read_b64_tr_b16 a[204:205], v246 offset:2048
 v_mul_f32 v223, s20, v223
 v_mfma_f32_16x16x32_bf16 v[36:39], a[212:215], v[140:143], v[36:39]
 v_exp_f32 v220, v220
 v_mfma_f32_16x16x32_bf16 v[36:39], a[208:211], v[136:139], v[36:39]
 v_exp_f32 v221, v221
 v_mfma_f32_16x16x32_bf16 v[68:71], a[208:211], v[144:147], v[68:71]
 s_add_u32 s38, s28, 32768
 v_exp_f32 v222, v222
 v_mfma_f32_16x16x32_bf16 v[68:71], a[212:215], v[148:151], v[68:71]
 s_add_u32 m0, s23, 32832
 v_exp_f32 v223, v223
 v_mfma_f32_16x16x32_bf16 v[100:103], a[212:215], v[156:159], v[100:103]
 ds_read_b64_tr_b16 a[206:207], v246 offset:3072
 v_cvt_pk_bf16_f32 v192, v220, v221
 v_mfma_f32_16x16x32_bf16 v[100:103], a[208:211], v[152:155], v[100:103]
 v_cvt_pk_bf16_f32 v193, v222, v223
 v_mul_f32 v208, s20, v208
 v_mfma_f32_16x16x32_bf16 a[4:7], a[208:211], v[160:163], a[4:7]
 buffer_load_dwordx4 v250, s[12:15], s38 offen offset:0 lds
 v_mfma_f32_16x16x32_bf16 a[4:7], a[212:215], v[164:167], a[4:7]
 ds_read_b64_tr_b16 a[208:209], v246 offset:8
 v_mul_f32 v209, s20, v209
 v_mfma_f32_16x16x32_bf16 a[112:115], a[132:135], v[128:131], a[112:115]
 ds_read_b64_tr_b16 a[210:211], v246 offset:1032
 v_mul_f32 v210, s20, v210
 v_mfma_f32_16x16x32_bf16 a[112:115], a[132:135], v[132:135], a[112:115]
 ds_read_b64_tr_b16 a[212:213], v246 offset:2056
 v_mul_f32 v211, s20, v211
 v_mfma_f32_16x16x32_bf16 a[128:131], a[132:135], v[160:163], a[128:131]
 v_exp_f32 v208, v208
 v_mfma_f32_16x16x32_bf16 a[128:131], a[132:135], v[164:167], a[128:131]
 s_waitcnt lgkmcnt(10)
 v_exp_f32 v209, v209
 v_mfma_f32_16x16x32_bf16 v[212:215], a[152:155], a[32:35], v[224:227]
 s_waitcnt lgkmcnt(9)
 v_exp_f32 v210, v210
 v_mfma_f32_16x16x32_bf16 v[212:215], a[156:159], a[36:39], v[212:215]
 s_waitcnt lgkmcnt(8)
 v_exp_f32 v211, v211
 v_mfma_f32_16x16x32_bf16 v[212:215], a[160:163], a[40:43], v[212:215]
 s_waitcnt lgkmcnt(7)
 ds_read_b64_tr_b16 a[214:215], v246 offset:3080
 v_cvt_pk_bf16_f32 v200, v208, v209
 v_mfma_f32_16x16x32_bf16 v[212:215], a[164:167], a[44:47], v[212:215]
 ds_read_b128 a[136:139], v244 offset:52992
 v_cvt_pk_bf16_f32 v201, v210, v211
 v_mfma_f32_16x16x32_bf16 v[216:219], a[164:167], a[60:63], v[228:231]
 ds_read_b128 a[140:143], v244 offset:53056
 ds_read_b128 a[144:147], v244 offset:53120
 v_mfma_f32_16x16x32_bf16 v[216:219], a[160:163], a[56:59], v[216:219]
 ds_read_b128 a[148:151], v244 offset:53184
 ds_read_b64_tr_b16 a[168:169], v248 offset:0
 v_mfma_f32_16x16x32_bf16 v[216:219], a[156:159], a[52:55], v[216:219]
 v_mul_f32 v212, s20, v212
 v_mul_f32 v213, s20, v213
 v_mfma_f32_16x16x32_bf16 v[216:219], a[152:155], a[48:51], v[216:219]
 buffer_load_dwordx4 v250, s[12:15], s38 offen offset:1024 lds
 v_mfma_f32_16x16x32_bf16 v[220:223], a[152:155], a[64:67], v[232:235]
 v_mul_f32 v214, s20, v214
 v_mul_f32 v215, s20, v215
 v_mfma_f32_16x16x32_bf16 v[220:223], a[156:159], a[68:71], v[220:223]
 v_exp_f32 v212, v212
 v_mfma_f32_16x16x32_bf16 v[220:223], a[160:163], a[72:75], v[220:223]
 v_exp_f32 v213, v213
 v_mfma_f32_16x16x32_bf16 v[220:223], a[164:167], a[76:79], v[220:223]
 v_exp_f32 v214, v214
 v_mfma_f32_16x16x32_bf16 v[208:211], a[164:167], a[92:95], v[236:239]
 v_exp_f32 v215, v215
 v_mfma_f32_16x16x32_bf16 v[208:211], a[160:163], a[88:91], v[208:211]
 v_cvt_pk_bf16_f32 v170, v212, v213
 v_cvt_pk_bf16_f32 v171, v214, v215
 v_mfma_f32_16x16x32_bf16 v[208:211], a[156:159], a[84:87], v[208:211]
 v_mul_f32 v216, s20, v216
 v_mul_f32 v217, s20, v217
 v_mfma_f32_16x16x32_bf16 v[208:211], a[152:155], a[80:83], v[208:211]
 v_mul_f32 v218, s20, v218
 v_mul_f32 v219, s20, v219
 v_mfma_f32_16x16x32_bf16 v[212:215], a[152:155], a[96:99], v[240:243]
 v_exp_f32 v216, v216
 v_mfma_f32_16x16x32_bf16 v[212:215], a[156:159], a[100:103], v[212:215]
 v_exp_f32 v217, v217
 v_mfma_f32_16x16x32_bf16 v[212:215], a[160:163], a[104:107], v[212:215]
 v_exp_f32 v218, v218
 v_mfma_f32_16x16x32_bf16 v[212:215], a[164:167], a[108:111], v[212:215]
 s_waitcnt lgkmcnt(11)
 v_exp_f32 v219, v219
 v_mfma_f32_16x16x32_bf16 v[8:11], a[200:203], v[128:131], v[8:11]
 s_waitcnt lgkmcnt(9)
 buffer_load_dwordx4 v250, s[12:15], s38 offen offset:2048 lds
 v_mfma_f32_16x16x32_bf16 v[8:11], a[204:207], v[132:135], v[8:11]
 v_cvt_pk_bf16_f32 v178, v216, v217
 v_cvt_pk_bf16_f32 v179, v218, v219
 v_mfma_f32_16x16x32_bf16 v[40:43], a[204:207], v[140:143], v[40:43]
 v_mul_f32 v220, s20, v220
 v_mul_f32 v221, s20, v221
 v_mfma_f32_16x16x32_bf16 v[40:43], a[200:203], v[136:139], v[40:43]
 v_mul_f32 v222, s20, v222
 v_mul_f32 v223, s20, v223
 v_mfma_f32_16x16x32_bf16 v[72:75], a[200:203], v[144:147], v[72:75]
 v_exp_f32 v220, v220
 v_mfma_f32_16x16x32_bf16 v[72:75], a[204:207], v[148:151], v[72:75]
 v_exp_f32 v221, v221
 v_mfma_f32_16x16x32_bf16 v[104:107], a[204:207], v[156:159], v[104:107]
 v_exp_f32 v222, v222
 v_mfma_f32_16x16x32_bf16 v[104:107], a[200:203], v[152:155], v[104:107]
 v_exp_f32 v223, v223
 v_mfma_f32_16x16x32_bf16 a[8:11], a[200:203], v[160:163], a[8:11]
 ds_read_b64_tr_b16 a[200:201], v247 offset:0
 v_cvt_pk_bf16_f32 v186, v220, v221
 v_mfma_f32_16x16x32_bf16 a[8:11], a[204:207], v[164:167], a[8:11]
 s_waitcnt lgkmcnt(8)
 ds_read_b64_tr_b16 a[202:203], v247 offset:1024
 v_cvt_pk_bf16_f32 v187, v222, v223
 v_mfma_f32_16x16x32_bf16 v[12:15], a[208:211], v[128:131], v[12:15]
 s_waitcnt lgkmcnt(7)
 ds_read_b64_tr_b16 a[204:205], v247 offset:2048
 v_mul_f32 v208, s20, v208
 v_mfma_f32_16x16x32_bf16 v[12:15], a[212:215], v[132:135], v[12:15]
 ds_read_b64_tr_b16 a[206:207], v247 offset:3072
 v_mul_f32 v209, s20, v209
 v_mfma_f32_16x16x32_bf16 v[44:47], a[212:215], v[140:143], v[44:47]
 v_mul_f32 v210, s20, v210
 v_mul_f32 v211, s20, v211
 v_mfma_f32_16x16x32_bf16 v[44:47], a[208:211], v[136:139], v[44:47]
 buffer_load_dwordx4 v250, s[12:15], s38 offen offset:3072 lds
 v_mfma_f32_16x16x32_bf16 v[76:79], a[208:211], v[144:147], v[76:79]
 v_exp_f32 v208, v208
 v_mfma_f32_16x16x32_bf16 v[76:79], a[212:215], v[148:151], v[76:79]
 v_exp_f32 v209, v209
 v_mfma_f32_16x16x32_bf16 v[108:111], a[212:215], v[156:159], v[108:111]
 v_exp_f32 v210, v210
 v_mfma_f32_16x16x32_bf16 v[108:111], a[208:211], v[152:155], v[108:111]
 v_exp_f32 v211, v211
 v_mfma_f32_16x16x32_bf16 a[12:15], a[208:211], v[160:163], a[12:15]
 v_cvt_pk_bf16_f32 v194, v208, v209
 v_cvt_pk_bf16_f32 v195, v210, v211
 v_mfma_f32_16x16x32_bf16 a[12:15], a[212:215], v[164:167], a[12:15]
 ds_read_b64_tr_b16 a[208:209], v247 offset:8
 v_mul_f32 v212, s20, v212
 v_mfma_f32_16x16x32_bf16 a[116:119], a[132:135], v[136:139], a[116:119]
 ds_read_b64_tr_b16 a[210:211], v247 offset:1032
 v_mul_f32 v213, s20, v213
 v_mfma_f32_16x16x32_bf16 a[116:119], a[132:135], v[140:143], a[116:119]
 s_waitcnt lgkmcnt(10)
 v_mul_f32 v214, s20, v214
 v_mul_f32 v215, s20, v215
 v_mfma_f32_16x16x32_bf16 v[216:219], a[136:139], a[32:35], v[224:227]
 s_waitcnt lgkmcnt(9)
 v_exp_f32 v212, v212
 v_mfma_f32_16x16x32_bf16 v[216:219], a[140:143], a[36:39], v[216:219]
 s_waitcnt lgkmcnt(8)
 v_exp_f32 v213, v213
 v_mfma_f32_16x16x32_bf16 v[216:219], a[144:147], a[40:43], v[216:219]
 s_waitcnt lgkmcnt(7)
 v_exp_f32 v214, v214
 v_mfma_f32_16x16x32_bf16 v[216:219], a[148:151], a[44:47], v[216:219]
 v_exp_f32 v215, v215
 v_mfma_f32_16x16x32_bf16 v[220:223], a[148:151], a[60:63], v[228:231]
 ds_read_b64_tr_b16 a[212:213], v247 offset:2056
 v_cvt_pk_bf16_f32 v202, v212, v213
 v_mfma_f32_16x16x32_bf16 v[220:223], a[144:147], a[56:59], v[220:223]
 ds_read_b64_tr_b16 a[214:215], v247 offset:3080
 v_cvt_pk_bf16_f32 v203, v214, v215
 v_mfma_f32_16x16x32_bf16 v[220:223], a[140:143], a[52:55], v[220:223]
 v_mul_f32 v216, s20, v216
 v_mul_f32 v217, s20, v217
 v_mfma_f32_16x16x32_bf16 v[220:223], a[136:139], a[48:51], v[220:223]
 v_mul_f32 v218, s20, v218
 v_mul_f32 v219, s20, v219
 v_mfma_f32_16x16x32_bf16 v[208:211], a[136:139], a[64:67], v[232:235]
 v_exp_f32 v216, v216
 v_mfma_f32_16x16x32_bf16 v[208:211], a[140:143], a[68:71], v[208:211]
 v_exp_f32 v217, v217
 v_mfma_f32_16x16x32_bf16 v[208:211], a[144:147], a[72:75], v[208:211]
 v_exp_f32 v218, v218
 v_mfma_f32_16x16x32_bf16 v[208:211], a[148:151], a[76:79], v[208:211]
 v_exp_f32 v219, v219
 v_mfma_f32_16x16x32_bf16 v[212:215], a[148:151], a[92:95], v[236:239]
 v_cvt_pk_bf16_f32 v172, v216, v217
 v_cvt_pk_bf16_f32 v173, v218, v219
 v_mfma_f32_16x16x32_bf16 v[212:215], a[144:147], a[88:91], v[212:215]
 ds_read_b64_tr_b16 a[170:171], v248 offset:1024
 v_mul_f32 v220, s20, v220
 v_mfma_f32_16x16x32_bf16 v[212:215], a[140:143], a[84:87], v[212:215]
 ds_read_b64_tr_b16 a[172:173], v248 offset:2048
 v_mul_f32 v221, s20, v221
 v_mfma_f32_16x16x32_bf16 v[212:215], a[136:139], a[80:83], v[212:215]
 ds_read_b64_tr_b16 a[174:175], v248 offset:3072
 v_mul_f32 v222, s20, v222
 v_mfma_f32_16x16x32_bf16 v[216:219], a[136:139], a[96:99], v[240:243]
 ds_read_b64_tr_b16 a[176:177], v248 offset:8
 v_mul_f32 v223, s20, v223
 v_mfma_f32_16x16x32_bf16 v[216:219], a[140:143], a[100:103], v[216:219]
 ds_read_b64_tr_b16 a[178:179], v248 offset:1032
 v_mul_f32 v208, s20, v208
 v_mfma_f32_16x16x32_bf16 v[216:219], a[144:147], a[104:107], v[216:219]
 ds_read_b64_tr_b16 a[180:181], v248 offset:2056
 v_mul_f32 v209, s20, v209
 v_mfma_f32_16x16x32_bf16 v[216:219], a[148:151], a[108:111], v[216:219]
 s_waitcnt lgkmcnt(12)
 ds_read_b64_tr_b16 a[182:183], v248 offset:3080
 v_mul_f32 v210, s20, v210
 v_mfma_f32_16x16x32_bf16 v[16:19], a[200:203], v[128:131], v[16:19]
 s_waitcnt lgkmcnt(11)
 ds_read_b128 a[152:155], v244 offset:54016
 v_mul_f32 v211, s20, v211
 v_mfma_f32_16x16x32_bf16 v[16:19], a[204:207], v[132:135], v[16:19]
 ds_read_b128 a[156:159], v244 offset:54080
 v_mul_f32 v212, s20, v212
 v_mfma_f32_16x16x32_bf16 v[48:51], a[204:207], v[140:143], v[48:51]
 ds_read_b128 a[160:163], v244 offset:54144
 v_mul_f32 v213, s20, v213
 v_mfma_f32_16x16x32_bf16 v[48:51], a[200:203], v[136:139], v[48:51]
 ds_read_b128 a[164:167], v244 offset:54208
 v_mul_f32 v214, s20, v214
 v_mfma_f32_16x16x32_bf16 v[80:83], a[200:203], v[144:147], v[80:83]
 v_exp_f32 v220, v220
 v_mfma_f32_16x16x32_bf16 v[80:83], a[204:207], v[148:151], v[80:83]
 v_exp_f32 v221, v221
 v_mfma_f32_16x16x32_bf16 v[112:115], a[204:207], v[156:159], v[112:115]
 v_exp_f32 v222, v222
 v_mfma_f32_16x16x32_bf16 v[112:115], a[200:203], v[152:155], v[112:115]
 v_exp_f32 v223, v223
 v_mfma_f32_16x16x32_bf16 a[16:19], a[200:203], v[160:163], a[16:19]
 v_cvt_pk_bf16_f32 v180, v220, v221
 v_cvt_pk_bf16_f32 v181, v222, v223
 v_mfma_f32_16x16x32_bf16 a[16:19], a[204:207], v[164:167], a[16:19]
 s_waitcnt lgkmcnt(13)
 v_exp_f32 v208, v208
 v_mfma_f32_16x16x32_bf16 v[20:23], a[208:211], v[128:131], v[20:23]
 s_waitcnt lgkmcnt(11)
 v_exp_f32 v209, v209
 v_mfma_f32_16x16x32_bf16 v[20:23], a[212:215], v[132:135], v[20:23]
 v_exp_f32 v210, v210
 v_mfma_f32_16x16x32_bf16 v[52:55], a[212:215], v[140:143], v[52:55]
 v_exp_f32 v211, v211
 v_mfma_f32_16x16x32_bf16 v[52:55], a[208:211], v[136:139], v[52:55]
 v_cvt_pk_bf16_f32 v188, v208, v209
 v_cvt_pk_bf16_f32 v189, v210, v211
 v_mfma_f32_16x16x32_bf16 v[84:87], a[208:211], v[144:147], v[84:87]
 v_mul_f32 v215, s20, v215
 v_mul_f32 v216, s20, v216
 v_mfma_f32_16x16x32_bf16 v[84:87], a[212:215], v[148:151], v[84:87]
 v_exp_f32 v212, v212
 v_mfma_f32_16x16x32_bf16 v[116:119], a[212:215], v[156:159], v[116:119]
 v_exp_f32 v213, v213
 v_mfma_f32_16x16x32_bf16 v[116:119], a[208:211], v[152:155], v[116:119]
 v_exp_f32 v214, v214
 v_mfma_f32_16x16x32_bf16 a[20:23], a[208:211], v[160:163], a[20:23]
 s_waitcnt vmcnt(10) lgkmcnt(0)
 ds_inc_u32 v249, v252
 v_cvt_pk_bf16_f32 v196, v212, v213
 v_mfma_f32_16x16x32_bf16 a[20:23], a[212:215], v[164:167], a[20:23]
 s_add_u32 s2, s2, 4
 v_exp_f32 v215, v215
 v_mfma_f32_16x16x32_bf16 a[120:123], a[132:135], v[144:147], a[120:123]
 v_cvt_pk_bf16_f32 v197, v214, v215
 v_mul_f32 v217, s20, v217
 v_mfma_f32_16x16x32_bf16 a[120:123], a[132:135], v[148:151], a[120:123]
 v_mul_f32 v218, s20, v218
 v_mul_f32 v219, s20, v219
 v_mfma_f32_16x16x32_bf16 v[220:223], a[152:155], a[32:35], v[224:227]
 v_exp_f32 v216, v216
 v_mfma_f32_16x16x32_bf16 v[220:223], a[156:159], a[36:39], v[220:223]
 v_exp_f32 v217, v217
 v_mfma_f32_16x16x32_bf16 v[220:223], a[160:163], a[40:43], v[220:223]
 v_exp_f32 v218, v218
 v_mfma_f32_16x16x32_bf16 v[220:223], a[164:167], a[44:47], v[220:223]
 v_exp_f32 v219, v219
 v_mfma_f32_16x16x32_bf16 v[208:211], a[164:167], a[60:63], v[228:231]
 v_cvt_pk_bf16_f32 v204, v216, v217
 v_cvt_pk_bf16_f32 v205, v218, v219
 v_mfma_f32_16x16x32_bf16 v[208:211], a[160:163], a[56:59], v[208:211]
 v_mfma_f32_16x16x32_bf16 v[208:211], a[156:159], a[52:55], v[208:211]
 v_mfma_f32_16x16x32_bf16 v[208:211], a[152:155], a[48:51], v[208:211]
 v_mfma_f32_16x16x32_bf16 v[212:215], a[152:155], a[64:67], v[232:235]
 v_mul_f32 v220, s20, v220
 v_mul_f32 v221, s20, v221
 v_mfma_f32_16x16x32_bf16 v[212:215], a[156:159], a[68:71], v[212:215]
 v_mul_f32 v222, s20, v222
 v_mul_f32 v223, s20, v223
 v_mfma_f32_16x16x32_bf16 v[212:215], a[160:163], a[72:75], v[212:215]
 v_exp_f32 v220, v220
 v_mfma_f32_16x16x32_bf16 v[212:215], a[164:167], a[76:79], v[212:215]
 v_exp_f32 v221, v221
 v_mfma_f32_16x16x32_bf16 v[216:219], a[164:167], a[92:95], v[236:239]
 v_exp_f32 v222, v222
 v_mfma_f32_16x16x32_bf16 v[216:219], a[160:163], a[88:91], v[216:219]
 v_exp_f32 v223, v223
 v_mfma_f32_16x16x32_bf16 v[216:219], a[156:159], a[84:87], v[216:219]
 v_cvt_pk_bf16_f32 v174, v220, v221
 v_cvt_pk_bf16_f32 v175, v222, v223
 v_mfma_f32_16x16x32_bf16 v[216:219], a[152:155], a[80:83], v[216:219]
 v_mul_f32 v208, s20, v208
 v_mul_f32 v209, s20, v209
 v_mfma_f32_16x16x32_bf16 v[220:223], a[152:155], a[96:99], v[240:243]
 v_mul_f32 v210, s20, v210
 v_mul_f32 v211, s20, v211
 v_mfma_f32_16x16x32_bf16 v[220:223], a[156:159], a[100:103], v[220:223]
 ds_read_b32 v207, v249
 v_mul_f32 v212, s20, v212
 v_mfma_f32_16x16x32_bf16 v[220:223], a[160:163], a[104:107], v[220:223]
 v_exp_f32 v208, v208
 v_mfma_f32_16x16x32_bf16 v[220:223], a[164:167], a[108:111], v[220:223]
 v_exp_f32 v209, v209
 v_mfma_f32_16x16x32_bf16 v[24:27], a[168:171], v[128:131], v[24:27]
 v_exp_f32 v210, v210
 v_mfma_f32_16x16x32_bf16 v[24:27], a[172:175], v[132:135], v[24:27]
 v_exp_f32 v211, v211
 v_mfma_f32_16x16x32_bf16 v[56:59], a[172:175], v[140:143], v[56:59]
 v_cvt_pk_bf16_f32 v182, v208, v209
 v_cvt_pk_bf16_f32 v183, v210, v211
 v_mfma_f32_16x16x32_bf16 v[56:59], a[168:171], v[136:139], v[56:59]
 v_mul_f32 v213, s20, v213
 v_mul_f32 v214, s20, v214
 v_mfma_f32_16x16x32_bf16 v[88:91], a[168:171], v[144:147], v[88:91]
 s_waitcnt lgkmcnt(0)
 v_cmp_gt_u32 vcc, s2, v207
 v_mul_f32 v215, s20, v215
 v_mfma_f32_16x16x32_bf16 v[88:91], a[172:175], v[148:151], v[88:91]
 s_add_u32 s38, s28, 0
 v_exp_f32 v212, v212
 v_mfma_f32_16x16x32_bf16 v[120:123], a[172:175], v[156:159], v[120:123]
 s_cbranch_vccnz Lspin5_7
Lback5_7:
 ds_read_b64_tr_b16 a[200:201], v245 offset:16416
 v_mul_f32 v216, s20, v216
 v_mfma_f32_16x16x32_bf16 v[120:123], a[168:171], v[152:155], v[120:123]
 s_add_u32 m0, s23, 0
 ds_read_b64_tr_b16 a[202:203], v245 offset:17440
 v_mul_f32 v217, s20, v217
 v_mfma_f32_16x16x32_bf16 a[24:27], a[168:171], v[160:163], a[24:27]
 buffer_load_dwordx4 v250, s[12:15], s38 offen offset:0 lds
 v_mfma_f32_16x16x32_bf16 a[24:27], a[172:175], v[164:167], a[24:27]
 ds_read_b64_tr_b16 a[204:205], v245 offset:18464
 v_mul_f32 v218, s20, v218
 v_mfma_f32_16x16x32_bf16 v[28:31], a[176:179], v[128:131], v[28:31]
 ds_read_b64_tr_b16 a[206:207], v245 offset:19488
 v_mul_f32 v219, s20, v219
 v_mfma_f32_16x16x32_bf16 v[28:31], a[180:183], v[132:135], v[28:31]
 v_exp_f32 v213, v213
 v_mfma_f32_16x16x32_bf16 v[60:63], a[180:183], v[140:143], v[60:63]
 buffer_load_dwordx4 v250, s[12:15], s38 offen offset:1024 lds
 v_mfma_f32_16x16x32_bf16 v[60:63], a[176:179], v[136:139], v[60:63]
 v_exp_f32 v214, v214
 v_mfma_f32_16x16x32_bf16 v[92:95], a[176:179], v[144:147], v[92:95]
 v_exp_f32 v215, v215
 v_mfma_f32_16x16x32_bf16 v[92:95], a[180:183], v[148:151], v[92:95]
 v_exp_f32 v216, v216
 v_mfma_f32_16x16x32_bf16 v[124:127], a[180:183], v[156:159], v[124:127]
 buffer_load_dwordx4 v250, s[12:15], s38 offen offset:2048 lds
 v_mfma_f32_16x16x32_bf16 v[124:127], a[176:179], v[152:155], v[124:127]
 v_exp_f32 v217, v217
 v_mfma_f32_16x16x32_bf16 a[28:31], a[176:179], v[160:163], a[28:31]
 v_exp_f32 v218, v218
 v_mfma_f32_16x16x32_bf16 a[28:31], a[180:183], v[164:167], a[28:31]
 v_exp_f32 v219, v219
 v_mfma_f32_16x16x32_bf16 a[124:127], a[132:135], v[152:155], a[124:127]
 buffer_load_dwordx4 v250, s[12:15], s38 offen offset:3072 lds
 v_mfma_f32_16x16x32_bf16 a[124:127], a[132:135], v[156:159], a[124:127]
 s_waitcnt lgkmcnt(2)
 ds_read_b64_tr_b16 a[208:209], v245 offset:16424
 v_cvt_pk_bf16_f32 v190, v212, v213
 v_mfma_f32_16x16x32_bf16 v[0:3], a[200:203], v[168:171], v[0:3]
 s_waitcnt lgkmcnt(1)
 ds_read_b64_tr_b16 a[210:211], v245 offset:17448
 v_cvt_pk_bf16_f32 v191, v214, v215
 v_mfma_f32_16x16x32_bf16 v[0:3], a[204:207], v[172:175], v[0:3]
 s_mov_b32 s27, s28
 ds_read_b64_tr_b16 a[212:213], v245 offset:18472
 v_cvt_pk_bf16_f32 v198, v216, v217
 v_mfma_f32_16x16x32_bf16 v[32:35], a[204:207], v[180:183], v[32:35]
 s_mov_b32 s50, s40
 ds_read_b64_tr_b16 a[214:215], v245 offset:19496
 v_cvt_pk_bf16_f32 v199, v218, v219
 v_mfma_f32_16x16x32_bf16 v[32:35], a[200:203], v[176:179], v[32:35]
 s_mov_b32 s51, s41
 v_mul_f32 v220, s20, v220
 v_mul_f32 v221, s20, v221
 v_mfma_f32_16x16x32_bf16 v[64:67], a[200:203], v[184:187], v[64:67]
 s_mov_b32 s60, s42
 v_mul_f32 v222, s20, v222
 v_mul_f32 v223, s20, v223
 v_mfma_f32_16x16x32_bf16 v[64:67], a[204:207], v[188:191], v[64:67]
 s_mov_b32 s61, s43
 v_exp_f32 v220, v220
 v_mfma_f32_16x16x32_bf16 v[96:99], a[204:207], v[196:199], v[96:99]
 s_mov_b32 s3, s44
 v_exp_f32 v221, v221
 v_exp_f32 v222, v222
 v_exp_f32 v223, v223
 v_mfma_f32_16x16x32_bf16 v[96:99], a[200:203], v[192:195], v[96:99]
 v_cvt_pk_bf16_f32 v206, v220, v221
 v_cvt_pk_bf16_f32 v207, v222, v223
 v_mfma_f32_16x16x32_bf16 a[0:3], a[200:203], v[200:203], a[0:3]
 buffer_load_dwordx4 a[76:79], v251, s[4:7], s34 offen offset:192
 v_mfma_f32_16x16x32_bf16 a[0:3], a[204:207], v[204:207], a[0:3]
 ds_read_b64_tr_b16 a[200:201], v246 offset:16416
 ds_read_b64_tr_b16 a[202:203], v246 offset:17440
 v_mfma_f32_16x16x32_bf16 a[112:115], a[132:135], v[168:171], a[112:115]
 ds_read_b64_tr_b16 a[204:205], v246 offset:18464
 ds_read_b64_tr_b16 a[206:207], v246 offset:19488
 v_mfma_f32_16x16x32_bf16 a[112:115], a[132:135], v[172:175], a[112:115]
 ds_read_b128 a[136:139], v244 offset:1024
 ds_read_b128 a[140:143], v244 offset:1088
 v_mfma_f32_16x16x32_bf16 a[116:119], a[132:135], v[176:179], a[116:119]
 ds_read_b128 a[144:147], v244 offset:1152
 v_accvgpr_read_b32 v128, a0
 v_mfma_f32_16x16x32_bf16 a[116:119], a[132:135], v[180:183], a[116:119]
 ds_read_b128 a[148:151], v244 offset:1216
 v_accvgpr_read_b32 v129, a1
 v_mfma_f32_16x16x32_bf16 a[120:123], a[132:135], v[184:187], a[120:123]
 ds_read_b128 a[152:155], v244 offset:2048
 v_accvgpr_read_b32 v226, a112
 v_mfma_f32_16x16x32_bf16 a[120:123], a[132:135], v[188:191], a[120:123]
 ds_read_b128 a[156:159], v244 offset:2112
 v_accvgpr_read_b32 v130, a2
 v_mfma_f32_16x16x32_bf16 a[124:127], a[132:135], v[192:195], a[124:127]
 ds_read_b128 a[160:163], v244 offset:2176
 v_accvgpr_read_b32 v230, a116
 v_mfma_f32_16x16x32_bf16 a[124:127], a[132:135], v[196:199], a[124:127]
 ds_read_b128 a[164:167], v244 offset:2240
 v_accvgpr_read_b32 v131, a3
 v_mfma_f32_16x16x32_bf16 a[128:131], a[132:135], v[200:203], a[128:131]
 ds_read_b128 a[168:171], v244 offset:3072
 v_accvgpr_read_b32 v234, a120
 v_mfma_f32_16x16x32_bf16 a[128:131], a[132:135], v[204:207], a[128:131]
 s_waitcnt lgkmcnt(15)
 v_rcp_f32 v224, v226
 v_mfma_f32_16x16x32_bf16 v[4:7], a[208:211], v[168:171], v[4:7]
 s_waitcnt lgkmcnt(13)
 ds_read_b128 a[172:175], v244 offset:3136
 v_accvgpr_read_b32 v238, a124
 v_mfma_f32_16x16x32_bf16 v[4:7], a[212:215], v[172:175], v[4:7]
 buffer_load_dwordx4 a[80:83], v251, s[4:7], s35 offen offset:0
 v_mfma_f32_16x16x32_bf16 v[36:39], a[212:215], v[180:183], v[36:39]
 ds_read_b128 a[176:179], v244 offset:3200
 v_accvgpr_read_b32 v242, a128
 v_mfma_f32_16x16x32_bf16 v[36:39], a[208:211], v[176:179], v[36:39]
 buffer_load_dwordx4 a[84:87], v251, s[4:7], s35 offen offset:64
 v_mfma_f32_16x16x32_bf16 v[68:71], a[208:211], v[184:187], v[68:71]
 ds_read_b128 a[180:183], v244 offset:3264
 v_mov_b32 v225, v224
 v_rcp_f32 v228, v230
 v_rcp_f32 v232, v234
 v_pk_mul_f32 v[6:7], v[6:7], v[224:225]
 v_pk_mul_f32 v[4:5], v[4:5], v[224:225]
 v_pk_mul_f32 v[0:1], v[0:1], v[224:225]
 v_pk_mul_f32 v[2:3], v[2:3], v[224:225]
 v_rcp_f32 v236, v238
 v_mfma_f32_16x16x32_bf16 v[68:71], a[212:215], v[188:191], v[68:71]
 ds_read_b128 a[184:187], v244 offset:4096
 v_mov_b32 v229, v228
 v_mfma_f32_16x16x32_bf16 v[100:103], a[212:215], v[196:199], v[100:103]
 ds_read_b128 a[188:191], v244 offset:4160
 v_mov_b32 v233, v232
 v_mfma_f32_16x16x32_bf16 v[100:103], a[208:211], v[192:195], v[100:103]
 ds_read_b128 a[192:195], v244 offset:4224
 v_mov_b32 v237, v236
 v_mfma_f32_16x16x32_bf16 a[4:7], a[208:211], v[200:203], a[4:7]
 ds_read_b64_tr_b16 a[208:209], v246 offset:16424
 v_add_f32 v209, v226, v224
 v_mfma_f32_16x16x32_bf16 a[4:7], a[212:215], v[204:207], a[4:7]
 s_waitcnt lgkmcnt(15)
 ds_read_b64_tr_b16 a[210:211], v246 offset:17448
 v_add_f32 v209, v230, v209
 v_mfma_f32_16x16x32_bf16 v[8:11], a[200:203], v[168:171], v[8:11]
 ds_read_b64_tr_b16 a[212:213], v246 offset:18472
 v_add_f32 v209, v228, v209
 v_mfma_f32_16x16x32_bf16 v[8:11], a[204:207], v[172:175], v[8:11]
 ds_read_b64_tr_b16 a[214:215], v246 offset:19496
 v_add_f32 v209, v234, v209
 v_mfma_f32_16x16x32_bf16 v[40:43], a[204:207], v[180:183], v[40:43]
 ds_read_b128 a[196:199], v244 offset:4288
 v_add_f32 v209, v232, v209
 v_rcp_f32 v240, v242
 v_add_f32 v209, v238, v209
 v_pk_mul_f32 v[38:39], v[38:39], v[228:229]
 v_pk_mul_f32 v[8:9], v[8:9], v[224:225]
 v_pk_mul_f32 v[10:11], v[10:11], v[224:225]
 v_pk_mul_f32 v[36:37], v[36:37], v[228:229]
 v_pk_mul_f32 v[32:33], v[32:33], v[228:229]
 v_pk_mul_f32 v[34:35], v[34:35], v[228:229]
 v_pk_mul_f32 v[70:71], v[70:71], v[232:233]
 v_pk_mul_f32 v[68:69], v[68:69], v[232:233]
 v_pk_mul_f32 v[64:65], v[64:65], v[232:233]
 v_pk_mul_f32 v[66:67], v[66:67], v[232:233]
 v_pk_mul_f32 v[102:103], v[102:103], v[236:237]
 v_pk_mul_f32 v[100:101], v[100:101], v[236:237]
 v_pk_mul_f32 v[96:97], v[96:97], v[236:237]
 v_pk_mul_f32 v[98:99], v[98:99], v[236:237]
 v_mov_b32 v241, v240
 v_mfma_f32_16x16x32_bf16 v[40:43], a[200:203], v[176:179], v[40:43]
 ds_read_b128 a[32:35], v252 offset:0
 v_add_f32 v209, v236, v209
 v_mfma_f32_16x16x32_bf16 v[72:75], a[200:203], v[184:187], v[72:75]
 ds_read_b128 a[36:39], v252 offset:1024
 v_add_f32 v209, v242, v209
 v_mfma_f32_16x16x32_bf16 v[72:75], a[204:207], v[188:191], v[72:75]
 ds_read_b128 a[40:43], v252 offset:2048
 v_add_f32 v209, v240, v209
 v_mfma_f32_16x16x32_bf16 v[104:107], a[204:207], v[196:199], v[104:107]
 buffer_load_dwordx4 a[88:91], v251, s[4:7], s35 offen offset:128
 v_mfma_f32_16x16x32_bf16 v[104:107], a[200:203], v[192:195], v[104:107]
 ds_read_b128 a[44:47], v252 offset:3072
 v_cmp_ngt_f32 vcc, s39, v209
 v_mfma_f32_16x16x32_bf16 a[8:11], a[200:203], v[200:203], a[8:11]
 buffer_load_dwordx4 a[92:95], v251, s[4:7], s35 offen offset:192
 v_mfma_f32_16x16x32_bf16 a[8:11], a[204:207], v[204:207], a[8:11]
 s_waitcnt lgkmcnt(7)
 ds_read_b64_tr_b16 a[200:201], v247 offset:16416
 v_accvgpr_read_b32 v134, a6
 v_mfma_f32_16x16x32_bf16 v[12:15], a[208:211], v[168:171], v[12:15]
 s_waitcnt lgkmcnt(6)
 ds_read_b64_tr_b16 a[202:203], v247 offset:17440
 v_accvgpr_read_b32 v135, a7
 v_accvgpr_read_b32 v132, a4
 v_accvgpr_read_b32 v133, a5
 v_accvgpr_read_b32 v136, a8
 v_pk_mul_f32 v[134:135], v[134:135], v[240:241]
 v_pk_mul_f32 v[132:133], v[132:133], v[240:241]
 v_pk_mul_f32 v[128:129], v[128:129], v[240:241]
 v_pk_mul_f32 v[130:131], v[130:131], v[240:241]
 v_pk_mul_f32 v[40:41], v[40:41], v[228:229]
 v_pk_mul_f32 v[42:43], v[42:43], v[228:229]
 v_pk_mul_f32 v[72:73], v[72:73], v[232:233]
 v_pk_mul_f32 v[74:75], v[74:75], v[232:233]
 v_pk_mul_f32 v[104:105], v[104:105], v[236:237]
 v_pk_mul_f32 v[106:107], v[106:107], v[236:237]
 v_cvt_pk_bf16_f32 v135, v134, v135
 v_mfma_f32_16x16x32_bf16 v[12:15], a[212:215], v[172:175], v[12:15]
 s_cmp_lg_u64 vcc, 0
 ds_read_b64_tr_b16 a[204:205], v247 offset:18464
 v_cvt_pk_bf16_f32 v134, v132, v133
 v_mfma_f32_16x16x32_bf16 v[44:47], a[212:215], v[180:183], v[44:47]
 s_cselect_b32 s63, s63, 0
 ds_read_b64_tr_b16 a[206:207], v247 offset:19488
 v_cvt_pk_bf16_f32 v132, v128, v129
 v_mfma_f32_16x16x32_bf16 v[44:47], a[208:211], v[176:179], v[44:47]
 s_or_b32 s45, s45, s63
 ds_read_b128 a[48:51], v252 offset:4096
 v_cvt_pk_bf16_f32 v133, v130, v131
 v_mfma_f32_16x16x32_bf16 v[76:79], a[208:211], v[184:187], v[76:79]
 ds_read_b128 a[52:55], v252 offset:5120
 v_accvgpr_read_b32 v137, a9
 v_mfma_f32_16x16x32_bf16 v[76:79], a[212:215], v[188:191], v[76:79]
 ds_read_b128 a[56:59], v252 offset:6144
 v_accvgpr_read_b32 v138, a10
 v_mfma_f32_16x16x32_bf16 v[108:111], a[212:215], v[196:199], v[108:111]
 ds_read_b128 a[60:63], v252 offset:7168
 v_accvgpr_read_b32 v139, a11
 v_mfma_f32_16x16x32_bf16 v[108:111], a[208:211], v[192:195], v[108:111]
 ds_read_b128 a[64:67], v252 offset:8192
 v_cvt_pk_bf16_f32 v7, v6, v7
 v_mfma_f32_16x16x32_bf16 a[12:15], a[208:211], v[200:203], a[12:15]
 ds_read_b64_tr_b16 a[208:209], v247 offset:16424
 v_cvt_pk_bf16_f32 v6, v4, v5
 v_cvt_pk_bf16_f32 v4, v0, v1
 v_cvt_pk_bf16_f32 v5, v2, v3
 v_cvt_pk_bf16_f32 v39, v38, v39
 v_pk_mul_f32 v[136:137], v[136:137], v[240:241]
 v_pk_mul_f32 v[138:139], v[138:139], v[240:241]
 v_pk_mul_f32 v[14:15], v[14:15], v[224:225]
 v_pk_mul_f32 v[12:13], v[12:13], v[224:225]
 v_pk_mul_f32 v[46:47], v[46:47], v[228:229]
 v_pk_mul_f32 v[44:45], v[44:45], v[228:229]
 v_pk_mul_f32 v[78:79], v[78:79], v[232:233]
 v_pk_mul_f32 v[76:77], v[76:77], v[232:233]
 v_pk_mul_f32 v[110:111], v[110:111], v[236:237]
 v_pk_mul_f32 v[108:109], v[108:109], v[236:237]
 v_cvt_pk_bf16_f32 v15, v14, v15
 v_mfma_f32_16x16x32_bf16 a[12:15], a[212:215], v[204:207], a[12:15]
 s_waitcnt lgkmcnt(8)
 ds_read_b64_tr_b16 a[210:211], v247 offset:17448
 v_cvt_pk_bf16_f32 v14, v12, v13
 v_mfma_f32_16x16x32_bf16 v[16:19], a[200:203], v[168:171], v[16:19]
 s_waitcnt lgkmcnt(7)
 ds_read_b64_tr_b16 a[212:213], v247 offset:18472
 v_cvt_pk_bf16_f32 v12, v8, v9
 v_mfma_f32_16x16x32_bf16 v[16:19], a[204:207], v[172:175], v[16:19]
 ds_read_b64_tr_b16 a[214:215], v247 offset:19496
 v_accvgpr_read_b32 v142, a14
 v_mfma_f32_16x16x32_bf16 v[48:51], a[204:207], v[180:183], v[48:51]
 buffer_load_dwordx4 a[96:99], v251, s[4:7], s36 offen offset:0
 v_mfma_f32_16x16x32_bf16 v[48:51], a[200:203], v[176:179], v[48:51]
 buffer_load_dwordx4 a[100:103], v251, s[4:7], s36 offen offset:64
 v_mfma_f32_16x16x32_bf16 v[80:83], a[200:203], v[184:187], v[80:83]
 ds_read_b128 a[68:71], v252 offset:9216
 v_accvgpr_read_b32 v143, a15
 v_mfma_f32_16x16x32_bf16 v[80:83], a[204:207], v[188:191], v[80:83]
 ds_read_b128 a[72:75], v252 offset:10240
 v_accvgpr_read_b32 v140, a12
 v_mfma_f32_16x16x32_bf16 v[112:115], a[204:207], v[196:199], v[112:115]
 ds_write_b128 v253, v[132:135] offset:8192
 v_accvgpr_read_b32 v141, a13
 v_pk_mul_f32 v[142:143], v[142:143], v[240:241]
 v_pk_mul_f32 v[140:141], v[140:141], v[240:241]
 v_pk_mul_f32 v[16:17], v[16:17], v[224:225]
 v_pk_mul_f32 v[18:19], v[18:19], v[224:225]
 v_pk_mul_f32 v[48:49], v[48:49], v[228:229]
 v_pk_mul_f32 v[50:51], v[50:51], v[228:229]
 v_pk_mul_f32 v[80:81], v[80:81], v[232:233]
 v_pk_mul_f32 v[82:83], v[82:83], v[232:233]
 v_cvt_pk_bf16_f32 v143, v142, v143
 v_mfma_f32_16x16x32_bf16 v[112:115], a[200:203], v[192:195], v[112:115]
 v_cvt_pk_bf16_f32 v142, v140, v141
 v_cvt_pk_bf16_f32 v13, v10, v11
 v_mfma_f32_16x16x32_bf16 a[16:19], a[200:203], v[200:203], a[16:19]
 ds_read_b64_tr_b16 a[200:201], v248 offset:16416
 v_cvt_pk_bf16_f32 v140, v136, v137
 v_mfma_f32_16x16x32_bf16 a[16:19], a[204:207], v[204:207], a[16:19]
 s_waitcnt lgkmcnt(6)
 ds_read_b64_tr_b16 a[202:203], v248 offset:17440
 v_cvt_pk_bf16_f32 v141, v138, v139
 v_mfma_f32_16x16x32_bf16 v[20:23], a[208:211], v[168:171], v[20:23]
 s_waitcnt lgkmcnt(5)
 ds_read_b64_tr_b16 a[204:205], v248 offset:18464
 v_cvt_pk_bf16_f32 v38, v36, v37
 v_mfma_f32_16x16x32_bf16 v[20:23], a[212:215], v[172:175], v[20:23]
 ds_read_b64_tr_b16 a[206:207], v248 offset:19488
 v_cvt_pk_bf16_f32 v36, v32, v33
 v_mfma_f32_16x16x32_bf16 v[52:55], a[212:215], v[180:183], v[52:55]
 ds_write_b128 v254, v[140:143] offset:8192
 v_mfma_f32_16x16x32_bf16 v[52:55], a[208:211], v[176:179], v[52:55]
 ds_read_b128 v[136:139], v252 offset:8192
 v_cvt_pk_bf16_f32 v37, v34, v35
 v_mfma_f32_16x16x32_bf16 v[84:87], a[208:211], v[184:187], v[84:87]
 ds_read_b128 v[140:143], v252 offset:9216
 v_cvt_pk_bf16_f32 v47, v46, v47
 v_cvt_pk_bf16_f32 v46, v44, v45
 v_cvt_pk_bf16_f32 v44, v40, v41
 v_cvt_pk_bf16_f32 v45, v42, v43
 v_pk_mul_f32 v[22:23], v[22:23], v[224:225]
 v_pk_mul_f32 v[20:21], v[20:21], v[224:225]
 v_pk_mul_f32 v[54:55], v[54:55], v[228:229]
 v_pk_mul_f32 v[52:53], v[52:53], v[228:229]
 v_pk_mul_f32 v[112:113], v[112:113], v[236:237]
 v_pk_mul_f32 v[114:115], v[114:115], v[236:237]
 v_cvt_pk_bf16_f32 v71, v70, v71
 v_mfma_f32_16x16x32_bf16 v[84:87], a[212:215], v[188:191], v[84:87]
 ds_write_b128 v253, v[4:7] offset:0
 v_mfma_f32_16x16x32_bf16 v[116:119], a[212:215], v[196:199], v[116:119]
 v_cvt_pk_bf16_f32 v70, v68, v69
 v_cvt_pk_bf16_f32 v79, v78, v79
 v_mfma_f32_16x16x32_bf16 v[116:119], a[208:211], v[192:195], v[116:119]
 buffer_load_dwordx4 a[104:107], v251, s[4:7], s36 offen offset:128
 v_mfma_f32_16x16x32_bf16 a[20:23], a[208:211], v[200:203], a[20:23]
 buffer_load_dwordx4 a[108:111], v251, s[4:7], s36 offen offset:192
 v_mfma_f32_16x16x32_bf16 a[20:23], a[212:215], v[204:207], a[20:23]
 s_waitcnt lgkmcnt(6)
 ds_read_b64_tr_b16 a[208:209], v248 offset:16424
 v_cvt_pk_bf16_f32 v68, v64, v65
 v_mfma_f32_16x16x32_bf16 v[24:27], a[200:203], v[168:171], v[24:27]
 s_waitcnt lgkmcnt(5)
 ds_read_b64_tr_b16 a[210:211], v248 offset:17448
 v_cvt_pk_bf16_f32 v69, v66, v67
 v_mfma_f32_16x16x32_bf16 v[24:27], a[204:207], v[172:175], v[24:27]
 ds_read_b64_tr_b16 a[212:213], v248 offset:18472
 v_cvt_pk_bf16_f32 v78, v76, v77
 v_mfma_f32_16x16x32_bf16 v[56:59], a[204:207], v[180:183], v[56:59]
 ds_read_b64_tr_b16 a[214:215], v248 offset:19496
 v_cvt_pk_bf16_f32 v76, v72, v73
 v_cvt_pk_bf16_f32 v77, v74, v75
 v_cvt_pk_bf16_f32 v103, v102, v103
 v_cvt_pk_bf16_f32 v102, v100, v101
 v_pk_mul_f32 v[86:87], v[86:87], v[232:233]
 v_pk_mul_f32 v[84:85], v[84:85], v[232:233]
 v_pk_mul_f32 v[118:119], v[118:119], v[236:237]
 v_pk_mul_f32 v[116:117], v[116:117], v[236:237]
 v_pk_mul_f32 v[24:25], v[24:25], v[224:225]
 v_pk_mul_f32 v[26:27], v[26:27], v[224:225]
 v_cvt_pk_bf16_f32 v100, v96, v97
 v_mfma_f32_16x16x32_bf16 v[56:59], a[200:203], v[176:179], v[56:59]
 ds_write_b128 v254, v[12:15] offset:0
 v_mfma_f32_16x16x32_bf16 v[88:91], a[200:203], v[184:187], v[88:91]
 ds_read_b128 a[224:227], v252 offset:0
 v_cvt_pk_bf16_f32 v101, v98, v99
 v_mfma_f32_16x16x32_bf16 v[88:91], a[204:207], v[188:191], v[88:91]
 ds_read_b128 a[228:231], v252 offset:1024
 v_cvt_pk_bf16_f32 v111, v110, v111
 v_mfma_f32_16x16x32_bf16 v[120:123], a[204:207], v[196:199], v[120:123]
 s_cmp_eq_u32 s24, 5
 ds_write_b128 v253, v[36:39] offset:2048
 v_mfma_f32_16x16x32_bf16 v[120:123], a[200:203], v[192:195], v[120:123]
 s_cbranch_scc1 Llast5_1
Llback5_1:
 v_cvt_pk_bf16_f32 v110, v108, v109
 v_accvgpr_read_b32 v150, a22
 v_mfma_f32_16x16x32_bf16 a[24:27], a[200:203], v[200:203], a[24:27]
 v_cvt_pk_bf16_f32 v108, v104, v105
 v_cvt_pk_bf16_f32 v109, v106, v107
 v_mfma_f32_16x16x32_bf16 a[24:27], a[204:207], v[204:207], a[24:27]
 s_waitcnt lgkmcnt(6)
 ds_write_b128 v254, v[44:47] offset:2048
 v_mfma_f32_16x16x32_bf16 v[28:31], a[208:211], v[168:171], v[28:31]
 s_waitcnt lgkmcnt(5)
 ds_read_b128 a[232:235], v252 offset:2048
 v_accvgpr_read_b32 v151, a23
 v_accvgpr_read_b32 v148, a20
 v_accvgpr_read_b32 v149, a21
 v_accvgpr_read_b32 v144, a16
 v_pk_mul_f32 v[150:151], v[150:151], v[240:241]
 v_pk_mul_f32 v[148:149], v[148:149], v[240:241]
 v_pk_mul_f32 v[56:57], v[56:57], v[228:229]
 v_pk_mul_f32 v[58:59], v[58:59], v[228:229]
 v_pk_mul_f32 v[88:89], v[88:89], v[232:233]
 v_pk_mul_f32 v[90:91], v[90:91], v[232:233]
 v_pk_mul_f32 v[120:121], v[120:121], v[236:237]
 v_pk_mul_f32 v[122:123], v[122:123], v[236:237]
 v_accvgpr_read_b32 v145, a17
 v_mfma_f32_16x16x32_bf16 v[28:31], a[212:215], v[172:175], v[28:31]
 ds_read_b128 a[236:239], v252 offset:3072
 v_accvgpr_read_b32 v146, a18
 v_mfma_f32_16x16x32_bf16 v[60:63], a[212:215], v[180:183], v[60:63]
 s_cmp_eq_u32 s24, 5
 buffer_store_dwordx4 v[136:139], v255, s[16:19], s44 offen offset:0 nt
 v_mfma_f32_16x16x32_bf16 v[60:63], a[208:211], v[176:179], v[60:63]
 s_cbranch_scc1 Llast5_2
Llback5_2:
 v_accvgpr_read_b32 v147, a19
 v_cvt_pk_bf16_f32 v151, v150, v151
 v_mfma_f32_16x16x32_bf16 v[92:95], a[208:211], v[184:187], v[92:95]
 v_cvt_pk_bf16_f32 v150, v148, v149
 v_accvgpr_read_b32 v152, a24
 v_mfma_f32_16x16x32_bf16 v[92:95], a[212:215], v[188:191], v[92:95]
 buffer_store_dwordx4 v[140:143], v255, s[16:19], s44 offen offset:2048 nt
 v_mfma_f32_16x16x32_bf16 v[124:127], a[212:215], v[196:199], v[124:127]
 v_accvgpr_read_b32 v153, a25
 v_accvgpr_read_b32 v154, a26
 v_mfma_f32_16x16x32_bf16 v[124:127], a[208:211], v[192:195], v[124:127]
 v_accvgpr_read_b32 v155, a27
 v_cvt_pk_bf16_f32 v23, v22, v23
 v_mfma_f32_16x16x32_bf16 a[28:31], a[208:211], v[200:203], a[28:31]
 ds_write_b128 v253, v[68:71] offset:4096
 v_cvt_pk_bf16_f32 v22, v20, v21
 v_pk_mul_f32 v[144:145], v[144:145], v[240:241]
 v_pk_mul_f32 v[146:147], v[146:147], v[240:241]
 v_pk_mul_f32 v[152:153], v[152:153], v[240:241]
 v_pk_mul_f32 v[154:155], v[154:155], v[240:241]
 v_pk_mul_f32 v[30:31], v[30:31], v[224:225]
 v_pk_mul_f32 v[28:29], v[28:29], v[224:225]
 v_pk_mul_f32 v[62:63], v[62:63], v[228:229]
 v_pk_mul_f32 v[60:61], v[60:61], v[228:229]
 v_pk_mul_f32 v[94:95], v[94:95], v[232:233]
 v_pk_mul_f32 v[92:93], v[92:93], v[232:233]
 v_pk_mul_f32 v[126:127], v[126:127], v[236:237]
 v_pk_mul_f32 v[124:125], v[124:125], v[236:237]
 v_cvt_pk_bf16_f32 v148, v144, v145
 v_mfma_f32_16x16x32_bf16 a[28:31], a[212:215], v[204:207], a[28:31]
 v_cvt_pk_bf16_f32 v149, v146, v147
 v_cvt_pk_bf16_f32 v20, v16, v17
 ds_write_b128 v254, v[76:79] offset:4096
 ds_read_b128 a[240:243], v252 offset:4096
 ds_read_b128 a[244:247], v252 offset:5120
 v_cvt_pk_bf16_f32 v21, v18, v19
 v_cvt_pk_bf16_f32 v55, v54, v55
 v_cvt_pk_bf16_f32 v54, v52, v53
 v_accvgpr_read_b32 v158, a30
 ds_write_b128 v253, v[100:103] offset:6144
 v_accvgpr_read_b32 v159, a31
 v_accvgpr_read_b32 v156, a28
 v_accvgpr_read_b32 v157, a29
 v_pk_mul_f32 v[158:159], v[158:159], v[240:241]
 v_pk_mul_f32 v[156:157], v[156:157], v[240:241]
 v_cvt_pk_bf16_f32 v159, v158, v159
 ds_write_b128 v254, v[108:111] offset:6144
 ds_read_b128 a[248:251], v252 offset:6144
 ds_read_b128 a[252:255], v252 offset:7168
 v_cvt_pk_bf16_f32 v158, v156, v157
 v_cvt_pk_bf16_f32 v156, v152, v153
 v_cvt_pk_bf16_f32 v157, v154, v155
 v_cvt_pk_bf16_f32 v52, v48, v49
 ds_write_b128 v253, v[148:151] offset:0
 v_cvt_pk_bf16_f32 v53, v50, v51
 v_cvt_pk_bf16_f32 v87, v86, v87
 v_cvt_pk_bf16_f32 v86, v84, v85
 v_cvt_pk_bf16_f32 v84, v80, v81
 v_cvt_pk_bf16_f32 v85, v82, v83
 v_cvt_pk_bf16_f32 v119, v118, v119
 ds_write_b128 v254, v[156:159] offset:0
 ds_read_b128 a[216:219], v252 offset:0
 ds_read_b128 a[220:223], v252 offset:1024
 v_cvt_pk_bf16_f32 v118, v116, v117
 v_cvt_pk_bf16_f32 v116, v112, v113
 v_cvt_pk_bf16_f32 v117, v114, v115
 v_cvt_pk_bf16_f32 v31, v30, v31
 v_cvt_pk_bf16_f32 v30, v28, v29
 v_cvt_pk_bf16_f32 v28, v24, v25
 v_cvt_pk_bf16_f32 v29, v26, v27
 v_cvt_pk_bf16_f32 v63, v62, v63
 v_cvt_pk_bf16_f32 v62, v60, v61
 v_cvt_pk_bf16_f32 v60, v56, v57
 v_cvt_pk_bf16_f32 v61, v58, v59
 s_cmp_eq_u32 s24, 5
 v_cvt_pk_bf16_f32 v95, v94, v95
 v_cvt_pk_bf16_f32 v94, v92, v93
 s_cbranch_scc1 Llast5_3
Llback5_3:
 v_cvt_pk_bf16_f32 v92, v88, v89
 v_cvt_pk_bf16_f32 v93, v90, v91
 s_cmp_eq_u32 s24, 5
 v_cvt_pk_bf16_f32 v127, v126, v127
 v_cvt_pk_bf16_f32 v126, v124, v125
 s_cbranch_scc1 Llast5_4
Llback5_4:
 v_cvt_pk_bf16_f32 v124, v120, v121
 v_cvt_pk_bf16_f32 v125, v122, v123
 s_add_u32 s24, s24, 1
 s_waitcnt lgkmcnt(0)
 s_cmp_eq_u32 s24, 6
 s_cbranch_scc1 L_done
 s_cmp_eq_u32 s31, 0
 s_cbranch_scc1 L_blk4
 s_branch L_blk5
.p2align 6
L_blk4:
 v_mfma_f32_16x16x32_bf16 v[208:211], a[136:139], a[32:35], 0
 s_add_u32 s55, s24, 1
 ds_write_b128 v253, v[20:23] offset:0
 v_mfma_f32_16x16x32_bf16 v[208:211], a[140:143], a[36:39], v[208:211]
 s_lshl_b32 s52, s55, 5
 v_mfma_f32_16x16x32_bf16 v[208:211], a[144:147], a[40:43], v[208:211]
 s_add_u32 s52, s52, s25
 v_mfma_f32_16x16x32_bf16 v[208:211], a[148:151], a[44:47], v[208:211]
 s_mul_i32 s53, s52, 43691
 ds_write_b128 v254, v[28:31] offset:0
 v_mfma_f32_16x16x32_bf16 v[212:215], a[148:151], a[60:63], 0
 s_lshr_b32 s53, s53, 17
 ds_read_b128 v[24:27], v252 offset:0
 ds_read_b128 v[28:31], v252 offset:1024
 v_mfma_f32_16x16x32_bf16 v[212:215], a[144:147], a[56:59], v[212:215]
 s_mul_i32 s54, s53, 3
 v_max3_f32 v169, v208, v209, v210
 v_max_f32 v168, v169, v211
 v_max_f32 v169, v169, v211
 v_mfma_f32_16x16x32_bf16 v[212:215], a[140:143], a[52:55], v[212:215]
 s_sub_u32 s54, s52, s54
 ds_write_b128 v253, v[52:55] offset:2048
 v_permlane32_swap_b32 v168, v169
 v_max_f32 v170, v168, v169
 v_max_f32 v171, v168, v169
 v_mfma_f32_16x16x32_bf16 v[212:215], a[136:139], a[48:51], v[212:215]
 s_lshl_b32 s53, s53, 3
 v_permlane16_swap_b32 v170, v171
 v_max_f32 v168, v170, v171
 v_sub_f32 v224, s59, v168
 v_sub_f32 v225, s59, v168
 v_sub_f32 v226, s59, v168
 v_sub_f32 v227, s59, v168
 v_pk_add_f32 v[208:209], v[208:209], v[224:225]
 v_pk_add_f32 v[210:211], v[210:211], v[226:227]
 v_pk_mul_f32 v[208:209], v[208:209], s[20:21]
 v_pk_mul_f32 v[210:211], v[210:211], s[20:21]
 v_max3_f32 v177, v212, v213, v214
 v_mfma_f32_16x16x32_bf16 v[216:219], a[152:155], a[32:35], v[224:227]
 s_add_u32 s53, s53, s26
 v_exp_f32 v208, v208
 v_mfma_f32_16x16x32_bf16 v[216:219], a[156:159], a[36:39], v[216:219]
 s_cmp_eq_u32 s54, 0
 ds_write_b128 v254, v[60:63] offset:2048
 v_mfma_f32_16x16x32_bf16 v[216:219], a[160:163], a[40:43], v[216:219]
 s_cselect_b32 s52, s46, s47
 ds_read_b128 v[56:59], v252 offset:2048
 v_max_f32 v176, v177, v215
 v_mfma_f32_16x16x32_bf16 v[216:219], a[164:167], a[44:47], v[216:219]
 s_cselect_b32 s31, 1, 0
 ds_read_b128 v[60:63], v252 offset:3072
 v_max_f32 v177, v177, v215
 v_mfma_f32_16x16x32_bf16 v[220:223], a[180:183], a[44:47], v[224:227]
 s_lshl_b32 s28, s53, 17
 ds_write_b128 v253, v[84:87] offset:4096
 v_mfma_f32_16x16x32_bf16 v[220:223], a[176:179], a[40:43], v[220:223]
 s_cmp_eq_u32 s54, 2
 v_exp_f32 v209, v209
 v_exp_f32 v210, v210
 v_exp_f32 v211, v211
 v_pk_mul_f32 v[216:217], v[216:217], s[20:21]
 v_pk_mul_f32 v[218:219], v[218:219], s[20:21]
 v_permlane32_swap_b32 v176, v177
 v_mfma_f32_16x16x32_bf16 v[220:223], a[172:175], a[36:39], v[220:223]
 s_waitcnt vmcnt(9)
 ds_inc_u32 v249, v252
 v_cvt_pk_bf16_f32 v128, v208, v209
 v_mfma_f32_16x16x32_bf16 v[220:223], a[168:171], a[32:35], v[220:223]
 s_cselect_b32 s52, s48, s52
 ds_write_b128 v254, v[92:95] offset:4096
 v_cvt_pk_bf16_f32 v129, v210, v211
 v_max_f32 v178, v176, v177
 v_max_f32 v179, v176, v177
 v_mfma_f32_16x16x32_bf16 v[208:211], a[184:187], a[32:35], v[224:227]
 s_cselect_b32 s31, s49, s31
 ds_read_b128 v[88:91], v252 offset:4096
 v_permlane16_swap_b32 v178, v179
 v_max_f32 v176, v178, v179
 v_sub_f32 v228, s59, v176
 v_sub_f32 v229, s59, v176
 v_pk_add_f32 v[212:213], v[212:213], v[228:229]
 v_pk_mul_f32 v[212:213], v[212:213], s[20:21]
 v_pk_mul_f32 v[220:221], v[220:221], s[20:21]
 v_pk_mul_f32 v[222:223], v[222:223], s[20:21]
 v_sub_f32 v230, s59, v176
 v_mfma_f32_16x16x32_bf16 v[208:211], a[188:191], a[36:39], v[208:211]
 s_add_u32 s37, s27, 49152
 ds_read_b128 v[92:95], v252 offset:5120
 v_sub_f32 v231, s59, v176
 v_add_f32 v214, v230, v214
 v_add_f32 v215, v231, v215
 v_mfma_f32_16x16x32_bf16 v[208:211], a[192:195], a[40:43], v[208:211]
 s_add_u32 m0, s22, 50944
 ds_write_b128 v253, v[116:119] offset:6144
 v_mul_f32 v214, s20, v214
 v_mul_f32 v215, s20, v215
 v_exp_f32 v212, v212
 v_exp_f32 v213, v213
 v_exp_f32 v214, v214
 v_exp_f32 v215, v215
 v_mfma_f32_16x16x32_bf16 v[208:211], a[196:199], a[44:47], v[208:211]
 s_waitcnt vmcnt(8)
 v_cvt_pk_bf16_f32 v136, v212, v213
 v_cvt_pk_bf16_f32 v137, v214, v215
 v_mfma_f32_16x16x32_bf16 v[212:215], a[148:151], a[76:79], 0
 s_add_u32 s2, s2, 4
 v_exp_f32 v216, v216
 v_mfma_f32_16x16x32_bf16 v[212:215], a[144:147], a[72:75], v[212:215]
 s_mul_i32 s53, s53, 217088
 buffer_load_dwordx4 v249, s[8:11], s37 offen offset:0 lds
 v_exp_f32 v217, v217
 v_pk_mul_f32 v[208:209], v[208:209], s[20:21]
 v_pk_mul_f32 v[210:211], v[210:211], s[20:21]
 v_exp_f32 v218, v218
 v_mfma_f32_16x16x32_bf16 v[212:215], a[140:143], a[68:71], v[212:215]
 s_add_u32 s30, s53, s52
 ds_write_b128 v254, v[124:127] offset:6144
 v_exp_f32 v219, v219
 v_mfma_f32_16x16x32_bf16 v[212:215], a[136:139], a[64:67], v[212:215]
 s_cmp_ge_u32 s55, 6
 ds_read_b128 v[120:123], v252 offset:6144
 v_cvt_pk_bf16_f32 v130, v216, v217
 v_cvt_pk_bf16_f32 v131, v218, v219
 v_mfma_f32_16x16x32_bf16 v[216:219], a[152:155], a[48:51], v[228:231]
 s_cselect_b32 s30, 117440512, s30
 ds_read_b128 v[124:127], v252 offset:7168
 v_mfma_f32_16x16x32_bf16 v[216:219], a[156:159], a[52:55], v[216:219]
 s_cselect_b32 s28, 67108864, s28
 s_waitcnt lgkmcnt(14)
 buffer_store_dwordx4 v[24:27], v255, s[16:19], s50 offen offset:128 nt
 s_waitcnt lgkmcnt(13)
 buffer_store_dwordx4 v[28:31], v255, s[16:19], s50 offen offset:2176 nt
 v_mfma_f32_16x16x32_bf16 v[216:219], a[160:163], a[56:59], v[216:219]
 s_add_u32 s36, s30, 16384
 v_exp_f32 v220, v220
 v_exp_f32 v221, v221
 v_exp_f32 v222, v222
 v_exp_f32 v223, v223
 v_mfma_f32_16x16x32_bf16 v[216:219], a[164:167], a[60:63], v[216:219]
 s_cmp_eq_u32 s31, 0
 buffer_load_dwordx4 v249, s[8:11], s37 offen offset:1024 lds
 v_cvt_pk_bf16_f32 v132, v220, v221
 v_cvt_pk_bf16_f32 v133, v222, v223
 v_mfma_f32_16x16x32_bf16 v[220:223], a[180:183], a[60:63], v[228:231]
 s_cselect_b32 s36, 117440512, s36
 v_max3_f32 v185, v212, v213, v214
 v_max_f32 v184, v185, v215
 v_exp_f32 v208, v208
 v_exp_f32 v209, v209
 v_pk_mul_f32 v[216:217], v[216:217], s[20:21]
 v_pk_mul_f32 v[218:219], v[218:219], s[20:21]
 v_exp_f32 v210, v210
 v_mfma_f32_16x16x32_bf16 v[220:223], a[176:179], a[56:59], v[220:223]
 s_mov_b32 s32, s30
 v_exp_f32 v211, v211
 v_mfma_f32_16x16x32_bf16 v[220:223], a[172:175], a[52:55], v[220:223]
 s_add_u32 s33, s30, 4096
 v_max_f32 v185, v185, v215
 v_cvt_pk_bf16_f32 v134, v208, v209
 v_mfma_f32_16x16x32_bf16 v[220:223], a[168:171], a[48:51], v[220:223]
 s_add_u32 s34, s30, 8192
 v_permlane32_swap_b32 v184, v185
 v_cvt_pk_bf16_f32 v135, v210, v211
 v_max_f32 v186, v184, v185
 v_max_f32 v187, v184, v185
 v_mfma_f32_16x16x32_bf16 v[208:211], a[184:187], a[48:51], v[228:231]
 s_add_u32 s35, s30, 12288
 v_permlane16_swap_b32 v186, v187
 v_max_f32 v184, v186, v187
 v_sub_f32 v232, s59, v184
 v_sub_f32 v233, s59, v184
 v_sub_f32 v234, s59, v184
 v_pk_add_f32 v[212:213], v[212:213], v[232:233]
 v_pk_mul_f32 v[212:213], v[212:213], s[20:21]
 v_pk_mul_f32 v[220:221], v[220:221], s[20:21]
 v_pk_mul_f32 v[222:223], v[222:223], s[20:21]
 v_sub_f32 v235, s59, v184
 v_mfma_f32_16x16x32_bf16 v[208:211], a[188:191], a[52:55], v[208:211]
 s_add_u32 s40, s29, 0
 buffer_load_dwordx4 v249, s[8:11], s37 offen offset:2048 lds
 v_add_f32 v214, v234, v214
 v_add_f32 v215, v235, v215
 v_mfma_f32_16x16x32_bf16 v[208:211], a[192:195], a[56:59], v[208:211]
 s_add_u32 s41, s29, 4096
 v_mul_f32 v214, s20, v214
 v_mul_f32 v215, s20, v215
 v_exp_f32 v212, v212
 v_exp_f32 v213, v213
 v_exp_f32 v214, v214
 v_exp_f32 v215, v215
 v_mfma_f32_16x16x32_bf16 v[208:211], a[196:199], a[60:63], v[208:211]
 s_waitcnt vmcnt(9)
 v_cvt_pk_bf16_f32 v144, v212, v213
 v_cvt_pk_bf16_f32 v145, v214, v215
 v_mfma_f32_16x16x32_bf16 v[212:215], a[148:151], a[92:95], 0
 s_add_u32 s42, s29, 8192
 v_exp_f32 v216, v216
 v_mfma_f32_16x16x32_bf16 v[212:215], a[144:147], a[88:91], v[212:215]
 s_add_u32 s43, s29, 12288
 ds_read_b32 v199, v249
 v_mul_f32 v208, s20, v208
 v_mfma_f32_16x16x32_bf16 v[212:215], a[140:143], a[84:87], v[212:215]
 s_lshl_b32 s63, 1, s24
 v_exp_f32 v217, v217
 v_exp_f32 v218, v218
 v_exp_f32 v219, v219
 v_mfma_f32_16x16x32_bf16 v[212:215], a[136:139], a[80:83], v[212:215]
 s_mov_b32 s29, s30
 buffer_load_dwordx4 v249, s[8:11], s37 offen offset:3072 lds
 v_cvt_pk_bf16_f32 v138, v216, v217
 v_cvt_pk_bf16_f32 v139, v218, v219
 v_mfma_f32_16x16x32_bf16 v[216:219], a[152:155], a[64:67], v[232:235]
 s_waitcnt lgkmcnt(1)
 v_exp_f32 v220, v220
 v_mfma_f32_16x16x32_bf16 v[216:219], a[156:159], a[68:71], v[216:219]
 v_exp_f32 v221, v221
 v_mfma_f32_16x16x32_bf16 v[216:219], a[160:163], a[72:75], v[216:219]
 v_exp_f32 v222, v222
 v_exp_f32 v223, v223
 v_mfma_f32_16x16x32_bf16 v[216:219], a[164:167], a[76:79], v[216:219]
 v_cvt_pk_bf16_f32 v140, v220, v221
 v_cvt_pk_bf16_f32 v141, v222, v223
 v_mfma_f32_16x16x32_bf16 v[220:223], a[180:183], a[76:79], v[232:235]
 s_waitcnt lgkmcnt(0)
 v_cmp_gt_u32 vcc, s2, v199
 v_max3_f32 v193, v212, v213, v214
 v_mfma_f32_16x16x32_bf16 v[220:223], a[176:179], a[72:75], v[220:223]
 s_add_u32 s38, s27, 16384
 v_mul_f32 v209, s20, v209
 v_mul_f32 v210, s20, v210
 v_mul_f32 v211, s20, v211
 v_max_f32 v192, v193, v215
 v_exp_f32 v208, v208
 v_pk_mul_f32 v[216:217], v[216:217], s[20:21]
 v_pk_mul_f32 v[218:219], v[218:219], s[20:21]
 v_exp_f32 v209, v209
 v_mfma_f32_16x16x32_bf16 v[220:223], a[172:175], a[68:71], v[220:223]
 s_cbranch_vccnz Lspin4_0
Lback4_0:
 v_exp_f32 v210, v210
 v_exp_f32 v211, v211
 v_max_f32 v193, v193, v215
 v_mfma_f32_16x16x32_bf16 v[220:223], a[168:171], a[64:67], v[220:223]
 s_add_u32 m0, s23, 16416
 ds_read_b128 a[136:139], v244 offset:17664
 v_permlane32_swap_b32 v192, v193
 v_cvt_pk_bf16_f32 v142, v208, v209
 v_cvt_pk_bf16_f32 v143, v210, v211
 v_max_f32 v194, v192, v193
 v_max_f32 v195, v192, v193
 v_mfma_f32_16x16x32_bf16 v[208:211], a[184:187], a[64:67], v[232:235]
 buffer_load_dwordx4 v250, s[12:15], s38 offen offset:0 lds
 v_permlane16_swap_b32 v194, v195
 v_max_f32 v192, v194, v195
 v_pk_mul_f32 v[220:221], v[220:221], s[20:21]
 v_pk_mul_f32 v[222:223], v[222:223], s[20:21]
 v_sub_f32 v236, s59, v192
 v_mfma_f32_16x16x32_bf16 v[208:211], a[188:191], a[68:71], v[208:211]
 ds_read_b128 a[140:143], v244 offset:17728
 v_sub_f32 v237, s59, v192
 v_sub_f32 v238, s59, v192
 v_sub_f32 v239, s59, v192
 v_add_f32 v212, v236, v212
 v_add_f32 v213, v237, v213
 v_add_f32 v214, v238, v214
 v_add_f32 v215, v239, v215
 v_mfma_f32_16x16x32_bf16 v[208:211], a[192:195], a[72:75], v[208:211]
 ds_read_b128 a[144:147], v244 offset:17792
 v_mul_f32 v212, s20, v212
 v_mul_f32 v213, s20, v213
 v_mul_f32 v214, s20, v214
 v_mul_f32 v215, s20, v215
 v_exp_f32 v212, v212
 v_exp_f32 v213, v213
 v_exp_f32 v214, v214
 v_exp_f32 v215, v215
 v_mfma_f32_16x16x32_bf16 v[208:211], a[196:199], a[76:79], v[208:211]
 ds_read_b128 a[148:151], v244 offset:17856
 v_cvt_pk_bf16_f32 v152, v212, v213
 v_cvt_pk_bf16_f32 v153, v214, v215
 v_mfma_f32_16x16x32_bf16 v[212:215], a[164:167], a[92:95], v[236:239]
 buffer_store_dwordx4 v[56:59], v255, s[16:19], s51 offen offset:128 nt
 buffer_store_dwordx4 v[60:63], v255, s[16:19], s51 offen offset:2176 nt
 v_mfma_f32_16x16x32_bf16 v[212:215], a[160:163], a[88:91], v[212:215]
 buffer_load_dwordx4 v250, s[12:15], s38 offen offset:1024 lds
 v_exp_f32 v216, v216
 v_pk_mul_f32 v[208:209], v[208:209], s[20:21]
 v_pk_mul_f32 v[210:211], v[210:211], s[20:21]
 v_exp_f32 v217, v217
 v_mfma_f32_16x16x32_bf16 v[212:215], a[156:159], a[84:87], v[212:215]
 v_exp_f32 v218, v218
 v_exp_f32 v219, v219
 v_mfma_f32_16x16x32_bf16 v[212:215], a[152:155], a[80:83], v[212:215]
 v_cvt_pk_bf16_f32 v146, v216, v217
 v_cvt_pk_bf16_f32 v147, v218, v219
 v_mfma_f32_16x16x32_bf16 v[216:219], a[168:171], a[80:83], v[236:239]
 buffer_load_dwordx4 v250, s[12:15], s38 offen offset:2048 lds
 v_mfma_f32_16x16x32_bf16 v[216:219], a[172:175], a[84:87], v[216:219]
 v_exp_f32 v220, v220
 v_mfma_f32_16x16x32_bf16 v[216:219], a[176:179], a[88:91], v[216:219]
 v_exp_f32 v221, v221
 v_exp_f32 v222, v222
 v_exp_f32 v223, v223
 v_pk_mul_f32 v[212:213], v[212:213], s[20:21]
 v_pk_mul_f32 v[214:215], v[214:215], s[20:21]
 v_cvt_pk_bf16_f32 v148, v220, v221
 v_mfma_f32_16x16x32_bf16 v[216:219], a[180:183], a[92:95], v[216:219]
 ds_read_b64_tr_b16 a[200:201], v245 offset:0
 v_cvt_pk_bf16_f32 v149, v222, v223
 v_mfma_f32_16x16x32_bf16 v[220:223], a[196:199], a[92:95], v[236:239]
 buffer_load_dwordx4 v250, s[12:15], s38 offen offset:3072 lds
 v_mfma_f32_16x16x32_bf16 v[220:223], a[192:195], a[88:91], v[220:223]
 v_exp_f32 v208, v208
 v_mfma_f32_16x16x32_bf16 v[220:223], a[188:191], a[84:87], v[220:223]
 v_exp_f32 v209, v209
 v_exp_f32 v210, v210
 v_exp_f32 v211, v211
 v_pk_mul_f32 v[216:217], v[216:217], s[20:21]
 v_pk_mul_f32 v[218:219], v[218:219], s[20:21]
 v_cvt_pk_bf16_f32 v150, v208, v209
 v_mfma_f32_16x16x32_bf16 v[220:223], a[184:187], a[80:83], v[220:223]
 s_waitcnt lgkmcnt(4)
 ds_read_b64_tr_b16 a[202:203], v245 offset:1024
 v_cvt_pk_bf16_f32 v151, v210, v211
 v_mfma_f32_16x16x32_bf16 v[208:211], a[136:139], a[32:35], v[224:227]
 s_waitcnt lgkmcnt(4)
 v_exp_f32 v212, v212
 v_mfma_f32_16x16x32_bf16 v[208:211], a[140:143], a[36:39], v[208:211]
 s_waitcnt lgkmcnt(3)
 v_exp_f32 v213, v213
 v_exp_f32 v214, v214
 v_exp_f32 v215, v215
 v_pk_mul_f32 v[220:221], v[220:221], s[20:21]
 v_pk_mul_f32 v[222:223], v[222:223], s[20:21]
 v_cvt_pk_bf16_f32 v154, v212, v213
 v_mfma_f32_16x16x32_bf16 v[208:211], a[144:147], a[40:43], v[208:211]
 s_waitcnt lgkmcnt(2)
 ds_read_b64_tr_b16 a[204:205], v245 offset:2048
 v_cvt_pk_bf16_f32 v155, v214, v215
 v_mfma_f32_16x16x32_bf16 v[208:211], a[148:151], a[44:47], v[208:211]
 v_exp_f32 v216, v216
 v_mfma_f32_16x16x32_bf16 v[212:215], a[148:151], a[60:63], v[228:231]
 v_exp_f32 v217, v217
 v_mfma_f32_16x16x32_bf16 v[212:215], a[144:147], a[56:59], v[212:215]
 v_exp_f32 v218, v218
 v_mfma_f32_16x16x32_bf16 v[212:215], a[140:143], a[52:55], v[212:215]
 v_exp_f32 v219, v219
 v_mfma_f32_16x16x32_bf16 v[212:215], a[136:139], a[48:51], v[212:215]
 ds_read_b64_tr_b16 a[206:207], v245 offset:3072
 v_cvt_pk_bf16_f32 v156, v216, v217
 v_cvt_pk_bf16_f32 v157, v218, v219
 v_exp_f32 v220, v220
 v_pk_mul_f32 v[208:209], v[208:209], s[20:21]
 v_pk_mul_f32 v[210:211], v[210:211], s[20:21]
 v_exp_f32 v221, v221
 v_mfma_f32_16x16x32_bf16 v[216:219], a[136:139], a[64:67], v[232:235]
 v_exp_f32 v222, v222
 v_mfma_f32_16x16x32_bf16 v[216:219], a[140:143], a[68:71], v[216:219]
 v_exp_f32 v223, v223
 v_mfma_f32_16x16x32_bf16 v[216:219], a[144:147], a[72:75], v[216:219]
 ds_read_b64_tr_b16 a[208:209], v245 offset:8
 v_cvt_pk_bf16_f32 v158, v220, v221
 v_mfma_f32_16x16x32_bf16 v[216:219], a[148:151], a[76:79], v[216:219]
 ds_read_b64_tr_b16 a[210:211], v245 offset:1032
 v_cvt_pk_bf16_f32 v159, v222, v223
 v_mfma_f32_16x16x32_bf16 v[220:223], a[148:151], a[92:95], v[236:239]
 ds_read_b64_tr_b16 a[212:213], v245 offset:2056
 v_mul_f32 v212, s20, v212
 v_mfma_f32_16x16x32_bf16 v[220:223], a[144:147], a[88:91], v[220:223]
 ds_read_b64_tr_b16 a[214:215], v245 offset:3080
 v_mul_f32 v213, s20, v213
 v_mfma_f32_16x16x32_bf16 v[220:223], a[140:143], a[84:87], v[220:223]
 ds_read_b128 a[152:155], v244 offset:18688
 v_mul_f32 v214, s20, v214
 v_mfma_f32_16x16x32_bf16 v[220:223], a[136:139], a[80:83], v[220:223]
 s_waitcnt lgkmcnt(7)
 ds_read_b128 a[156:159], v244 offset:18752
 v_mul_f32 v215, s20, v215
 v_mfma_f32_16x16x32_bf16 v[0:3], a[200:203], v[128:131], 0
 s_waitcnt lgkmcnt(6)
 ds_read_b128 a[160:163], v244 offset:18816
 v_mul_f32 v216, s20, v216
 v_mfma_f32_16x16x32_bf16 v[0:3], a[204:207], v[132:135], v[0:3]
 ds_read_b128 a[164:167], v244 offset:18880
 v_mul_f32 v217, s20, v217
 v_mfma_f32_16x16x32_bf16 v[32:35], a[204:207], v[140:143], 0
 v_exp_f32 v208, v208
 v_mfma_f32_16x16x32_bf16 v[32:35], a[200:203], v[136:139], v[32:35]
 v_exp_f32 v209, v209
 v_mfma_f32_16x16x32_bf16 v[64:67], a[200:203], v[144:147], 0
 s_add_u32 s37, s27, 65536
 v_exp_f32 v210, v210
 v_mfma_f32_16x16x32_bf16 v[64:67], a[204:207], v[148:151], v[64:67]
 s_add_u32 m0, s22, 1024
 v_exp_f32 v211, v211
 v_mfma_f32_16x16x32_bf16 v[96:99], a[204:207], v[156:159], 0
 ds_read_b64_tr_b16 a[204:205], v246 offset:2048
 v_cvt_pk_bf16_f32 v168, v208, v209
 v_mfma_f32_16x16x32_bf16 v[96:99], a[200:203], v[152:155], v[96:99]
 s_waitcnt lgkmcnt(7)
 ds_read_b64_tr_b16 a[200:201], v246 offset:0
 v_cvt_pk_bf16_f32 v169, v210, v211
 v_mfma_f32_16x16x32_bf16 v[4:7], a[208:211], v[128:131], 0
 s_waitcnt lgkmcnt(6)
 buffer_load_dwordx4 v249, s[8:11], s37 offen offset:0 lds
 v_mfma_f32_16x16x32_bf16 v[4:7], a[212:215], v[132:135], v[4:7]
 buffer_store_dwordx4 v[88:91], v255, s[16:19], s60 offen offset:128 nt
 buffer_store_dwordx4 v[92:95], v255, s[16:19], s60 offen offset:2176 nt
 v_mfma_f32_16x16x32_bf16 v[36:39], a[212:215], v[140:143], 0
 v_exp_f32 v212, v212
 v_mfma_f32_16x16x32_bf16 v[36:39], a[208:211], v[136:139], v[36:39]
 v_exp_f32 v213, v213
 v_mfma_f32_16x16x32_bf16 v[68:71], a[208:211], v[144:147], 0
 v_exp_f32 v214, v214
 v_mfma_f32_16x16x32_bf16 v[68:71], a[212:215], v[148:151], v[68:71]
 v_exp_f32 v215, v215
 v_mfma_f32_16x16x32_bf16 v[100:103], a[212:215], v[156:159], 0
 ds_read_b64_tr_b16 a[202:203], v246 offset:1024
 v_cvt_pk_bf16_f32 v176, v212, v213
 v_mfma_f32_16x16x32_bf16 v[100:103], a[208:211], v[152:155], v[100:103]
 ds_read_b64_tr_b16 a[206:207], v246 offset:3072
 v_cvt_pk_bf16_f32 v177, v214, v215
 v_mfma_f32_16x16x32_bf16 a[112:115], a[132:135], v[128:131], 0
 ds_read_b64_tr_b16 a[208:209], v246 offset:8
 v_mul_f32 v218, s20, v218
 v_mfma_f32_16x16x32_bf16 a[112:115], a[132:135], v[132:135], a[112:115]
 s_waitcnt lgkmcnt(8)
 ds_read_b64_tr_b16 a[210:211], v246 offset:1032
 v_mul_f32 v219, s20, v219
 v_mfma_f32_16x16x32_bf16 v[208:211], a[152:155], a[32:35], v[224:227]
 s_waitcnt lgkmcnt(8)
 buffer_load_dwordx4 v249, s[8:11], s37 offen offset:1024 lds
 v_mfma_f32_16x16x32_bf16 v[208:211], a[156:159], a[36:39], v[208:211]
 s_waitcnt lgkmcnt(7)
 v_exp_f32 v216, v216
 v_mfma_f32_16x16x32_bf16 v[208:211], a[160:163], a[40:43], v[208:211]
 s_waitcnt lgkmcnt(6)
 v_exp_f32 v217, v217
 v_mfma_f32_16x16x32_bf16 v[208:211], a[164:167], a[44:47], v[208:211]
 v_exp_f32 v218, v218
 v_mfma_f32_16x16x32_bf16 v[212:215], a[164:167], a[60:63], v[228:231]
 v_exp_f32 v219, v219
 v_mfma_f32_16x16x32_bf16 v[212:215], a[160:163], a[56:59], v[212:215]
 ds_read_b64_tr_b16 a[212:213], v246 offset:2056
 v_cvt_pk_bf16_f32 v184, v216, v217
 v_mfma_f32_16x16x32_bf16 v[212:215], a[156:159], a[52:55], v[212:215]
 ds_read_b64_tr_b16 a[214:215], v246 offset:3080
 v_cvt_pk_bf16_f32 v185, v218, v219
 v_mfma_f32_16x16x32_bf16 v[212:215], a[152:155], a[48:51], v[212:215]
 v_mul_f32 v220, s20, v220
 v_mul_f32 v221, s20, v221
 v_mfma_f32_16x16x32_bf16 v[216:219], a[152:155], a[64:67], v[232:235]
 v_mul_f32 v222, s20, v222
 v_mul_f32 v223, s20, v223
 v_mfma_f32_16x16x32_bf16 v[216:219], a[156:159], a[68:71], v[216:219]
 v_exp_f32 v220, v220
 v_mfma_f32_16x16x32_bf16 v[216:219], a[160:163], a[72:75], v[216:219]
 v_exp_f32 v221, v221
 v_exp_f32 v222, v222
 v_exp_f32 v223, v223
 v_mfma_f32_16x16x32_bf16 v[216:219], a[164:167], a[76:79], v[216:219]
 buffer_load_dwordx4 v249, s[8:11], s37 offen offset:2048 lds
 v_cvt_pk_bf16_f32 v192, v220, v221
 v_cvt_pk_bf16_f32 v193, v222, v223
 v_mfma_f32_16x16x32_bf16 v[220:223], a[164:167], a[92:95], v[236:239]
 ds_read_b128 a[136:139], v244 offset:19712
 v_mul_f32 v208, s20, v208
 v_mfma_f32_16x16x32_bf16 v[220:223], a[160:163], a[88:91], v[220:223]
 ds_read_b128 a[140:143], v244 offset:19776
 v_mul_f32 v209, s20, v209
 v_mfma_f32_16x16x32_bf16 v[220:223], a[156:159], a[84:87], v[220:223]
 ds_read_b128 a[144:147], v244 offset:19840
 v_mul_f32 v210, s20, v210
 v_mfma_f32_16x16x32_bf16 v[220:223], a[152:155], a[80:83], v[220:223]
 s_waitcnt lgkmcnt(8)
 ds_read_b128 a[148:151], v244 offset:19904
 v_mul_f32 v211, s20, v211
 v_mfma_f32_16x16x32_bf16 v[8:11], a[200:203], v[128:131], 0
 s_waitcnt lgkmcnt(8)
 v_exp_f32 v208, v208
 v_mfma_f32_16x16x32_bf16 v[8:11], a[204:207], v[132:135], v[8:11]
 v_exp_f32 v209, v209
 v_mfma_f32_16x16x32_bf16 v[40:43], a[204:207], v[140:143], 0
 v_exp_f32 v210, v210
 v_mfma_f32_16x16x32_bf16 v[40:43], a[200:203], v[136:139], v[40:43]
 v_exp_f32 v211, v211
 v_mfma_f32_16x16x32_bf16 v[72:75], a[200:203], v[144:147], 0
 buffer_load_dwordx4 v249, s[8:11], s37 offen offset:3072 lds
 v_cvt_pk_bf16_f32 v170, v208, v209
 v_cvt_pk_bf16_f32 v171, v210, v211
 v_pk_mul_f32 v[212:213], v[212:213], s[20:21]
 v_pk_mul_f32 v[214:215], v[214:215], s[20:21]
 v_pk_mul_f32 v[216:217], v[216:217], s[20:21]
 v_pk_mul_f32 v[218:219], v[218:219], s[20:21]
 v_pk_mul_f32 v[220:221], v[220:221], s[20:21]
 v_pk_mul_f32 v[222:223], v[222:223], s[20:21]
 v_exp_f32 v212, v212
 v_mfma_f32_16x16x32_bf16 v[72:75], a[204:207], v[148:151], v[72:75]
 v_exp_f32 v213, v213
 v_mfma_f32_16x16x32_bf16 v[104:107], a[204:207], v[156:159], 0
 v_exp_f32 v214, v214
 v_mfma_f32_16x16x32_bf16 v[104:107], a[200:203], v[152:155], v[104:107]
 s_waitcnt lgkmcnt(6)
 v_exp_f32 v215, v215
 v_mfma_f32_16x16x32_bf16 v[12:15], a[208:211], v[128:131], 0
 s_waitcnt lgkmcnt(4)
 ds_read_b64_tr_b16 a[200:201], v247 offset:0
 v_cvt_pk_bf16_f32 v178, v212, v213
 v_mfma_f32_16x16x32_bf16 v[12:15], a[212:215], v[132:135], v[12:15]
 ds_read_b64_tr_b16 a[202:203], v247 offset:1024
 v_cvt_pk_bf16_f32 v179, v214, v215
 v_mfma_f32_16x16x32_bf16 v[44:47], a[212:215], v[140:143], 0
 v_exp_f32 v216, v216
 v_mfma_f32_16x16x32_bf16 v[44:47], a[208:211], v[136:139], v[44:47]
 v_exp_f32 v217, v217
 v_mfma_f32_16x16x32_bf16 v[76:79], a[208:211], v[144:147], 0
 s_add_u32 m0, s62, 0
 v_exp_f32 v218, v218
 v_mfma_f32_16x16x32_bf16 v[76:79], a[212:215], v[148:151], v[76:79]
 v_exp_f32 v219, v219
 v_mfma_f32_16x16x32_bf16 v[108:111], a[212:215], v[156:159], 0
 buffer_load_dwordx4 v251, s[4:7], s32 offen offset:0 lds
 v_mfma_f32_16x16x32_bf16 v[108:111], a[208:211], v[152:155], v[108:111]
 s_add_u32 m0, s62, 960
 ds_read_b64_tr_b16 a[204:205], v247 offset:2048
 v_cvt_pk_bf16_f32 v186, v216, v217
 v_mfma_f32_16x16x32_bf16 a[116:119], a[132:135], v[136:139], 0
 ds_read_b64_tr_b16 a[206:207], v247 offset:3072
 v_cvt_pk_bf16_f32 v187, v218, v219
 v_mfma_f32_16x16x32_bf16 a[116:119], a[132:135], v[140:143], a[116:119]
 s_waitcnt lgkmcnt(7)
 buffer_load_dwordx4 v251, s[4:7], s32 offen offset:64 lds
 v_mfma_f32_16x16x32_bf16 v[208:211], a[136:139], a[32:35], v[224:227]
 s_waitcnt lgkmcnt(6)
 v_exp_f32 v220, v220
 v_mfma_f32_16x16x32_bf16 v[208:211], a[140:143], a[36:39], v[208:211]
 s_waitcnt lgkmcnt(5)
 v_exp_f32 v221, v221
 v_mfma_f32_16x16x32_bf16 v[208:211], a[144:147], a[40:43], v[208:211]
 s_waitcnt lgkmcnt(4)
 v_exp_f32 v222, v222
 v_mfma_f32_16x16x32_bf16 v[208:211], a[148:151], a[44:47], v[208:211]
 v_exp_f32 v223, v223
 v_mfma_f32_16x16x32_bf16 v[212:215], a[148:151], a[60:63], v[228:231]
 buffer_store_dwordx4 v[120:123], v255, s[16:19], s61 offen offset:128 nt
 buffer_store_dwordx4 v[124:127], v255, s[16:19], s61 offen offset:2176 nt
 v_mfma_f32_16x16x32_bf16 v[212:215], a[144:147], a[56:59], v[212:215]
 ds_read_b64_tr_b16 a[208:209], v247 offset:8
 v_cvt_pk_bf16_f32 v194, v220, v221
 v_mfma_f32_16x16x32_bf16 v[212:215], a[140:143], a[52:55], v[212:215]
 ds_read_b64_tr_b16 a[210:211], v247 offset:1032
 v_cvt_pk_bf16_f32 v195, v222, v223
 v_mfma_f32_16x16x32_bf16 v[212:215], a[136:139], a[48:51], v[212:215]
 ds_read_b64_tr_b16 a[168:169], v248 offset:0
 v_mul_f32 v208, s20, v208
 v_mfma_f32_16x16x32_bf16 v[216:219], a[136:139], a[64:67], v[232:235]
 ds_read_b64_tr_b16 a[170:171], v248 offset:1024
 v_mul_f32 v209, s20, v209
 v_mfma_f32_16x16x32_bf16 v[216:219], a[140:143], a[68:71], v[216:219]
 ds_read_b64_tr_b16 a[172:173], v248 offset:2048
 v_mul_f32 v210, s20, v210
 v_mfma_f32_16x16x32_bf16 v[216:219], a[144:147], a[72:75], v[216:219]
 ds_read_b64_tr_b16 a[174:175], v248 offset:3072
 v_mul_f32 v211, s20, v211
 v_mfma_f32_16x16x32_bf16 v[216:219], a[148:151], a[76:79], v[216:219]
 ds_read_b64_tr_b16 a[176:177], v248 offset:8
 v_mul_f32 v212, s20, v212
 v_mfma_f32_16x16x32_bf16 v[220:223], a[148:151], a[92:95], v[236:239]
 ds_read_b64_tr_b16 a[178:179], v248 offset:1032
 v_mul_f32 v213, s20, v213
 v_mfma_f32_16x16x32_bf16 v[220:223], a[144:147], a[88:91], v[220:223]
 ds_read_b64_tr_b16 a[180:181], v248 offset:2056
 v_mul_f32 v214, s20, v214
 v_mfma_f32_16x16x32_bf16 v[220:223], a[140:143], a[84:87], v[220:223]
 ds_read_b64_tr_b16 a[182:183], v248 offset:3080
 v_mul_f32 v215, s20, v215
 v_mfma_f32_16x16x32_bf16 v[220:223], a[136:139], a[80:83], v[220:223]
 s_waitcnt lgkmcnt(12)
 ds_read_b128 a[152:155], v244 offset:20736
 v_mul_f32 v216, s20, v216
 v_mfma_f32_16x16x32_bf16 v[16:19], a[200:203], v[128:131], 0
 s_waitcnt lgkmcnt(11)
 ds_read_b128 a[156:159], v244 offset:20800
 v_mul_f32 v217, s20, v217
 ds_read_b128 a[160:163], v244 offset:20864
 ds_read_b128 a[164:167], v244 offset:20928
 ds_read_b64_tr_b16 a[212:213], v247 offset:2056
 ds_read_b64_tr_b16 a[214:215], v247 offset:3080
 v_mfma_f32_16x16x32_bf16 v[16:19], a[204:207], v[132:135], v[16:19]
 v_exp_f32 v208, v208
 v_mfma_f32_16x16x32_bf16 v[48:51], a[204:207], v[140:143], 0
 v_exp_f32 v209, v209
 v_mfma_f32_16x16x32_bf16 v[48:51], a[200:203], v[136:139], v[48:51]
 v_exp_f32 v210, v210
 v_mfma_f32_16x16x32_bf16 v[80:83], a[200:203], v[144:147], 0
 v_exp_f32 v211, v211
 v_mfma_f32_16x16x32_bf16 v[80:83], a[204:207], v[148:151], v[80:83]
 v_cvt_pk_bf16_f32 v172, v208, v209
 v_cvt_pk_bf16_f32 v173, v210, v211
 v_mfma_f32_16x16x32_bf16 v[112:115], a[204:207], v[156:159], 0
 v_exp_f32 v212, v212
 v_mfma_f32_16x16x32_bf16 v[112:115], a[200:203], v[152:155], v[112:115]
 s_waitcnt lgkmcnt(14)
 v_exp_f32 v213, v213
 v_mfma_f32_16x16x32_bf16 v[20:23], a[208:211], v[128:131], 0
 s_waitcnt vmcnt(10) lgkmcnt(0)
 ds_inc_u32 v249, v252
 v_cvt_pk_bf16_f32 v180, v212, v213
 v_mfma_f32_16x16x32_bf16 v[20:23], a[212:215], v[132:135], v[20:23]
 s_add_u32 s2, s2, 4
 v_exp_f32 v214, v214
 v_mfma_f32_16x16x32_bf16 v[52:55], a[212:215], v[140:143], 0
 v_exp_f32 v215, v215
 v_mfma_f32_16x16x32_bf16 v[52:55], a[208:211], v[136:139], v[52:55]
 v_cvt_pk_bf16_f32 v181, v214, v215
 v_mul_f32 v218, s20, v218
 v_mfma_f32_16x16x32_bf16 v[84:87], a[208:211], v[144:147], 0
 v_mul_f32 v219, s20, v219
 v_mul_f32 v220, s20, v220
 v_mfma_f32_16x16x32_bf16 v[84:87], a[212:215], v[148:151], v[84:87]
 v_exp_f32 v216, v216
 v_mfma_f32_16x16x32_bf16 v[116:119], a[212:215], v[156:159], 0
 v_exp_f32 v217, v217
 v_mfma_f32_16x16x32_bf16 v[116:119], a[208:211], v[152:155], v[116:119]
 v_exp_f32 v218, v218
 v_mfma_f32_16x16x32_bf16 a[120:123], a[132:135], v[144:147], 0
 v_exp_f32 v219, v219
 v_mfma_f32_16x16x32_bf16 a[120:123], a[132:135], v[148:151], a[120:123]
 v_cvt_pk_bf16_f32 v188, v216, v217
 v_cvt_pk_bf16_f32 v189, v218, v219
 v_mfma_f32_16x16x32_bf16 v[208:211], a[152:155], a[32:35], v[224:227]
 v_mul_f32 v221, s20, v221
 v_mul_f32 v222, s20, v222
 v_mfma_f32_16x16x32_bf16 v[208:211], a[156:159], a[36:39], v[208:211]
 v_exp_f32 v220, v220
 v_mfma_f32_16x16x32_bf16 v[208:211], a[160:163], a[40:43], v[208:211]
 v_exp_f32 v221, v221
 v_mfma_f32_16x16x32_bf16 v[208:211], a[164:167], a[44:47], v[208:211]
 v_mul_f32 v223, s20, v223
 v_cvt_pk_bf16_f32 v196, v220, v221
 v_mfma_f32_16x16x32_bf16 v[212:215], a[164:167], a[60:63], v[228:231]
 v_exp_f32 v222, v222
 v_mfma_f32_16x16x32_bf16 v[212:215], a[160:163], a[56:59], v[212:215]
 v_exp_f32 v223, v223
 v_mfma_f32_16x16x32_bf16 v[212:215], a[156:159], a[52:55], v[212:215]
 v_cvt_pk_bf16_f32 v197, v222, v223
 v_mul_f32 v208, s20, v208
 v_mfma_f32_16x16x32_bf16 v[212:215], a[152:155], a[48:51], v[212:215]
 v_mul_f32 v209, s20, v209
 v_mul_f32 v210, s20, v210
 v_mfma_f32_16x16x32_bf16 v[216:219], a[152:155], a[64:67], v[232:235]
 v_exp_f32 v208, v208
 v_mfma_f32_16x16x32_bf16 v[216:219], a[156:159], a[68:71], v[216:219]
 v_exp_f32 v209, v209
 v_mfma_f32_16x16x32_bf16 v[216:219], a[160:163], a[72:75], v[216:219]
 v_mul_f32 v211, s20, v211
 v_cvt_pk_bf16_f32 v174, v208, v209
 v_mfma_f32_16x16x32_bf16 v[216:219], a[164:167], a[76:79], v[216:219]
 ds_read_b32 v199, v249
 v_mul_f32 v212, s20, v212
 v_mfma_f32_16x16x32_bf16 v[220:223], a[164:167], a[92:95], v[236:239]
 v_exp_f32 v210, v210
 v_mfma_f32_16x16x32_bf16 v[220:223], a[160:163], a[88:91], v[220:223]
 v_exp_f32 v211, v211
 v_mfma_f32_16x16x32_bf16 v[220:223], a[156:159], a[84:87], v[220:223]
 v_cvt_pk_bf16_f32 v175, v210, v211
 v_mul_f32 v213, s20, v213
 v_mfma_f32_16x16x32_bf16 v[220:223], a[152:155], a[80:83], v[220:223]
 v_mul_f32 v214, s20, v214
 v_mul_f32 v215, s20, v215
 v_mfma_f32_16x16x32_bf16 v[24:27], a[168:171], v[128:131], 0
 v_exp_f32 v212, v212
 v_mfma_f32_16x16x32_bf16 v[24:27], a[172:175], v[132:135], v[24:27]
 v_exp_f32 v213, v213
 v_mfma_f32_16x16x32_bf16 v[56:59], a[172:175], v[140:143], 0
 s_waitcnt lgkmcnt(0)
 v_cmp_gt_u32 vcc, s2, v199
 v_cvt_pk_bf16_f32 v182, v212, v213
 v_mfma_f32_16x16x32_bf16 v[56:59], a[168:171], v[136:139], v[56:59]
 s_add_u32 s38, s27, 49152
 v_exp_f32 v214, v214
 v_mfma_f32_16x16x32_bf16 v[88:91], a[168:171], v[144:147], 0
 s_cbranch_vccnz Lspin4_1
Lback4_1:
 ds_read_b128 a[136:139], v244 offset:34304
 v_mul_f32 v216, s20, v216
 v_mfma_f32_16x16x32_bf16 v[88:91], a[172:175], v[148:151], v[88:91]
 s_add_u32 m0, s23, 0
 ds_read_b128 a[140:143], v244 offset:34368
 v_mul_f32 v217, s20, v217
 v_mfma_f32_16x16x32_bf16 v[120:123], a[172:175], v[156:159], 0
 buffer_load_dwordx4 v250, s[12:15], s38 offen offset:0 lds
 v_exp_f32 v215, v215
 v_pk_mul_f32 v[218:219], v[218:219], s[20:21]
 v_pk_mul_f32 v[220:221], v[220:221], s[20:21]
 v_pk_mul_f32 v[222:223], v[222:223], s[20:21]
 v_cvt_pk_bf16_f32 v183, v214, v215
 v_mfma_f32_16x16x32_bf16 v[120:123], a[168:171], v[152:155], v[120:123]
 v_exp_f32 v216, v216
 v_mfma_f32_16x16x32_bf16 v[28:31], a[176:179], v[128:131], 0
 v_exp_f32 v217, v217
 v_mfma_f32_16x16x32_bf16 v[28:31], a[180:183], v[132:135], v[28:31]
 ds_read_b128 a[144:147], v244 offset:34432
 v_cvt_pk_bf16_f32 v190, v216, v217
 v_mfma_f32_16x16x32_bf16 v[60:63], a[180:183], v[140:143], 0
 v_exp_f32 v218, v218
 v_mfma_f32_16x16x32_bf16 v[60:63], a[176:179], v[136:139], v[60:63]
 ds_read_b128 a[148:151], v244 offset:34496
 ds_read_b64_tr_b16 a[200:201], v245 offset:16416
 v_mfma_f32_16x16x32_bf16 v[92:95], a[176:179], v[144:147], 0
 v_exp_f32 v219, v219
 v_mfma_f32_16x16x32_bf16 v[92:95], a[180:183], v[148:151], v[92:95]
 ds_read_b64_tr_b16 a[202:203], v245 offset:17440
 v_cvt_pk_bf16_f32 v191, v218, v219
 v_mfma_f32_16x16x32_bf16 v[124:127], a[180:183], v[156:159], 0
 v_exp_f32 v220, v220
 v_mfma_f32_16x16x32_bf16 v[124:127], a[176:179], v[152:155], v[124:127]
 buffer_load_dwordx4 v250, s[12:15], s38 offen offset:1024 lds
 v_mfma_f32_16x16x32_bf16 a[124:127], a[132:135], v[152:155], 0
 v_exp_f32 v221, v221
 v_mfma_f32_16x16x32_bf16 a[124:127], a[132:135], v[156:159], a[124:127]
 s_waitcnt lgkmcnt(5)
 ds_read_b64_tr_b16 a[204:205], v245 offset:18464
 v_cvt_pk_bf16_f32 v198, v220, v221
 v_mfma_f32_16x16x32_bf16 v[208:211], a[136:139], a[32:35], v[224:227]
 s_waitcnt lgkmcnt(5)
 v_exp_f32 v222, v222
 v_mfma_f32_16x16x32_bf16 v[208:211], a[140:143], a[36:39], v[208:211]
 s_waitcnt lgkmcnt(4)
 v_exp_f32 v223, v223
 v_mfma_f32_16x16x32_bf16 v[208:211], a[144:147], a[40:43], v[208:211]
 s_waitcnt lgkmcnt(3)
 ds_read_b64_tr_b16 a[206:207], v245 offset:19488
 v_cvt_pk_bf16_f32 v199, v222, v223
 v_mfma_f32_16x16x32_bf16 v[208:211], a[148:151], a[44:47], v[208:211]
 ds_read_b64_tr_b16 a[208:209], v245 offset:16424
 ds_read_b64_tr_b16 a[210:211], v245 offset:17448
 v_mfma_f32_16x16x32_bf16 v[212:215], a[148:151], a[60:63], v[228:231]
 ds_read_b64_tr_b16 a[212:213], v245 offset:18472
 ds_read_b64_tr_b16 a[214:215], v245 offset:19496
 v_mfma_f32_16x16x32_bf16 v[212:215], a[144:147], a[56:59], v[212:215]
 ds_read_b128 a[152:155], v244 offset:35328
 ds_read_b128 a[156:159], v244 offset:35392
 v_mfma_f32_16x16x32_bf16 v[212:215], a[140:143], a[52:55], v[212:215]
 buffer_load_dwordx4 v250, s[12:15], s38 offen offset:2048 lds
 v_mfma_f32_16x16x32_bf16 v[212:215], a[136:139], a[48:51], v[212:215]
 ds_read_b128 a[160:163], v244 offset:35456
 v_mul_f32 v208, s20, v208
 v_mfma_f32_16x16x32_bf16 v[216:219], a[136:139], a[64:67], v[232:235]
 ds_read_b128 a[164:167], v244 offset:35520
 v_mul_f32 v209, s20, v209
 v_mfma_f32_16x16x32_bf16 v[216:219], a[140:143], a[68:71], v[216:219]
 v_mul_f32 v210, s20, v210
 v_mul_f32 v211, s20, v211
 v_mfma_f32_16x16x32_bf16 v[216:219], a[144:147], a[72:75], v[216:219]
 v_exp_f32 v208, v208
 v_mfma_f32_16x16x32_bf16 v[216:219], a[148:151], a[76:79], v[216:219]
 v_exp_f32 v209, v209
 v_mfma_f32_16x16x32_bf16 v[220:223], a[148:151], a[92:95], v[236:239]
 v_exp_f32 v210, v210
 v_mfma_f32_16x16x32_bf16 v[220:223], a[144:147], a[88:91], v[220:223]
 v_exp_f32 v211, v211
 v_mfma_f32_16x16x32_bf16 v[220:223], a[140:143], a[84:87], v[220:223]
 v_cvt_pk_bf16_f32 v128, v208, v209
 v_cvt_pk_bf16_f32 v129, v210, v211
 v_mfma_f32_16x16x32_bf16 v[220:223], a[136:139], a[80:83], v[220:223]
 s_waitcnt lgkmcnt(10)
 buffer_load_dwordx4 v250, s[12:15], s38 offen offset:3072 lds
 v_mfma_f32_16x16x32_bf16 v[0:3], a[200:203], v[168:171], v[0:3]
 s_waitcnt lgkmcnt(8)
 v_mul_f32 v212, s20, v212
 v_mul_f32 v213, s20, v213
 v_mfma_f32_16x16x32_bf16 v[0:3], a[204:207], v[172:175], v[0:3]
 v_mul_f32 v214, s20, v214
 v_mul_f32 v215, s20, v215
 v_mfma_f32_16x16x32_bf16 v[32:35], a[204:207], v[180:183], v[32:35]
 v_exp_f32 v212, v212
 v_mfma_f32_16x16x32_bf16 v[32:35], a[200:203], v[176:179], v[32:35]
 v_exp_f32 v213, v213
 v_mfma_f32_16x16x32_bf16 v[64:67], a[200:203], v[184:187], v[64:67]
 s_add_u32 s37, s27, 81920
 v_exp_f32 v214, v214
 v_mfma_f32_16x16x32_bf16 v[64:67], a[204:207], v[188:191], v[64:67]
 s_add_u32 m0, s22, 17664
 v_exp_f32 v215, v215
 v_mfma_f32_16x16x32_bf16 v[96:99], a[204:207], v[196:199], v[96:99]
 ds_read_b64_tr_b16 a[204:205], v246 offset:18464
 v_cvt_pk_bf16_f32 v136, v212, v213
 v_mfma_f32_16x16x32_bf16 v[96:99], a[200:203], v[192:195], v[96:99]
 s_waitcnt lgkmcnt(7)
 ds_read_b64_tr_b16 a[200:201], v246 offset:16416
 v_cvt_pk_bf16_f32 v137, v214, v215
 v_mfma_f32_16x16x32_bf16 v[4:7], a[208:211], v[168:171], v[4:7]
 s_waitcnt lgkmcnt(6)
 buffer_load_dwordx4 v249, s[8:11], s37 offen offset:0 lds
 v_mfma_f32_16x16x32_bf16 v[4:7], a[212:215], v[172:175], v[4:7]
 ds_read_b64_tr_b16 a[202:203], v246 offset:17440
 v_mul_f32 v216, s20, v216
 v_mfma_f32_16x16x32_bf16 v[36:39], a[212:215], v[180:183], v[36:39]
 ds_read_b64_tr_b16 a[206:207], v246 offset:19488
 v_mul_f32 v217, s20, v217
 v_mfma_f32_16x16x32_bf16 v[36:39], a[208:211], v[176:179], v[36:39]
 v_mul_f32 v218, s20, v218
 v_mul_f32 v219, s20, v219
 v_mfma_f32_16x16x32_bf16 v[68:71], a[208:211], v[184:187], v[68:71]
 v_exp_f32 v216, v216
 v_mfma_f32_16x16x32_bf16 v[68:71], a[212:215], v[188:191], v[68:71]
 v_exp_f32 v217, v217
 v_mfma_f32_16x16x32_bf16 v[100:103], a[212:215], v[196:199], v[100:103]
 v_exp_f32 v218, v218
 v_mfma_f32_16x16x32_bf16 v[100:103], a[208:211], v[192:195], v[100:103]
 v_exp_f32 v219, v219
 v_mfma_f32_16x16x32_bf16 a[112:115], a[132:135], v[168:171], a[112:115]
 ds_read_b64_tr_b16 a[208:209], v246 offset:16424
 v_cvt_pk_bf16_f32 v144, v216, v217
 v_mfma_f32_16x16x32_bf16 a[112:115], a[132:135], v[172:175], a[112:115]
 s_waitcnt lgkmcnt(8)
 buffer_load_dwordx4 v249, s[8:11], s37 offen offset:1024 lds
 v_mfma_f32_16x16x32_bf16 v[208:211], a[152:155], a[32:35], v[224:227]
 s_waitcnt lgkmcnt(7)
 ds_read_b64_tr_b16 a[210:211], v246 offset:17448
 v_cvt_pk_bf16_f32 v145, v218, v219
 v_mfma_f32_16x16x32_bf16 v[208:211], a[156:159], a[36:39], v[208:211]
 s_waitcnt lgkmcnt(7)
 ds_read_b64_tr_b16 a[212:213], v246 offset:18472
 v_mul_f32 v220, s20, v220
 v_mfma_f32_16x16x32_bf16 v[208:211], a[160:163], a[40:43], v[208:211]
 s_waitcnt lgkmcnt(7)
 ds_read_b64_tr_b16 a[214:215], v246 offset:19496
 v_mul_f32 v221, s20, v221
 v_mfma_f32_16x16x32_bf16 v[208:211], a[164:167], a[44:47], v[208:211]
 v_mul_f32 v222, s20, v222
 v_mul_f32 v223, s20, v223
 v_mfma_f32_16x16x32_bf16 v[212:215], a[164:167], a[60:63], v[228:231]
 v_exp_f32 v220, v220
 v_mfma_f32_16x16x32_bf16 v[212:215], a[160:163], a[56:59], v[212:215]
 v_exp_f32 v221, v221
 v_mfma_f32_16x16x32_bf16 v[212:215], a[156:159], a[52:55], v[212:215]
 v_exp_f32 v222, v222
 v_mfma_f32_16x16x32_bf16 v[212:215], a[152:155], a[48:51], v[212:215]
 v_exp_f32 v223, v223
 v_mfma_f32_16x16x32_bf16 v[216:219], a[152:155], a[64:67], v[232:235]
 buffer_load_dwordx4 v249, s[8:11], s37 offen offset:2048 lds
 v_mfma_f32_16x16x32_bf16 v[216:219], a[156:159], a[68:71], v[216:219]
 v_cvt_pk_bf16_f32 v152, v220, v221
 v_cvt_pk_bf16_f32 v153, v222, v223
 v_mfma_f32_16x16x32_bf16 v[216:219], a[160:163], a[72:75], v[216:219]
 ds_read_b128 a[136:139], v244 offset:36352
 v_mul_f32 v208, s20, v208
 v_mfma_f32_16x16x32_bf16 v[216:219], a[164:167], a[76:79], v[216:219]
 ds_read_b128 a[140:143], v244 offset:36416
 v_mul_f32 v209, s20, v209
 v_mfma_f32_16x16x32_bf16 v[220:223], a[164:167], a[92:95], v[236:239]
 ds_read_b128 a[144:147], v244 offset:36480
 v_mul_f32 v210, s20, v210
 v_mfma_f32_16x16x32_bf16 v[220:223], a[160:163], a[88:91], v[220:223]
 ds_read_b128 a[148:151], v244 offset:36544
 v_mul_f32 v211, s20, v211
 v_mfma_f32_16x16x32_bf16 v[220:223], a[156:159], a[84:87], v[220:223]
 v_exp_f32 v208, v208
 v_mfma_f32_16x16x32_bf16 v[220:223], a[152:155], a[80:83], v[220:223]
 s_waitcnt lgkmcnt(9)
 v_exp_f32 v209, v209
 v_mfma_f32_16x16x32_bf16 v[8:11], a[200:203], v[168:171], v[8:11]
 s_waitcnt lgkmcnt(8)
 v_exp_f32 v210, v210
 v_mfma_f32_16x16x32_bf16 v[8:11], a[204:207], v[172:175], v[8:11]
 buffer_load_dwordx4 v249, s[8:11], s37 offen offset:3072 lds
 v_exp_f32 v211, v211
 v_pk_mul_f32 v[212:213], v[212:213], s[20:21]
 v_pk_mul_f32 v[214:215], v[214:215], s[20:21]
 v_pk_mul_f32 v[216:217], v[216:217], s[20:21]
 v_pk_mul_f32 v[218:219], v[218:219], s[20:21]
 v_pk_mul_f32 v[220:221], v[220:221], s[20:21]
 v_pk_mul_f32 v[222:223], v[222:223], s[20:21]
 v_cvt_pk_bf16_f32 v130, v208, v209
 v_mfma_f32_16x16x32_bf16 v[40:43], a[204:207], v[180:183], v[40:43]
 ds_read_b64_tr_b16 a[168:169], v248 offset:16416
 v_cvt_pk_bf16_f32 v131, v210, v211
 v_mfma_f32_16x16x32_bf16 v[40:43], a[200:203], v[176:179], v[40:43]
 v_exp_f32 v212, v212
 v_mfma_f32_16x16x32_bf16 v[72:75], a[200:203], v[184:187], v[72:75]
 v_exp_f32 v213, v213
 v_mfma_f32_16x16x32_bf16 v[72:75], a[204:207], v[188:191], v[72:75]
 v_exp_f32 v214, v214
 v_mfma_f32_16x16x32_bf16 v[104:107], a[204:207], v[196:199], v[104:107]
 v_exp_f32 v215, v215
 v_mfma_f32_16x16x32_bf16 v[104:107], a[200:203], v[192:195], v[104:107]
 s_waitcnt lgkmcnt(7)
 ds_read_b64_tr_b16 a[200:201], v247 offset:16416
 v_cvt_pk_bf16_f32 v138, v212, v213
 v_mfma_f32_16x16x32_bf16 v[12:15], a[208:211], v[168:171], v[12:15]
 s_waitcnt lgkmcnt(6)
 ds_read_b64_tr_b16 a[202:203], v247 offset:17440
 v_cvt_pk_bf16_f32 v139, v214, v215
 v_mfma_f32_16x16x32_bf16 v[12:15], a[212:215], v[172:175], v[12:15]
 s_add_u32 m0, s62, 1920
 v_exp_f32 v216, v216
 v_mfma_f32_16x16x32_bf16 v[44:47], a[212:215], v[180:183], v[44:47]
 buffer_load_dwordx4 v251, s[4:7], s32 offen offset:128 lds
 v_mfma_f32_16x16x32_bf16 v[44:47], a[208:211], v[176:179], v[44:47]
 s_add_u32 m0, s62, 2880
 v_exp_f32 v217, v217
 v_mfma_f32_16x16x32_bf16 v[76:79], a[208:211], v[184:187], v[76:79]
 v_exp_f32 v218, v218
 v_mfma_f32_16x16x32_bf16 v[76:79], a[212:215], v[188:191], v[76:79]
 buffer_load_dwordx4 v251, s[4:7], s32 offen offset:192 lds
 v_mfma_f32_16x16x32_bf16 v[108:111], a[212:215], v[196:199], v[108:111]
 v_exp_f32 v219, v219
 v_mfma_f32_16x16x32_bf16 v[108:111], a[208:211], v[192:195], v[108:111]
 ds_read_b64_tr_b16 a[204:205], v247 offset:18464
 v_cvt_pk_bf16_f32 v146, v216, v217
 v_mfma_f32_16x16x32_bf16 a[116:119], a[132:135], v[176:179], a[116:119]
 ds_read_b64_tr_b16 a[206:207], v247 offset:19488
 v_cvt_pk_bf16_f32 v147, v218, v219
 v_mfma_f32_16x16x32_bf16 a[116:119], a[132:135], v[180:183], a[116:119]
 s_waitcnt lgkmcnt(8)
 v_exp_f32 v220, v220
 v_mfma_f32_16x16x32_bf16 v[208:211], a[136:139], a[32:35], v[224:227]
 s_waitcnt lgkmcnt(7)
 v_exp_f32 v221, v221
 v_mfma_f32_16x16x32_bf16 v[208:211], a[140:143], a[36:39], v[208:211]
 s_waitcnt lgkmcnt(6)
 v_exp_f32 v222, v222
 v_mfma_f32_16x16x32_bf16 v[208:211], a[144:147], a[40:43], v[208:211]
 s_waitcnt lgkmcnt(5)
 v_exp_f32 v223, v223
 v_mfma_f32_16x16x32_bf16 v[208:211], a[148:151], a[44:47], v[208:211]
 ds_read_b64_tr_b16 a[208:209], v247 offset:16424
 v_cvt_pk_bf16_f32 v154, v220, v221
 v_mfma_f32_16x16x32_bf16 v[212:215], a[148:151], a[60:63], v[228:231]
 ds_read_b64_tr_b16 a[210:211], v247 offset:17448
 v_cvt_pk_bf16_f32 v155, v222, v223
 v_mfma_f32_16x16x32_bf16 v[212:215], a[144:147], a[56:59], v[212:215]
 ds_read_b64_tr_b16 a[170:171], v248 offset:17440
 ds_read_b64_tr_b16 a[172:173], v248 offset:18464
 v_mfma_f32_16x16x32_bf16 v[212:215], a[140:143], a[52:55], v[212:215]
 ds_read_b64_tr_b16 a[174:175], v248 offset:19488
 v_mul_f32 v208, s20, v208
 v_mfma_f32_16x16x32_bf16 v[212:215], a[136:139], a[48:51], v[212:215]
 ds_read_b64_tr_b16 a[176:177], v248 offset:16424
 v_mul_f32 v209, s20, v209
 v_mfma_f32_16x16x32_bf16 v[216:219], a[136:139], a[64:67], v[232:235]
 ds_read_b64_tr_b16 a[178:179], v248 offset:17448
 v_mul_f32 v210, s20, v210
 v_mfma_f32_16x16x32_bf16 v[216:219], a[140:143], a[68:71], v[216:219]
 ds_read_b64_tr_b16 a[180:181], v248 offset:18472
 v_mul_f32 v211, s20, v211
 v_mfma_f32_16x16x32_bf16 v[216:219], a[144:147], a[72:75], v[216:219]
 ds_read_b64_tr_b16 a[182:183], v248 offset:19496
 v_mul_f32 v212, s20, v212
 v_mfma_f32_16x16x32_bf16 v[216:219], a[148:151], a[76:79], v[216:219]
 ds_read_b128 a[152:155], v244 offset:37376
 v_mul_f32 v213, s20, v213
 v_mfma_f32_16x16x32_bf16 v[220:223], a[148:151], a[92:95], v[236:239]
 ds_read_b128 a[156:159], v244 offset:37440
 v_mul_f32 v214, s20, v214
 v_mfma_f32_16x16x32_bf16 v[220:223], a[144:147], a[88:91], v[220:223]
 ds_read_b128 a[160:163], v244 offset:37504
 v_mul_f32 v215, s20, v215
 v_mfma_f32_16x16x32_bf16 v[220:223], a[140:143], a[84:87], v[220:223]
 ds_read_b128 a[164:167], v244 offset:37568
 v_mul_f32 v216, s20, v216
 v_mfma_f32_16x16x32_bf16 v[220:223], a[136:139], a[80:83], v[220:223]
 s_waitcnt lgkmcnt(15)
 ds_read_b64_tr_b16 a[212:213], v247 offset:18472
 v_mul_f32 v217, s20, v217
 v_mfma_f32_16x16x32_bf16 v[16:19], a[200:203], v[168:171], v[16:19]
 s_waitcnt lgkmcnt(14)
 ds_read_b64_tr_b16 a[214:215], v247 offset:19496
 v_mul_f32 v218, s20, v218
 v_mfma_f32_16x16x32_bf16 v[16:19], a[204:207], v[172:175], v[16:19]
 v_exp_f32 v208, v208
 v_mfma_f32_16x16x32_bf16 v[48:51], a[204:207], v[180:183], v[48:51]
 v_exp_f32 v209, v209
 v_mfma_f32_16x16x32_bf16 v[48:51], a[200:203], v[176:179], v[48:51]
 v_exp_f32 v210, v210
 v_mfma_f32_16x16x32_bf16 v[80:83], a[200:203], v[184:187], v[80:83]
 v_exp_f32 v211, v211
 v_mfma_f32_16x16x32_bf16 v[80:83], a[204:207], v[188:191], v[80:83]
 v_cvt_pk_bf16_f32 v132, v208, v209
 v_cvt_pk_bf16_f32 v133, v210, v211
 v_mfma_f32_16x16x32_bf16 v[112:115], a[204:207], v[196:199], v[112:115]
 v_exp_f32 v212, v212
 v_mfma_f32_16x16x32_bf16 v[112:115], a[200:203], v[192:195], v[112:115]
 s_waitcnt lgkmcnt(13)
 v_exp_f32 v213, v213
 v_mfma_f32_16x16x32_bf16 v[20:23], a[208:211], v[168:171], v[20:23]
 s_waitcnt vmcnt(16) lgkmcnt(0)
 ds_inc_u32 v249, v252
 v_cvt_pk_bf16_f32 v140, v212, v213
 v_mfma_f32_16x16x32_bf16 v[20:23], a[212:215], v[172:175], v[20:23]
 s_add_u32 s2, s2, 4
 v_exp_f32 v214, v214
 v_mfma_f32_16x16x32_bf16 v[52:55], a[212:215], v[180:183], v[52:55]
 v_exp_f32 v215, v215
 v_mfma_f32_16x16x32_bf16 v[52:55], a[208:211], v[176:179], v[52:55]
 v_cvt_pk_bf16_f32 v141, v214, v215
 v_mul_f32 v219, s20, v219
 v_mfma_f32_16x16x32_bf16 v[84:87], a[208:211], v[184:187], v[84:87]
 v_exp_f32 v216, v216
 v_mfma_f32_16x16x32_bf16 v[84:87], a[212:215], v[188:191], v[84:87]
 v_exp_f32 v217, v217
 v_mfma_f32_16x16x32_bf16 v[116:119], a[212:215], v[196:199], v[116:119]
 v_exp_f32 v218, v218
 v_mfma_f32_16x16x32_bf16 v[116:119], a[208:211], v[192:195], v[116:119]
 v_exp_f32 v219, v219
 v_mfma_f32_16x16x32_bf16 a[120:123], a[132:135], v[184:187], a[120:123]
 v_cvt_pk_bf16_f32 v148, v216, v217
 v_cvt_pk_bf16_f32 v149, v218, v219
 v_mfma_f32_16x16x32_bf16 a[120:123], a[132:135], v[188:191], a[120:123]
 v_mul_f32 v220, s20, v220
 v_mul_f32 v221, s20, v221
 v_mfma_f32_16x16x32_bf16 v[208:211], a[152:155], a[32:35], v[224:227]
 v_mul_f32 v222, s20, v222
 v_mul_f32 v223, s20, v223
 v_mfma_f32_16x16x32_bf16 v[208:211], a[156:159], a[36:39], v[208:211]
 v_exp_f32 v220, v220
 v_mfma_f32_16x16x32_bf16 v[208:211], a[160:163], a[40:43], v[208:211]
 v_exp_f32 v221, v221
 v_mfma_f32_16x16x32_bf16 v[208:211], a[164:167], a[44:47], v[208:211]
 v_exp_f32 v222, v222
 v_mfma_f32_16x16x32_bf16 v[212:215], a[164:167], a[60:63], v[228:231]
 v_exp_f32 v223, v223
 v_mfma_f32_16x16x32_bf16 v[212:215], a[160:163], a[56:59], v[212:215]
 v_cvt_pk_bf16_f32 v156, v220, v221
 v_cvt_pk_bf16_f32 v157, v222, v223
 v_mfma_f32_16x16x32_bf16 v[212:215], a[156:159], a[52:55], v[212:215]
 v_mfma_f32_16x16x32_bf16 v[212:215], a[152:155], a[48:51], v[212:215]
 v_mul_f32 v208, s20, v208
 v_mul_f32 v209, s20, v209
 v_mfma_f32_16x16x32_bf16 v[216:219], a[152:155], a[64:67], v[232:235]
 v_mul_f32 v210, s20, v210
 v_mul_f32 v211, s20, v211
 v_mfma_f32_16x16x32_bf16 v[216:219], a[156:159], a[68:71], v[216:219]
 v_exp_f32 v208, v208
 v_mfma_f32_16x16x32_bf16 v[216:219], a[160:163], a[72:75], v[216:219]
 v_exp_f32 v209, v209
 v_mfma_f32_16x16x32_bf16 v[216:219], a[164:167], a[76:79], v[216:219]
 ds_read_b32 v159, v249
 v_cvt_pk_bf16_f32 v134, v208, v209
 v_mfma_f32_16x16x32_bf16 v[220:223], a[164:167], a[92:95], v[236:239]
 v_exp_f32 v210, v210
 v_mfma_f32_16x16x32_bf16 v[220:223], a[160:163], a[88:91], v[220:223]
 v_exp_f32 v211, v211
 v_mfma_f32_16x16x32_bf16 v[220:223], a[156:159], a[84:87], v[220:223]
 v_cvt_pk_bf16_f32 v135, v210, v211
 v_mul_f32 v212, s20, v212
 v_mfma_f32_16x16x32_bf16 v[220:223], a[152:155], a[80:83], v[220:223]
 v_mul_f32 v213, s20, v213
 v_mul_f32 v214, s20, v214
 v_mfma_f32_16x16x32_bf16 v[24:27], a[168:171], v[168:171], v[24:27]
 v_mul_f32 v215, s20, v215
 v_mul_f32 v216, s20, v216
 v_mfma_f32_16x16x32_bf16 v[24:27], a[172:175], v[172:175], v[24:27]
 v_exp_f32 v212, v212
 v_mfma_f32_16x16x32_bf16 v[56:59], a[172:175], v[180:183], v[56:59]
 s_waitcnt lgkmcnt(0)
 v_cmp_gt_u32 vcc, s2, v159
 v_mul_f32 v217, s20, v217
 v_mfma_f32_16x16x32_bf16 v[56:59], a[168:171], v[176:179], v[56:59]
 s_add_u32 s38, s27, 65536
 v_exp_f32 v213, v213
 v_mfma_f32_16x16x32_bf16 v[88:91], a[168:171], v[184:187], v[88:91]
 s_cbranch_vccnz Lspin4_2
Lback4_2:
 ds_read_b128 a[136:139], v244 offset:50944
 v_cvt_pk_bf16_f32 v142, v212, v213
 v_mfma_f32_16x16x32_bf16 v[88:91], a[172:175], v[188:191], v[88:91]
 s_add_u32 m0, s23, 16416
 ds_read_b128 a[140:143], v244 offset:51008
 v_mul_f32 v218, s20, v218
 v_mfma_f32_16x16x32_bf16 v[120:123], a[172:175], v[196:199], v[120:123]
 buffer_load_dwordx4 v250, s[12:15], s38 offen offset:0 lds
 v_mfma_f32_16x16x32_bf16 v[120:123], a[168:171], v[192:195], v[120:123]
 ds_read_b128 a[144:147], v244 offset:51072
 v_mul_f32 v219, s20, v219
 v_mfma_f32_16x16x32_bf16 v[28:31], a[176:179], v[168:171], v[28:31]
 ds_read_b128 a[148:151], v244 offset:51136
 v_mul_f32 v220, s20, v220
 v_mfma_f32_16x16x32_bf16 v[28:31], a[180:183], v[172:175], v[28:31]
 v_exp_f32 v214, v214
 v_mfma_f32_16x16x32_bf16 v[60:63], a[180:183], v[180:183], v[60:63]
 v_exp_f32 v215, v215
 v_mfma_f32_16x16x32_bf16 v[60:63], a[176:179], v[176:179], v[60:63]
 ds_read_b64_tr_b16 a[200:201], v245 offset:32832
 v_cvt_pk_bf16_f32 v143, v214, v215
 v_mfma_f32_16x16x32_bf16 v[92:95], a[176:179], v[184:187], v[92:95]
 v_exp_f32 v216, v216
 v_mfma_f32_16x16x32_bf16 v[92:95], a[180:183], v[188:191], v[92:95]
 v_exp_f32 v217, v217
 v_mfma_f32_16x16x32_bf16 v[124:127], a[180:183], v[196:199], v[124:127]
 v_exp_f32 v218, v218
 v_mfma_f32_16x16x32_bf16 v[124:127], a[176:179], v[192:195], v[124:127]
 buffer_load_dwordx4 v250, s[12:15], s38 offen offset:1024 lds
 v_mfma_f32_16x16x32_bf16 a[124:127], a[132:135], v[192:195], a[124:127]
 v_exp_f32 v219, v219
 v_mfma_f32_16x16x32_bf16 a[124:127], a[132:135], v[196:199], a[124:127]
 s_waitcnt lgkmcnt(4)
 ds_read_b64_tr_b16 a[202:203], v245 offset:33856
 v_cvt_pk_bf16_f32 v150, v216, v217
 v_mfma_f32_16x16x32_bf16 v[208:211], a[136:139], a[32:35], v[224:227]
 s_waitcnt lgkmcnt(4)
 ds_read_b64_tr_b16 a[204:205], v245 offset:34880
 v_cvt_pk_bf16_f32 v151, v218, v219
 v_mfma_f32_16x16x32_bf16 v[208:211], a[140:143], a[36:39], v[208:211]
 s_waitcnt lgkmcnt(4)
 ds_read_b64_tr_b16 a[206:207], v245 offset:35904
 v_mul_f32 v221, s20, v221
 v_mfma_f32_16x16x32_bf16 v[208:211], a[144:147], a[40:43], v[208:211]
 s_waitcnt lgkmcnt(4)
 ds_read_b64_tr_b16 a[208:209], v245 offset:32840
 v_mul_f32 v222, s20, v222
 v_mfma_f32_16x16x32_bf16 v[208:211], a[148:151], a[44:47], v[208:211]
 ds_read_b64_tr_b16 a[210:211], v245 offset:33864
 v_mul_f32 v223, s20, v223
 v_mfma_f32_16x16x32_bf16 v[212:215], a[148:151], a[60:63], v[228:231]
 v_exp_f32 v220, v220
 v_mfma_f32_16x16x32_bf16 v[212:215], a[144:147], a[56:59], v[212:215]
 v_exp_f32 v221, v221
 v_mfma_f32_16x16x32_bf16 v[212:215], a[140:143], a[52:55], v[212:215]
 buffer_load_dwordx4 v250, s[12:15], s38 offen offset:2048 lds
 v_mfma_f32_16x16x32_bf16 v[212:215], a[136:139], a[48:51], v[212:215]
 v_exp_f32 v222, v222
 v_mfma_f32_16x16x32_bf16 v[216:219], a[136:139], a[64:67], v[232:235]
 v_exp_f32 v223, v223
 v_mfma_f32_16x16x32_bf16 v[216:219], a[140:143], a[68:71], v[216:219]
 ds_read_b64_tr_b16 a[212:213], v245 offset:34888
 v_cvt_pk_bf16_f32 v158, v220, v221
 v_mfma_f32_16x16x32_bf16 v[216:219], a[144:147], a[72:75], v[216:219]
 buffer_store_dwordx4 a[216:219], v255, s[16:19], s3 offen offset:128 nt
 buffer_store_dwordx4 a[220:223], v255, s[16:19], s3 offen offset:2176 nt
 v_pk_mul_f32 v[208:209], v[208:209], s[20:21]
 v_pk_mul_f32 v[210:211], v[210:211], s[20:21]
 v_pk_mul_f32 v[212:213], v[212:213], s[20:21]
 v_pk_mul_f32 v[214:215], v[214:215], s[20:21]
 v_cvt_pk_bf16_f32 v159, v222, v223
 v_mfma_f32_16x16x32_bf16 v[216:219], a[148:151], a[76:79], v[216:219]
 v_exp_f32 v208, v208
 v_mfma_f32_16x16x32_bf16 v[220:223], a[148:151], a[92:95], v[236:239]
 v_exp_f32 v209, v209
 v_mfma_f32_16x16x32_bf16 v[220:223], a[144:147], a[88:91], v[220:223]
 ds_read_b64_tr_b16 a[214:215], v245 offset:35912
 v_cvt_pk_bf16_f32 v168, v208, v209
 v_mfma_f32_16x16x32_bf16 v[220:223], a[140:143], a[84:87], v[220:223]
 v_exp_f32 v210, v210
 v_mfma_f32_16x16x32_bf16 v[220:223], a[136:139], a[80:83], v[220:223]
 s_waitcnt lgkmcnt(6)
 buffer_load_dwordx4 v250, s[12:15], s38 offen offset:3072 lds
 v_mfma_f32_16x16x32_bf16 v[0:3], a[200:203], v[128:131], v[0:3]
 s_waitcnt lgkmcnt(4)
 ds_read_b128 a[152:155], v244 offset:51968
 v_mul_f32 v216, s20, v216
 v_mfma_f32_16x16x32_bf16 v[0:3], a[204:207], v[132:135], v[0:3]
 ds_read_b128 a[156:159], v244 offset:52032
 v_mul_f32 v217, s20, v217
 v_mfma_f32_16x16x32_bf16 v[32:35], a[204:207], v[140:143], v[32:35]
 ds_read_b128 a[160:163], v244 offset:52096
 v_mul_f32 v218, s20, v218
 v_mfma_f32_16x16x32_bf16 v[32:35], a[200:203], v[136:139], v[32:35]
 ds_read_b128 a[164:167], v244 offset:52160
 v_mul_f32 v219, s20, v219
 v_mfma_f32_16x16x32_bf16 v[64:67], a[200:203], v[144:147], v[64:67]
 s_add_u32 s37, s27, 98304
 v_exp_f32 v211, v211
 v_mfma_f32_16x16x32_bf16 v[64:67], a[204:207], v[148:151], v[64:67]
 s_add_u32 m0, s22, 34304
 v_cvt_pk_bf16_f32 v169, v210, v211
 v_mul_f32 v220, s20, v220
 v_mfma_f32_16x16x32_bf16 v[96:99], a[204:207], v[156:159], v[96:99]
 v_exp_f32 v212, v212
 v_mfma_f32_16x16x32_bf16 v[96:99], a[200:203], v[152:155], v[96:99]
 s_waitcnt lgkmcnt(6)
 v_exp_f32 v213, v213
 v_mfma_f32_16x16x32_bf16 v[4:7], a[208:211], v[128:131], v[4:7]
 s_waitcnt lgkmcnt(4)
 buffer_load_dwordx4 v249, s[8:11], s37 offen offset:0 lds
 v_mfma_f32_16x16x32_bf16 v[4:7], a[212:215], v[132:135], v[4:7]
 v_exp_f32 v214, v214
 v_mfma_f32_16x16x32_bf16 v[36:39], a[212:215], v[140:143], v[36:39]
 v_exp_f32 v215, v215
 v_mfma_f32_16x16x32_bf16 v[36:39], a[208:211], v[136:139], v[36:39]
 ds_read_b64_tr_b16 a[200:201], v246 offset:32832
 v_cvt_pk_bf16_f32 v176, v212, v213
 v_mfma_f32_16x16x32_bf16 v[68:71], a[208:211], v[144:147], v[68:71]
 ds_read_b64_tr_b16 a[202:203], v246 offset:33856
 v_cvt_pk_bf16_f32 v177, v214, v215
 v_mfma_f32_16x16x32_bf16 v[68:71], a[212:215], v[148:151], v[68:71]
 v_exp_f32 v216, v216
 v_mfma_f32_16x16x32_bf16 v[100:103], a[212:215], v[156:159], v[100:103]
 v_exp_f32 v217, v217
 v_mfma_f32_16x16x32_bf16 v[100:103], a[208:211], v[152:155], v[100:103]
 v_exp_f32 v218, v218
 v_mfma_f32_16x16x32_bf16 a[112:115], a[132:135], v[128:131], a[112:115]
 v_exp_f32 v219, v219
 v_mfma_f32_16x16x32_bf16 a[112:115], a[132:135], v[132:135], a[112:115]
 s_waitcnt lgkmcnt(5)
 buffer_load_dwordx4 v249, s[8:11], s37 offen offset:1024 lds
 v_mfma_f32_16x16x32_bf16 v[208:211], a[152:155], a[32:35], v[224:227]
 s_waitcnt lgkmcnt(4)
 ds_read_b64_tr_b16 a[204:205], v246 offset:34880
 v_cvt_pk_bf16_f32 v184, v216, v217
 v_mfma_f32_16x16x32_bf16 v[208:211], a[156:159], a[36:39], v[208:211]
 s_waitcnt lgkmcnt(4)
 ds_read_b64_tr_b16 a[206:207], v246 offset:35904
 v_cvt_pk_bf16_f32 v185, v218, v219
 v_mfma_f32_16x16x32_bf16 v[208:211], a[160:163], a[40:43], v[208:211]
 s_waitcnt lgkmcnt(4)
 ds_read_b64_tr_b16 a[208:209], v246 offset:32840
 v_mul_f32 v221, s20, v221
 v_mfma_f32_16x16x32_bf16 v[208:211], a[164:167], a[44:47], v[208:211]
 ds_read_b64_tr_b16 a[210:211], v246 offset:33864
 v_mul_f32 v222, s20, v222
 v_mfma_f32_16x16x32_bf16 v[212:215], a[164:167], a[60:63], v[228:231]
 ds_read_b64_tr_b16 a[212:213], v246 offset:34888
 v_mul_f32 v223, s20, v223
 v_mfma_f32_16x16x32_bf16 v[212:215], a[160:163], a[56:59], v[212:215]
 v_exp_f32 v220, v220
 v_mfma_f32_16x16x32_bf16 v[212:215], a[156:159], a[52:55], v[212:215]
 v_exp_f32 v221, v221
 v_mfma_f32_16x16x32_bf16 v[212:215], a[152:155], a[48:51], v[212:215]
 v_exp_f32 v222, v222
 v_mfma_f32_16x16x32_bf16 v[216:219], a[152:155], a[64:67], v[232:235]
 buffer_load_dwordx4 v249, s[8:11], s37 offen offset:2048 lds
 v_mfma_f32_16x16x32_bf16 v[216:219], a[156:159], a[68:71], v[216:219]
 v_exp_f32 v223, v223
 v_mfma_f32_16x16x32_bf16 v[216:219], a[160:163], a[72:75], v[216:219]
 ds_read_b64_tr_b16 a[214:215], v246 offset:35912
 v_cvt_pk_bf16_f32 v192, v220, v221
 v_mfma_f32_16x16x32_bf16 v[216:219], a[164:167], a[76:79], v[216:219]
 ds_read_b128 a[136:139], v244 offset:52992
 v_cvt_pk_bf16_f32 v193, v222, v223
 v_mfma_f32_16x16x32_bf16 v[220:223], a[164:167], a[92:95], v[236:239]
 ds_read_b128 a[140:143], v244 offset:53056
 v_mul_f32 v208, s20, v208
 v_mfma_f32_16x16x32_bf16 v[220:223], a[160:163], a[88:91], v[220:223]
 ds_read_b128 a[144:147], v244 offset:53120
 v_mul_f32 v209, s20, v209
 v_mfma_f32_16x16x32_bf16 v[220:223], a[156:159], a[84:87], v[220:223]
 ds_read_b128 a[148:151], v244 offset:53184
 v_mul_f32 v210, s20, v210
 v_mfma_f32_16x16x32_bf16 v[220:223], a[152:155], a[80:83], v[220:223]
 s_waitcnt lgkmcnt(10)
 v_mul_f32 v211, s20, v211
 v_mul_f32 v212, s20, v212
 v_mfma_f32_16x16x32_bf16 v[8:11], a[200:203], v[128:131], v[8:11]
 s_waitcnt lgkmcnt(8)
 v_exp_f32 v208, v208
 v_mfma_f32_16x16x32_bf16 v[8:11], a[204:207], v[132:135], v[8:11]
 buffer_load_dwordx4 v249, s[8:11], s37 offen offset:3072 lds
 v_exp_f32 v209, v209
 v_pk_mul_f32 v[214:215], v[214:215], s[20:21]
 v_pk_mul_f32 v[216:217], v[216:217], s[20:21]
 v_pk_mul_f32 v[218:219], v[218:219], s[20:21]
 v_pk_mul_f32 v[220:221], v[220:221], s[20:21]
 v_pk_mul_f32 v[222:223], v[222:223], s[20:21]
 v_exp_f32 v210, v210
 v_mfma_f32_16x16x32_bf16 v[40:43], a[204:207], v[140:143], v[40:43]
 v_exp_f32 v211, v211
 v_mfma_f32_16x16x32_bf16 v[40:43], a[200:203], v[136:139], v[40:43]
 v_cvt_pk_bf16_f32 v170, v208, v209
 v_cvt_pk_bf16_f32 v171, v210, v211
 v_mfma_f32_16x16x32_bf16 v[72:75], a[200:203], v[144:147], v[72:75]
 ds_read_b64_tr_b16 a[168:169], v248 offset:32832
 v_mul_f32 v213, s20, v213
 v_mfma_f32_16x16x32_bf16 v[72:75], a[204:207], v[148:151], v[72:75]
 v_exp_f32 v212, v212
 v_mfma_f32_16x16x32_bf16 v[104:107], a[204:207], v[156:159], v[104:107]
 v_exp_f32 v213, v213
 v_mfma_f32_16x16x32_bf16 v[104:107], a[200:203], v[152:155], v[104:107]
 s_waitcnt lgkmcnt(7)
 v_exp_f32 v214, v214
 v_mfma_f32_16x16x32_bf16 v[12:15], a[208:211], v[128:131], v[12:15]
 s_waitcnt lgkmcnt(5)
 v_exp_f32 v215, v215
 v_mfma_f32_16x16x32_bf16 v[12:15], a[212:215], v[132:135], v[12:15]
 s_add_u32 m0, s62, 4096
 ds_read_b64_tr_b16 a[200:201], v247 offset:32832
 v_cvt_pk_bf16_f32 v178, v212, v213
 v_mfma_f32_16x16x32_bf16 v[44:47], a[212:215], v[140:143], v[44:47]
 buffer_load_dwordx4 v251, s[4:7], s33 offen offset:0 lds
 v_mfma_f32_16x16x32_bf16 v[44:47], a[208:211], v[136:139], v[44:47]
 s_add_u32 m0, s62, 5056
 ds_read_b64_tr_b16 a[202:203], v247 offset:33856
 v_cvt_pk_bf16_f32 v179, v214, v215
 v_mfma_f32_16x16x32_bf16 v[76:79], a[208:211], v[144:147], v[76:79]
 v_exp_f32 v216, v216
 v_mfma_f32_16x16x32_bf16 v[76:79], a[212:215], v[148:151], v[76:79]
 buffer_load_dwordx4 v251, s[4:7], s33 offen offset:64 lds
 v_mfma_f32_16x16x32_bf16 v[108:111], a[212:215], v[156:159], v[108:111]
 v_exp_f32 v217, v217
 v_mfma_f32_16x16x32_bf16 v[108:111], a[208:211], v[152:155], v[108:111]
 v_exp_f32 v218, v218
 v_mfma_f32_16x16x32_bf16 a[116:119], a[132:135], v[136:139], a[116:119]
 v_exp_f32 v219, v219
 v_mfma_f32_16x16x32_bf16 a[116:119], a[132:135], v[140:143], a[116:119]
 s_waitcnt lgkmcnt(6)
 ds_read_b64_tr_b16 a[204:205], v247 offset:34880
 v_cvt_pk_bf16_f32 v186, v216, v217
 v_mfma_f32_16x16x32_bf16 v[208:211], a[136:139], a[32:35], v[224:227]
 s_waitcnt lgkmcnt(6)
 ds_read_b64_tr_b16 a[206:207], v247 offset:35904
 v_cvt_pk_bf16_f32 v187, v218, v219
 v_mfma_f32_16x16x32_bf16 v[208:211], a[140:143], a[36:39], v[208:211]
 s_waitcnt lgkmcnt(6)
 v_exp_f32 v220, v220
 v_mfma_f32_16x16x32_bf16 v[208:211], a[144:147], a[40:43], v[208:211]
 s_waitcnt lgkmcnt(5)
 v_exp_f32 v221, v221
 v_mfma_f32_16x16x32_bf16 v[208:211], a[148:151], a[44:47], v[208:211]
 v_exp_f32 v222, v222
 v_mfma_f32_16x16x32_bf16 v[212:215], a[148:151], a[60:63], v[228:231]
 v_exp_f32 v223, v223
 v_mfma_f32_16x16x32_bf16 v[212:215], a[144:147], a[56:59], v[212:215]
 ds_read_b64_tr_b16 a[208:209], v247 offset:32840
 v_cvt_pk_bf16_f32 v194, v220, v221
 v_mfma_f32_16x16x32_bf16 v[212:215], a[140:143], a[52:55], v[212:215]
 ds_read_b64_tr_b16 a[210:211], v247 offset:33864
 v_cvt_pk_bf16_f32 v195, v222, v223
 v_mfma_f32_16x16x32_bf16 v[212:215], a[136:139], a[48:51], v[212:215]
 ds_read_b64_tr_b16 a[170:171], v248 offset:33856
 v_mul_f32 v208, s20, v208
 v_mfma_f32_16x16x32_bf16 v[216:219], a[136:139], a[64:67], v[232:235]
 ds_read_b64_tr_b16 a[172:173], v248 offset:34880
 v_mul_f32 v209, s20, v209
 v_mfma_f32_16x16x32_bf16 v[216:219], a[140:143], a[68:71], v[216:219]
 ds_read_b64_tr_b16 a[174:175], v248 offset:35904
 v_mul_f32 v210, s20, v210
 v_mfma_f32_16x16x32_bf16 v[216:219], a[144:147], a[72:75], v[216:219]
 ds_read_b64_tr_b16 a[176:177], v248 offset:32840
 v_mul_f32 v211, s20, v211
 v_mfma_f32_16x16x32_bf16 v[216:219], a[148:151], a[76:79], v[216:219]
 ds_read_b64_tr_b16 a[178:179], v248 offset:33864
 v_mul_f32 v212, s20, v212
 v_mfma_f32_16x16x32_bf16 v[220:223], a[148:151], a[92:95], v[236:239]
 ds_read_b64_tr_b16 a[180:181], v248 offset:34888
 v_mul_f32 v213, s20, v213
 v_mfma_f32_16x16x32_bf16 v[220:223], a[144:147], a[88:91], v[220:223]
 ds_read_b64_tr_b16 a[182:183], v248 offset:35912
 v_mul_f32 v214, s20, v214
 v_mfma_f32_16x16x32_bf16 v[220:223], a[140:143], a[84:87], v[220:223]
 ds_read_b128 a[152:155], v244 offset:54016
 v_mul_f32 v215, s20, v215
 v_mfma_f32_16x16x32_bf16 v[220:223], a[136:139], a[80:83], v[220:223]
 s_waitcnt lgkmcnt(12)
 ds_read_b128 a[156:159], v244 offset:54080
 v_mul_f32 v216, s20, v216
 v_mfma_f32_16x16x32_bf16 v[16:19], a[200:203], v[128:131], v[16:19]
 s_waitcnt lgkmcnt(11)
 ds_read_b128 a[160:163], v244 offset:54144
 v_mul_f32 v217, s20, v217
 ds_read_b128 a[164:167], v244 offset:54208
 ds_read_b64_tr_b16 a[212:213], v247 offset:34888
 ds_read_b64_tr_b16 a[214:215], v247 offset:35912
 v_mfma_f32_16x16x32_bf16 v[16:19], a[204:207], v[132:135], v[16:19]
 v_exp_f32 v208, v208
 v_mfma_f32_16x16x32_bf16 v[48:51], a[204:207], v[140:143], v[48:51]
 v_exp_f32 v209, v209
 v_mfma_f32_16x16x32_bf16 v[48:51], a[200:203], v[136:139], v[48:51]
 v_exp_f32 v210, v210
 v_mfma_f32_16x16x32_bf16 v[80:83], a[200:203], v[144:147], v[80:83]
 v_exp_f32 v211, v211
 v_mfma_f32_16x16x32_bf16 v[80:83], a[204:207], v[148:151], v[80:83]
 v_cvt_pk_bf16_f32 v172, v208, v209
 v_cvt_pk_bf16_f32 v173, v210, v211
 v_mfma_f32_16x16x32_bf16 v[112:115], a[204:207], v[156:159], v[112:115]
 v_exp_f32 v212, v212
 v_mfma_f32_16x16x32_bf16 v[112:115], a[200:203], v[152:155], v[112:115]
 s_waitcnt lgkmcnt(13)
 v_exp_f32 v213, v213
 v_mfma_f32_16x16x32_bf16 v[20:23], a[208:211], v[128:131], v[20:23]
 s_waitcnt vmcnt(18) lgkmcnt(0)
 ds_inc_u32 v249, v252
 v_cvt_pk_bf16_f32 v180, v212, v213
 v_mfma_f32_16x16x32_bf16 v[20:23], a[212:215], v[132:135], v[20:23]
 s_add_u32 s2, s2, 4
 v_exp_f32 v214, v214
 v_mfma_f32_16x16x32_bf16 v[52:55], a[212:215], v[140:143], v[52:55]
 v_exp_f32 v215, v215
 v_mfma_f32_16x16x32_bf16 v[52:55], a[208:211], v[136:139], v[52:55]
 v_cvt_pk_bf16_f32 v181, v214, v215
 v_mul_f32 v218, s20, v218
 v_mfma_f32_16x16x32_bf16 v[84:87], a[208:211], v[144:147], v[84:87]
 v_mul_f32 v219, s20, v219
 v_mul_f32 v220, s20, v220
 v_mfma_f32_16x16x32_bf16 v[84:87], a[212:215], v[148:151], v[84:87]
 v_exp_f32 v216, v216
 v_mfma_f32_16x16x32_bf16 v[116:119], a[212:215], v[156:159], v[116:119]
 v_exp_f32 v217, v217
 v_mfma_f32_16x16x32_bf16 v[116:119], a[208:211], v[152:155], v[116:119]
 v_exp_f32 v218, v218
 v_mfma_f32_16x16x32_bf16 a[120:123], a[132:135], v[144:147], a[120:123]
 v_exp_f32 v219, v219
 v_mfma_f32_16x16x32_bf16 a[120:123], a[132:135], v[148:151], a[120:123]
 v_cvt_pk_bf16_f32 v188, v216, v217
 v_cvt_pk_bf16_f32 v189, v218, v219
 v_mfma_f32_16x16x32_bf16 v[208:211], a[152:155], a[32:35], v[224:227]
 v_mul_f32 v221, s20, v221
 v_mul_f32 v222, s20, v222
 v_mfma_f32_16x16x32_bf16 v[208:211], a[156:159], a[36:39], v[208:211]
 v_exp_f32 v220, v220
 v_mfma_f32_16x16x32_bf16 v[208:211], a[160:163], a[40:43], v[208:211]
 v_exp_f32 v221, v221
 v_mfma_f32_16x16x32_bf16 v[208:211], a[164:167], a[44:47], v[208:211]
 v_mul_f32 v223, s20, v223
 v_cvt_pk_bf16_f32 v196, v220, v221
 v_mfma_f32_16x16x32_bf16 v[212:215], a[164:167], a[60:63], v[228:231]
 v_exp_f32 v222, v222
 v_mfma_f32_16x16x32_bf16 v[212:215], a[160:163], a[56:59], v[212:215]
 v_exp_f32 v223, v223
 v_mfma_f32_16x16x32_bf16 v[212:215], a[156:159], a[52:55], v[212:215]
 v_cvt_pk_bf16_f32 v197, v222, v223
 v_mul_f32 v208, s20, v208
 v_mfma_f32_16x16x32_bf16 v[212:215], a[152:155], a[48:51], v[212:215]
 v_mul_f32 v209, s20, v209
 v_mul_f32 v210, s20, v210
 v_mfma_f32_16x16x32_bf16 v[216:219], a[152:155], a[64:67], v[232:235]
 v_exp_f32 v208, v208
 v_mfma_f32_16x16x32_bf16 v[216:219], a[156:159], a[68:71], v[216:219]
 v_exp_f32 v209, v209
 v_mfma_f32_16x16x32_bf16 v[216:219], a[160:163], a[72:75], v[216:219]
 v_mul_f32 v211, s20, v211
 v_cvt_pk_bf16_f32 v174, v208, v209
 v_mfma_f32_16x16x32_bf16 v[216:219], a[164:167], a[76:79], v[216:219]
 ds_read_b32 v199, v249
 v_mul_f32 v212, s20, v212
 v_mfma_f32_16x16x32_bf16 v[220:223], a[164:167], a[92:95], v[236:239]
 v_exp_f32 v210, v210
 v_mfma_f32_16x16x32_bf16 v[220:223], a[160:163], a[88:91], v[220:223]
 v_exp_f32 v211, v211
 v_mfma_f32_16x16x32_bf16 v[220:223], a[156:159], a[84:87], v[220:223]
 v_cvt_pk_bf16_f32 v175, v210, v211
 v_mul_f32 v213, s20, v213
 v_mfma_f32_16x16x32_bf16 v[220:223], a[152:155], a[80:83], v[220:223]
 v_mul_f32 v214, s20, v214
 v_mul_f32 v215, s20, v215
 v_mfma_f32_16x16x32_bf16 v[24:27], a[168:171], v[128:131], v[24:27]
 v_exp_f32 v212, v212
 v_mfma_f32_16x16x32_bf16 v[24:27], a[172:175], v[132:135], v[24:27]
 v_exp_f32 v213, v213
 v_mfma_f32_16x16x32_bf16 v[56:59], a[172:175], v[140:143], v[56:59]
 s_waitcnt lgkmcnt(0)
 v_cmp_gt_u32 vcc, s2, v199
 v_cvt_pk_bf16_f32 v182, v212, v213
 v_mfma_f32_16x16x32_bf16 v[56:59], a[168:171], v[136:139], v[56:59]
 s_add_u32 s38, s27, 81920
 v_exp_f32 v214, v214
 v_mfma_f32_16x16x32_bf16 v[88:91], a[168:171], v[144:147], v[88:91]
 s_cbranch_vccnz Lspin4_3
Lback4_3:
 ds_read_b128 a[136:139], v244 offset:1024
 v_mul_f32 v216, s20, v216
 v_mfma_f32_16x16x32_bf16 v[88:91], a[172:175], v[148:151], v[88:91]
 s_add_u32 m0, s23, 32832
 ds_read_b128 a[140:143], v244 offset:1088
 v_mul_f32 v217, s20, v217
 v_mfma_f32_16x16x32_bf16 v[120:123], a[172:175], v[156:159], v[120:123]
 buffer_load_dwordx4 v250, s[12:15], s38 offen offset:0 lds
 v_exp_f32 v215, v215
 v_pk_mul_f32 v[218:219], v[218:219], s[20:21]
 v_pk_mul_f32 v[220:221], v[220:221], s[20:21]
 v_pk_mul_f32 v[222:223], v[222:223], s[20:21]
 v_cvt_pk_bf16_f32 v183, v214, v215
 v_mfma_f32_16x16x32_bf16 v[120:123], a[168:171], v[152:155], v[120:123]
 v_exp_f32 v216, v216
 v_mfma_f32_16x16x32_bf16 v[28:31], a[176:179], v[128:131], v[28:31]
 v_exp_f32 v217, v217
 v_mfma_f32_16x16x32_bf16 v[28:31], a[180:183], v[132:135], v[28:31]
 ds_read_b128 a[144:147], v244 offset:1152
 v_cvt_pk_bf16_f32 v190, v216, v217
 v_mfma_f32_16x16x32_bf16 v[60:63], a[180:183], v[140:143], v[60:63]
 v_exp_f32 v218, v218
 v_mfma_f32_16x16x32_bf16 v[60:63], a[176:179], v[136:139], v[60:63]
 ds_read_b128 a[148:151], v244 offset:1216
 ds_read_b64_tr_b16 a[200:201], v245 offset:0
 v_mfma_f32_16x16x32_bf16 v[92:95], a[176:179], v[144:147], v[92:95]
 v_exp_f32 v219, v219
 v_mfma_f32_16x16x32_bf16 v[92:95], a[180:183], v[148:151], v[92:95]
 ds_read_b64_tr_b16 a[202:203], v245 offset:1024
 v_cvt_pk_bf16_f32 v191, v218, v219
 v_mfma_f32_16x16x32_bf16 v[124:127], a[180:183], v[156:159], v[124:127]
 v_exp_f32 v220, v220
 v_mfma_f32_16x16x32_bf16 v[124:127], a[176:179], v[152:155], v[124:127]
 buffer_load_dwordx4 v250, s[12:15], s38 offen offset:1024 lds
 v_mfma_f32_16x16x32_bf16 a[124:127], a[132:135], v[152:155], a[124:127]
 v_exp_f32 v221, v221
 v_mfma_f32_16x16x32_bf16 a[124:127], a[132:135], v[156:159], a[124:127]
 s_waitcnt lgkmcnt(5)
 ds_read_b64_tr_b16 a[204:205], v245 offset:2048
 v_cvt_pk_bf16_f32 v198, v220, v221
 v_mfma_f32_16x16x32_bf16 v[208:211], a[136:139], a[32:35], v[224:227]
 s_waitcnt lgkmcnt(5)
 v_exp_f32 v222, v222
 v_mfma_f32_16x16x32_bf16 v[208:211], a[140:143], a[36:39], v[208:211]
 s_waitcnt lgkmcnt(4)
 v_exp_f32 v223, v223
 v_mfma_f32_16x16x32_bf16 v[208:211], a[144:147], a[40:43], v[208:211]
 s_waitcnt lgkmcnt(3)
 ds_read_b64_tr_b16 a[206:207], v245 offset:3072
 v_cvt_pk_bf16_f32 v199, v222, v223
 v_mfma_f32_16x16x32_bf16 v[208:211], a[148:151], a[44:47], v[208:211]
 ds_read_b64_tr_b16 a[208:209], v245 offset:8
 ds_read_b64_tr_b16 a[210:211], v245 offset:1032
 v_mfma_f32_16x16x32_bf16 v[212:215], a[148:151], a[60:63], v[228:231]
 ds_read_b64_tr_b16 a[212:213], v245 offset:2056
 ds_read_b64_tr_b16 a[214:215], v245 offset:3080
 v_mfma_f32_16x16x32_bf16 v[212:215], a[144:147], a[56:59], v[212:215]
 ds_read_b128 a[152:155], v244 offset:2048
 ds_read_b128 a[156:159], v244 offset:2112
 v_mfma_f32_16x16x32_bf16 v[212:215], a[140:143], a[52:55], v[212:215]
 buffer_load_dwordx4 v250, s[12:15], s38 offen offset:2048 lds
 v_mfma_f32_16x16x32_bf16 v[212:215], a[136:139], a[48:51], v[212:215]
 ds_read_b128 a[160:163], v244 offset:2176
 v_mul_f32 v208, s20, v208
 v_mfma_f32_16x16x32_bf16 v[216:219], a[136:139], a[64:67], v[232:235]
 ds_read_b128 a[164:167], v244 offset:2240
 v_mul_f32 v209, s20, v209
 v_mfma_f32_16x16x32_bf16 v[216:219], a[140:143], a[68:71], v[216:219]
 v_mul_f32 v210, s20, v210
 v_mul_f32 v211, s20, v211
 v_mfma_f32_16x16x32_bf16 v[216:219], a[144:147], a[72:75], v[216:219]
 buffer_store_dwordx4 a[224:227], v255, s[16:19], s50 offen offset:0 nt
 buffer_store_dwordx4 a[228:231], v255, s[16:19], s50 offen offset:2048 nt
 v_mfma_f32_16x16x32_bf16 v[216:219], a[148:151], a[76:79], v[216:219]
 v_exp_f32 v208, v208
 v_mfma_f32_16x16x32_bf16 v[220:223], a[148:151], a[92:95], v[236:239]
 v_exp_f32 v209, v209
 v_mfma_f32_16x16x32_bf16 v[220:223], a[144:147], a[88:91], v[220:223]
 v_exp_f32 v210, v210
 v_mfma_f32_16x16x32_bf16 v[220:223], a[140:143], a[84:87], v[220:223]
 v_exp_f32 v211, v211
 v_mfma_f32_16x16x32_bf16 v[220:223], a[136:139], a[80:83], v[220:223]
 s_waitcnt lgkmcnt(10)
 buffer_load_dwordx4 v250, s[12:15], s38 offen offset:3072 lds
 v_mfma_f32_16x16x32_bf16 v[0:3], a[200:203], v[168:171], v[0:3]
 s_waitcnt lgkmcnt(8)
 v_cvt_pk_bf16_f32 v128, v208, v209
 v_cvt_pk_bf16_f32 v129, v210, v211
 v_mfma_f32_16x16x32_bf16 v[0:3], a[204:207], v[172:175], v[0:3]
 v_mul_f32 v212, s20, v212
 v_mul_f32 v213, s20, v213
 v_mfma_f32_16x16x32_bf16 v[32:35], a[204:207], v[180:183], v[32:35]
 v_mul_f32 v214, s20, v214
 v_mul_f32 v215, s20, v215
 v_mfma_f32_16x16x32_bf16 v[32:35], a[200:203], v[176:179], v[32:35]
 v_exp_f32 v212, v212
 v_mfma_f32_16x16x32_bf16 v[64:67], a[200:203], v[184:187], v[64:67]
 s_add_u32 s37, s27, 114688
 v_exp_f32 v213, v213
 v_mfma_f32_16x16x32_bf16 v[64:67], a[204:207], v[188:191], v[64:67]
 s_add_u32 m0, s22, 50944
 v_exp_f32 v214, v214
 v_mfma_f32_16x16x32_bf16 v[96:99], a[204:207], v[196:199], v[96:99]
 v_exp_f32 v215, v215
 v_mfma_f32_16x16x32_bf16 v[96:99], a[200:203], v[192:195], v[96:99]
 s_waitcnt lgkmcnt(6)
 ds_read_b64_tr_b16 a[200:201], v246 offset:0
 v_cvt_pk_bf16_f32 v136, v212, v213
 v_mfma_f32_16x16x32_bf16 v[4:7], a[208:211], v[168:171], v[4:7]
 s_waitcnt lgkmcnt(5)
 buffer_load_dwordx4 v249, s[8:11], s37 offen offset:0 lds
 v_mfma_f32_16x16x32_bf16 v[4:7], a[212:215], v[172:175], v[4:7]
 ds_read_b64_tr_b16 a[202:203], v246 offset:1024
 v_cvt_pk_bf16_f32 v137, v214, v215
 v_mfma_f32_16x16x32_bf16 v[36:39], a[212:215], v[180:183], v[36:39]
 ds_read_b64_tr_b16 a[204:205], v246 offset:2048
 v_mul_f32 v216, s20, v216
 v_mfma_f32_16x16x32_bf16 v[36:39], a[208:211], v[176:179], v[36:39]
 ds_read_b64_tr_b16 a[206:207], v246 offset:3072
 v_mul_f32 v217, s20, v217
 v_mfma_f32_16x16x32_bf16 v[68:71], a[208:211], v[184:187], v[68:71]
 v_mul_f32 v218, s20, v218
 v_mul_f32 v219, s20, v219
 v_mfma_f32_16x16x32_bf16 v[68:71], a[212:215], v[188:191], v[68:71]
 v_exp_f32 v216, v216
 v_mfma_f32_16x16x32_bf16 v[100:103], a[212:215], v[196:199], v[100:103]
 v_exp_f32 v217, v217
 v_mfma_f32_16x16x32_bf16 v[100:103], a[208:211], v[192:195], v[100:103]
 v_exp_f32 v218, v218
 v_mfma_f32_16x16x32_bf16 a[112:115], a[132:135], v[168:171], a[112:115]
 v_exp_f32 v219, v219
 v_mfma_f32_16x16x32_bf16 a[112:115], a[132:135], v[172:175], a[112:115]
 s_waitcnt lgkmcnt(7)
 buffer_load_dwordx4 v249, s[8:11], s37 offen offset:1024 lds
 v_mfma_f32_16x16x32_bf16 v[208:211], a[152:155], a[32:35], v[224:227]
 s_waitcnt lgkmcnt(6)
 ds_read_b64_tr_b16 a[208:209], v246 offset:8
 v_cvt_pk_bf16_f32 v144, v216, v217
 v_mfma_f32_16x16x32_bf16 v[208:211], a[156:159], a[36:39], v[208:211]
 s_waitcnt lgkmcnt(6)
 ds_read_b64_tr_b16 a[210:211], v246 offset:1032
 v_cvt_pk_bf16_f32 v145, v218, v219
 v_mfma_f32_16x16x32_bf16 v[208:211], a[160:163], a[40:43], v[208:211]
 s_waitcnt lgkmcnt(6)
 ds_read_b64_tr_b16 a[212:213], v246 offset:2056
 v_mul_f32 v220, s20, v220
 v_mfma_f32_16x16x32_bf16 v[208:211], a[164:167], a[44:47], v[208:211]
 ds_read_b64_tr_b16 a[214:215], v246 offset:3080
 v_mul_f32 v221, s20, v221
 v_mfma_f32_16x16x32_bf16 v[212:215], a[164:167], a[60:63], v[228:231]
 v_mul_f32 v222, s20, v222
 v_mul_f32 v223, s20, v223
 v_mfma_f32_16x16x32_bf16 v[212:215], a[160:163], a[56:59], v[212:215]
 v_exp_f32 v220, v220
 v_mfma_f32_16x16x32_bf16 v[212:215], a[156:159], a[52:55], v[212:215]
 v_exp_f32 v221, v221
 v_mfma_f32_16x16x32_bf16 v[212:215], a[152:155], a[48:51], v[212:215]
 v_exp_f32 v222, v222
 v_mfma_f32_16x16x32_bf16 v[216:219], a[152:155], a[64:67], v[232:235]
 buffer_load_dwordx4 v249, s[8:11], s37 offen offset:2048 lds
 v_mfma_f32_16x16x32_bf16 v[216:219], a[156:159], a[68:71], v[216:219]
 v_exp_f32 v223, v223
 v_mfma_f32_16x16x32_bf16 v[216:219], a[160:163], a[72:75], v[216:219]
 v_cvt_pk_bf16_f32 v152, v220, v221
 v_cvt_pk_bf16_f32 v153, v222, v223
 v_mfma_f32_16x16x32_bf16 v[216:219], a[164:167], a[76:79], v[216:219]
 ds_read_b128 a[136:139], v244 offset:3072
 v_mul_f32 v208, s20, v208
 v_mfma_f32_16x16x32_bf16 v[220:223], a[164:167], a[92:95], v[236:239]
 ds_read_b128 a[140:143], v244 offset:3136
 v_mul_f32 v209, s20, v209
 v_mfma_f32_16x16x32_bf16 v[220:223], a[160:163], a[88:91], v[220:223]
 ds_read_b128 a[144:147], v244 offset:3200
 v_mul_f32 v210, s20, v210
 v_mfma_f32_16x16x32_bf16 v[220:223], a[156:159], a[84:87], v[220:223]
 ds_read_b128 a[148:151], v244 offset:3264
 v_mul_f32 v211, s20, v211
 v_mfma_f32_16x16x32_bf16 v[220:223], a[152:155], a[80:83], v[220:223]
 s_waitcnt lgkmcnt(10)
 v_exp_f32 v208, v208
 v_mfma_f32_16x16x32_bf16 v[8:11], a[200:203], v[168:171], v[8:11]
 s_waitcnt lgkmcnt(8)
 v_exp_f32 v209, v209
 v_mfma_f32_16x16x32_bf16 v[8:11], a[204:207], v[172:175], v[8:11]
 buffer_load_dwordx4 v249, s[8:11], s37 offen offset:3072 lds
 v_exp_f32 v210, v210
 v_pk_mul_f32 v[212:213], v[212:213], s[20:21]
 v_pk_mul_f32 v[214:215], v[214:215], s[20:21]
 v_pk_mul_f32 v[216:217], v[216:217], s[20:21]
 v_pk_mul_f32 v[218:219], v[218:219], s[20:21]
 v_pk_mul_f32 v[220:221], v[220:221], s[20:21]
 v_pk_mul_f32 v[222:223], v[222:223], s[20:21]
 v_exp_f32 v211, v211
 v_mfma_f32_16x16x32_bf16 v[40:43], a[204:207], v[180:183], v[40:43]
 v_cvt_pk_bf16_f32 v130, v208, v209
 v_cvt_pk_bf16_f32 v131, v210, v211
 v_mfma_f32_16x16x32_bf16 v[40:43], a[200:203], v[176:179], v[40:43]
 v_exp_f32 v212, v212
 v_mfma_f32_16x16x32_bf16 v[72:75], a[200:203], v[184:187], v[72:75]
 v_exp_f32 v213, v213
 v_mfma_f32_16x16x32_bf16 v[72:75], a[204:207], v[188:191], v[72:75]
 v_exp_f32 v214, v214
 v_mfma_f32_16x16x32_bf16 v[104:107], a[204:207], v[196:199], v[104:107]
 v_exp_f32 v215, v215
 v_mfma_f32_16x16x32_bf16 v[104:107], a[200:203], v[192:195], v[104:107]
 s_waitcnt lgkmcnt(6)
 ds_read_b64_tr_b16 a[200:201], v247 offset:0
 v_cvt_pk_bf16_f32 v138, v212, v213
 v_mfma_f32_16x16x32_bf16 v[12:15], a[208:211], v[168:171], v[12:15]
 s_waitcnt lgkmcnt(5)
 ds_read_b64_tr_b16 a[202:203], v247 offset:1024
 v_cvt_pk_bf16_f32 v139, v214, v215
 v_mfma_f32_16x16x32_bf16 v[12:15], a[212:215], v[172:175], v[12:15]
 s_add_u32 m0, s62, 6016
 v_exp_f32 v216, v216
 v_mfma_f32_16x16x32_bf16 v[44:47], a[212:215], v[180:183], v[44:47]
 buffer_load_dwordx4 v251, s[4:7], s33 offen offset:128 lds
 v_mfma_f32_16x16x32_bf16 v[44:47], a[208:211], v[176:179], v[44:47]
 s_add_u32 m0, s62, 6976
 v_exp_f32 v217, v217
 v_mfma_f32_16x16x32_bf16 v[76:79], a[208:211], v[184:187], v[76:79]
 v_exp_f32 v218, v218
 v_mfma_f32_16x16x32_bf16 v[76:79], a[212:215], v[188:191], v[76:79]
 buffer_load_dwordx4 v251, s[4:7], s33 offen offset:192 lds
 v_mfma_f32_16x16x32_bf16 v[108:111], a[212:215], v[196:199], v[108:111]
 v_exp_f32 v219, v219
 v_mfma_f32_16x16x32_bf16 v[108:111], a[208:211], v[192:195], v[108:111]
 ds_read_b64_tr_b16 a[204:205], v247 offset:2048
 v_cvt_pk_bf16_f32 v146, v216, v217
 v_mfma_f32_16x16x32_bf16 a[116:119], a[132:135], v[176:179], a[116:119]
 ds_read_b64_tr_b16 a[206:207], v247 offset:3072
 v_cvt_pk_bf16_f32 v147, v218, v219
 v_mfma_f32_16x16x32_bf16 a[116:119], a[132:135], v[180:183], a[116:119]
 s_waitcnt lgkmcnt(7)
 v_exp_f32 v220, v220
 v_mfma_f32_16x16x32_bf16 v[208:211], a[136:139], a[32:35], v[224:227]
 s_waitcnt lgkmcnt(6)
 v_exp_f32 v221, v221
 v_mfma_f32_16x16x32_bf16 v[208:211], a[140:143], a[36:39], v[208:211]
 s_waitcnt lgkmcnt(5)
 v_exp_f32 v222, v222
 v_mfma_f32_16x16x32_bf16 v[208:211], a[144:147], a[40:43], v[208:211]
 s_waitcnt lgkmcnt(4)
 v_exp_f32 v223, v223
 v_mfma_f32_16x16x32_bf16 v[208:211], a[148:151], a[44:47], v[208:211]
 ds_read_b64_tr_b16 a[208:209], v247 offset:8
 v_cvt_pk_bf16_f32 v154, v220, v221
 v_mfma_f32_16x16x32_bf16 v[212:215], a[148:151], a[60:63], v[228:231]
 ds_read_b64_tr_b16 a[210:211], v247 offset:1032
 v_cvt_pk_bf16_f32 v155, v222, v223
 v_mfma_f32_16x16x32_bf16 v[212:215], a[144:147], a[56:59], v[212:215]
 ds_read_b64_tr_b16 a[168:169], v248 offset:0
 ds_read_b64_tr_b16 a[170:171], v248 offset:1024
 v_mfma_f32_16x16x32_bf16 v[212:215], a[140:143], a[52:55], v[212:215]
 ds_read_b64_tr_b16 a[172:173], v248 offset:2048
 v_mul_f32 v208, s20, v208
 v_mfma_f32_16x16x32_bf16 v[212:215], a[136:139], a[48:51], v[212:215]
 ds_read_b64_tr_b16 a[174:175], v248 offset:3072
 v_mul_f32 v209, s20, v209
 v_mfma_f32_16x16x32_bf16 v[216:219], a[136:139], a[64:67], v[232:235]
 ds_read_b64_tr_b16 a[176:177], v248 offset:8
 v_mul_f32 v210, s20, v210
 v_mfma_f32_16x16x32_bf16 v[216:219], a[140:143], a[68:71], v[216:219]
 ds_read_b64_tr_b16 a[178:179], v248 offset:1032
 v_mul_f32 v211, s20, v211
 v_mfma_f32_16x16x32_bf16 v[216:219], a[144:147], a[72:75], v[216:219]
 ds_read_b64_tr_b16 a[180:181], v248 offset:2056
 v_mul_f32 v212, s20, v212
 v_mfma_f32_16x16x32_bf16 v[216:219], a[148:151], a[76:79], v[216:219]
 ds_read_b64_tr_b16 a[182:183], v248 offset:3080
 v_mul_f32 v213, s20, v213
 v_mfma_f32_16x16x32_bf16 v[220:223], a[148:151], a[92:95], v[236:239]
 ds_read_b128 a[152:155], v244 offset:4096
 v_mul_f32 v214, s20, v214
 v_mfma_f32_16x16x32_bf16 v[220:223], a[144:147], a[88:91], v[220:223]
 ds_read_b128 a[156:159], v244 offset:4160
 v_mul_f32 v215, s20, v215
 v_mfma_f32_16x16x32_bf16 v[220:223], a[140:143], a[84:87], v[220:223]
 ds_read_b128 a[160:163], v244 offset:4224
 v_mul_f32 v216, s20, v216
 v_mfma_f32_16x16x32_bf16 v[220:223], a[136:139], a[80:83], v[220:223]
 s_waitcnt lgkmcnt(15)
 ds_read_b128 a[164:167], v244 offset:4288
 v_mul_f32 v217, s20, v217
 v_mfma_f32_16x16x32_bf16 v[16:19], a[200:203], v[168:171], v[16:19]
 s_waitcnt lgkmcnt(14)
 ds_read_b64_tr_b16 a[212:213], v247 offset:2056
 v_mul_f32 v218, s20, v218
 ds_read_b64_tr_b16 a[214:215], v247 offset:3080
 v_mfma_f32_16x16x32_bf16 v[16:19], a[204:207], v[172:175], v[16:19]
 v_exp_f32 v208, v208
 v_mfma_f32_16x16x32_bf16 v[48:51], a[204:207], v[180:183], v[48:51]
 v_exp_f32 v209, v209
 v_mfma_f32_16x16x32_bf16 v[48:51], a[200:203], v[176:179], v[48:51]
 v_exp_f32 v210, v210
 v_mfma_f32_16x16x32_bf16 v[80:83], a[200:203], v[184:187], v[80:83]
 v_exp_f32 v211, v211
 v_mfma_f32_16x16x32_bf16 v[80:83], a[204:207], v[188:191], v[80:83]
 v_cvt_pk_bf16_f32 v132, v208, v209
 v_cvt_pk_bf16_f32 v133, v210, v211
 v_mfma_f32_16x16x32_bf16 v[112:115], a[204:207], v[196:199], v[112:115]
 v_exp_f32 v212, v212
 v_mfma_f32_16x16x32_bf16 v[112:115], a[200:203], v[192:195], v[112:115]
 s_waitcnt lgkmcnt(14)
 v_exp_f32 v213, v213
 v_mfma_f32_16x16x32_bf16 v[20:23], a[208:211], v[168:171], v[20:23]
 s_waitcnt vmcnt(18) lgkmcnt(0)
 ds_inc_u32 v249, v252
 v_cvt_pk_bf16_f32 v140, v212, v213
 v_mfma_f32_16x16x32_bf16 v[20:23], a[212:215], v[172:175], v[20:23]
 s_add_u32 s2, s2, 4
 v_exp_f32 v214, v214
 v_mfma_f32_16x16x32_bf16 v[52:55], a[212:215], v[180:183], v[52:55]
 v_exp_f32 v215, v215
 v_mfma_f32_16x16x32_bf16 v[52:55], a[208:211], v[176:179], v[52:55]
 v_cvt_pk_bf16_f32 v141, v214, v215
 v_mul_f32 v219, s20, v219
 v_mfma_f32_16x16x32_bf16 v[84:87], a[208:211], v[184:187], v[84:87]
 v_exp_f32 v216, v216
 v_mfma_f32_16x16x32_bf16 v[84:87], a[212:215], v[188:191], v[84:87]
 v_exp_f32 v217, v217
 v_mfma_f32_16x16x32_bf16 v[116:119], a[212:215], v[196:199], v[116:119]
 v_exp_f32 v218, v218
 v_mfma_f32_16x16x32_bf16 v[116:119], a[208:211], v[192:195], v[116:119]
 v_exp_f32 v219, v219
 v_mfma_f32_16x16x32_bf16 a[120:123], a[132:135], v[184:187], a[120:123]
 v_cvt_pk_bf16_f32 v148, v216, v217
 v_cvt_pk_bf16_f32 v149, v218, v219
 v_mfma_f32_16x16x32_bf16 a[120:123], a[132:135], v[188:191], a[120:123]
 v_mul_f32 v220, s20, v220
 v_mul_f32 v221, s20, v221
 v_mfma_f32_16x16x32_bf16 v[208:211], a[152:155], a[32:35], v[224:227]
 v_mul_f32 v222, s20, v222
 v_mul_f32 v223, s20, v223
 v_mfma_f32_16x16x32_bf16 v[208:211], a[156:159], a[36:39], v[208:211]
 v_exp_f32 v220, v220
 v_mfma_f32_16x16x32_bf16 v[208:211], a[160:163], a[40:43], v[208:211]
 v_exp_f32 v221, v221
 v_mfma_f32_16x16x32_bf16 v[208:211], a[164:167], a[44:47], v[208:211]
 v_exp_f32 v222, v222
 v_mfma_f32_16x16x32_bf16 v[212:215], a[164:167], a[60:63], v[228:231]
 v_exp_f32 v223, v223
 v_mfma_f32_16x16x32_bf16 v[212:215], a[160:163], a[56:59], v[212:215]
 v_cvt_pk_bf16_f32 v156, v220, v221
 v_cvt_pk_bf16_f32 v157, v222, v223
 v_mfma_f32_16x16x32_bf16 v[212:215], a[156:159], a[52:55], v[212:215]
 v_mfma_f32_16x16x32_bf16 v[212:215], a[152:155], a[48:51], v[212:215]
 v_mul_f32 v208, s20, v208
 v_mul_f32 v209, s20, v209
 v_mfma_f32_16x16x32_bf16 v[216:219], a[152:155], a[64:67], v[232:235]
 v_mul_f32 v210, s20, v210
 v_mul_f32 v211, s20, v211
 v_mfma_f32_16x16x32_bf16 v[216:219], a[156:159], a[68:71], v[216:219]
 v_exp_f32 v208, v208
 v_mfma_f32_16x16x32_bf16 v[216:219], a[160:163], a[72:75], v[216:219]
 v_exp_f32 v209, v209
 v_mfma_f32_16x16x32_bf16 v[216:219], a[164:167], a[76:79], v[216:219]
 ds_read_b32 v159, v249
 v_cvt_pk_bf16_f32 v134, v208, v209
 v_mfma_f32_16x16x32_bf16 v[220:223], a[164:167], a[92:95], v[236:239]
 v_exp_f32 v210, v210
 v_mfma_f32_16x16x32_bf16 v[220:223], a[160:163], a[88:91], v[220:223]
 v_exp_f32 v211, v211
 v_mfma_f32_16x16x32_bf16 v[220:223], a[156:159], a[84:87], v[220:223]
 v_cvt_pk_bf16_f32 v135, v210, v211
 v_mul_f32 v212, s20, v212
 v_mfma_f32_16x16x32_bf16 v[220:223], a[152:155], a[80:83], v[220:223]
 v_mul_f32 v213, s20, v213
 v_mul_f32 v214, s20, v214
 v_mfma_f32_16x16x32_bf16 v[24:27], a[168:171], v[168:171], v[24:27]
 v_mul_f32 v215, s20, v215
 v_mul_f32 v216, s20, v216
 v_mfma_f32_16x16x32_bf16 v[24:27], a[172:175], v[172:175], v[24:27]
 v_exp_f32 v212, v212
 v_mfma_f32_16x16x32_bf16 v[56:59], a[172:175], v[180:183], v[56:59]
 s_waitcnt lgkmcnt(0)
 v_cmp_gt_u32 vcc, s2, v159
 v_mul_f32 v217, s20, v217
 v_mfma_f32_16x16x32_bf16 v[56:59], a[168:171], v[176:179], v[56:59]
 s_add_u32 s38, s27, 98304
 v_exp_f32 v213, v213
 v_mfma_f32_16x16x32_bf16 v[88:91], a[168:171], v[184:187], v[88:91]
 s_cbranch_vccnz Lspin4_4
Lback4_4:
 ds_read_b128 a[136:139], v244 offset:17664
 v_cvt_pk_bf16_f32 v142, v212, v213
 v_mfma_f32_16x16x32_bf16 v[88:91], a[172:175], v[188:191], v[88:91]
 s_add_u32 m0, s23, 0
 ds_read_b128 a[140:143], v244 offset:17728
 v_mul_f32 v218, s20, v218
 v_mfma_f32_16x16x32_bf16 v[120:123], a[172:175], v[196:199], v[120:123]
 buffer_load_dwordx4 v250, s[12:15], s38 offen offset:0 lds
 v_mfma_f32_16x16x32_bf16 v[120:123], a[168:171], v[192:195], v[120:123]
 ds_read_b128 a[144:147], v244 offset:17792
 v_mul_f32 v219, s20, v219
 v_mfma_f32_16x16x32_bf16 v[28:31], a[176:179], v[168:171], v[28:31]
 ds_read_b128 a[148:151], v244 offset:17856
 v_mul_f32 v220, s20, v220
 v_mfma_f32_16x16x32_bf16 v[28:31], a[180:183], v[172:175], v[28:31]
 v_exp_f32 v214, v214
 v_mfma_f32_16x16x32_bf16 v[60:63], a[180:183], v[180:183], v[60:63]
 v_exp_f32 v215, v215
 v_mfma_f32_16x16x32_bf16 v[60:63], a[176:179], v[176:179], v[60:63]
 ds_read_b64_tr_b16 a[200:201], v245 offset:16416
 v_cvt_pk_bf16_f32 v143, v214, v215
 v_mfma_f32_16x16x32_bf16 v[92:95], a[176:179], v[184:187], v[92:95]
 v_exp_f32 v216, v216
 v_mfma_f32_16x16x32_bf16 v[92:95], a[180:183], v[188:191], v[92:95]
 v_exp_f32 v217, v217
 v_mfma_f32_16x16x32_bf16 v[124:127], a[180:183], v[196:199], v[124:127]
 v_exp_f32 v218, v218
 v_mfma_f32_16x16x32_bf16 v[124:127], a[176:179], v[192:195], v[124:127]
 buffer_load_dwordx4 v250, s[12:15], s38 offen offset:1024 lds
 v_mfma_f32_16x16x32_bf16 a[124:127], a[132:135], v[192:195], a[124:127]
 v_exp_f32 v219, v219
 v_mfma_f32_16x16x32_bf16 a[124:127], a[132:135], v[196:199], a[124:127]
 s_waitcnt lgkmcnt(4)
 ds_read_b64_tr_b16 a[202:203], v245 offset:17440
 v_cvt_pk_bf16_f32 v150, v216, v217
 v_mfma_f32_16x16x32_bf16 v[208:211], a[136:139], a[32:35], v[224:227]
 s_waitcnt lgkmcnt(4)
 ds_read_b64_tr_b16 a[204:205], v245 offset:18464
 v_cvt_pk_bf16_f32 v151, v218, v219
 v_mfma_f32_16x16x32_bf16 v[208:211], a[140:143], a[36:39], v[208:211]
 s_waitcnt lgkmcnt(4)
 ds_read_b64_tr_b16 a[206:207], v245 offset:19488
 v_mul_f32 v221, s20, v221
 v_mfma_f32_16x16x32_bf16 v[208:211], a[144:147], a[40:43], v[208:211]
 s_waitcnt lgkmcnt(4)
 ds_read_b64_tr_b16 a[208:209], v245 offset:16424
 v_mul_f32 v222, s20, v222
 v_mfma_f32_16x16x32_bf16 v[208:211], a[148:151], a[44:47], v[208:211]
 ds_read_b64_tr_b16 a[210:211], v245 offset:17448
 v_mul_f32 v223, s20, v223
 v_mfma_f32_16x16x32_bf16 v[212:215], a[148:151], a[60:63], v[228:231]
 v_exp_f32 v220, v220
 v_mfma_f32_16x16x32_bf16 v[212:215], a[144:147], a[56:59], v[212:215]
 v_exp_f32 v221, v221
 v_mfma_f32_16x16x32_bf16 v[212:215], a[140:143], a[52:55], v[212:215]
 buffer_load_dwordx4 v250, s[12:15], s38 offen offset:2048 lds
 v_mfma_f32_16x16x32_bf16 v[212:215], a[136:139], a[48:51], v[212:215]
 v_exp_f32 v222, v222
 v_mfma_f32_16x16x32_bf16 v[216:219], a[136:139], a[64:67], v[232:235]
 v_exp_f32 v223, v223
 v_mfma_f32_16x16x32_bf16 v[216:219], a[140:143], a[68:71], v[216:219]
 ds_read_b64_tr_b16 a[212:213], v245 offset:18472
 v_cvt_pk_bf16_f32 v158, v220, v221
 v_mfma_f32_16x16x32_bf16 v[216:219], a[144:147], a[72:75], v[216:219]
 buffer_store_dwordx4 a[232:235], v255, s[16:19], s51 offen offset:0 nt
 buffer_store_dwordx4 a[236:239], v255, s[16:19], s51 offen offset:2048 nt
 v_pk_mul_f32 v[208:209], v[208:209], s[20:21]
 v_pk_mul_f32 v[210:211], v[210:211], s[20:21]
 v_pk_mul_f32 v[212:213], v[212:213], s[20:21]
 v_pk_mul_f32 v[214:215], v[214:215], s[20:21]
 v_cvt_pk_bf16_f32 v159, v222, v223
 v_mfma_f32_16x16x32_bf16 v[216:219], a[148:151], a[76:79], v[216:219]
 v_exp_f32 v208, v208
 v_mfma_f32_16x16x32_bf16 v[220:223], a[148:151], a[92:95], v[236:239]
 v_exp_f32 v209, v209
 v_mfma_f32_16x16x32_bf16 v[220:223], a[144:147], a[88:91], v[220:223]
 ds_read_b64_tr_b16 a[214:215], v245 offset:19496
 v_cvt_pk_bf16_f32 v168, v208, v209
 v_mfma_f32_16x16x32_bf16 v[220:223], a[140:143], a[84:87], v[220:223]
 v_exp_f32 v210, v210
 v_mfma_f32_16x16x32_bf16 v[220:223], a[136:139], a[80:83], v[220:223]
 s_waitcnt lgkmcnt(6)
 buffer_load_dwordx4 v250, s[12:15], s38 offen offset:3072 lds
 v_mfma_f32_16x16x32_bf16 v[0:3], a[200:203], v[128:131], v[0:3]
 s_waitcnt lgkmcnt(4)
 ds_read_b128 a[152:155], v244 offset:18688
 v_mul_f32 v216, s20, v216
 v_mfma_f32_16x16x32_bf16 v[0:3], a[204:207], v[132:135], v[0:3]
 ds_read_b128 a[156:159], v244 offset:18752
 v_mul_f32 v217, s20, v217
 v_mfma_f32_16x16x32_bf16 v[32:35], a[204:207], v[140:143], v[32:35]
 ds_read_b128 a[160:163], v244 offset:18816
 v_mul_f32 v218, s20, v218
 v_mfma_f32_16x16x32_bf16 v[32:35], a[200:203], v[136:139], v[32:35]
 ds_read_b128 a[164:167], v244 offset:18880
 v_mul_f32 v219, s20, v219
 v_mfma_f32_16x16x32_bf16 v[64:67], a[200:203], v[144:147], v[64:67]
 s_add_u32 s37, s28, 0
 v_exp_f32 v211, v211
 v_mfma_f32_16x16x32_bf16 v[64:67], a[204:207], v[148:151], v[64:67]
 s_add_u32 m0, s22, 1024
 v_cvt_pk_bf16_f32 v169, v210, v211
 v_mul_f32 v220, s20, v220
 v_mfma_f32_16x16x32_bf16 v[96:99], a[204:207], v[156:159], v[96:99]
 v_exp_f32 v212, v212
 v_mfma_f32_16x16x32_bf16 v[96:99], a[200:203], v[152:155], v[96:99]
 s_waitcnt lgkmcnt(6)
 v_exp_f32 v213, v213
 v_mfma_f32_16x16x32_bf16 v[4:7], a[208:211], v[128:131], v[4:7]
 s_waitcnt lgkmcnt(4)
 buffer_load_dwordx4 v249, s[8:11], s37 offen offset:0 lds
 v_mfma_f32_16x16x32_bf16 v[4:7], a[212:215], v[132:135], v[4:7]
 v_exp_f32 v214, v214
 v_mfma_f32_16x16x32_bf16 v[36:39], a[212:215], v[140:143], v[36:39]
 v_exp_f32 v215, v215
 v_mfma_f32_16x16x32_bf16 v[36:39], a[208:211], v[136:139], v[36:39]
 ds_read_b64_tr_b16 a[200:201], v246 offset:16416
 v_cvt_pk_bf16_f32 v176, v212, v213
 v_mfma_f32_16x16x32_bf16 v[68:71], a[208:211], v[144:147], v[68:71]
 ds_read_b64_tr_b16 a[202:203], v246 offset:17440
 v_cvt_pk_bf16_f32 v177, v214, v215
 v_mfma_f32_16x16x32_bf16 v[68:71], a[212:215], v[148:151], v[68:71]
 v_exp_f32 v216, v216
 v_mfma_f32_16x16x32_bf16 v[100:103], a[212:215], v[156:159], v[100:103]
 v_exp_f32 v217, v217
 v_mfma_f32_16x16x32_bf16 v[100:103], a[208:211], v[152:155], v[100:103]
 v_exp_f32 v218, v218
 v_mfma_f32_16x16x32_bf16 a[112:115], a[132:135], v[128:131], a[112:115]
 v_exp_f32 v219, v219
 v_mfma_f32_16x16x32_bf16 a[112:115], a[132:135], v[132:135], a[112:115]
 s_waitcnt lgkmcnt(5)
 buffer_load_dwordx4 v249, s[8:11], s37 offen offset:1024 lds
 v_mfma_f32_16x16x32_bf16 v[208:211], a[152:155], a[32:35], v[224:227]
 s_waitcnt lgkmcnt(4)
 ds_read_b64_tr_b16 a[204:205], v246 offset:18464
 v_cvt_pk_bf16_f32 v184, v216, v217
 v_mfma_f32_16x16x32_bf16 v[208:211], a[156:159], a[36:39], v[208:211]
 s_waitcnt lgkmcnt(4)
 ds_read_b64_tr_b16 a[206:207], v246 offset:19488
 v_cvt_pk_bf16_f32 v185, v218, v219
 v_mfma_f32_16x16x32_bf16 v[208:211], a[160:163], a[40:43], v[208:211]
 s_waitcnt lgkmcnt(4)
 ds_read_b64_tr_b16 a[208:209], v246 offset:16424
 v_mul_f32 v221, s20, v221
 v_mfma_f32_16x16x32_bf16 v[208:211], a[164:167], a[44:47], v[208:211]
 ds_read_b64_tr_b16 a[210:211], v246 offset:17448
 v_mul_f32 v222, s20, v222
 v_mfma_f32_16x16x32_bf16 v[212:215], a[164:167], a[60:63], v[228:231]
 ds_read_b64_tr_b16 a[212:213], v246 offset:18472
 v_mul_f32 v223, s20, v223
 v_mfma_f32_16x16x32_bf16 v[212:215], a[160:163], a[56:59], v[212:215]
 v_exp_f32 v220, v220
 v_mfma_f32_16x16x32_bf16 v[212:215], a[156:159], a[52:55], v[212:215]
 v_exp_f32 v221, v221
 v_mfma_f32_16x16x32_bf16 v[212:215], a[152:155], a[48:51], v[212:215]
 v_exp_f32 v222, v222
 v_mfma_f32_16x16x32_bf16 v[216:219], a[152:155], a[64:67], v[232:235]
 buffer_load_dwordx4 v249, s[8:11], s37 offen offset:2048 lds
 v_mfma_f32_16x16x32_bf16 v[216:219], a[156:159], a[68:71], v[216:219]
 v_exp_f32 v223, v223
 v_mfma_f32_16x16x32_bf16 v[216:219], a[160:163], a[72:75], v[216:219]
 ds_read_b64_tr_b16 a[214:215], v246 offset:19496
 v_cvt_pk_bf16_f32 v192, v220, v221
 v_mfma_f32_16x16x32_bf16 v[216:219], a[164:167], a[76:79], v[216:219]
 ds_read_b128 a[136:139], v244 offset:19712
 v_cvt_pk_bf16_f32 v193, v222, v223
 v_mfma_f32_16x16x32_bf16 v[220:223], a[164:167], a[92:95], v[236:239]
 ds_read_b128 a[140:143], v244 offset:19776
 v_mul_f32 v208, s20, v208
 v_mfma_f32_16x16x32_bf16 v[220:223], a[160:163], a[88:91], v[220:223]
 ds_read_b128 a[144:147], v244 offset:19840
 v_mul_f32 v209, s20, v209
 v_mfma_f32_16x16x32_bf16 v[220:223], a[156:159], a[84:87], v[220:223]
 ds_read_b128 a[148:151], v244 offset:19904
 v_mul_f32 v210, s20, v210
 v_mfma_f32_16x16x32_bf16 v[220:223], a[152:155], a[80:83], v[220:223]
 s_waitcnt lgkmcnt(10)
 v_mul_f32 v211, s20, v211
 v_mul_f32 v212, s20, v212
 v_mfma_f32_16x16x32_bf16 v[8:11], a[200:203], v[128:131], v[8:11]
 s_waitcnt lgkmcnt(8)
 v_exp_f32 v208, v208
 v_mfma_f32_16x16x32_bf16 v[8:11], a[204:207], v[132:135], v[8:11]
 buffer_load_dwordx4 v249, s[8:11], s37 offen offset:3072 lds
 v_exp_f32 v209, v209
 v_pk_mul_f32 v[214:215], v[214:215], s[20:21]
 v_pk_mul_f32 v[216:217], v[216:217], s[20:21]
 v_pk_mul_f32 v[218:219], v[218:219], s[20:21]
 v_pk_mul_f32 v[220:221], v[220:221], s[20:21]
 v_pk_mul_f32 v[222:223], v[222:223], s[20:21]
 v_exp_f32 v210, v210
 v_mfma_f32_16x16x32_bf16 v[40:43], a[204:207], v[140:143], v[40:43]
 v_exp_f32 v211, v211
 v_mfma_f32_16x16x32_bf16 v[40:43], a[200:203], v[136:139], v[40:43]
 v_cvt_pk_bf16_f32 v170, v208, v209
 v_cvt_pk_bf16_f32 v171, v210, v211
 v_mfma_f32_16x16x32_bf16 v[72:75], a[200:203], v[144:147], v[72:75]
 ds_read_b64_tr_b16 a[168:169], v248 offset:16416
 v_mul_f32 v213, s20, v213
 v_mfma_f32_16x16x32_bf16 v[72:75], a[204:207], v[148:151], v[72:75]
 v_exp_f32 v212, v212
 v_mfma_f32_16x16x32_bf16 v[104:107], a[204:207], v[156:159], v[104:107]
 v_exp_f32 v213, v213
 v_mfma_f32_16x16x32_bf16 v[104:107], a[200:203], v[152:155], v[104:107]
 s_waitcnt lgkmcnt(7)
 v_exp_f32 v214, v214
 v_mfma_f32_16x16x32_bf16 v[12:15], a[208:211], v[128:131], v[12:15]
 s_waitcnt lgkmcnt(5)
 v_exp_f32 v215, v215
 v_mfma_f32_16x16x32_bf16 v[12:15], a[212:215], v[132:135], v[12:15]
 s_add_u32 m0, s62, 8192
 ds_read_b64_tr_b16 a[200:201], v247 offset:16416
 v_cvt_pk_bf16_f32 v178, v212, v213
 v_mfma_f32_16x16x32_bf16 v[44:47], a[212:215], v[140:143], v[44:47]
 buffer_load_dwordx4 v251, s[4:7], s34 offen offset:0 lds
 v_mfma_f32_16x16x32_bf16 v[44:47], a[208:211], v[136:139], v[44:47]
 s_add_u32 m0, s62, 9152
 ds_read_b64_tr_b16 a[202:203], v247 offset:17440
 v_cvt_pk_bf16_f32 v179, v214, v215
 v_mfma_f32_16x16x32_bf16 v[76:79], a[208:211], v[144:147], v[76:79]
 v_exp_f32 v216, v216
 v_mfma_f32_16x16x32_bf16 v[76:79], a[212:215], v[148:151], v[76:79]
 buffer_load_dwordx4 v251, s[4:7], s34 offen offset:64 lds
 v_mfma_f32_16x16x32_bf16 v[108:111], a[212:215], v[156:159], v[108:111]
 v_exp_f32 v217, v217
 v_mfma_f32_16x16x32_bf16 v[108:111], a[208:211], v[152:155], v[108:111]
 v_exp_f32 v218, v218
 v_mfma_f32_16x16x32_bf16 a[116:119], a[132:135], v[136:139], a[116:119]
 v_exp_f32 v219, v219
 v_mfma_f32_16x16x32_bf16 a[116:119], a[132:135], v[140:143], a[116:119]
 s_waitcnt lgkmcnt(6)
 ds_read_b64_tr_b16 a[204:205], v247 offset:18464
 v_cvt_pk_bf16_f32 v186, v216, v217
 v_mfma_f32_16x16x32_bf16 v[208:211], a[136:139], a[32:35], v[224:227]
 s_waitcnt lgkmcnt(6)
 ds_read_b64_tr_b16 a[206:207], v247 offset:19488
 v_cvt_pk_bf16_f32 v187, v218, v219
 v_mfma_f32_16x16x32_bf16 v[208:211], a[140:143], a[36:39], v[208:211]
 s_waitcnt lgkmcnt(6)
 v_exp_f32 v220, v220
 v_mfma_f32_16x16x32_bf16 v[208:211], a[144:147], a[40:43], v[208:211]
 s_waitcnt lgkmcnt(5)
 v_exp_f32 v221, v221
 v_mfma_f32_16x16x32_bf16 v[208:211], a[148:151], a[44:47], v[208:211]
 v_exp_f32 v222, v222
 v_mfma_f32_16x16x32_bf16 v[212:215], a[148:151], a[60:63], v[228:231]
 v_exp_f32 v223, v223
 v_mfma_f32_16x16x32_bf16 v[212:215], a[144:147], a[56:59], v[212:215]
 ds_read_b64_tr_b16 a[208:209], v247 offset:16424
 v_cvt_pk_bf16_f32 v194, v220, v221
 v_mfma_f32_16x16x32_bf16 v[212:215], a[140:143], a[52:55], v[212:215]
 ds_read_b64_tr_b16 a[210:211], v247 offset:17448
 v_cvt_pk_bf16_f32 v195, v222, v223
 v_mfma_f32_16x16x32_bf16 v[212:215], a[136:139], a[48:51], v[212:215]
 ds_read_b64_tr_b16 a[170:171], v248 offset:17440
 v_mul_f32 v208, s20, v208
 v_mfma_f32_16x16x32_bf16 v[216:219], a[136:139], a[64:67], v[232:235]
 ds_read_b64_tr_b16 a[172:173], v248 offset:18464
 v_mul_f32 v209, s20, v209
 v_mfma_f32_16x16x32_bf16 v[216:219], a[140:143], a[68:71], v[216:219]
 ds_read_b64_tr_b16 a[174:175], v248 offset:19488
 v_mul_f32 v210, s20, v210
 v_mfma_f32_16x16x32_bf16 v[216:219], a[144:147], a[72:75], v[216:219]
 ds_read_b64_tr_b16 a[176:177], v248 offset:16424
 v_mul_f32 v211, s20, v211
 v_mfma_f32_16x16x32_bf16 v[216:219], a[148:151], a[76:79], v[216:219]
 ds_read_b64_tr_b16 a[178:179], v248 offset:17448
 v_mul_f32 v212, s20, v212
 v_mfma_f32_16x16x32_bf16 v[220:223], a[148:151], a[92:95], v[236:239]
 ds_read_b64_tr_b16 a[180:181], v248 offset:18472
 v_mul_f32 v213, s20, v213
 v_mfma_f32_16x16x32_bf16 v[220:223], a[144:147], a[88:91], v[220:223]
 ds_read_b64_tr_b16 a[182:183], v248 offset:19496
 v_mul_f32 v214, s20, v214
 v_mfma_f32_16x16x32_bf16 v[220:223], a[140:143], a[84:87], v[220:223]
 ds_read_b128 a[152:155], v244 offset:20736
 v_mul_f32 v215, s20, v215
 v_mfma_f32_16x16x32_bf16 v[220:223], a[136:139], a[80:83], v[220:223]
 s_waitcnt lgkmcnt(12)
 ds_read_b128 a[156:159], v244 offset:20800
 v_mul_f32 v216, s20, v216
 v_mfma_f32_16x16x32_bf16 v[16:19], a[200:203], v[128:131], v[16:19]
 s_waitcnt lgkmcnt(11)
 ds_read_b128 a[160:163], v244 offset:20864
 v_mul_f32 v217, s20, v217
 ds_read_b128 a[164:167], v244 offset:20928
 ds_read_b64_tr_b16 a[212:213], v247 offset:18472
 ds_read_b64_tr_b16 a[214:215], v247 offset:19496
 v_mfma_f32_16x16x32_bf16 v[16:19], a[204:207], v[132:135], v[16:19]
 v_exp_f32 v208, v208
 v_mfma_f32_16x16x32_bf16 v[48:51], a[204:207], v[140:143], v[48:51]
 v_exp_f32 v209, v209
 v_mfma_f32_16x16x32_bf16 v[48:51], a[200:203], v[136:139], v[48:51]
 v_exp_f32 v210, v210
 v_mfma_f32_16x16x32_bf16 v[80:83], a[200:203], v[144:147], v[80:83]
 v_exp_f32 v211, v211
 v_mfma_f32_16x16x32_bf16 v[80:83], a[204:207], v[148:151], v[80:83]
 v_cvt_pk_bf16_f32 v172, v208, v209
 v_cvt_pk_bf16_f32 v173, v210, v211
 v_mfma_f32_16x16x32_bf16 v[112:115], a[204:207], v[156:159], v[112:115]
 v_exp_f32 v212, v212
 v_mfma_f32_16x16x32_bf16 v[112:115], a[200:203], v[152:155], v[112:115]
 s_waitcnt lgkmcnt(13)
 v_exp_f32 v213, v213
 v_mfma_f32_16x16x32_bf16 v[20:23], a[208:211], v[128:131], v[20:23]
 s_waitcnt vmcnt(18) lgkmcnt(0)
 ds_inc_u32 v249, v252
 v_cvt_pk_bf16_f32 v180, v212, v213
 v_mfma_f32_16x16x32_bf16 v[20:23], a[212:215], v[132:135], v[20:23]
 s_add_u32 s2, s2, 4
 v_exp_f32 v214, v214
 v_mfma_f32_16x16x32_bf16 v[52:55], a[212:215], v[140:143], v[52:55]
 v_exp_f32 v215, v215
 v_mfma_f32_16x16x32_bf16 v[52:55], a[208:211], v[136:139], v[52:55]
 v_cvt_pk_bf16_f32 v181, v214, v215
 v_mul_f32 v218, s20, v218
 v_mfma_f32_16x16x32_bf16 v[84:87], a[208:211], v[144:147], v[84:87]
 v_mul_f32 v219, s20, v219
 v_mul_f32 v220, s20, v220
 v_mfma_f32_16x16x32_bf16 v[84:87], a[212:215], v[148:151], v[84:87]
 v_exp_f32 v216, v216
 v_mfma_f32_16x16x32_bf16 v[116:119], a[212:215], v[156:159], v[116:119]
 v_exp_f32 v217, v217
 v_mfma_f32_16x16x32_bf16 v[116:119], a[208:211], v[152:155], v[116:119]
 v_exp_f32 v218, v218
 v_mfma_f32_16x16x32_bf16 a[120:123], a[132:135], v[144:147], a[120:123]
 v_exp_f32 v219, v219
 v_mfma_f32_16x16x32_bf16 a[120:123], a[132:135], v[148:151], a[120:123]
 v_cvt_pk_bf16_f32 v188, v216, v217
 v_cvt_pk_bf16_f32 v189, v218, v219
 v_mfma_f32_16x16x32_bf16 v[208:211], a[152:155], a[32:35], v[224:227]
 v_mul_f32 v221, s20, v221
 v_mul_f32 v222, s20, v222
 v_mfma_f32_16x16x32_bf16 v[208:211], a[156:159], a[36:39], v[208:211]
 v_exp_f32 v220, v220
 v_mfma_f32_16x16x32_bf16 v[208:211], a[160:163], a[40:43], v[208:211]
 v_exp_f32 v221, v221
 v_mfma_f32_16x16x32_bf16 v[208:211], a[164:167], a[44:47], v[208:211]
 v_mul_f32 v223, s20, v223
 v_cvt_pk_bf16_f32 v196, v220, v221
 v_mfma_f32_16x16x32_bf16 v[212:215], a[164:167], a[60:63], v[228:231]
 v_exp_f32 v222, v222
 v_mfma_f32_16x16x32_bf16 v[212:215], a[160:163], a[56:59], v[212:215]
 v_exp_f32 v223, v223
 v_mfma_f32_16x16x32_bf16 v[212:215], a[156:159], a[52:55], v[212:215]
 v_cvt_pk_bf16_f32 v197, v222, v223
 v_mul_f32 v208, s20, v208
 v_mfma_f32_16x16x32_bf16 v[212:215], a[152:155], a[48:51], v[212:215]
 v_mul_f32 v209, s20, v209
 v_mul_f32 v210, s20, v210
 v_mfma_f32_16x16x32_bf16 v[216:219], a[152:155], a[64:67], v[232:235]
 v_exp_f32 v208, v208
 v_mfma_f32_16x16x32_bf16 v[216:219], a[156:159], a[68:71], v[216:219]
 v_exp_f32 v209, v209
 v_mfma_f32_16x16x32_bf16 v[216:219], a[160:163], a[72:75], v[216:219]
 v_mul_f32 v211, s20, v211
 v_cvt_pk_bf16_f32 v174, v208, v209
 v_mfma_f32_16x16x32_bf16 v[216:219], a[164:167], a[76:79], v[216:219]
 ds_read_b32 v199, v249
 v_mul_f32 v212, s20, v212
 v_mfma_f32_16x16x32_bf16 v[220:223], a[164:167], a[92:95], v[236:239]
 v_exp_f32 v210, v210
 v_mfma_f32_16x16x32_bf16 v[220:223], a[160:163], a[88:91], v[220:223]
 v_exp_f32 v211, v211
 v_mfma_f32_16x16x32_bf16 v[220:223], a[156:159], a[84:87], v[220:223]
 v_cvt_pk_bf16_f32 v175, v210, v211
 v_mul_f32 v213, s20, v213
 v_mfma_f32_16x16x32_bf16 v[220:223], a[152:155], a[80:83], v[220:223]
 v_mul_f32 v214, s20, v214
 v_mul_f32 v215, s20, v215
 v_mfma_f32_16x16x32_bf16 v[24:27], a[168:171], v[128:131], v[24:27]
 v_exp_f32 v212, v212
 v_mfma_f32_16x16x32_bf16 v[24:27], a[172:175], v[132:135], v[24:27]
 v_exp_f32 v213, v213
 v_mfma_f32_16x16x32_bf16 v[56:59], a[172:175], v[140:143], v[56:59]
 s_waitcnt lgkmcnt(0)
 v_cmp_gt_u32 vcc, s2, v199
 v_cvt_pk_bf16_f32 v182, v212, v213
 v_mfma_f32_16x16x32_bf16 v[56:59], a[168:171], v[136:139], v[56:59]
 s_add_u32 s38, s27, 114688
 v_exp_f32 v214, v214
 v_mfma_f32_16x16x32_bf16 v[88:91], a[168:171], v[144:147], v[88:91]
 s_cbranch_vccnz Lspin4_5
Lback4_5:
 ds_read_b128 a[136:139], v244 offset:34304
 v_mul_f32 v216, s20, v216
 v_mfma_f32_16x16x32_bf16 v[88:91], a[172:175], v[148:151], v[88:91]
 s_add_u32 m0, s23, 16416
 ds_read_b128 a[140:143], v244 offset:34368
 v_mul_f32 v217, s20, v217
 v_mfma_f32_16x16x32_bf16 v[120:123], a[172:175], v[156:159], v[120:123]
 buffer_load_dwordx4 v250, s[12:15], s38 offen offset:0 lds
 v_exp_f32 v215, v215
 v_pk_mul_f32 v[218:219], v[218:219], s[20:21]
 v_pk_mul_f32 v[220:221], v[220:221], s[20:21]
 v_pk_mul_f32 v[222:223], v[222:223], s[20:21]
 v_cvt_pk_bf16_f32 v183, v214, v215
 v_mfma_f32_16x16x32_bf16 v[120:123], a[168:171], v[152:155], v[120:123]
 v_exp_f32 v216, v216
 v_mfma_f32_16x16x32_bf16 v[28:31], a[176:179], v[128:131], v[28:31]
 v_exp_f32 v217, v217
 v_mfma_f32_16x16x32_bf16 v[28:31], a[180:183], v[132:135], v[28:31]
 ds_read_b128 a[144:147], v244 offset:34432
 v_cvt_pk_bf16_f32 v190, v216, v217
 v_mfma_f32_16x16x32_bf16 v[60:63], a[180:183], v[140:143], v[60:63]
 v_exp_f32 v218, v218
 v_mfma_f32_16x16x32_bf16 v[60:63], a[176:179], v[136:139], v[60:63]
 ds_read_b128 a[148:151], v244 offset:34496
 ds_read_b64_tr_b16 a[200:201], v245 offset:32832
 v_mfma_f32_16x16x32_bf16 v[92:95], a[176:179], v[144:147], v[92:95]
 v_exp_f32 v219, v219
 v_mfma_f32_16x16x32_bf16 v[92:95], a[180:183], v[148:151], v[92:95]
 ds_read_b64_tr_b16 a[202:203], v245 offset:33856
 v_cvt_pk_bf16_f32 v191, v218, v219
 v_mfma_f32_16x16x32_bf16 v[124:127], a[180:183], v[156:159], v[124:127]
 v_exp_f32 v220, v220
 v_mfma_f32_16x16x32_bf16 v[124:127], a[176:179], v[152:155], v[124:127]
 buffer_load_dwordx4 v250, s[12:15], s38 offen offset:1024 lds
 v_mfma_f32_16x16x32_bf16 a[124:127], a[132:135], v[152:155], a[124:127]
 v_exp_f32 v221, v221
 v_mfma_f32_16x16x32_bf16 a[124:127], a[132:135], v[156:159], a[124:127]
 s_waitcnt lgkmcnt(5)
 ds_read_b64_tr_b16 a[204:205], v245 offset:34880
 v_cvt_pk_bf16_f32 v198, v220, v221
 v_mfma_f32_16x16x32_bf16 v[208:211], a[136:139], a[32:35], v[224:227]
 s_waitcnt lgkmcnt(5)
 v_exp_f32 v222, v222
 v_mfma_f32_16x16x32_bf16 v[208:211], a[140:143], a[36:39], v[208:211]
 s_waitcnt lgkmcnt(4)
 v_exp_f32 v223, v223
 v_mfma_f32_16x16x32_bf16 v[208:211], a[144:147], a[40:43], v[208:211]
 s_waitcnt lgkmcnt(3)
 ds_read_b64_tr_b16 a[206:207], v245 offset:35904
 v_cvt_pk_bf16_f32 v199, v222, v223
 v_mfma_f32_16x16x32_bf16 v[208:211], a[148:151], a[44:47], v[208:211]
 ds_read_b64_tr_b16 a[208:209], v245 offset:32840
 ds_read_b64_tr_b16 a[210:211], v245 offset:33864
 v_mfma_f32_16x16x32_bf16 v[212:215], a[148:151], a[60:63], v[228:231]
 ds_read_b64_tr_b16 a[212:213], v245 offset:34888
 ds_read_b64_tr_b16 a[214:215], v245 offset:35912
 v_mfma_f32_16x16x32_bf16 v[212:215], a[144:147], a[56:59], v[212:215]
 ds_read_b128 a[152:155], v244 offset:35328
 ds_read_b128 a[156:159], v244 offset:35392
 v_mfma_f32_16x16x32_bf16 v[212:215], a[140:143], a[52:55], v[212:215]
 buffer_load_dwordx4 v250, s[12:15], s38 offen offset:2048 lds
 v_mfma_f32_16x16x32_bf16 v[212:215], a[136:139], a[48:51], v[212:215]
 ds_read_b128 a[160:163], v244 offset:35456
 v_mul_f32 v208, s20, v208
 v_mfma_f32_16x16x32_bf16 v[216:219], a[136:139], a[64:67], v[232:235]
 ds_read_b128 a[164:167], v244 offset:35520
 v_mul_f32 v209, s20, v209
 v_mfma_f32_16x16x32_bf16 v[216:219], a[140:143], a[68:71], v[216:219]
 v_mul_f32 v210, s20, v210
 v_mul_f32 v211, s20, v211
 v_mfma_f32_16x16x32_bf16 v[216:219], a[144:147], a[72:75], v[216:219]
 buffer_store_dwordx4 a[240:243], v255, s[16:19], s60 offen offset:0 nt
 buffer_store_dwordx4 a[244:247], v255, s[16:19], s60 offen offset:2048 nt
 v_mfma_f32_16x16x32_bf16 v[216:219], a[148:151], a[76:79], v[216:219]
 v_exp_f32 v208, v208
 v_mfma_f32_16x16x32_bf16 v[220:223], a[148:151], a[92:95], v[236:239]
 v_exp_f32 v209, v209
 v_mfma_f32_16x16x32_bf16 v[220:223], a[144:147], a[88:91], v[220:223]
 v_exp_f32 v210, v210
 v_mfma_f32_16x16x32_bf16 v[220:223], a[140:143], a[84:87], v[220:223]
 v_exp_f32 v211, v211
 v_mfma_f32_16x16x32_bf16 v[220:223], a[136:139], a[80:83], v[220:223]
 s_waitcnt lgkmcnt(10)
 buffer_load_dwordx4 v250, s[12:15], s38 offen offset:3072 lds
 v_mfma_f32_16x16x32_bf16 v[0:3], a[200:203], v[168:171], v[0:3]
 s_waitcnt lgkmcnt(8)
 v_cvt_pk_bf16_f32 v128, v208, v209
 v_cvt_pk_bf16_f32 v129, v210, v211
 v_mfma_f32_16x16x32_bf16 v[0:3], a[204:207], v[172:175], v[0:3]
 v_mul_f32 v212, s20, v212
 v_mul_f32 v213, s20, v213
 v_mfma_f32_16x16x32_bf16 v[32:35], a[204:207], v[180:183], v[32:35]
 v_mul_f32 v214, s20, v214
 v_mul_f32 v215, s20, v215
 v_mfma_f32_16x16x32_bf16 v[32:35], a[200:203], v[176:179], v[32:35]
 v_exp_f32 v212, v212
 v_mfma_f32_16x16x32_bf16 v[64:67], a[200:203], v[184:187], v[64:67]
 s_add_u32 s37, s28, 16384
 v_exp_f32 v213, v213
 v_mfma_f32_16x16x32_bf16 v[64:67], a[204:207], v[188:191], v[64:67]
 s_add_u32 m0, s22, 17664
 v_exp_f32 v214, v214
 v_mfma_f32_16x16x32_bf16 v[96:99], a[204:207], v[196:199], v[96:99]
 v_exp_f32 v215, v215
 v_mfma_f32_16x16x32_bf16 v[96:99], a[200:203], v[192:195], v[96:99]
 s_waitcnt lgkmcnt(6)
 ds_read_b64_tr_b16 a[200:201], v246 offset:32832
 v_cvt_pk_bf16_f32 v136, v212, v213
 v_mfma_f32_16x16x32_bf16 v[4:7], a[208:211], v[168:171], v[4:7]
 s_waitcnt lgkmcnt(5)
 buffer_load_dwordx4 v249, s[8:11], s37 offen offset:0 lds
 v_mfma_f32_16x16x32_bf16 v[4:7], a[212:215], v[172:175], v[4:7]
 ds_read_b64_tr_b16 a[202:203], v246 offset:33856
 v_cvt_pk_bf16_f32 v137, v214, v215
 v_mfma_f32_16x16x32_bf16 v[36:39], a[212:215], v[180:183], v[36:39]
 ds_read_b64_tr_b16 a[204:205], v246 offset:34880
 v_mul_f32 v216, s20, v216
 v_mfma_f32_16x16x32_bf16 v[36:39], a[208:211], v[176:179], v[36:39]
 ds_read_b64_tr_b16 a[206:207], v246 offset:35904
 v_mul_f32 v217, s20, v217
 v_mfma_f32_16x16x32_bf16 v[68:71], a[208:211], v[184:187], v[68:71]
 v_mul_f32 v218, s20, v218
 v_mul_f32 v219, s20, v219
 v_mfma_f32_16x16x32_bf16 v[68:71], a[212:215], v[188:191], v[68:71]
 v_exp_f32 v216, v216
 v_mfma_f32_16x16x32_bf16 v[100:103], a[212:215], v[196:199], v[100:103]
 v_exp_f32 v217, v217
 v_mfma_f32_16x16x32_bf16 v[100:103], a[208:211], v[192:195], v[100:103]
 v_exp_f32 v218, v218
 v_mfma_f32_16x16x32_bf16 a[112:115], a[132:135], v[168:171], a[112:115]
 v_exp_f32 v219, v219
 v_mfma_f32_16x16x32_bf16 a[112:115], a[132:135], v[172:175], a[112:115]
 s_waitcnt lgkmcnt(7)
 buffer_load_dwordx4 v249, s[8:11], s37 offen offset:1024 lds
 v_mfma_f32_16x16x32_bf16 v[208:211], a[152:155], a[32:35], v[224:227]
 s_waitcnt lgkmcnt(6)
 ds_read_b64_tr_b16 a[208:209], v246 offset:32840
 v_cvt_pk_bf16_f32 v144, v216, v217
 v_mfma_f32_16x16x32_bf16 v[208:211], a[156:159], a[36:39], v[208:211]
 s_waitcnt lgkmcnt(6)
 ds_read_b64_tr_b16 a[210:211], v246 offset:33864
 v_cvt_pk_bf16_f32 v145, v218, v219
 v_mfma_f32_16x16x32_bf16 v[208:211], a[160:163], a[40:43], v[208:211]
 s_waitcnt lgkmcnt(6)
 ds_read_b64_tr_b16 a[212:213], v246 offset:34888
 v_mul_f32 v220, s20, v220
 v_mfma_f32_16x16x32_bf16 v[208:211], a[164:167], a[44:47], v[208:211]
 ds_read_b64_tr_b16 a[214:215], v246 offset:35912
 v_mul_f32 v221, s20, v221
 v_mfma_f32_16x16x32_bf16 v[212:215], a[164:167], a[60:63], v[228:231]
 v_mul_f32 v222, s20, v222
 v_mul_f32 v223, s20, v223
 v_mfma_f32_16x16x32_bf16 v[212:215], a[160:163], a[56:59], v[212:215]
 v_exp_f32 v220, v220
 v_mfma_f32_16x16x32_bf16 v[212:215], a[156:159], a[52:55], v[212:215]
 v_exp_f32 v221, v221
 v_mfma_f32_16x16x32_bf16 v[212:215], a[152:155], a[48:51], v[212:215]
 v_exp_f32 v222, v222
 v_mfma_f32_16x16x32_bf16 v[216:219], a[152:155], a[64:67], v[232:235]
 buffer_load_dwordx4 v249, s[8:11], s37 offen offset:2048 lds
 v_mfma_f32_16x16x32_bf16 v[216:219], a[156:159], a[68:71], v[216:219]
 v_exp_f32 v223, v223
 v_mfma_f32_16x16x32_bf16 v[216:219], a[160:163], a[72:75], v[216:219]
 v_cvt_pk_bf16_f32 v152, v220, v221
 v_cvt_pk_bf16_f32 v153, v222, v223
 v_mfma_f32_16x16x32_bf16 v[216:219], a[164:167], a[76:79], v[216:219]
 ds_read_b128 a[136:139], v244 offset:36352
 v_mul_f32 v208, s20, v208
 v_mfma_f32_16x16x32_bf16 v[220:223], a[164:167], a[92:95], v[236:239]
 ds_read_b128 a[140:143], v244 offset:36416
 v_mul_f32 v209, s20, v209
 v_mfma_f32_16x16x32_bf16 v[220:223], a[160:163], a[88:91], v[220:223]
 ds_read_b128 a[144:147], v244 offset:36480
 v_mul_f32 v210, s20, v210
 v_mfma_f32_16x16x32_bf16 v[220:223], a[156:159], a[84:87], v[220:223]
 ds_read_b128 a[148:151], v244 offset:36544
 v_mul_f32 v211, s20, v211
 v_mfma_f32_16x16x32_bf16 v[220:223], a[152:155], a[80:83], v[220:223]
 s_waitcnt lgkmcnt(10)
 v_exp_f32 v208, v208
 v_mfma_f32_16x16x32_bf16 v[8:11], a[200:203], v[168:171], v[8:11]
 s_waitcnt lgkmcnt(8)
 v_exp_f32 v209, v209
 v_mfma_f32_16x16x32_bf16 v[8:11], a[204:207], v[172:175], v[8:11]
 buffer_load_dwordx4 v249, s[8:11], s37 offen offset:3072 lds
 v_exp_f32 v210, v210
 v_pk_mul_f32 v[212:213], v[212:213], s[20:21]
 v_pk_mul_f32 v[214:215], v[214:215], s[20:21]
 v_pk_mul_f32 v[216:217], v[216:217], s[20:21]
 v_pk_mul_f32 v[218:219], v[218:219], s[20:21]
 v_pk_mul_f32 v[220:221], v[220:221], s[20:21]
 v_pk_mul_f32 v[222:223], v[222:223], s[20:21]
 v_exp_f32 v211, v211
 v_mfma_f32_16x16x32_bf16 v[40:43], a[204:207], v[180:183], v[40:43]
 v_cvt_pk_bf16_f32 v130, v208, v209
 v_cvt_pk_bf16_f32 v131, v210, v211
 v_mfma_f32_16x16x32_bf16 v[40:43], a[200:203], v[176:179], v[40:43]
 v_exp_f32 v212, v212
 v_mfma_f32_16x16x32_bf16 v[72:75], a[200:203], v[184:187], v[72:75]
 v_exp_f32 v213, v213
 v_mfma_f32_16x16x32_bf16 v[72:75], a[204:207], v[188:191], v[72:75]
 v_exp_f32 v214, v214
 v_mfma_f32_16x16x32_bf16 v[104:107], a[204:207], v[196:199], v[104:107]
 v_exp_f32 v215, v215
 v_mfma_f32_16x16x32_bf16 v[104:107], a[200:203], v[192:195], v[104:107]
 s_waitcnt lgkmcnt(6)
 ds_read_b64_tr_b16 a[200:201], v247 offset:32832
 v_cvt_pk_bf16_f32 v138, v212, v213
 v_mfma_f32_16x16x32_bf16 v[12:15], a[208:211], v[168:171], v[12:15]
 s_waitcnt lgkmcnt(5)
 ds_read_b64_tr_b16 a[202:203], v247 offset:33856
 v_cvt_pk_bf16_f32 v139, v214, v215
 v_mfma_f32_16x16x32_bf16 v[12:15], a[212:215], v[172:175], v[12:15]
 s_add_u32 m0, s62, 10112
 v_exp_f32 v216, v216
 v_mfma_f32_16x16x32_bf16 v[44:47], a[212:215], v[180:183], v[44:47]
 buffer_load_dwordx4 v251, s[4:7], s34 offen offset:128 lds
 v_mfma_f32_16x16x32_bf16 v[44:47], a[208:211], v[176:179], v[44:47]
 v_exp_f32 v217, v217
 v_mfma_f32_16x16x32_bf16 v[76:79], a[208:211], v[184:187], v[76:79]
 v_exp_f32 v218, v218
 v_mfma_f32_16x16x32_bf16 v[76:79], a[212:215], v[188:191], v[76:79]
 v_exp_f32 v219, v219
 v_mfma_f32_16x16x32_bf16 v[108:111], a[212:215], v[196:199], v[108:111]
 ds_read_b64_tr_b16 a[204:205], v247 offset:34880
 v_cvt_pk_bf16_f32 v146, v216, v217
 v_mfma_f32_16x16x32_bf16 v[108:111], a[208:211], v[192:195], v[108:111]
 ds_read_b64_tr_b16 a[206:207], v247 offset:35904
 v_cvt_pk_bf16_f32 v147, v218, v219
 v_mfma_f32_16x16x32_bf16 a[116:119], a[132:135], v[176:179], a[116:119]
 v_exp_f32 v220, v220
 v_mfma_f32_16x16x32_bf16 a[116:119], a[132:135], v[180:183], a[116:119]
 s_waitcnt lgkmcnt(7)
 v_exp_f32 v221, v221
 v_mfma_f32_16x16x32_bf16 v[208:211], a[136:139], a[32:35], v[224:227]
 s_waitcnt lgkmcnt(6)
 v_exp_f32 v222, v222
 v_mfma_f32_16x16x32_bf16 v[208:211], a[140:143], a[36:39], v[208:211]
 s_waitcnt lgkmcnt(5)
 v_exp_f32 v223, v223
 v_mfma_f32_16x16x32_bf16 v[208:211], a[144:147], a[40:43], v[208:211]
 s_waitcnt lgkmcnt(4)
 ds_read_b64_tr_b16 a[208:209], v247 offset:32840
 v_cvt_pk_bf16_f32 v154, v220, v221
 v_mfma_f32_16x16x32_bf16 v[208:211], a[148:151], a[44:47], v[208:211]
 ds_read_b64_tr_b16 a[210:211], v247 offset:33864
 v_cvt_pk_bf16_f32 v155, v222, v223
 v_mfma_f32_16x16x32_bf16 v[212:215], a[148:151], a[60:63], v[228:231]
 ds_read_b64_tr_b16 a[168:169], v248 offset:32832
 ds_read_b64_tr_b16 a[170:171], v248 offset:33856
 v_mfma_f32_16x16x32_bf16 v[212:215], a[144:147], a[56:59], v[212:215]
 ds_read_b64_tr_b16 a[172:173], v248 offset:34880
 ds_read_b64_tr_b16 a[174:175], v248 offset:35904
 v_mfma_f32_16x16x32_bf16 v[212:215], a[140:143], a[52:55], v[212:215]
 ds_read_b64_tr_b16 a[176:177], v248 offset:32840
 v_mul_f32 v208, s20, v208
 v_mfma_f32_16x16x32_bf16 v[212:215], a[136:139], a[48:51], v[212:215]
 ds_read_b64_tr_b16 a[178:179], v248 offset:33864
 v_mul_f32 v209, s20, v209
 v_mfma_f32_16x16x32_bf16 v[216:219], a[136:139], a[64:67], v[232:235]
 ds_read_b64_tr_b16 a[180:181], v248 offset:34888
 v_mul_f32 v210, s20, v210
 v_mfma_f32_16x16x32_bf16 v[216:219], a[140:143], a[68:71], v[216:219]
 ds_read_b64_tr_b16 a[182:183], v248 offset:35912
 v_mul_f32 v211, s20, v211
 v_mfma_f32_16x16x32_bf16 v[216:219], a[144:147], a[72:75], v[216:219]
 ds_read_b128 a[152:155], v244 offset:37376
 v_mul_f32 v212, s20, v212
 v_mfma_f32_16x16x32_bf16 v[216:219], a[148:151], a[76:79], v[216:219]
 ds_read_b128 a[156:159], v244 offset:37440
 v_mul_f32 v213, s20, v213
 v_mfma_f32_16x16x32_bf16 v[220:223], a[148:151], a[92:95], v[236:239]
 ds_read_b128 a[160:163], v244 offset:37504
 v_mul_f32 v214, s20, v214
 v_mfma_f32_16x16x32_bf16 v[220:223], a[144:147], a[88:91], v[220:223]
 ds_read_b128 a[164:167], v244 offset:37568
 v_mul_f32 v215, s20, v215
 v_mfma_f32_16x16x32_bf16 v[220:223], a[140:143], a[84:87], v[220:223]
 ds_read_b64_tr_b16 a[212:213], v247 offset:34888
 v_mul_f32 v216, s20, v216
 v_mfma_f32_16x16x32_bf16 v[220:223], a[136:139], a[80:83], v[220:223]
 s_waitcnt lgkmcnt(15)
 ds_read_b64_tr_b16 a[214:215], v247 offset:35912
 v_mul_f32 v217, s20, v217
 v_mfma_f32_16x16x32_bf16 v[16:19], a[200:203], v[168:171], v[16:19]
 v_exp_f32 v208, v208
 v_mfma_f32_16x16x32_bf16 v[16:19], a[204:207], v[172:175], v[16:19]
 v_exp_f32 v209, v209
 v_mfma_f32_16x16x32_bf16 v[48:51], a[204:207], v[180:183], v[48:51]
 v_exp_f32 v210, v210
 v_mfma_f32_16x16x32_bf16 v[48:51], a[200:203], v[176:179], v[48:51]
 v_exp_f32 v211, v211
 v_mfma_f32_16x16x32_bf16 v[80:83], a[200:203], v[184:187], v[80:83]
 v_cvt_pk_bf16_f32 v132, v208, v209
 v_cvt_pk_bf16_f32 v133, v210, v211
 v_mfma_f32_16x16x32_bf16 v[80:83], a[204:207], v[188:191], v[80:83]
 v_exp_f32 v212, v212
 v_mfma_f32_16x16x32_bf16 v[112:115], a[204:207], v[196:199], v[112:115]
 v_exp_f32 v213, v213
 v_mfma_f32_16x16x32_bf16 v[112:115], a[200:203], v[192:195], v[112:115]
 s_waitcnt lgkmcnt(14)
 v_exp_f32 v214, v214
 v_mfma_f32_16x16x32_bf16 v[20:23], a[208:211], v[168:171], v[20:23]
 s_waitcnt vmcnt(17) lgkmcnt(0)
 ds_inc_u32 v249, v252
 v_cvt_pk_bf16_f32 v140, v212, v213
 v_mfma_f32_16x16x32_bf16 v[20:23], a[212:215], v[172:175], v[20:23]
 s_add_u32 s2, s2, 4
 v_exp_f32 v215, v215
 v_mfma_f32_16x16x32_bf16 v[52:55], a[212:215], v[180:183], v[52:55]
 v_cvt_pk_bf16_f32 v141, v214, v215
 v_mul_f32 v218, s20, v218
 v_mfma_f32_16x16x32_bf16 v[52:55], a[208:211], v[176:179], v[52:55]
 v_mul_f32 v219, s20, v219
 v_mul_f32 v220, s20, v220
 v_mfma_f32_16x16x32_bf16 v[84:87], a[208:211], v[184:187], v[84:87]
 v_exp_f32 v216, v216
 v_mfma_f32_16x16x32_bf16 v[84:87], a[212:215], v[188:191], v[84:87]
 v_exp_f32 v217, v217
 v_mfma_f32_16x16x32_bf16 v[116:119], a[212:215], v[196:199], v[116:119]
 v_exp_f32 v218, v218
 v_mfma_f32_16x16x32_bf16 v[116:119], a[208:211], v[192:195], v[116:119]
 v_exp_f32 v219, v219
 v_mfma_f32_16x16x32_bf16 a[120:123], a[132:135], v[184:187], a[120:123]
 v_cvt_pk_bf16_f32 v148, v216, v217
 v_cvt_pk_bf16_f32 v149, v218, v219
 v_mfma_f32_16x16x32_bf16 a[120:123], a[132:135], v[188:191], a[120:123]
 v_mul_f32 v221, s20, v221
 v_mul_f32 v222, s20, v222
 v_mfma_f32_16x16x32_bf16 v[208:211], a[152:155], a[32:35], v[224:227]
 v_exp_f32 v220, v220
 v_mfma_f32_16x16x32_bf16 v[208:211], a[156:159], a[36:39], v[208:211]
 v_exp_f32 v221, v221
 v_mfma_f32_16x16x32_bf16 v[208:211], a[160:163], a[40:43], v[208:211]
 v_mul_f32 v223, s20, v223
 v_cvt_pk_bf16_f32 v156, v220, v221
 v_mfma_f32_16x16x32_bf16 v[208:211], a[164:167], a[44:47], v[208:211]
 v_exp_f32 v222, v222
 v_mfma_f32_16x16x32_bf16 v[212:215], a[164:167], a[60:63], v[228:231]
 v_exp_f32 v223, v223
 v_mfma_f32_16x16x32_bf16 v[212:215], a[160:163], a[56:59], v[212:215]
 v_cvt_pk_bf16_f32 v157, v222, v223
 v_mfma_f32_16x16x32_bf16 v[212:215], a[156:159], a[52:55], v[212:215]
 v_mfma_f32_16x16x32_bf16 v[212:215], a[152:155], a[48:51], v[212:215]
 v_mfma_f32_16x16x32_bf16 v[216:219], a[152:155], a[64:67], v[232:235]
 v_mul_f32 v208, s20, v208
 v_mul_f32 v209, s20, v209
 v_mfma_f32_16x16x32_bf16 v[216:219], a[156:159], a[68:71], v[216:219]
 v_mul_f32 v210, s20, v210
 v_mul_f32 v211, s20, v211
 v_mfma_f32_16x16x32_bf16 v[216:219], a[160:163], a[72:75], v[216:219]
 v_exp_f32 v208, v208
 v_mfma_f32_16x16x32_bf16 v[216:219], a[164:167], a[76:79], v[216:219]
 ds_read_b32 v159, v249
 v_mul_f32 v212, s20, v212
 v_mfma_f32_16x16x32_bf16 v[220:223], a[164:167], a[92:95], v[236:239]
 v_exp_f32 v209, v209
 v_mfma_f32_16x16x32_bf16 v[220:223], a[160:163], a[88:91], v[220:223]
 v_exp_f32 v210, v210
 v_mfma_f32_16x16x32_bf16 v[220:223], a[156:159], a[84:87], v[220:223]
 v_exp_f32 v211, v211
 v_mfma_f32_16x16x32_bf16 v[220:223], a[152:155], a[80:83], v[220:223]
 v_cvt_pk_bf16_f32 v134, v208, v209
 v_cvt_pk_bf16_f32 v135, v210, v211
 v_mfma_f32_16x16x32_bf16 v[24:27], a[168:171], v[168:171], v[24:27]
 v_mul_f32 v213, s20, v213
 v_mul_f32 v214, s20, v214
 v_mfma_f32_16x16x32_bf16 v[24:27], a[172:175], v[172:175], v[24:27]
 v_mul_f32 v215, s20, v215
 v_mul_f32 v216, s20, v216
 v_mfma_f32_16x16x32_bf16 v[56:59], a[172:175], v[180:183], v[56:59]
 s_waitcnt lgkmcnt(0)
 v_cmp_gt_u32 vcc, s2, v159
 v_mul_f32 v217, s20, v217
 v_mfma_f32_16x16x32_bf16 v[56:59], a[168:171], v[176:179], v[56:59]
 s_add_u32 s37, s28, 32768
 v_exp_f32 v212, v212
 v_mfma_f32_16x16x32_bf16 v[88:91], a[168:171], v[184:187], v[88:91]
 s_cbranch_vccnz Lspin4_6
Lback4_6:
 ds_read_b128 a[136:139], v244 offset:50944
 v_mul_f32 v218, s20, v218
 v_mfma_f32_16x16x32_bf16 v[88:91], a[172:175], v[188:191], v[88:91]
 s_add_u32 m0, s22, 34304
 ds_read_b128 a[140:143], v244 offset:51008
 v_mul_f32 v219, s20, v219
 v_mfma_f32_16x16x32_bf16 v[120:123], a[172:175], v[196:199], v[120:123]
 buffer_load_dwordx4 v249, s[8:11], s37 offen offset:0 lds
 v_mfma_f32_16x16x32_bf16 v[120:123], a[168:171], v[192:195], v[120:123]
 ds_read_b128 a[144:147], v244 offset:51072
 v_mul_f32 v220, s20, v220
 v_mfma_f32_16x16x32_bf16 v[28:31], a[176:179], v[168:171], v[28:31]
 ds_read_b128 a[148:151], v244 offset:51136
 v_mul_f32 v221, s20, v221
 v_mfma_f32_16x16x32_bf16 v[28:31], a[180:183], v[172:175], v[28:31]
 v_exp_f32 v213, v213
 v_mfma_f32_16x16x32_bf16 v[60:63], a[180:183], v[180:183], v[60:63]
 v_exp_f32 v214, v214
 v_mfma_f32_16x16x32_bf16 v[60:63], a[176:179], v[176:179], v[60:63]
 v_exp_f32 v215, v215
 v_mfma_f32_16x16x32_bf16 v[92:95], a[176:179], v[184:187], v[92:95]
 ds_read_b64_tr_b16 a[200:201], v245 offset:0
 v_cvt_pk_bf16_f32 v142, v212, v213
 v_mfma_f32_16x16x32_bf16 v[92:95], a[180:183], v[188:191], v[92:95]
 ds_read_b64_tr_b16 a[202:203], v245 offset:1024
 v_cvt_pk_bf16_f32 v143, v214, v215
 v_mfma_f32_16x16x32_bf16 v[124:127], a[180:183], v[196:199], v[124:127]
 v_exp_f32 v216, v216
 v_mfma_f32_16x16x32_bf16 v[124:127], a[176:179], v[192:195], v[124:127]
 v_exp_f32 v217, v217
 v_mfma_f32_16x16x32_bf16 a[124:127], a[132:135], v[192:195], a[124:127]
 v_exp_f32 v218, v218
 v_mfma_f32_16x16x32_bf16 a[124:127], a[132:135], v[196:199], a[124:127]
 s_waitcnt lgkmcnt(5)
 buffer_load_dwordx4 v249, s[8:11], s37 offen offset:1024 lds
 v_mfma_f32_16x16x32_bf16 v[208:211], a[136:139], a[32:35], v[224:227]
 s_waitcnt lgkmcnt(4)
 v_exp_f32 v219, v219
 v_mfma_f32_16x16x32_bf16 v[208:211], a[140:143], a[36:39], v[208:211]
 s_waitcnt lgkmcnt(3)
 ds_read_b64_tr_b16 a[204:205], v245 offset:2048
 v_cvt_pk_bf16_f32 v150, v216, v217
 v_mfma_f32_16x16x32_bf16 v[208:211], a[144:147], a[40:43], v[208:211]
 s_waitcnt lgkmcnt(3)
 ds_read_b64_tr_b16 a[206:207], v245 offset:3072
 v_cvt_pk_bf16_f32 v151, v218, v219
 v_mfma_f32_16x16x32_bf16 v[208:211], a[148:151], a[44:47], v[208:211]
 ds_read_b64_tr_b16 a[208:209], v245 offset:8
 v_mul_f32 v222, s20, v222
 v_mfma_f32_16x16x32_bf16 v[212:215], a[148:151], a[60:63], v[228:231]
 ds_read_b64_tr_b16 a[210:211], v245 offset:1032
 v_mul_f32 v223, s20, v223
 v_mfma_f32_16x16x32_bf16 v[212:215], a[144:147], a[56:59], v[212:215]
 v_exp_f32 v220, v220
 v_mfma_f32_16x16x32_bf16 v[212:215], a[140:143], a[52:55], v[212:215]
 v_exp_f32 v221, v221
 v_mfma_f32_16x16x32_bf16 v[212:215], a[136:139], a[48:51], v[212:215]
 v_exp_f32 v222, v222
 v_mfma_f32_16x16x32_bf16 v[216:219], a[136:139], a[64:67], v[232:235]
 v_exp_f32 v223, v223
 v_mfma_f32_16x16x32_bf16 v[216:219], a[140:143], a[68:71], v[216:219]
 ds_read_b64_tr_b16 a[212:213], v245 offset:2056
 v_cvt_pk_bf16_f32 v158, v220, v221
 v_mfma_f32_16x16x32_bf16 v[216:219], a[144:147], a[72:75], v[216:219]
 ds_read_b64_tr_b16 a[214:215], v245 offset:3080
 v_cvt_pk_bf16_f32 v159, v222, v223
 v_mfma_f32_16x16x32_bf16 v[216:219], a[148:151], a[76:79], v[216:219]
 buffer_load_dwordx4 v249, s[8:11], s37 offen offset:2048 lds
 v_pk_mul_f32 v[208:209], v[208:209], s[20:21]
 v_pk_mul_f32 v[210:211], v[210:211], s[20:21]
 v_pk_mul_f32 v[212:213], v[212:213], s[20:21]
 v_pk_mul_f32 v[214:215], v[214:215], s[20:21]
 v_exp_f32 v208, v208
 v_mfma_f32_16x16x32_bf16 v[220:223], a[148:151], a[92:95], v[236:239]
 v_exp_f32 v209, v209
 v_mfma_f32_16x16x32_bf16 v[220:223], a[144:147], a[88:91], v[220:223]
 ds_read_b128 a[152:155], v244 offset:51968
 v_cvt_pk_bf16_f32 v168, v208, v209
 v_mfma_f32_16x16x32_bf16 v[220:223], a[140:143], a[84:87], v[220:223]
 ds_read_b128 a[156:159], v244 offset:52032
 v_mul_f32 v216, s20, v216
 v_mfma_f32_16x16x32_bf16 v[220:223], a[136:139], a[80:83], v[220:223]
 s_waitcnt lgkmcnt(8)
 buffer_store_dwordx4 a[248:251], v255, s[16:19], s61 offen offset:0 nt
 buffer_store_dwordx4 a[252:255], v255, s[16:19], s61 offen offset:2048 nt
 v_mfma_f32_16x16x32_bf16 v[0:3], a[200:203], v[128:131], v[0:3]
 s_waitcnt lgkmcnt(6)
 ds_read_b128 a[160:163], v244 offset:52096
 v_mul_f32 v217, s20, v217
 v_mfma_f32_16x16x32_bf16 v[0:3], a[204:207], v[132:135], v[0:3]
 ds_read_b128 a[164:167], v244 offset:52160
 v_mul_f32 v218, s20, v218
 v_mfma_f32_16x16x32_bf16 v[32:35], a[204:207], v[140:143], v[32:35]
 v_exp_f32 v210, v210
 v_mfma_f32_16x16x32_bf16 v[32:35], a[200:203], v[136:139], v[32:35]
 v_exp_f32 v211, v211
 v_mfma_f32_16x16x32_bf16 v[64:67], a[200:203], v[144:147], v[64:67]
 v_cvt_pk_bf16_f32 v169, v210, v211
 v_mul_f32 v219, s20, v219
 v_mfma_f32_16x16x32_bf16 v[64:67], a[204:207], v[148:151], v[64:67]
 buffer_load_dwordx4 v249, s[8:11], s37 offen offset:3072 lds
 v_mfma_f32_16x16x32_bf16 v[96:99], a[204:207], v[156:159], v[96:99]
 v_exp_f32 v212, v212
 v_mfma_f32_16x16x32_bf16 v[96:99], a[200:203], v[152:155], v[96:99]
 s_waitcnt lgkmcnt(6)
 v_exp_f32 v213, v213
 v_mfma_f32_16x16x32_bf16 v[4:7], a[208:211], v[128:131], v[4:7]
 s_waitcnt lgkmcnt(4)
 v_exp_f32 v214, v214
 v_mfma_f32_16x16x32_bf16 v[4:7], a[212:215], v[132:135], v[4:7]
 v_exp_f32 v215, v215
 v_mfma_f32_16x16x32_bf16 v[36:39], a[212:215], v[140:143], v[36:39]
 ds_read_b64_tr_b16 a[200:201], v246 offset:0
 v_cvt_pk_bf16_f32 v176, v212, v213
 v_mfma_f32_16x16x32_bf16 v[36:39], a[208:211], v[136:139], v[36:39]
 ds_read_b64_tr_b16 a[202:203], v246 offset:1024
 v_cvt_pk_bf16_f32 v177, v214, v215
 v_mfma_f32_16x16x32_bf16 v[68:71], a[208:211], v[144:147], v[68:71]
 s_add_u32 s38, s28, 32768
 v_exp_f32 v216, v216
 v_mfma_f32_16x16x32_bf16 v[68:71], a[212:215], v[148:151], v[68:71]
 s_add_u32 m0, s23, 32832
 v_exp_f32 v217, v217
 v_mfma_f32_16x16x32_bf16 v[100:103], a[212:215], v[156:159], v[100:103]
 v_exp_f32 v218, v218
 v_mfma_f32_16x16x32_bf16 v[100:103], a[208:211], v[152:155], v[100:103]
 v_exp_f32 v219, v219
 v_mfma_f32_16x16x32_bf16 a[112:115], a[132:135], v[128:131], a[112:115]
 buffer_load_dwordx4 v250, s[12:15], s38 offen offset:0 lds
 v_mfma_f32_16x16x32_bf16 a[112:115], a[132:135], v[132:135], a[112:115]
 s_waitcnt lgkmcnt(5)
 ds_read_b64_tr_b16 a[204:205], v246 offset:2048
 v_cvt_pk_bf16_f32 v184, v216, v217
 v_mfma_f32_16x16x32_bf16 v[208:211], a[152:155], a[32:35], v[224:227]
 s_waitcnt lgkmcnt(5)
 ds_read_b64_tr_b16 a[206:207], v246 offset:3072
 v_cvt_pk_bf16_f32 v185, v218, v219
 v_mfma_f32_16x16x32_bf16 v[208:211], a[156:159], a[36:39], v[208:211]
 s_waitcnt lgkmcnt(5)
 ds_read_b64_tr_b16 a[208:209], v246 offset:8
 v_mul_f32 v220, s20, v220
 v_mfma_f32_16x16x32_bf16 v[208:211], a[160:163], a[40:43], v[208:211]
 s_waitcnt lgkmcnt(5)
 ds_read_b64_tr_b16 a[210:211], v246 offset:1032
 v_mul_f32 v221, s20, v221
 v_mfma_f32_16x16x32_bf16 v[208:211], a[164:167], a[44:47], v[208:211]
 ds_read_b64_tr_b16 a[212:213], v246 offset:2056
 v_mul_f32 v222, s20, v222
 v_mfma_f32_16x16x32_bf16 v[212:215], a[164:167], a[60:63], v[228:231]
 ds_read_b64_tr_b16 a[214:215], v246 offset:3080
 v_mul_f32 v223, s20, v223
 v_mfma_f32_16x16x32_bf16 v[212:215], a[160:163], a[56:59], v[212:215]
 v_exp_f32 v220, v220
 v_mfma_f32_16x16x32_bf16 v[212:215], a[156:159], a[52:55], v[212:215]
 v_exp_f32 v221, v221
 v_mfma_f32_16x16x32_bf16 v[212:215], a[152:155], a[48:51], v[212:215]
 v_exp_f32 v222, v222
 v_mfma_f32_16x16x32_bf16 v[216:219], a[152:155], a[64:67], v[232:235]
 v_exp_f32 v223, v223
 v_mfma_f32_16x16x32_bf16 v[216:219], a[156:159], a[68:71], v[216:219]
 buffer_load_dwordx4 v250, s[12:15], s38 offen offset:1024 lds
 v_mfma_f32_16x16x32_bf16 v[216:219], a[160:163], a[72:75], v[216:219]
 v_cvt_pk_bf16_f32 v192, v220, v221
 v_cvt_pk_bf16_f32 v193, v222, v223
 v_mfma_f32_16x16x32_bf16 v[216:219], a[164:167], a[76:79], v[216:219]
 ds_read_b128 a[136:139], v244 offset:52992
 v_mul_f32 v208, s20, v208
 v_mfma_f32_16x16x32_bf16 v[220:223], a[164:167], a[92:95], v[236:239]
 ds_read_b128 a[140:143], v244 offset:53056
 v_mul_f32 v209, s20, v209
 v_mfma_f32_16x16x32_bf16 v[220:223], a[160:163], a[88:91], v[220:223]
 ds_read_b128 a[144:147], v244 offset:53120
 v_mul_f32 v210, s20, v210
 v_mfma_f32_16x16x32_bf16 v[220:223], a[156:159], a[84:87], v[220:223]
 ds_read_b128 a[148:151], v244 offset:53184
 v_mul_f32 v211, s20, v211
 v_mfma_f32_16x16x32_bf16 v[220:223], a[152:155], a[80:83], v[220:223]
 s_waitcnt lgkmcnt(10)
 v_exp_f32 v208, v208
 v_mfma_f32_16x16x32_bf16 v[8:11], a[200:203], v[128:131], v[8:11]
 s_waitcnt lgkmcnt(8)
 v_exp_f32 v209, v209
 v_mfma_f32_16x16x32_bf16 v[8:11], a[204:207], v[132:135], v[8:11]
 v_exp_f32 v210, v210
 v_mfma_f32_16x16x32_bf16 v[40:43], a[204:207], v[140:143], v[40:43]
 v_exp_f32 v211, v211
 v_mfma_f32_16x16x32_bf16 v[40:43], a[200:203], v[136:139], v[40:43]
 v_cvt_pk_bf16_f32 v170, v208, v209
 v_cvt_pk_bf16_f32 v171, v210, v211
 v_mfma_f32_16x16x32_bf16 v[72:75], a[200:203], v[144:147], v[72:75]
 buffer_load_dwordx4 v250, s[12:15], s38 offen offset:2048 lds
 v_pk_mul_f32 v[212:213], v[212:213], s[20:21]
 v_pk_mul_f32 v[214:215], v[214:215], s[20:21]
 v_pk_mul_f32 v[216:217], v[216:217], s[20:21]
 v_pk_mul_f32 v[218:219], v[218:219], s[20:21]
 v_pk_mul_f32 v[220:221], v[220:221], s[20:21]
 v_pk_mul_f32 v[222:223], v[222:223], s[20:21]
 v_exp_f32 v212, v212
 v_mfma_f32_16x16x32_bf16 v[72:75], a[204:207], v[148:151], v[72:75]
 v_exp_f32 v213, v213
 v_mfma_f32_16x16x32_bf16 v[104:107], a[204:207], v[156:159], v[104:107]
 v_exp_f32 v214, v214
 v_mfma_f32_16x16x32_bf16 v[104:107], a[200:203], v[152:155], v[104:107]
 s_waitcnt lgkmcnt(6)
 v_exp_f32 v215, v215
 v_mfma_f32_16x16x32_bf16 v[12:15], a[208:211], v[128:131], v[12:15]
 s_waitcnt lgkmcnt(4)
 ds_read_b64_tr_b16 a[200:201], v247 offset:0
 v_cvt_pk_bf16_f32 v178, v212, v213
 v_mfma_f32_16x16x32_bf16 v[12:15], a[212:215], v[132:135], v[12:15]
 ds_read_b64_tr_b16 a[202:203], v247 offset:1024
 v_cvt_pk_bf16_f32 v179, v214, v215
 v_mfma_f32_16x16x32_bf16 v[44:47], a[212:215], v[140:143], v[44:47]
 v_exp_f32 v216, v216
 v_mfma_f32_16x16x32_bf16 v[44:47], a[208:211], v[136:139], v[44:47]
 v_exp_f32 v217, v217
 v_mfma_f32_16x16x32_bf16 v[76:79], a[208:211], v[144:147], v[76:79]
 v_exp_f32 v218, v218
 v_mfma_f32_16x16x32_bf16 v[76:79], a[212:215], v[148:151], v[76:79]
 v_exp_f32 v219, v219
 v_mfma_f32_16x16x32_bf16 v[108:111], a[212:215], v[156:159], v[108:111]
 ds_read_b64_tr_b16 a[204:205], v247 offset:2048
 v_cvt_pk_bf16_f32 v186, v216, v217
 v_mfma_f32_16x16x32_bf16 v[108:111], a[208:211], v[152:155], v[108:111]
 buffer_load_dwordx4 v250, s[12:15], s38 offen offset:3072 lds
 v_mfma_f32_16x16x32_bf16 a[116:119], a[132:135], v[136:139], a[116:119]
 ds_read_b64_tr_b16 a[206:207], v247 offset:3072
 v_cvt_pk_bf16_f32 v187, v218, v219
 v_mfma_f32_16x16x32_bf16 a[116:119], a[132:135], v[140:143], a[116:119]
 s_waitcnt lgkmcnt(7)
 v_exp_f32 v220, v220
 v_mfma_f32_16x16x32_bf16 v[208:211], a[136:139], a[32:35], v[224:227]
 s_waitcnt lgkmcnt(6)
 v_exp_f32 v221, v221
 v_mfma_f32_16x16x32_bf16 v[208:211], a[140:143], a[36:39], v[208:211]
 s_waitcnt lgkmcnt(5)
 v_exp_f32 v222, v222
 v_mfma_f32_16x16x32_bf16 v[208:211], a[144:147], a[40:43], v[208:211]
 s_waitcnt lgkmcnt(4)
 v_exp_f32 v223, v223
 v_mfma_f32_16x16x32_bf16 v[208:211], a[148:151], a[44:47], v[208:211]
 ds_read_b64_tr_b16 a[208:209], v247 offset:8
 v_cvt_pk_bf16_f32 v194, v220, v221
 v_mfma_f32_16x16x32_bf16 v[212:215], a[148:151], a[60:63], v[228:231]
 ds_read_b64_tr_b16 a[210:211], v247 offset:1032
 v_cvt_pk_bf16_f32 v195, v222, v223
 v_mfma_f32_16x16x32_bf16 v[212:215], a[144:147], a[56:59], v[212:215]
 ds_read_b64_tr_b16 a[168:169], v248 offset:0
 ds_read_b64_tr_b16 a[170:171], v248 offset:1024
 v_mfma_f32_16x16x32_bf16 v[212:215], a[140:143], a[52:55], v[212:215]
 ds_read_b64_tr_b16 a[172:173], v248 offset:2048
 v_mul_f32 v208, s20, v208
 v_mfma_f32_16x16x32_bf16 v[212:215], a[136:139], a[48:51], v[212:215]
 ds_read_b64_tr_b16 a[174:175], v248 offset:3072
 v_mul_f32 v209, s20, v209
 v_mfma_f32_16x16x32_bf16 v[216:219], a[136:139], a[64:67], v[232:235]
 ds_read_b64_tr_b16 a[176:177], v248 offset:8
 v_mul_f32 v210, s20, v210
 v_mfma_f32_16x16x32_bf16 v[216:219], a[140:143], a[68:71], v[216:219]
 ds_read_b64_tr_b16 a[178:179], v248 offset:1032
 v_mul_f32 v211, s20, v211
 v_mfma_f32_16x16x32_bf16 v[216:219], a[144:147], a[72:75], v[216:219]
 ds_read_b64_tr_b16 a[180:181], v248 offset:2056
 v_mul_f32 v212, s20, v212
 v_mfma_f32_16x16x32_bf16 v[216:219], a[148:151], a[76:79], v[216:219]
 ds_read_b64_tr_b16 a[182:183], v248 offset:3080
 v_mul_f32 v213, s20, v213
 v_mfma_f32_16x16x32_bf16 v[220:223], a[148:151], a[92:95], v[236:239]
 ds_read_b128 a[152:155], v244 offset:54016
 v_mul_f32 v214, s20, v214
 v_mfma_f32_16x16x32_bf16 v[220:223], a[144:147], a[88:91], v[220:223]
 ds_read_b128 a[156:159], v244 offset:54080
 v_mul_f32 v215, s20, v215
 v_mfma_f32_16x16x32_bf16 v[220:223], a[140:143], a[84:87], v[220:223]
 ds_read_b128 a[160:163], v244 offset:54144
 v_mul_f32 v216, s20, v216
 v_mfma_f32_16x16x32_bf16 v[220:223], a[136:139], a[80:83], v[220:223]
 s_waitcnt lgkmcnt(15)
 ds_read_b128 a[164:167], v244 offset:54208
 v_mul_f32 v217, s20, v217
 v_mfma_f32_16x16x32_bf16 v[16:19], a[200:203], v[128:131], v[16:19]
 s_waitcnt lgkmcnt(14)
 ds_read_b64_tr_b16 a[212:213], v247 offset:2056
 v_mul_f32 v218, s20, v218
 ds_read_b64_tr_b16 a[214:215], v247 offset:3080
 v_mfma_f32_16x16x32_bf16 v[16:19], a[204:207], v[132:135], v[16:19]
 v_exp_f32 v208, v208
 v_mfma_f32_16x16x32_bf16 v[48:51], a[204:207], v[140:143], v[48:51]
 v_exp_f32 v209, v209
 v_mfma_f32_16x16x32_bf16 v[48:51], a[200:203], v[136:139], v[48:51]
 v_exp_f32 v210, v210
 v_mfma_f32_16x16x32_bf16 v[80:83], a[200:203], v[144:147], v[80:83]
 v_exp_f32 v211, v211
 v_mfma_f32_16x16x32_bf16 v[80:83], a[204:207], v[148:151], v[80:83]
 v_cvt_pk_bf16_f32 v172, v208, v209
 v_cvt_pk_bf16_f32 v173, v210, v211
 v_mfma_f32_16x16x32_bf16 v[112:115], a[204:207], v[156:159], v[112:115]
 v_exp_f32 v212, v212
 v_mfma_f32_16x16x32_bf16 v[112:115], a[200:203], v[152:155], v[112:115]
 s_waitcnt lgkmcnt(14)
 v_exp_f32 v213, v213
 v_mfma_f32_16x16x32_bf16 v[20:23], a[208:211], v[128:131], v[20:23]
 s_waitcnt vmcnt(10) lgkmcnt(0)
 ds_inc_u32 v249, v252
 v_cvt_pk_bf16_f32 v180, v212, v213
 v_mfma_f32_16x16x32_bf16 v[20:23], a[212:215], v[132:135], v[20:23]
 s_add_u32 s2, s2, 4
 v_exp_f32 v214, v214
 v_mfma_f32_16x16x32_bf16 v[52:55], a[212:215], v[140:143], v[52:55]
 v_exp_f32 v215, v215
 v_mfma_f32_16x16x32_bf16 v[52:55], a[208:211], v[136:139], v[52:55]
 v_cvt_pk_bf16_f32 v181, v214, v215
 v_mul_f32 v219, s20, v219
 v_mfma_f32_16x16x32_bf16 v[84:87], a[208:211], v[144:147], v[84:87]
 v_exp_f32 v216, v216
 v_mfma_f32_16x16x32_bf16 v[84:87], a[212:215], v[148:151], v[84:87]
 v_exp_f32 v217, v217
 v_mfma_f32_16x16x32_bf16 v[116:119], a[212:215], v[156:159], v[116:119]
 v_exp_f32 v218, v218
 v_mfma_f32_16x16x32_bf16 v[116:119], a[208:211], v[152:155], v[116:119]
 v_exp_f32 v219, v219
 v_mfma_f32_16x16x32_bf16 a[120:123], a[132:135], v[144:147], a[120:123]
 v_cvt_pk_bf16_f32 v188, v216, v217
 v_cvt_pk_bf16_f32 v189, v218, v219
 v_mfma_f32_16x16x32_bf16 a[120:123], a[132:135], v[148:151], a[120:123]
 v_mul_f32 v220, s20, v220
 v_mul_f32 v221, s20, v221
 v_mfma_f32_16x16x32_bf16 v[208:211], a[152:155], a[32:35], v[224:227]
 v_mul_f32 v222, s20, v222
 v_mul_f32 v223, s20, v223
 v_mfma_f32_16x16x32_bf16 v[208:211], a[156:159], a[36:39], v[208:211]
 v_exp_f32 v220, v220
 v_mfma_f32_16x16x32_bf16 v[208:211], a[160:163], a[40:43], v[208:211]
 v_exp_f32 v221, v221
 v_mfma_f32_16x16x32_bf16 v[208:211], a[164:167], a[44:47], v[208:211]
 v_exp_f32 v222, v222
 v_mfma_f32_16x16x32_bf16 v[212:215], a[164:167], a[60:63], v[228:231]
 v_exp_f32 v223, v223
 v_mfma_f32_16x16x32_bf16 v[212:215], a[160:163], a[56:59], v[212:215]
 v_cvt_pk_bf16_f32 v196, v220, v221
 v_cvt_pk_bf16_f32 v197, v222, v223
 v_mfma_f32_16x16x32_bf16 v[212:215], a[156:159], a[52:55], v[212:215]
 v_mfma_f32_16x16x32_bf16 v[212:215], a[152:155], a[48:51], v[212:215]
 v_mul_f32 v208, s20, v208
 v_mul_f32 v209, s20, v209
 v_mfma_f32_16x16x32_bf16 v[216:219], a[152:155], a[64:67], v[232:235]
 v_mul_f32 v210, s20, v210
 v_mul_f32 v211, s20, v211
 v_mfma_f32_16x16x32_bf16 v[216:219], a[156:159], a[68:71], v[216:219]
 v_exp_f32 v208, v208
 v_mfma_f32_16x16x32_bf16 v[216:219], a[160:163], a[72:75], v[216:219]
 v_exp_f32 v209, v209
 v_mfma_f32_16x16x32_bf16 v[216:219], a[164:167], a[76:79], v[216:219]
 ds_read_b32 v199, v249
 v_mul_f32 v212, s20, v212
 v_mfma_f32_16x16x32_bf16 v[220:223], a[164:167], a[92:95], v[236:239]
 v_exp_f32 v210, v210
 v_mfma_f32_16x16x32_bf16 v[220:223], a[160:163], a[88:91], v[220:223]
 v_exp_f32 v211, v211
 v_mfma_f32_16x16x32_bf16 v[220:223], a[156:159], a[84:87], v[220:223]
 v_mul_f32 v213, s20, v213
 v_mul_f32 v214, s20, v214
 v_mfma_f32_16x16x32_bf16 v[220:223], a[152:155], a[80:83], v[220:223]
 v_mul_f32 v215, s20, v215
 v_cvt_pk_bf16_f32 v174, v208, v209
 v_mfma_f32_16x16x32_bf16 v[24:27], a[168:171], v[128:131], v[24:27]
 v_exp_f32 v212, v212
 v_mfma_f32_16x16x32_bf16 v[24:27], a[172:175], v[132:135], v[24:27]
 v_exp_f32 v213, v213
 v_mfma_f32_16x16x32_bf16 v[56:59], a[172:175], v[140:143], v[56:59]
 s_waitcnt lgkmcnt(0)
 v_cmp_gt_u32 vcc, s2, v199
 v_cvt_pk_bf16_f32 v175, v210, v211
 v_mfma_f32_16x16x32_bf16 v[56:59], a[168:171], v[136:139], v[56:59]
 s_add_u32 s38, s28, 0
 v_exp_f32 v214, v214
 v_mfma_f32_16x16x32_bf16 v[88:91], a[168:171], v[144:147], v[88:91]
 s_cbranch_vccnz Lspin4_7
Lback4_7:
 ds_read_b64_tr_b16 a[200:201], v245 offset:16416
 v_cvt_pk_bf16_f32 v182, v212, v213
 v_mfma_f32_16x16x32_bf16 v[88:91], a[172:175], v[148:151], v[88:91]
 s_add_u32 m0, s23, 0
 ds_read_b64_tr_b16 a[202:203], v245 offset:17440
 v_mul_f32 v216, s20, v216
 v_mfma_f32_16x16x32_bf16 v[120:123], a[172:175], v[156:159], v[120:123]
 buffer_load_dwordx4 v250, s[12:15], s38 offen offset:0 lds
 v_exp_f32 v215, v215
 v_pk_mul_f32 v[218:219], v[218:219], s[20:21]
 v_pk_mul_f32 v[220:221], v[220:221], s[20:21]
 v_pk_mul_f32 v[222:223], v[222:223], s[20:21]
 v_cvt_pk_bf16_f32 v183, v214, v215
 v_mfma_f32_16x16x32_bf16 v[120:123], a[168:171], v[152:155], v[120:123]
 ds_read_b64_tr_b16 a[204:205], v245 offset:18464
 v_mul_f32 v217, s20, v217
 v_mfma_f32_16x16x32_bf16 v[28:31], a[176:179], v[128:131], v[28:31]
 v_exp_f32 v216, v216
 v_mfma_f32_16x16x32_bf16 v[28:31], a[180:183], v[132:135], v[28:31]
 ds_read_b64_tr_b16 a[206:207], v245 offset:19488
 ds_read_b64_tr_b16 a[208:209], v245 offset:16424
 v_mfma_f32_16x16x32_bf16 v[60:63], a[180:183], v[140:143], v[60:63]
 buffer_load_dwordx4 v250, s[12:15], s38 offen offset:1024 lds
 v_mfma_f32_16x16x32_bf16 v[60:63], a[176:179], v[136:139], v[60:63]
 v_exp_f32 v217, v217
 v_mfma_f32_16x16x32_bf16 v[92:95], a[176:179], v[144:147], v[92:95]
 v_exp_f32 v218, v218
 v_mfma_f32_16x16x32_bf16 v[92:95], a[180:183], v[148:151], v[92:95]
 v_exp_f32 v219, v219
 v_mfma_f32_16x16x32_bf16 v[124:127], a[180:183], v[156:159], v[124:127]
 buffer_load_dwordx4 v250, s[12:15], s38 offen offset:2048 lds
 v_mfma_f32_16x16x32_bf16 v[124:127], a[176:179], v[152:155], v[124:127]
 v_exp_f32 v220, v220
 v_mfma_f32_16x16x32_bf16 a[124:127], a[132:135], v[152:155], a[124:127]
 v_exp_f32 v221, v221
 v_mfma_f32_16x16x32_bf16 a[124:127], a[132:135], v[156:159], a[124:127]
 s_waitcnt lgkmcnt(3)
 v_exp_f32 v222, v222
 v_mfma_f32_16x16x32_bf16 v[0:3], a[200:203], v[168:171], v[0:3]
 s_waitcnt lgkmcnt(1)
 buffer_load_dwordx4 v250, s[12:15], s38 offen offset:3072 lds
 v_mfma_f32_16x16x32_bf16 v[0:3], a[204:207], v[172:175], v[0:3]
 s_mov_b32 s27, s28
 v_exp_f32 v223, v223
 v_mfma_f32_16x16x32_bf16 v[32:35], a[204:207], v[180:183], v[32:35]
 s_mov_b32 s50, s40
 ds_read_b64_tr_b16 a[210:211], v245 offset:17448
 v_cvt_pk_bf16_f32 v190, v216, v217
 v_mfma_f32_16x16x32_bf16 v[32:35], a[200:203], v[176:179], v[32:35]
 s_mov_b32 s51, s41
 ds_read_b64_tr_b16 a[212:213], v245 offset:18472
 v_cvt_pk_bf16_f32 v191, v218, v219
 v_mfma_f32_16x16x32_bf16 v[64:67], a[200:203], v[184:187], v[64:67]
 s_mov_b32 s60, s42
 ds_read_b64_tr_b16 a[214:215], v245 offset:19496
 v_cvt_pk_bf16_f32 v198, v220, v221
 v_cvt_pk_bf16_f32 v199, v222, v223
 v_mfma_f32_16x16x32_bf16 v[64:67], a[204:207], v[188:191], v[64:67]
 s_mov_b32 s61, s43
 ds_read_b128 a[32:35], v252 offset:0
 ds_read_b128 a[36:39], v252 offset:1024
 v_mfma_f32_16x16x32_bf16 v[96:99], a[204:207], v[196:199], v[96:99]
 s_mov_b32 s3, 117440512
 ds_read_b64_tr_b16 a[204:205], v246 offset:18464
 ds_read_b64_tr_b16 a[206:207], v246 offset:19488
 v_mfma_f32_16x16x32_bf16 v[96:99], a[200:203], v[192:195], v[96:99]
 ds_read_b64_tr_b16 a[200:201], v246 offset:16416
 ds_read_b64_tr_b16 a[202:203], v246 offset:17440
 v_mfma_f32_16x16x32_bf16 a[112:115], a[132:135], v[168:171], a[112:115]
 ds_read_b128 a[136:139], v244 offset:1024
 ds_read_b128 a[140:143], v244 offset:1088
 v_mfma_f32_16x16x32_bf16 a[112:115], a[132:135], v[172:175], a[112:115]
 ds_read_b128 a[144:147], v244 offset:1152
 ds_read_b128 a[148:151], v244 offset:1216
 v_mfma_f32_16x16x32_bf16 a[116:119], a[132:135], v[176:179], a[116:119]
 ds_read_b128 a[152:155], v244 offset:2048
 ds_read_b128 a[40:43], v252 offset:2048
 v_mfma_f32_16x16x32_bf16 a[116:119], a[132:135], v[180:183], a[116:119]
 buffer_load_dwordx4 a[76:79], v251, s[4:7], s34 offen offset:192
 v_mfma_f32_16x16x32_bf16 a[120:123], a[132:135], v[184:187], a[120:123]
 ds_read_b128 a[156:159], v244 offset:2112
 v_accvgpr_read_b32 v226, a112
 v_mfma_f32_16x16x32_bf16 a[120:123], a[132:135], v[188:191], a[120:123]
 v_rcp_f32 v224, v226
 v_mfma_f32_16x16x32_bf16 a[124:127], a[132:135], v[192:195], a[124:127]
 ds_read_b128 a[160:163], v244 offset:2176
 v_mov_b32 v225, v224
 v_mfma_f32_16x16x32_bf16 a[124:127], a[132:135], v[196:199], a[124:127]
 s_waitcnt lgkmcnt(15)
 ds_read_b128 a[164:167], v244 offset:2240
 v_accvgpr_read_b32 v230, a116
 v_mfma_f32_16x16x32_bf16 v[4:7], a[208:211], v[168:171], v[4:7]
 s_waitcnt lgkmcnt(15)
 ds_read_b128 a[168:171], v244 offset:3072
 v_accvgpr_read_b32 v234, a120
 v_mfma_f32_16x16x32_bf16 v[4:7], a[212:215], v[172:175], v[4:7]
 ds_read_b128 a[172:175], v244 offset:3136
 v_accvgpr_read_b32 v238, a124
 v_mfma_f32_16x16x32_bf16 v[36:39], a[212:215], v[180:183], v[36:39]
 ds_read_b128 a[176:179], v244 offset:3200
 v_add_f32 v209, v226, v224
 v_mfma_f32_16x16x32_bf16 v[36:39], a[208:211], v[176:179], v[36:39]
 ds_read_b128 a[180:183], v244 offset:3264
 v_add_f32 v209, v230, v209
 v_mfma_f32_16x16x32_bf16 v[68:71], a[208:211], v[184:187], v[68:71]
 ds_read_b128 a[184:187], v244 offset:4096
 v_mul_f32 v6, v224, v6
 v_mfma_f32_16x16x32_bf16 v[68:71], a[212:215], v[188:191], v[68:71]
 ds_read_b128 a[188:191], v244 offset:4160
 v_mul_f32 v7, v225, v7
 v_mfma_f32_16x16x32_bf16 v[100:103], a[212:215], v[196:199], v[100:103]
 buffer_load_dwordx4 a[80:83], v251, s[4:7], s35 offen offset:0
 v_mfma_f32_16x16x32_bf16 v[100:103], a[208:211], v[192:195], v[100:103]
 s_waitcnt lgkmcnt(15)
 ds_read_b64_tr_b16 a[208:209], v246 offset:16424
 v_cvt_pk_bf16_f32 v7, v6, v7
 ds_read_b64_tr_b16 a[210:211], v246 offset:17448
 v_mfma_f32_16x16x32_bf16 v[8:11], a[200:203], v[168:171], v[8:11]
 buffer_load_dwordx4 a[84:87], v251, s[4:7], s35 offen offset:64
 ds_read_b64_tr_b16 a[212:213], v246 offset:18472
 ds_read_b64_tr_b16 a[214:215], v246 offset:19496
 v_mfma_f32_16x16x32_bf16 v[8:11], a[204:207], v[172:175], v[8:11]
 ds_read_b128 a[192:195], v244 offset:4224
 v_mul_f32 v4, v224, v4
 v_mfma_f32_16x16x32_bf16 v[40:43], a[204:207], v[180:183], v[40:43]
 ds_read_b128 a[196:199], v244 offset:4288
 v_mul_f32 v5, v225, v5
 v_mfma_f32_16x16x32_bf16 v[40:43], a[200:203], v[176:179], v[40:43]
 ds_read_b128 a[44:47], v252 offset:3072
 v_cvt_pk_bf16_f32 v6, v4, v5
 v_rcp_f32 v228, v230
 v_rcp_f32 v232, v234
 v_pk_mul_f32 v[0:1], v[0:1], v[224:225]
 v_pk_mul_f32 v[2:3], v[2:3], v[224:225]
 v_pk_mul_f32 v[8:9], v[8:9], v[224:225]
 v_pk_mul_f32 v[10:11], v[10:11], v[224:225]
 v_rcp_f32 v236, v238
 v_mfma_f32_16x16x32_bf16 v[72:75], a[200:203], v[184:187], v[72:75]
 ds_read_b128 a[48:51], v252 offset:4096
 v_mov_b32 v229, v228
 v_mfma_f32_16x16x32_bf16 v[72:75], a[204:207], v[188:191], v[72:75]
 ds_read_b128 a[52:55], v252 offset:5120
 v_mov_b32 v233, v232
 v_mfma_f32_16x16x32_bf16 v[104:107], a[204:207], v[196:199], v[104:107]
 ds_read_b64_tr_b16 a[204:205], v247 offset:18464
 v_mov_b32 v237, v236
 v_mfma_f32_16x16x32_bf16 v[104:107], a[200:203], v[192:195], v[104:107]
 s_waitcnt lgkmcnt(8)
 ds_read_b64_tr_b16 a[200:201], v247 offset:16416
 v_add_f32 v209, v228, v209
 ds_read_b64_tr_b16 a[202:203], v247 offset:17440
 v_mfma_f32_16x16x32_bf16 v[12:15], a[208:211], v[168:171], v[12:15]
 s_waitcnt lgkmcnt(8)
 ds_read_b64_tr_b16 a[206:207], v247 offset:19488
 v_add_f32 v209, v234, v209
 v_mfma_f32_16x16x32_bf16 v[12:15], a[212:215], v[172:175], v[12:15]
 ds_read_b128 a[56:59], v252 offset:6144
 v_add_f32 v209, v232, v209
 v_mfma_f32_16x16x32_bf16 v[44:47], a[212:215], v[180:183], v[44:47]
 buffer_load_dwordx4 a[88:91], v251, s[4:7], s35 offen offset:128
 v_mfma_f32_16x16x32_bf16 v[44:47], a[208:211], v[176:179], v[44:47]
 ds_read_b128 a[60:63], v252 offset:7168
 v_add_f32 v209, v238, v209
 v_add_f32 v209, v236, v209
 v_cmp_ngt_f32 vcc, s39, v209
 v_cvt_pk_bf16_f32 v4, v0, v1
 v_pk_mul_f32 v[14:15], v[14:15], v[224:225]
 v_pk_mul_f32 v[12:13], v[12:13], v[224:225]
 v_pk_mul_f32 v[38:39], v[38:39], v[228:229]
 v_pk_mul_f32 v[36:37], v[36:37], v[228:229]
 v_pk_mul_f32 v[32:33], v[32:33], v[228:229]
 v_pk_mul_f32 v[34:35], v[34:35], v[228:229]
 v_pk_mul_f32 v[46:47], v[46:47], v[228:229]
 v_pk_mul_f32 v[44:45], v[44:45], v[228:229]
 v_pk_mul_f32 v[40:41], v[40:41], v[228:229]
 v_pk_mul_f32 v[42:43], v[42:43], v[228:229]
 v_pk_mul_f32 v[70:71], v[70:71], v[232:233]
 v_pk_mul_f32 v[68:69], v[68:69], v[232:233]
 v_pk_mul_f32 v[64:65], v[64:65], v[232:233]
 v_pk_mul_f32 v[66:67], v[66:67], v[232:233]
 v_pk_mul_f32 v[72:73], v[72:73], v[232:233]
 v_pk_mul_f32 v[74:75], v[74:75], v[232:233]
 v_pk_mul_f32 v[102:103], v[102:103], v[236:237]
 v_pk_mul_f32 v[100:101], v[100:101], v[236:237]
 v_pk_mul_f32 v[96:97], v[96:97], v[236:237]
 v_pk_mul_f32 v[98:99], v[98:99], v[236:237]
 v_pk_mul_f32 v[104:105], v[104:105], v[236:237]
 v_pk_mul_f32 v[106:107], v[106:107], v[236:237]
 v_cvt_pk_bf16_f32 v5, v2, v3
 v_mfma_f32_16x16x32_bf16 v[76:79], a[208:211], v[184:187], v[76:79]
 s_cmp_lg_u64 vcc, 0
 buffer_load_dwordx4 a[92:95], v251, s[4:7], s35 offen offset:192
 v_mfma_f32_16x16x32_bf16 v[76:79], a[212:215], v[188:191], v[76:79]
 s_cselect_b32 s63, s63, 0
 ds_read_b128 a[64:67], v252 offset:8192
 v_cvt_pk_bf16_f32 v15, v14, v15
 v_mfma_f32_16x16x32_bf16 v[108:111], a[212:215], v[196:199], v[108:111]
 s_or_b32 s45, s45, s63
 ds_read_b64_tr_b16 a[212:213], v247 offset:18472
 v_cvt_pk_bf16_f32 v14, v12, v13
 v_mfma_f32_16x16x32_bf16 v[108:111], a[208:211], v[192:195], v[108:111]
 s_waitcnt lgkmcnt(5)
 ds_read_b64_tr_b16 a[208:209], v247 offset:16424
 v_cvt_pk_bf16_f32 v12, v8, v9
 ds_read_b64_tr_b16 a[210:211], v247 offset:17448
 v_mfma_f32_16x16x32_bf16 v[16:19], a[200:203], v[168:171], v[16:19]
 s_waitcnt lgkmcnt(6)
 ds_read_b64_tr_b16 a[214:215], v247 offset:19496
 v_cvt_pk_bf16_f32 v13, v10, v11
 v_mfma_f32_16x16x32_bf16 v[16:19], a[204:207], v[172:175], v[16:19]
 ds_read_b128 a[68:71], v252 offset:9216
 v_cvt_pk_bf16_f32 v39, v38, v39
 v_mfma_f32_16x16x32_bf16 v[48:51], a[204:207], v[180:183], v[48:51]
 ds_read_b128 a[72:75], v252 offset:10240
 v_cvt_pk_bf16_f32 v38, v36, v37
 v_mfma_f32_16x16x32_bf16 v[48:51], a[200:203], v[176:179], v[48:51]
 ds_write_b128 v253, v[4:7] offset:0
 v_cvt_pk_bf16_f32 v36, v32, v33
 v_pk_mul_f32 v[78:79], v[78:79], v[232:233]
 v_pk_mul_f32 v[76:77], v[76:77], v[232:233]
 v_pk_mul_f32 v[110:111], v[110:111], v[236:237]
 v_pk_mul_f32 v[108:109], v[108:109], v[236:237]
 v_pk_mul_f32 v[16:17], v[16:17], v[224:225]
 v_pk_mul_f32 v[18:19], v[18:19], v[224:225]
 v_pk_mul_f32 v[48:49], v[48:49], v[228:229]
 v_pk_mul_f32 v[50:51], v[50:51], v[228:229]
 v_cvt_pk_bf16_f32 v37, v34, v35
 v_mfma_f32_16x16x32_bf16 v[80:83], a[200:203], v[184:187], v[80:83]
 v_cvt_pk_bf16_f32 v47, v46, v47
 v_cvt_pk_bf16_f32 v71, v70, v71
 v_mfma_f32_16x16x32_bf16 v[80:83], a[204:207], v[188:191], v[80:83]
 v_cvt_pk_bf16_f32 v46, v44, v45
 v_cvt_pk_bf16_f32 v70, v68, v69
 v_mfma_f32_16x16x32_bf16 v[112:115], a[204:207], v[196:199], v[112:115]
 buffer_load_dwordx4 a[96:99], v251, s[4:7], s36 offen offset:0
 v_mfma_f32_16x16x32_bf16 v[112:115], a[200:203], v[192:195], v[112:115]
 s_waitcnt lgkmcnt(4)
 ds_read_b64_tr_b16 a[200:201], v248 offset:16416
 v_cvt_pk_bf16_f32 v44, v40, v41
 ds_read_b64_tr_b16 a[202:203], v248 offset:17440
 v_mfma_f32_16x16x32_bf16 v[20:23], a[208:211], v[168:171], v[20:23]
 s_waitcnt lgkmcnt(5)
 buffer_load_dwordx4 a[100:103], v251, s[4:7], s36 offen offset:64
 ds_read_b64_tr_b16 a[204:205], v248 offset:18464
 ds_read_b64_tr_b16 a[206:207], v248 offset:19488
 v_mfma_f32_16x16x32_bf16 v[20:23], a[212:215], v[172:175], v[20:23]
 v_cvt_pk_bf16_f32 v45, v42, v43
 v_cvt_pk_bf16_f32 v68, v64, v65
 v_mfma_f32_16x16x32_bf16 v[52:55], a[212:215], v[180:183], v[52:55]
 v_cvt_pk_bf16_f32 v69, v66, v67
 v_cvt_pk_bf16_f32 v79, v78, v79
 v_mfma_f32_16x16x32_bf16 v[52:55], a[208:211], v[176:179], v[52:55]
 ds_write_b128 v254, v[12:15] offset:0
 v_cvt_pk_bf16_f32 v78, v76, v77
 v_pk_mul_f32 v[22:23], v[22:23], v[224:225]
 v_pk_mul_f32 v[20:21], v[20:21], v[224:225]
 v_pk_mul_f32 v[80:81], v[80:81], v[232:233]
 v_pk_mul_f32 v[82:83], v[82:83], v[232:233]
 v_pk_mul_f32 v[112:113], v[112:113], v[236:237]
 v_pk_mul_f32 v[114:115], v[114:115], v[236:237]
 v_pk_mul_f32 v[54:55], v[54:55], v[228:229]
 v_pk_mul_f32 v[52:53], v[52:53], v[228:229]
 v_cvt_pk_bf16_f32 v76, v72, v73
 v_mfma_f32_16x16x32_bf16 v[84:87], a[208:211], v[184:187], v[84:87]
 ds_read_b128 a[224:227], v252 offset:0
 v_cvt_pk_bf16_f32 v77, v74, v75
 v_mfma_f32_16x16x32_bf16 v[84:87], a[212:215], v[188:191], v[84:87]
 ds_read_b128 a[228:231], v252 offset:1024
 v_cvt_pk_bf16_f32 v103, v102, v103
 v_mfma_f32_16x16x32_bf16 v[116:119], a[212:215], v[196:199], v[116:119]
 s_cmp_eq_u32 s24, 5
 ds_read_b64_tr_b16 a[212:213], v248 offset:18472
 v_cvt_pk_bf16_f32 v102, v100, v101
 v_mfma_f32_16x16x32_bf16 v[116:119], a[208:211], v[192:195], v[116:119]
 s_waitcnt lgkmcnt(6)
 ds_read_b64_tr_b16 a[208:209], v248 offset:16424
 v_cvt_pk_bf16_f32 v100, v96, v97
 ds_read_b64_tr_b16 a[210:211], v248 offset:17448
 v_mfma_f32_16x16x32_bf16 v[24:27], a[200:203], v[168:171], v[24:27]
 s_waitcnt lgkmcnt(6)
 ds_read_b64_tr_b16 a[214:215], v248 offset:19496
 v_cvt_pk_bf16_f32 v101, v98, v99
 v_mfma_f32_16x16x32_bf16 v[24:27], a[204:207], v[172:175], v[24:27]
 s_cbranch_scc1 Llast4_1
Llback4_1:
 ds_write_b128 v253, v[36:39] offset:2048
 v_mfma_f32_16x16x32_bf16 v[56:59], a[204:207], v[180:183], v[56:59]
 v_cvt_pk_bf16_f32 v111, v110, v111
 v_cvt_pk_bf16_f32 v23, v22, v23
 v_mfma_f32_16x16x32_bf16 v[56:59], a[200:203], v[176:179], v[56:59]
 buffer_load_dwordx4 a[104:107], v251, s[4:7], s36 offen offset:128
 v_cvt_pk_bf16_f32 v110, v108, v109
 v_cvt_pk_bf16_f32 v108, v104, v105
 v_pk_mul_f32 v[86:87], v[86:87], v[232:233]
 v_pk_mul_f32 v[84:85], v[84:85], v[232:233]
 v_pk_mul_f32 v[118:119], v[118:119], v[236:237]
 v_pk_mul_f32 v[116:117], v[116:117], v[236:237]
 v_pk_mul_f32 v[24:25], v[24:25], v[224:225]
 v_pk_mul_f32 v[26:27], v[26:27], v[224:225]
 v_pk_mul_f32 v[56:57], v[56:57], v[228:229]
 v_pk_mul_f32 v[58:59], v[58:59], v[228:229]
 v_cvt_pk_bf16_f32 v109, v106, v107
 v_mfma_f32_16x16x32_bf16 v[88:91], a[200:203], v[184:187], v[88:91]
 buffer_load_dwordx4 a[108:111], v251, s[4:7], s36 offen offset:192
 v_mfma_f32_16x16x32_bf16 v[88:91], a[204:207], v[188:191], v[88:91]
 v_cvt_pk_bf16_f32 v22, v20, v21
 v_cvt_pk_bf16_f32 v55, v54, v55
 v_mfma_f32_16x16x32_bf16 v[120:123], a[204:207], v[196:199], v[120:123]
 v_cvt_pk_bf16_f32 v20, v16, v17
 v_cvt_pk_bf16_f32 v21, v18, v19
 v_mfma_f32_16x16x32_bf16 v[120:123], a[200:203], v[192:195], v[120:123]
 s_waitcnt lgkmcnt(2)
 ds_write_b128 v254, v[44:47] offset:2048
 v_mfma_f32_16x16x32_bf16 v[28:31], a[208:211], v[168:171], v[28:31]
 s_waitcnt lgkmcnt(2)
 ds_read_b128 a[232:235], v252 offset:2048
 v_cvt_pk_bf16_f32 v54, v52, v53
 v_mfma_f32_16x16x32_bf16 v[28:31], a[212:215], v[172:175], v[28:31]
 ds_read_b128 a[236:239], v252 offset:3072
 v_cvt_pk_bf16_f32 v52, v48, v49
 v_mfma_f32_16x16x32_bf16 v[60:63], a[212:215], v[180:183], v[60:63]
 s_cmp_eq_u32 s24, 5
 ds_write_b128 v253, v[68:71] offset:4096
 v_mfma_f32_16x16x32_bf16 v[60:63], a[208:211], v[176:179], v[60:63]
 s_cbranch_scc1 Llast4_2
Llback4_2:
 v_cvt_pk_bf16_f32 v53, v50, v51
 v_cvt_pk_bf16_f32 v87, v86, v87
 v_cvt_pk_bf16_f32 v86, v84, v85
 v_cvt_pk_bf16_f32 v84, v80, v81
 v_cvt_pk_bf16_f32 v85, v82, v83
 v_pk_mul_f32 v[30:31], v[30:31], v[224:225]
 v_pk_mul_f32 v[28:29], v[28:29], v[224:225]
 v_pk_mul_f32 v[62:63], v[62:63], v[228:229]
 v_pk_mul_f32 v[60:61], v[60:61], v[228:229]
 v_pk_mul_f32 v[88:89], v[88:89], v[232:233]
 v_pk_mul_f32 v[90:91], v[90:91], v[232:233]
 v_pk_mul_f32 v[120:121], v[120:121], v[236:237]
 v_pk_mul_f32 v[122:123], v[122:123], v[236:237]
 v_cvt_pk_bf16_f32 v119, v118, v119
 v_mfma_f32_16x16x32_bf16 v[92:95], a[208:211], v[184:187], v[92:95]
 v_cvt_pk_bf16_f32 v118, v116, v117
 v_cvt_pk_bf16_f32 v31, v30, v31
 v_mfma_f32_16x16x32_bf16 v[92:95], a[212:215], v[188:191], v[92:95]
 ds_write_b128 v254, v[76:79] offset:4096
 v_mfma_f32_16x16x32_bf16 v[124:127], a[212:215], v[196:199], v[124:127]
 ds_read_b128 a[240:243], v252 offset:4096
 v_cvt_pk_bf16_f32 v116, v112, v113
 v_mfma_f32_16x16x32_bf16 v[124:127], a[208:211], v[192:195], v[124:127]
 ds_read_b128 a[244:247], v252 offset:5120
 v_cvt_pk_bf16_f32 v117, v114, v115
 ds_write_b128 v253, v[100:103] offset:6144
 v_cvt_pk_bf16_f32 v30, v28, v29
 v_cvt_pk_bf16_f32 v28, v24, v25
 v_cvt_pk_bf16_f32 v29, v26, v27
 v_cvt_pk_bf16_f32 v63, v62, v63
 v_cvt_pk_bf16_f32 v62, v60, v61
 v_cvt_pk_bf16_f32 v60, v56, v57
 ds_write_b128 v254, v[108:111] offset:6144
 ds_read_b128 a[248:251], v252 offset:6144
 ds_read_b128 a[252:255], v252 offset:7168
 v_cvt_pk_bf16_f32 v61, v58, v59
 v_pk_mul_f32 v[94:95], v[94:95], v[232:233]
 s_cmp_eq_u32 s24, 5
 v_pk_mul_f32 v[92:93], v[92:93], v[232:233]
 v_cvt_pk_bf16_f32 v95, v94, v95
 v_cvt_pk_bf16_f32 v94, v92, v93
 s_cbranch_scc1 Llast4_3
Llback4_3:
 v_cvt_pk_bf16_f32 v92, v88, v89
 v_cvt_pk_bf16_f32 v93, v90, v91
 v_pk_mul_f32 v[126:127], v[126:127], v[236:237]
 s_cmp_eq_u32 s24, 5
 v_pk_mul_f32 v[124:125], v[124:125], v[236:237]
 v_cvt_pk_bf16_f32 v127, v126, v127
 v_cvt_pk_bf16_f32 v126, v124, v125
 s_cbranch_scc1 Llast4_4
Llback4_4:
 v_cvt_pk_bf16_f32 v124, v120, v121
 v_cvt_pk_bf16_f32 v125, v122, v123
 s_add_u32 s24, s24, 1
 s_waitcnt lgkmcnt(0)
 s_cmp_eq_u32 s24, 6
 s_cbranch_scc1 L_done
 s_cmp_eq_u32 s31, 0
 s_cbranch_scc1 L_blk4
 s_branch L_blk5
Llast5_1:
 s_waitcnt lgkmcnt(0)
 buffer_store_dwordx4 a[224:227], v255, s[16:19], s40 offen offset:0 nt
 buffer_store_dwordx4 a[228:231], v255, s[16:19], s40 offen offset:2048 nt
 s_branch Llback5_1
Llast5_2:
 s_waitcnt lgkmcnt(0)
 buffer_store_dwordx4 a[232:235], v255, s[16:19], s41 offen offset:0 nt
 buffer_store_dwordx4 a[236:239], v255, s[16:19], s41 offen offset:2048 nt
 s_branch Llback5_2
Llast5_3:
 s_waitcnt lgkmcnt(0)
 buffer_store_dwordx4 a[240:243], v255, s[16:19], s42 offen offset:0 nt
 buffer_store_dwordx4 a[244:247], v255, s[16:19], s42 offen offset:2048 nt
 s_branch Llback5_3
Llast5_4:
 s_waitcnt lgkmcnt(0)
 buffer_store_dwordx4 a[248:251], v255, s[16:19], s43 offen offset:0 nt
 buffer_store_dwordx4 a[252:255], v255, s[16:19], s43 offen offset:2048 nt
 s_branch Llback5_4
Llast4_1:
 s_waitcnt lgkmcnt(0)
 buffer_store_dwordx4 a[224:227], v255, s[16:19], s40 offen offset:0 nt
 buffer_store_dwordx4 a[228:231], v255, s[16:19], s40 offen offset:2048 nt
 s_branch Llback4_1
Llast4_2:
 s_waitcnt lgkmcnt(0)
 buffer_store_dwordx4 a[232:235], v255, s[16:19], s41 offen offset:0 nt
 buffer_store_dwordx4 a[236:239], v255, s[16:19], s41 offen offset:2048 nt
 s_branch Llback4_2
Llast4_3:
 s_waitcnt lgkmcnt(0)
 buffer_store_dwordx4 a[240:243], v255, s[16:19], s42 offen offset:0 nt
 buffer_store_dwordx4 a[244:247], v255, s[16:19], s42 offen offset:2048 nt
 s_branch Llback4_3
Llast4_4:
 s_waitcnt lgkmcnt(0)
 buffer_store_dwordx4 a[248:251], v255, s[16:19], s43 offen offset:0 nt
 buffer_store_dwordx4 a[252:255], v255, s[16:19], s43 offen offset:2048 nt
 s_branch Llback4_4
Lspin5f_1:
 ds_read_b32 v207, v249
 s_waitcnt lgkmcnt(0)
 v_cmp_gt_u32 vcc, s2, v207
 s_nop 1
 s_cbranch_vccnz Lspin5f_1
 s_branch Lback5f_1
Lspin4f_1:
 ds_read_b32 v199, v249
 s_waitcnt lgkmcnt(0)
 v_cmp_gt_u32 vcc, s2, v199
 s_nop 1
 s_cbranch_vccnz Lspin4f_1
 s_branch Lback4f_1
Lspin5_0:
 ds_read_b32 v207, v249
 s_waitcnt lgkmcnt(0)
 v_cmp_gt_u32 vcc, s2, v207
 s_nop 1
 s_cbranch_vccnz Lspin5_0
 s_branch Lback5_0
Lspin5_1:
 ds_read_b32 v207, v249
 s_waitcnt lgkmcnt(0)
 v_cmp_gt_u32 vcc, s2, v207
 s_nop 1
 s_cbranch_vccnz Lspin5_1
 s_branch Lback5_1
Lspin5_2:
 ds_read_b32 v167, v249
 s_waitcnt lgkmcnt(0)
 v_cmp_gt_u32 vcc, s2, v167
 s_nop 1
 s_cbranch_vccnz Lspin5_2
 s_branch Lback5_2
Lspin5_3:
 ds_read_b32 v207, v249
 s_waitcnt lgkmcnt(0)
 v_cmp_gt_u32 vcc, s2, v207
 s_nop 1
 s_cbranch_vccnz Lspin5_3
 s_branch Lback5_3
Lspin5_4:
 ds_read_b32 v167, v249
 s_waitcnt lgkmcnt(0)
 v_cmp_gt_u32 vcc, s2, v167
 s_nop 1
 s_cbranch_vccnz Lspin5_4
 s_branch Lback5_4
Lspin5_5:
 ds_read_b32 v207, v249
 s_waitcnt lgkmcnt(0)
 v_cmp_gt_u32 vcc, s2, v207
 s_nop 1
 s_cbranch_vccnz Lspin5_5
 s_branch Lback5_5
Lspin5_6:
 ds_read_b32 v167, v249
 s_waitcnt lgkmcnt(0)
 v_cmp_gt_u32 vcc, s2, v167
 s_nop 1
 s_cbranch_vccnz Lspin5_6
 s_branch Lback5_6
Lspin5_7:
 ds_read_b32 v207, v249
 s_waitcnt lgkmcnt(0)
 v_cmp_gt_u32 vcc, s2, v207
 s_nop 1
 s_cbranch_vccnz Lspin5_7
 s_branch Lback5_7
Lspin4_0:
 ds_read_b32 v199, v249
 s_waitcnt lgkmcnt(0)
 v_cmp_gt_u32 vcc, s2, v199
 s_nop 1
 s_cbranch_vccnz Lspin4_0
 s_branch Lback4_0
Lspin4_1:
 ds_read_b32 v199, v249
 s_waitcnt lgkmcnt(0)
 v_cmp_gt_u32 vcc, s2, v199
 s_nop 1
 s_cbranch_vccnz Lspin4_1
 s_branch Lback4_1
Lspin4_2:
 ds_read_b32 v159, v249
 s_waitcnt lgkmcnt(0)
 v_cmp_gt_u32 vcc, s2, v159
 s_nop 1
 s_cbranch_vccnz Lspin4_2
 s_branch Lback4_2
Lspin4_3:
 ds_read_b32 v199, v249
 s_waitcnt lgkmcnt(0)
 v_cmp_gt_u32 vcc, s2, v199
 s_nop 1
 s_cbranch_vccnz Lspin4_3
 s_branch Lback4_3
Lspin4_4:
 ds_read_b32 v159, v249
 s_waitcnt lgkmcnt(0)
 v_cmp_gt_u32 vcc, s2, v159
 s_nop 1
 s_cbranch_vccnz Lspin4_4
 s_branch Lback4_4
Lspin4_5:
 ds_read_b32 v199, v249
 s_waitcnt lgkmcnt(0)
 v_cmp_gt_u32 vcc, s2, v199
 s_nop 1
 s_cbranch_vccnz Lspin4_5
 s_branch Lback4_5
Lspin4_6:
 ds_read_b32 v159, v249
 s_waitcnt lgkmcnt(0)
 v_cmp_gt_u32 vcc, s2, v159
 s_nop 1
 s_cbranch_vccnz Lspin4_6
 s_branch Lback4_6
Lspin4_7:
 ds_read_b32 v199, v249
 s_waitcnt lgkmcnt(0)
 v_cmp_gt_u32 vcc, s2, v199
 s_nop 1
 s_cbranch_vccnz Lspin4_7
 s_branch Lback4_7
L_done:
 s_nop 1
 ds_write_b128 v253, v[20:23] offset:0
 ds_write_b128 v254, v[28:31] offset:0
 ds_read_b128 v[24:27], v252 offset:0
 ds_read_b128 v[28:31], v252 offset:1024
 buffer_store_dwordx4 a[216:219], v255, s[16:19], s3 offen offset:128 nt
 buffer_store_dwordx4 a[220:223], v255, s[16:19], s3 offen offset:2176 nt
 ds_write_b128 v253, v[52:55] offset:2048
 ds_write_b128 v254, v[60:63] offset:2048
 ds_read_b128 v[56:59], v252 offset:2048
 ds_read_b128 v[60:63], v252 offset:3072
 ds_write_b128 v253, v[84:87] offset:4096
 ds_write_b128 v254, v[92:95] offset:4096
 ds_read_b128 v[88:91], v252 offset:4096
 ds_read_b128 v[92:95], v252 offset:5120
 ds_write_b128 v253, v[116:119] offset:6144
 ds_write_b128 v254, v[124:127] offset:6144
 ds_read_b128 v[120:123], v252 offset:6144
 ds_read_b128 v[124:127], v252 offset:7168
 s_waitcnt lgkmcnt(0)
 buffer_store_dwordx4 v[24:27], v255, s[16:19], s50 offen offset:128 nt
 buffer_store_dwordx4 v[28:31], v255, s[16:19], s50 offen offset:2176 nt
 buffer_store_dwordx4 v[56:59], v255, s[16:19], s51 offen offset:128 nt
 buffer_store_dwordx4 v[60:63], v255, s[16:19], s51 offen offset:2176 nt
 buffer_store_dwordx4 v[88:91], v255, s[16:19], s60 offen offset:128 nt
 buffer_store_dwordx4 v[92:95], v255, s[16:19], s60 offen offset:2176 nt
 buffer_store_dwordx4 v[120:123], v255, s[16:19], s61 offen offset:128 nt
 buffer_store_dwordx4 v[124:127], v255, s[16:19], s61 offen offset:2176 nt
L_fin:
 s_waitcnt vmcnt(0)
 s_barrier
 s_cmp_eq_u32 s45, 0
 s_cbranch_scc1 L_end
 v_mbcnt_lo_u32_b32 v105, -1, 0
 v_mbcnt_hi_u32_b32 v105, -1, v105
 v_lshlrev_b32 v112, 4, v105
 v_lshrrev_b32 v106, 2, v105
 v_lshlrev_b32 v106, 8, v106
 v_and_b32 v105, 3, v105
 v_lshl_add_u32 v106, v105, 4, v106
 s_lshl_b32 s37, s100, 12
 s_sub_u32 s8, s8, s37
 s_subb_u32 s9, s9, 0
 s_mov_b32 s10, 67108864
 s_lshl_b32 s37, s100, 13
 v_add_u32 v108, s37, v106
 v_mov_b32 v100, 0x3f803f80
 v_mov_b32 v101, 0x3f803f80
 v_mov_b32 v102, 0x3f803f80
 v_mov_b32 v103, 0x3f803f80
L_slow_blk:
 s_ff1_i32_b32 s24, s45
 s_bitset0_b32 s45, s24
 s_add_u32 s55, s24, 0
 s_lshl_b32 s52, s55, 5
 s_add_u32 s52, s52, s25
 s_mul_i32 s53, s52, 43691
 s_lshr_b32 s53, s53, 17
 s_mul_i32 s54, s53, 3
 s_sub_u32 s54, s52, s54
 s_lshl_b32 s53, s53, 3
 s_add_u32 s53, s53, s26
 s_lshl_b32 s28, s53, 17
 s_mul_i32 s53, s53, 217088
 s_cmp_eq_u32 s54, 0
 s_cselect_b32 s52, s46, s47
 s_cselect_b32 s31, 1, 0
 s_cmp_eq_u32 s54, 2
 s_cselect_b32 s52, s48, s52
 s_cselect_b32 s31, s49, s31
 s_add_u32 s30, s53, s52
 s_cmp_ge_u32 s55, 6
 s_cselect_b32 s28, 67108864, s28
 s_cselect_b32 s30, 117440512, s30
 s_add_u32 s56, s31, 4
 s_mov_b32 s59, s30
L_slow_tile:
 buffer_load_dwordx4 v[0:3], v251, s[4:7], s59 offen offset:0
 buffer_load_dwordx4 v[4:7], v251, s[4:7], s59 offen offset:64
 buffer_load_dwordx4 v[8:11], v251, s[4:7], s59 offen offset:128
 buffer_load_dwordx4 v[12:15], v251, s[4:7], s59 offen offset:192
 v_mov_b32 v104, 0xff800000
 s_mov_b32 s57, s28
 s_mov_b32 s58, 32
L_slow_p1:
 buffer_load_dwordx4 v[16:19], v251, s[8:11], s57 offen offset:0
 buffer_load_dwordx4 v[20:23], v251, s[8:11], s57 offen offset:64
 buffer_load_dwordx4 v[24:27], v251, s[8:11], s57 offen offset:128
 buffer_load_dwordx4 v[28:31], v251, s[8:11], s57 offen offset:192
 s_waitcnt vmcnt(0)
 v_mfma_f32_16x16x32_bf16 v[48:51], v[16:19], v[0:3], 0
 v_mfma_f32_16x16x32_bf16 v[48:51], v[20:23], v[4:7], v[48:51]
 v_mfma_f32_16x16x32_bf16 v[48:51], v[24:27], v[8:11], v[48:51]
 v_mfma_f32_16x16x32_bf16 v[48:51], v[28:31], v[12:15], v[48:51]
 s_nop 7
 v_max3_f32 v104, v104, v48, v49
 v_max3_f32 v104, v104, v50, v51
 s_add_u32 s57, s57, 4096
 s_sub_u32 s58, s58, 1
 s_cmp_lg_u32 s58, 0
 s_cbranch_scc1 L_slow_p1
 v_mov_b32 v105, v104
 s_nop 1
 v_permlane32_swap_b32 v105, v104
 v_max_f32 v104, v105, v104
 v_mov_b32 v105, v104
 s_nop 1
 v_permlane16_swap_b32 v105, v104
 v_max_f32 v104, v105, v104
 v_mov_b32 v64, 0
 v_mov_b32 v65, 0
 v_mov_b32 v66, 0
 v_mov_b32 v67, 0
 v_mov_b32 v68, 0
 v_mov_b32 v69, 0
 v_mov_b32 v70, 0
 v_mov_b32 v71, 0
 v_mov_b32 v72, 0
 v_mov_b32 v73, 0
 v_mov_b32 v74, 0
 v_mov_b32 v75, 0
 v_mov_b32 v76, 0
 v_mov_b32 v77, 0
 v_mov_b32 v78, 0
 v_mov_b32 v79, 0
 v_mov_b32 v80, 0
 v_mov_b32 v81, 0
 v_mov_b32 v82, 0
 v_mov_b32 v83, 0
 v_mov_b32 v84, 0
 v_mov_b32 v85, 0
 v_mov_b32 v86, 0
 v_mov_b32 v87, 0
 v_mov_b32 v88, 0
 v_mov_b32 v89, 0
 v_mov_b32 v90, 0
 v_mov_b32 v91, 0
 v_mov_b32 v92, 0
 v_mov_b32 v93, 0
 v_mov_b32 v94, 0
 v_mov_b32 v95, 0
 v_mov_b32 v96, 0
 v_mov_b32 v97, 0
 v_mov_b32 v98, 0
 v_mov_b32 v99, 0
 s_mov_b32 s57, s28
 s_mov_b32 s58, 16
L_slow_p2:
 s_add_u32 s38, s57, 0
 buffer_load_dwordx4 v[16:19], v251, s[8:11], s38 offen offset:0
 buffer_load_dwordx4 v[20:23], v251, s[8:11], s38 offen offset:64
 buffer_load_dwordx4 v[24:27], v251, s[8:11], s38 offen offset:128
 buffer_load_dwordx4 v[28:31], v251, s[8:11], s38 offen offset:192
 s_add_u32 m0, s37, 0
 s_nop 0
 buffer_load_dwordx4 v112, s[12:15], s38 offen offset:0 lds
 buffer_load_dwordx4 v112, s[12:15], s38 offen offset:1024 lds
 buffer_load_dwordx4 v112, s[12:15], s38 offen offset:2048 lds
 buffer_load_dwordx4 v112, s[12:15], s38 offen offset:3072 lds
 s_add_u32 s38, s57, 4096
 buffer_load_dwordx4 v[32:35], v251, s[8:11], s38 offen offset:0
 buffer_load_dwordx4 v[36:39], v251, s[8:11], s38 offen offset:64
 buffer_load_dwordx4 v[40:43], v251, s[8:11], s38 offen offset:128
 buffer_load_dwordx4 v[44:47], v251, s[8:11], s38 offen offset:192
 s_add_u32 m0, s37, 4096
 s_nop 0
 buffer_load_dwordx4 v112, s[12:15], s38 offen offset:0 lds
 buffer_load_dwordx4 v112, s[12:15], s38 offen offset:1024 lds
 buffer_load_dwordx4 v112, s[12:15], s38 offen offset:2048 lds
 buffer_load_dwordx4 v112, s[12:15], s38 offen offset:3072 lds
 s_waitcnt vmcnt(0)
 v_mfma_f32_16x16x32_bf16 v[48:51], v[16:19], v[0:3], 0
 v_mfma_f32_16x16x32_bf16 v[48:51], v[20:23], v[4:7], v[48:51]
 v_mfma_f32_16x16x32_bf16 v[48:51], v[24:27], v[8:11], v[48:51]
 v_mfma_f32_16x16x32_bf16 v[48:51], v[28:31], v[12:15], v[48:51]
 v_mfma_f32_16x16x32_bf16 v[52:55], v[32:35], v[0:3], 0
 v_mfma_f32_16x16x32_bf16 v[52:55], v[36:39], v[4:7], v[52:55]
 v_mfma_f32_16x16x32_bf16 v[52:55], v[40:43], v[8:11], v[52:55]
 v_mfma_f32_16x16x32_bf16 v[52:55], v[44:47], v[12:15], v[52:55]
 s_nop 7
 v_sub_f32 v48, v48, v104
 v_sub_f32 v49, v49, v104
 v_sub_f32 v50, v50, v104
 v_sub_f32 v51, v51, v104
 v_sub_f32 v52, v52, v104
 v_sub_f32 v53, v53, v104
 v_sub_f32 v54, v54, v104
 v_sub_f32 v55, v55, v104
 v_mul_f32 v48, s20, v48
 v_mul_f32 v49, s20, v49
 v_mul_f32 v50, s20, v50
 v_mul_f32 v51, s20, v51
 v_mul_f32 v52, s20, v52
 v_mul_f32 v53, s20, v53
 v_mul_f32 v54, s20, v54
 v_mul_f32 v55, s20, v55
 v_exp_f32 v48, v48
 v_exp_f32 v49, v49
 v_exp_f32 v50, v50
 v_exp_f32 v51, v51
 v_exp_f32 v52, v52
 v_exp_f32 v53, v53
 v_exp_f32 v54, v54
 v_exp_f32 v55, v55
 s_nop 0
 v_cvt_pk_bf16_f32 v56, v48, v49
 v_cvt_pk_bf16_f32 v57, v50, v51
 v_cvt_pk_bf16_f32 v58, v52, v53
 v_cvt_pk_bf16_f32 v59, v54, v55
 s_nop 1
 v_mfma_f32_16x16x32_bf16 v[96:99], v[100:103], v[56:59], v[96:99]
 ds_read_b64_tr_b16 v[60:61], v108 offset:0
 ds_read_b64_tr_b16 v[62:63], v108 offset:4096
 s_waitcnt lgkmcnt(0)
 v_mfma_f32_16x16x32_bf16 v[64:67], v[60:63], v[56:59], v[64:67]
 s_nop 3
 ds_read_b64_tr_b16 v[60:61], v108 offset:8
 ds_read_b64_tr_b16 v[62:63], v108 offset:4104
 s_waitcnt lgkmcnt(0)
 v_mfma_f32_16x16x32_bf16 v[68:71], v[60:63], v[56:59], v[68:71]
 s_nop 3
 ds_read_b64_tr_b16 v[60:61], v108 offset:64
 ds_read_b64_tr_b16 v[62:63], v108 offset:4160
 s_waitcnt lgkmcnt(0)
 v_mfma_f32_16x16x32_bf16 v[72:75], v[60:63], v[56:59], v[72:75]
 s_nop 3
 ds_read_b64_tr_b16 v[60:61], v108 offset:72
 ds_read_b64_tr_b16 v[62:63], v108 offset:4168
 s_waitcnt lgkmcnt(0)
 v_mfma_f32_16x16x32_bf16 v[76:79], v[60:63], v[56:59], v[76:79]
 s_nop 3
 ds_read_b64_tr_b16 v[60:61], v108 offset:128
 ds_read_b64_tr_b16 v[62:63], v108 offset:4224
 s_waitcnt lgkmcnt(0)
 v_mfma_f32_16x16x32_bf16 v[80:83], v[60:63], v[56:59], v[80:83]
 s_nop 3
 ds_read_b64_tr_b16 v[60:61], v108 offset:136
 ds_read_b64_tr_b16 v[62:63], v108 offset:4232
 s_waitcnt lgkmcnt(0)
 v_mfma_f32_16x16x32_bf16 v[84:87], v[60:63], v[56:59], v[84:87]
 s_nop 3
 ds_read_b64_tr_b16 v[60:61], v108 offset:192
 ds_read_b64_tr_b16 v[62:63], v108 offset:4288
 s_waitcnt lgkmcnt(0)
 v_mfma_f32_16x16x32_bf16 v[88:91], v[60:63], v[56:59], v[88:91]
 s_nop 3
 ds_read_b64_tr_b16 v[60:61], v108 offset:200
 ds_read_b64_tr_b16 v[62:63], v108 offset:4296
 s_waitcnt lgkmcnt(0)
 v_mfma_f32_16x16x32_bf16 v[92:95], v[60:63], v[56:59], v[92:95]
 s_nop 3
 s_add_u32 s57, s57, 8192
 s_sub_u32 s58, s58, 1
 s_cmp_lg_u32 s58, 0
 s_cbranch_scc1 L_slow_p2
 s_nop 7
 v_rcp_f32 v105, v96
 s_nop 0
 v_mul_f32 v64, v105, v64
 v_mul_f32 v65, v105, v65
 v_mul_f32 v66, v105, v66
 v_mul_f32 v67, v105, v67
 v_mul_f32 v68, v105, v68
 v_mul_f32 v69, v105, v69
 v_mul_f32 v70, v105, v70
 v_mul_f32 v71, v105, v71
 v_mul_f32 v72, v105, v72
 v_mul_f32 v73, v105, v73
 v_mul_f32 v74, v105, v74
 v_mul_f32 v75, v105, v75
 v_mul_f32 v76, v105, v76
 v_mul_f32 v77, v105, v77
 v_mul_f32 v78, v105, v78
 v_mul_f32 v79, v105, v79
 v_mul_f32 v80, v105, v80
 v_mul_f32 v81, v105, v81
 v_mul_f32 v82, v105, v82
 v_mul_f32 v83, v105, v83
 v_mul_f32 v84, v105, v84
 v_mul_f32 v85, v105, v85
 v_mul_f32 v86, v105, v86
 v_mul_f32 v87, v105, v87
 v_mul_f32 v88, v105, v88
 v_mul_f32 v89, v105, v89
 v_mul_f32 v90, v105, v90
 v_mul_f32 v91, v105, v91
 v_mul_f32 v92, v105, v92
 v_mul_f32 v93, v105, v93
 v_mul_f32 v94, v105, v94
 v_mul_f32 v95, v105, v95
 v_cvt_pk_bf16_f32 v64, v64, v65
 v_cvt_pk_bf16_f32 v65, v66, v67
 v_cvt_pk_bf16_f32 v66, v68, v69
 v_cvt_pk_bf16_f32 v67, v70, v71
 buffer_store_dwordx4 v[64:67], v251, s[16:19], s59 offen offset:0
 v_cvt_pk_bf16_f32 v72, v72, v73
 v_cvt_pk_bf16_f32 v73, v74, v75
 v_cvt_pk_bf16_f32 v74, v76, v77
 v_cvt_pk_bf16_f32 v75, v78, v79
 buffer_store_dwordx4 v[72:75], v251, s[16:19], s59 offen offset:64
 v_cvt_pk_bf16_f32 v80, v80, v81
 v_cvt_pk_bf16_f32 v81, v82, v83
 v_cvt_pk_bf16_f32 v82, v84, v85
 v_cvt_pk_bf16_f32 v83, v86, v87
 buffer_store_dwordx4 v[80:83], v251, s[16:19], s59 offen offset:128
 v_cvt_pk_bf16_f32 v88, v88, v89
 v_cvt_pk_bf16_f32 v89, v90, v91
 v_cvt_pk_bf16_f32 v90, v92, v93
 v_cvt_pk_bf16_f32 v91, v94, v95
 buffer_store_dwordx4 v[88:91], v251, s[16:19], s59 offen offset:192
 s_waitcnt vmcnt(0)
 s_add_u32 s59, s59, 4096
 s_sub_u32 s56, s56, 1
 s_cmp_lg_u32 s56, 0
 s_cbranch_scc1 L_slow_tile
 s_cmp_lg_u32 s45, 0
 s_cbranch_scc1 L_slow_blk
L_end:
    s_endpgm
.section .rodata,"a"
.p2align 6
.amdhsa_kernel standalone__mha_softmax__near_ridge_kernel
  .amdhsa_next_free_vgpr 512
  .amdhsa_next_free_sgpr 102
  .amdhsa_accum_offset 256
  .amdhsa_group_segment_fixed_size 0
  .amdhsa_kernarg_size 48
  .amdhsa_user_sgpr_count 2
  .amdhsa_user_sgpr_kernarg_segment_ptr 1
  .amdhsa_system_sgpr_workgroup_id_x 1
  .amdhsa_float_denorm_mode_32 3
.end_amdhsa_kernel
```
